```python
import torch

def _softmax(x, axis=-1):
    return torch.softmax(x, dim=axis)
def _gelu(x):
    return torch.nn.functional.gelu(x, approximate="tanh")
def _silu(x):
    return torch.nn.functional.silu(x)
def _sigmoid(x):
    return torch.sigmoid(x)
def _layernorm(x, axis=-1, eps=1e-5):
    m = x.mean(dim=axis, keepdim=True)
    v = x.var(dim=axis, keepdim=True, unbiased=False)
    return (x - m) / torch.sqrt(v + eps)
def _scatter_add(tgt, idx, src, axis=0):
    return tgt.clone().index_add_(axis, idx, src)
def _segment_sum(src, seg, n):
    out = torch.zeros((n,) + src.shape[1:], dtype=src.dtype)
    return out.index_add_(0, seg, src)
def _pad(x, pw):
    flat = tuple(v for pair in reversed(pw) for v in pair)
    return torch.nn.functional.pad(x, flat)

kernel_name = 'gated_mix__compressed_kv_cla__ssm_conv_h3__prompt'

def setup_inputs():

    _w = (lambda a: (lambda t: t.to(torch.bfloat16) if t.is_floating_point() else t)(torch.as_tensor(a)))
    def _A_setup():
        B, H, Sq, Sk, D, M = 1, 32, 2048, 2048, 128, 640
        Dc = 4 * D
        return {
            "x": _w((lambda *s: torch.randn(*s, dtype=torch.bfloat16) * 0.05)(B, Sq, M)),
            "c_kv": _w((lambda *s: torch.randn(*s, dtype=torch.bfloat16) * 0.4)(B, Sk, Dc)),
            "w_q": _w((lambda *s: torch.randn(*s, dtype=torch.bfloat16) * 6.4)(M, H, D) * (M ** -0.5)),
            "w_uk": _w((lambda *s: torch.randn(*s, dtype=torch.bfloat16) * 6.4)(Dc, H, D) * (Dc ** -0.5)),
            "w_uv": _w((lambda *s: torch.randn(*s, dtype=torch.bfloat16) * 0.4)(Dc, H, D) * (Dc ** -0.5)),
            "w_o": _w((lambda *s: torch.randn(*s, dtype=torch.bfloat16) * 0.4)(H, D, M) * ((H * D) ** -0.5)),
        }
    _A_in = _A_setup()

    def _B_setup():
        B, S, D = 1, 2048, 640
        ks = 4
        return {
            "q": _w((lambda *s: torch.randn(*s, dtype=torch.bfloat16) * 0.05)(B, S, D)),
            "k": _w((lambda *s: torch.randn(*s, dtype=torch.bfloat16) * 0.4)(B, S, D)),
            "v": _w((lambda *s: torch.randn(*s, dtype=torch.bfloat16) * 0.4)(B, S, D)),
            "shift_k": _w((lambda *s: torch.randn(*s, dtype=torch.bfloat16) * 0.4)(D, ks) * 0.5),
            "ssm_k": _w((lambda *s: torch.randn(*s, dtype=torch.bfloat16) * 0.8)(D, S) * (1.0 / S ** 0.5)),
            "ssm_D": _w((lambda *s: torch.randn(*s, dtype=torch.bfloat16) * 0.4)(D)),
        }
    _B_in = _B_setup()

    return {
        "A_x": _A_in["x"],
        "A_c_kv": _A_in["c_kv"],
        "A_w_q": _A_in["w_q"],
        "A_w_uk": _A_in["w_uk"],
        "A_w_uv": _A_in["w_uv"],
        "A_w_o": _A_in["w_o"],
        "B_q": _B_in["q"],
        "B_k": _B_in["k"],
        "B_v": _B_in["v"],
        "B_shift_k": _B_in["shift_k"],
        "B_ssm_k": _B_in["ssm_k"],
        "B_ssm_D": _B_in["ssm_D"],
        "gate_w": _w((lambda *s: torch.randn(*s, dtype=torch.bfloat16) * 0.05)(640) * 16.0),
    }

def reference(A_x, A_c_kv, A_w_q, A_w_uk, A_w_uv, A_w_o, B_q, B_k, B_v, B_shift_k, B_ssm_k, B_ssm_D, gate_w):
    def _A_ref(x, c_kv, w_q, w_uk, w_uv, w_o):
        B, Sq, M = x.shape[0], x.shape[1], x.shape[2]
        Sk = c_kv.shape[1]
        H, D = w_q.shape[1], w_q.shape[2]
        q = torch.einsum("bqm,mhd->bhqd", x, w_q)
        k = torch.einsum("bkc,chd->bhkd", c_kv, w_uk)
        v = torch.einsum("bkc,chd->bhkd", c_kv, w_uv)
        scores = torch.einsum("bhqd,bhkd->bhqk", q, k) * (D ** -0.5)
        off = Sk - Sq
        qi = torch.arange(Sq)[:, None]
        kj = torch.arange(Sk)[None, :]
        cmask = kj <= (qi + off)
        scores = torch.where(cmask[None, None], scores, -1e9)
        p = _softmax(scores, axis=-1)
        ctx = torch.einsum("bhqk,bhkd->bhqd", p, v)
        return torch.einsum("bhqd,hdm->bqm", ctx, w_o)

    def _B_ref(q, k, v, shift_k, ssm_k, ssm_D):
        B, S, D = q.shape
        ks = shift_k.shape[-1]
        k_pad = _pad(k, ((0, 0), (ks - 1, 0), (0, 0)))
        k_shift = torch.zeros_like(k)
        for t in range(ks):
            k_shift = k_shift + k_pad[:, t:t + S, :] * shift_k[:, ks - 1 - t][None, None, :]
        kv = k_shift * v
        L = 2 * S
        kv_pad = _pad(kv, ((0, 0), (0, S), (0, 0)))
        kf_pad = _pad(ssm_k, ((0, 0), (0, S)))
        kv_f = (lambda x, axes=(-2,-1): torch.fft.rfft2(x.float(), dim=axes))(kv_pad[:, None, :, :], axes=(1, 2))
        kf_f = (lambda x, axes=(-2,-1): torch.fft.rfft2(x.float(), dim=axes))(kf_pad[:, None, :], axes=(1, 2))
        kf_f = (lambda x, *d: x.permute(*d))(kf_f, 1, 2, 0)
        y_f = kv_f * kf_f[None, :, :, :]
        y = (lambda x, s, axes=(-2,-1): torch.fft.irfft2(x, s=s, dim=axes).to(torch.bfloat16))(y_f, (1, L), axes=(1, 2))[:, 0, :S, :]
        y = y + kv * ssm_D[None, None, :]
        return q * y

    x = A_x
    g = _sigmoid((x * gate_w).sum(-1, keepdims=True))
    a = _A_ref(x, A_c_kv, A_w_q, A_w_uk, A_w_uv, A_w_o)
    b = _B_ref(x, B_k, B_v, B_shift_k, B_ssm_k, B_ssm_D)
    return g * a + (1 - g) * b
```

```asm
; @launch kernel=main_kernel grid=(256,1,1) block=(512,1,1) lds=163840
.amdgcn_target "amdgcn-amd-amdhsa--gfx950"
.text
.globl main_kernel
.p2align 8
.type main_kernel,@function
main_kernel:
    s_cmp_ge_u32 s2, 256
    s_cbranch_scc1 k12_done_1
    s_load_dwordx4 s[4:7], s[0:1], 0
    s_load_dwordx4 s[8:11], s[0:1], 24
    s_load_dwordx2 s[48:49], s[0:1], 16
    s_load_dwordx4 s[36:39], s[0:1], 112
    s_getpc_b64 s[28:29]
cpf_pc_2:
    s_lshr_b32 s30, s2, 3
    s_mul_i32 s30, s30, 24
    v_min_u32 v1, 23, v0
    v_add_u32 v1, s30, v1
    v_lshlrev_b32 v1, 7, v1
    s_mov_b32 s30, p4_table-cpf_pc_2
    v_min_u32 v1, s30, v1
    global_load_dword v227, v1, s[28:29]
    v_lshrrev_b32 v1, 6, v0
    v_and_b32 v2, 63, v0
    v_readfirstlane_b32 s3, v1
    s_and_b32 s12, s2, 7
    s_lshr_b32 s13, s2, 3
    s_lshr_b32 s14, s13, 3
    s_lshl_b32 s12, s12, 2
    s_add_u32 s12, s12, s14
    s_and_b32 s13, s13, 7
    s_lshr_b32 s14, s3, 2
    s_and_b32 s15, s3, 3
    v_lshrrev_b32 v9, 4, v2
    v_and_b32 v10, 7, v2
    v_xor_b32 v9, v9, v10
    v_xor_b32 v10, 4, v9
    v_lshlrev_b32 v9, 4, v9
    v_lshlrev_b32 v10, 4, v10
    v_lshrrev_b32 v11, 3, v2
    s_lshl_b32 s28, s13, 8
    s_lshl_b32 s29, s3, 5
    s_add_u32 s28, s28, s29
    v_add_u32 v8, s28, v11
    v_lshlrev_b32 v8, 10, v8
    v_add3_u32 v228, v8, v9, 0
    v_add3_u32 v229, v8, v10, 0
    v_add_u32 v229, 7168, v229
    v_add3_u32 v230, v8, v9, 0
    v_add_u32 v230, 14336, v230
    v_add3_u32 v231, v8, v10, 0
    v_add_u32 v231, 21504, v231
    v_bfe_u32 v8, v2, 2, 2
    v_lshlrev_b32 v8, 13, v8
    v_lshrrev_b32 v12, 4, v2
    v_lshl_add_u32 v8, v12, 6, v8
    s_lshl_b32 s28, s12, 8
    v_add_u32 v8, s28, v8
    v_and_b32 v12, 3, v2
    v_xor_b32 v13, 2, v12
    v_lshl_add_u32 v12, v12, 4, v8
    v_lshl_add_u32 v13, v13, 4, v8
    s_lshl_b32 s28, s15, 17
    s_add_u32 s29, s28, 0
    v_add_u32 v232, s29, v12
    s_add_u32 s29, s28, 31744
    v_add_u32 v233, s29, v12
    s_add_u32 s29, s28, 63488
    v_add_u32 v234, s29, v13
    s_add_u32 s29, s28, 95232
    v_add_u32 v235, s29, v13
    s_lshl_b32 s30, s3, 12
    s_add_u32 s31, s12, s13
    s_mul_i32 s41, s31, 52
    s_lshr_b32 s41, s41, 8
    s_mul_i32 s41, s41, 5
    s_sub_u32 s41, s31, s41
    s_waitcnt lgkmcnt(0)
    s_mov_b32 s16, s6
    s_mov_b32 s17, s7
    s_mov_b32 s18, 0x200000
    s_mov_b32 s19, 0x20000
    s_cmp_eq_u32 s14, 0
    s_cselect_b32 s20, s8, s10
    s_cselect_b32 s21, s9, s11
    s_mov_b32 s22, 0x400000
    s_mov_b32 s23, 0x20000
    s_add_u32 m0, s30, 0
    s_add_u32 s32, s31, 0
    s_and_b32 s32, s32, 7
    s_lshl_b32 s32, s32, 7
    buffer_load_dwordx4 v228, s[16:19], s32 offen offset:0 lds
    buffer_load_dwordx4 v229, s[16:19], s32 offen offset:1024 lds
    buffer_load_dwordx4 v230, s[16:19], s32 offen offset:2048 lds
    buffer_load_dwordx4 v231, s[16:19], s32 offen offset:3072 lds
    s_add_u32 m0, s30, 32768
    s_add_u32 s32, s31, 0
    s_and_b32 s32, s32, 7
    s_lshl_b32 s32, s32, 19
    buffer_load_dwordx4 v232, s[20:23], s32 offen offset:0 lds
    buffer_load_dwordx4 v233, s[20:23], s32 offen offset:1024 lds
    buffer_load_dwordx4 v234, s[20:23], s32 offen offset:2048 lds
    buffer_load_dwordx4 v235, s[20:23], s32 offen offset:3072 lds
    s_mov_b32 s24, s38
    s_mov_b32 s25, s39
    s_mov_b32 s26, 0x2000000
    s_mov_b32 s27, 0x20000
    s_add_u32 s26, s12, 1
    s_lshl_b32 s26, s26, 20
    s_add_u32 s44, s38, 0x2800000
    s_addc_u32 s45, s39, 0
    s_mov_b32 s46, 0x1000000
    s_mov_b32 s47, 0x20000
    s_mov_b32 s52, s4
    s_mov_b32 s53, s5
    s_mov_b32 s54, 0x280000
    s_mov_b32 s55, 0x20000
    s_mov_b32 s56, s48
    s_mov_b32 s57, s49
    s_mov_b32 s58, 0x500000
    s_mov_b32 s59, 0x20000
    s_mov_b32 s60, s36
    s_mov_b32 s61, s37
    s_mov_b32 s62, 0x100
    s_mov_b32 s63, 0x20000
    s_add_u32 s92, s38, 0x5200000
    s_addc_u32 s93, s39, 0
    s_mov_b32 s94, 0x8000
    s_mov_b32 s95, 0x20000
    v_mov_b32 v220, 0
    v_mov_b32 v222, 0
    v_mov_b32 v223, 0
    s_lshl_b32 s28, s2, 3
    s_add_u32 s28, s28, s3
    s_cmp_lg_u32 s28, 4
    s_cbranch_scc1 noepoch_3
    s_mov_b64 exec, 1
    s_movk_i32 s28, 8192
    buffer_load_dword v222, v220, s[92:95], s28 offen sc1
    s_waitcnt vmcnt(0)
    s_mov_b32 s29, 1664525
    v_mul_lo_u32 v222, v222, s29
    v_add_u32 v222, 1013904223, v222
    v_mov_b32 v223, 1
    buffer_store_dwordx2 v[222:223], v220, s[60:63], 0 offen sc1
    buffer_store_dword v222, v220, s[92:95], s28 offen sc1
    s_mov_b64 exec, -1
noepoch_3:
    s_sub_u32 s38, 15, s13
    s_cmp_eq_u32 s14, 0
    s_cselect_b32 s39, s38, s13
    s_lshl_b32 s40, s39, 2
    s_add_u32 s40, s40, s15
    s_lshl_b32 s28, s40, 5
    v_add_u32 v8, s28, v11
    v_mul_u32_u24 v8, 1280, v8
    v_add3_u32 v236, v8, v9, 0
    v_add3_u32 v237, v8, v10, 0
    v_add_u32 v237, 9216, v237
    v_add3_u32 v238, v8, v9, 0
    v_add_u32 v238, 18432, v238
    v_add3_u32 v239, v8, v10, 0
    v_add_u32 v239, 27648, v239
    s_lshl_b32 s28, s3, 17
    s_add_u32 s29, s28, 0
    v_add_u32 v240, s29, v12
    s_add_u32 s29, s28, 31744
    v_add_u32 v241, s29, v12
    s_add_u32 s29, s28, 63488
    v_add_u32 v242, s29, v13
    s_add_u32 s29, s28, 95232
    v_add_u32 v243, s29, v13
    s_add_u32 m0, s30, 65536
    s_add_u32 s32, s31, 1
    s_and_b32 s32, s32, 7
    s_lshl_b32 s32, s32, 7
    buffer_load_dwordx4 v228, s[16:19], s32 offen offset:0 lds
    buffer_load_dwordx4 v229, s[16:19], s32 offen offset:1024 lds
    buffer_load_dwordx4 v230, s[16:19], s32 offen offset:2048 lds
    buffer_load_dwordx4 v231, s[16:19], s32 offen offset:3072 lds
    s_add_u32 m0, s30, 98304
    s_add_u32 s32, s31, 1
    s_and_b32 s32, s32, 7
    s_lshl_b32 s32, s32, 19
    buffer_load_dwordx4 v232, s[20:23], s32 offen offset:0 lds
    buffer_load_dwordx4 v233, s[20:23], s32 offen offset:1024 lds
    buffer_load_dwordx4 v234, s[20:23], s32 offen offset:2048 lds
    buffer_load_dwordx4 v235, s[20:23], s32 offen offset:3072 lds
    v_lshrrev_b32 v8, 1, v2
    v_and_b32 v14, 1, v2
    s_lshl_b32 s29, s13, 6
    s_lshl_b32 s33, s15, 5
    s_add_u32 s29, s29, s33
    v_add_u32 v216, s29, v8
    v_lshlrev_b32 v216, 13, v216
    v_lshl_add_u32 v216, v14, 7, v216
    s_lshl_b32 s33, s12, 8
    v_add_u32 v216, s33, v216
    s_lshl_b32 s29, s2, 13
    v_lshlrev_b32 v217, 7, v2
    v_add_u32 v217, s29, v217
    s_mul_i32 s29, s2, 10240
    s_and_b32 s33, s3, 1
    s_lshl_b32 s33, s33, 13
    s_add_u32 s29, s29, s33
    v_lshlrev_b32 v218, 7, v2
    v_add_u32 v218, s29, v218
    s_mul_i32 s29, s13, 80
    s_lshl_b32 s33, s15, 5
    s_add_u32 s29, s29, s33
    v_add_u32 v219, s29, v8
    v_lshlrev_b32 v219, 13, v219
    v_lshl_add_u32 v219, v14, 7, v219
    s_lshl_b32 s33, s12, 8
    v_add_u32 v219, s33, v219
    s_cmp_eq_u32 s3, 2
    s_cselect_b32 s96, s16, s20
    s_cselect_b32 s97, s17, s21
    s_cselect_b32 s98, s18, s22
    s_mov_b32 s99, 0x20000
    s_cselect_b64 vcc, -1, 0
    v_cndmask_b32 v216, v216, v217, vcc
    s_cselect_b32 s100, 0, 0x40000000
    s_cmp_lt_u32 s15, 2
    s_cselect_b32 s100, 0, s100
    s_load_dwordx2 s[4:5], s[0:1], 72
    s_load_dwordx4 s[8:11], s[0:1], 88
    v_lshlrev_b32 v217, 7, v2
    s_waitcnt lgkmcnt(0)
    s_cmp_eq_u32 s3, 3
    s_cselect_b32 s96, s4, s96
    s_cselect_b32 s97, s5, s97
    s_cselect_b32 s98, 5120, s98
    s_cselect_b32 s100, 0, s100
    s_cselect_b64 vcc, -1, 0
    v_cndmask_b32 v216, v216, v217, vcc
    s_cmp_eq_u32 s3, 6
    s_cselect_b32 s96, s10, s96
    s_cselect_b32 s97, s11, s97
    s_cselect_b32 s98, 1280, s98
    s_cselect_b32 s100, 0, s100
    s_cselect_b64 vcc, -1, 0
    v_cndmask_b32 v216, v216, v217, vcc
    s_cmp_eq_u32 s3, 7
    s_cselect_b32 s96, s8, s96
    s_cselect_b32 s97, s9, s97
    s_cselect_b32 s98, 1280, s98
    s_cselect_b32 s100, 0, s100
    s_cselect_b64 vcc, -1, 0
    v_cndmask_b32 v216, v216, v217, vcc
    s_add_u32 s28, s14, 2
    s_cmp_lt_u32 s15, s28
    s_cselect_b32 s101, 0, 0x40000000
    s_mul_i32 s29, s2, 10240
    s_mul_i32 s33, s15, 2560
    s_add_u32 s29, s29, s33
    v_min_u32 v218, 3, v2
    v_lshlrev_b32 v218, 7, v218
    v_add_u32 v218, s29, v218
    s_mul_i32 s29, s13, 80
    s_mul_i32 s33, s15, 20
    s_add_u32 s29, s29, s33
    v_min_u32 v219, 3, v8
    v_add_u32 v219, s29, v219
    v_lshlrev_b32 v219, 13, v219
    v_lshl_add_u32 v219, v14, 7, v219
    s_lshl_b32 s33, s12, 8
    v_add_u32 v219, s33, v219
    v_and_b32 v8, 15, v2
    v_lshrrev_b32 v1, 4, v2
    v_lshlrev_b32 v11, 2, v1
    v_sub_u32 v6, v8, v11
    v_lshlrev_b32 v7, 7, v8
    v_bfe_u32 v9, v2, 1, 3
    v_xor_b32 v9, v9, v1
    v_xor_b32 v244, 0, v9
    v_lshl_add_u32 v244, v244, 4, v7
    v_xor_b32 v245, 4, v9
    v_lshl_add_u32 v245, v245, 4, v7
    v_lshlrev_b32 v9, 11, v1
    v_bfe_u32 v8, v2, 2, 2
    v_lshl_add_u32 v9, v8, 6, v9
    v_and_b32 v8, 3, v2
    v_lshl_add_u32 v9, v8, 3, v9
    v_bfe_u32 v8, v2, 4, 1
    v_lshl_add_u32 v246, v8, 5, v9
    v_xor_b32 v247, 32, v246
    s_lshr_b32 s34, s15, 1
    s_lshl_b32 s34, s34, 14
    s_lshl_b32 s35, s14, 14
    s_and_b32 s29, s15, 1
    s_lshl_b32 s29, s29, 9
    s_add_u32 s35, s35, s29
    s_lshl_b32 s28, s12, 6
    s_lshl_b32 s29, s13, 3
    s_add_u32 s28, s28, s29
    s_lshr_b32 s29, s15, 1
    s_lshl_b32 s29, s29, 2
    s_add_u32 s28, s28, s29
    s_lshl_b32 s28, s28, 14
    s_lshl_b32 s29, s14, 13
    s_add_u32 s28, s28, s29
    s_and_b32 s29, s15, 1
    s_add_u32 s33, s14, 11
    s_lshl_b32 s29, s29, s33
    s_add_u32 s28, s28, s29
    v_lshlrev_b32 v3, 4, v2
    v_add_u32 v252, s28, v3
    s_lshr_b32 s29, 4096, s14
    v_add_u32 v253, s29, v252
    s_add_u32 s28, s34, 0
    s_add_u32 s29, s35, 32768
    v_add_u32 v248, s28, v244
    v_add_u32 v249, s28, v245
    v_add_u32 v250, s29, v246
    v_add_u32 v251, s29, v247
    s_waitcnt vmcnt(8)
    s_barrier
    ds_read_b64_tr_b16 v[48:49], v250 offset:0
    ds_read_b64_tr_b16 v[50:51], v250 offset:1024
    ds_read_b128 v[16:19], v248 offset:0
    ds_read_b64_tr_b16 v[52:53], v251 offset:0
    ds_read_b64_tr_b16 v[54:55], v251 offset:1024
    ds_read_b128 v[20:23], v248 offset:2048
    ds_read_b128 v[24:27], v248 offset:4096
    ds_read_b64_tr_b16 v[56:57], v250 offset:256
    ds_read_b64_tr_b16 v[58:59], v250 offset:1280
    ds_read_b64_tr_b16 v[60:61], v251 offset:256
    ds_read_b128 v[28:31], v248 offset:6144
    ds_read_b64_tr_b16 v[62:63], v251 offset:1280
    ds_read_b128 v[32:35], v248 offset:8192
    ds_read_b128 v[36:39], v248 offset:10240
    ds_read_b128 v[40:43], v248 offset:12288
    ds_read_b128 v[44:47], v248 offset:14336
    s_cmp_eq_u32 s14, 0
    s_cbranch_scc0 kv_v_4
    s_waitcnt lgkmcnt(13)
    v_mfma_f32_16x16x32_bf16 v[80:83], v[48:51], v[16:19], 0
    s_waitcnt lgkmcnt(11)
    v_mfma_f32_16x16x32_bf16 v[84:87], v[52:55], v[16:19], 0
    ds_read_b64_tr_b16 v[64:65], v250 offset:8192
    s_waitcnt lgkmcnt(8)
    v_mfma_f32_16x16x32_bf16 v[88:91], v[56:59], v[16:19], 0
    s_add_u32 m0, s30, 131072
    s_add_u32 s32, s31, 2
    s_and_b32 s32, s32, 7
    s_lshl_b32 s32, s32, 7
    buffer_load_dwordx4 v228, s[16:19], s32 offen offset:0 lds
    s_waitcnt lgkmcnt(5)
    v_mfma_f32_16x16x32_bf16 v[92:95], v[60:63], v[16:19], 0
    ds_read_b128 v[16:19], v249 offset:0
    v_mfma_f32_16x16x32_bf16 v[96:99], v[48:51], v[20:23], 0
    v_mfma_f32_16x16x32_bf16 v[100:103], v[52:55], v[20:23], 0
    ds_read_b64_tr_b16 v[66:67], v250 offset:9216
    v_mfma_f32_16x16x32_bf16 v[104:107], v[56:59], v[20:23], 0
    v_mfma_f32_16x16x32_bf16 v[108:111], v[60:63], v[20:23], 0
    ds_read_b128 v[20:23], v249 offset:2048
    v_mfma_f32_16x16x32_bf16 v[112:115], v[48:51], v[24:27], 0
    v_mfma_f32_16x16x32_bf16 v[116:119], v[52:55], v[24:27], 0
    ds_read_b64_tr_b16 v[68:69], v251 offset:8192
    v_mfma_f32_16x16x32_bf16 v[120:123], v[56:59], v[24:27], 0
    buffer_load_dwordx4 v229, s[16:19], s32 offen offset:1024 lds
    v_mfma_f32_16x16x32_bf16 v[124:127], v[60:63], v[24:27], 0
    ds_read_b128 v[24:27], v249 offset:4096
    v_mfma_f32_16x16x32_bf16 v[128:131], v[48:51], v[28:31], 0
    v_mfma_f32_16x16x32_bf16 v[132:135], v[52:55], v[28:31], 0
    ds_read_b64_tr_b16 v[70:71], v251 offset:9216
    v_mfma_f32_16x16x32_bf16 v[136:139], v[56:59], v[28:31], 0
    v_mfma_f32_16x16x32_bf16 v[140:143], v[60:63], v[28:31], 0
    ds_read_b128 v[28:31], v249 offset:6144
    s_waitcnt lgkmcnt(11)
    v_mfma_f32_16x16x32_bf16 v[144:147], v[48:51], v[32:35], 0
    v_mfma_f32_16x16x32_bf16 v[148:151], v[52:55], v[32:35], 0
    ds_read_b64_tr_b16 v[72:73], v250 offset:8448
    v_mfma_f32_16x16x32_bf16 v[152:155], v[56:59], v[32:35], 0
    buffer_load_dwordx4 v230, s[16:19], s32 offen offset:2048 lds
    v_mfma_f32_16x16x32_bf16 v[156:159], v[60:63], v[32:35], 0
    ds_read_b128 v[32:35], v249 offset:8192
    s_waitcnt lgkmcnt(12)
    v_mfma_f32_16x16x32_bf16 v[160:163], v[48:51], v[36:39], 0
    v_mfma_f32_16x16x32_bf16 v[164:167], v[52:55], v[36:39], 0
    ds_read_b64_tr_b16 v[74:75], v250 offset:9472
    v_mfma_f32_16x16x32_bf16 v[168:171], v[56:59], v[36:39], 0
    v_mfma_f32_16x16x32_bf16 v[172:175], v[60:63], v[36:39], 0
    ds_read_b128 v[36:39], v249 offset:10240
    s_waitcnt lgkmcnt(13)
    v_mfma_f32_16x16x32_bf16 v[176:179], v[48:51], v[40:43], 0
    v_mfma_f32_16x16x32_bf16 v[180:183], v[52:55], v[40:43], 0
    ds_read_b64_tr_b16 v[76:77], v251 offset:8448
    v_mfma_f32_16x16x32_bf16 v[184:187], v[56:59], v[40:43], 0
    buffer_load_dwordx4 v231, s[16:19], s32 offen offset:3072 lds
    v_mfma_f32_16x16x32_bf16 v[188:191], v[60:63], v[40:43], 0
    ds_read_b128 v[40:43], v249 offset:12288
    s_waitcnt lgkmcnt(14)
    v_mfma_f32_16x16x32_bf16 v[192:195], v[48:51], v[44:47], 0
    v_mfma_f32_16x16x32_bf16 v[196:199], v[52:55], v[44:47], 0
    ds_read_b64_tr_b16 v[78:79], v251 offset:9472
    v_mfma_f32_16x16x32_bf16 v[200:203], v[56:59], v[44:47], 0
    v_mfma_f32_16x16x32_bf16 v[204:207], v[60:63], v[44:47], 0
    ds_read_b128 v[44:47], v249 offset:14336
    s_waitcnt lgkmcnt(13)
    v_mfma_f32_16x16x32_bf16 v[80:83], v[64:67], v[16:19], v[80:83]
    s_waitcnt lgkmcnt(9)
    v_mfma_f32_16x16x32_bf16 v[84:87], v[68:71], v[16:19], v[84:87]
    s_waitcnt lgkmcnt(5)
    v_mfma_f32_16x16x32_bf16 v[88:91], v[72:75], v[16:19], v[88:91]
    s_waitcnt lgkmcnt(1)
    v_mfma_f32_16x16x32_bf16 v[92:95], v[76:79], v[16:19], v[92:95]
    v_mfma_f32_16x16x32_bf16 v[96:99], v[64:67], v[20:23], v[96:99]
    v_mfma_f32_16x16x32_bf16 v[100:103], v[68:71], v[20:23], v[100:103]
    v_mfma_f32_16x16x32_bf16 v[104:107], v[72:75], v[20:23], v[104:107]
    v_mfma_f32_16x16x32_bf16 v[108:111], v[76:79], v[20:23], v[108:111]
    s_waitcnt lgkmcnt(0)
    s_waitcnt vmcnt(4)
    s_barrier
    s_add_u32 s28, s34, 65536
    s_add_u32 s29, s35, 98304
    v_add_u32 v248, s28, v244
    v_add_u32 v249, s28, v245
    v_add_u32 v250, s29, v246
    v_add_u32 v251, s29, v247
    v_mfma_f32_16x16x32_bf16 v[112:115], v[64:67], v[24:27], v[112:115]
    ds_read_b64_tr_b16 v[48:49], v250 offset:0
    ds_read_b64_tr_b16 v[50:51], v250 offset:1024
    v_mfma_f32_16x16x32_bf16 v[116:119], v[68:71], v[24:27], v[116:119]
    ds_read_b128 v[16:19], v248 offset:0
    ds_read_b64_tr_b16 v[52:53], v251 offset:0
    v_mfma_f32_16x16x32_bf16 v[120:123], v[72:75], v[24:27], v[120:123]
    ds_read_b64_tr_b16 v[54:55], v251 offset:1024
    ds_read_b128 v[20:23], v248 offset:2048
    s_add_u32 m0, s30, 0
    s_add_u32 s32, s31, 2
    s_and_b32 s32, s32, 7
    s_lshl_b32 s32, s32, 19
    buffer_load_dwordx4 v232, s[20:23], s32 offen offset:0 lds
    v_mfma_f32_16x16x32_bf16 v[124:127], v[76:79], v[24:27], v[124:127]
    ds_read_b128 v[24:27], v248 offset:4096
    v_mfma_f32_16x16x32_bf16 v[128:131], v[64:67], v[28:31], v[128:131]
    ds_read_b64_tr_b16 v[56:57], v250 offset:256
    v_mfma_f32_16x16x32_bf16 v[132:135], v[68:71], v[28:31], v[132:135]
    ds_read_b64_tr_b16 v[58:59], v250 offset:1280
    v_mfma_f32_16x16x32_bf16 v[136:139], v[72:75], v[28:31], v[136:139]
    ds_read_b64_tr_b16 v[60:61], v251 offset:256
    v_mfma_f32_16x16x32_bf16 v[140:143], v[76:79], v[28:31], v[140:143]
    ds_read_b128 v[28:31], v248 offset:6144
    v_mfma_f32_16x16x32_bf16 v[144:147], v[64:67], v[32:35], v[144:147]
    ds_read_b64_tr_b16 v[62:63], v251 offset:1280
    buffer_load_dwordx4 v233, s[20:23], s32 offen offset:1024 lds
    v_mfma_f32_16x16x32_bf16 v[148:151], v[68:71], v[32:35], v[148:151]
    v_mfma_f32_16x16x32_bf16 v[152:155], v[72:75], v[32:35], v[152:155]
    v_mfma_f32_16x16x32_bf16 v[156:159], v[76:79], v[32:35], v[156:159]
    ds_read_b128 v[32:35], v248 offset:8192
    v_mfma_f32_16x16x32_bf16 v[160:163], v[64:67], v[36:39], v[160:163]
    v_mfma_f32_16x16x32_bf16 v[164:167], v[68:71], v[36:39], v[164:167]
    v_mfma_f32_16x16x32_bf16 v[168:171], v[72:75], v[36:39], v[168:171]
    buffer_load_dwordx4 v234, s[20:23], s32 offen offset:2048 lds
    v_mfma_f32_16x16x32_bf16 v[172:175], v[76:79], v[36:39], v[172:175]
    ds_read_b128 v[36:39], v248 offset:10240
    v_mfma_f32_16x16x32_bf16 v[176:179], v[64:67], v[40:43], v[176:179]
    v_mfma_f32_16x16x32_bf16 v[180:183], v[68:71], v[40:43], v[180:183]
    v_mfma_f32_16x16x32_bf16 v[184:187], v[72:75], v[40:43], v[184:187]
    v_mfma_f32_16x16x32_bf16 v[188:191], v[76:79], v[40:43], v[188:191]
    ds_read_b128 v[40:43], v248 offset:12288
    v_mfma_f32_16x16x32_bf16 v[192:195], v[64:67], v[44:47], v[192:195]
    buffer_load_dwordx4 v235, s[20:23], s32 offen offset:3072 lds
    v_mfma_f32_16x16x32_bf16 v[196:199], v[68:71], v[44:47], v[196:199]
    v_mfma_f32_16x16x32_bf16 v[200:203], v[72:75], v[44:47], v[200:203]
    v_mfma_f32_16x16x32_bf16 v[204:207], v[76:79], v[44:47], v[204:207]
    ds_read_b128 v[44:47], v248 offset:14336
    s_waitcnt lgkmcnt(13)
    v_mfma_f32_16x16x32_bf16 v[80:83], v[48:51], v[16:19], v[80:83]
    s_waitcnt lgkmcnt(11)
    v_mfma_f32_16x16x32_bf16 v[84:87], v[52:55], v[16:19], v[84:87]
    ds_read_b64_tr_b16 v[64:65], v250 offset:8192
    s_waitcnt lgkmcnt(8)
    v_mfma_f32_16x16x32_bf16 v[88:91], v[56:59], v[16:19], v[88:91]
    s_add_u32 m0, s30, 32768
    s_add_u32 s32, s31, 3
    s_and_b32 s32, s32, 7
    s_lshl_b32 s32, s32, 7
    buffer_load_dwordx4 v228, s[16:19], s32 offen offset:0 lds
    s_waitcnt lgkmcnt(5)
    v_mfma_f32_16x16x32_bf16 v[92:95], v[60:63], v[16:19], v[92:95]
    ds_read_b128 v[16:19], v249 offset:0
    v_mfma_f32_16x16x32_bf16 v[96:99], v[48:51], v[20:23], v[96:99]
    v_mfma_f32_16x16x32_bf16 v[100:103], v[52:55], v[20:23], v[100:103]
    ds_read_b64_tr_b16 v[66:67], v250 offset:9216
    v_mfma_f32_16x16x32_bf16 v[104:107], v[56:59], v[20:23], v[104:107]
    v_mfma_f32_16x16x32_bf16 v[108:111], v[60:63], v[20:23], v[108:111]
    ds_read_b128 v[20:23], v249 offset:2048
    v_mfma_f32_16x16x32_bf16 v[112:115], v[48:51], v[24:27], v[112:115]
    v_mfma_f32_16x16x32_bf16 v[116:119], v[52:55], v[24:27], v[116:119]
    ds_read_b64_tr_b16 v[68:69], v251 offset:8192
    v_mfma_f32_16x16x32_bf16 v[120:123], v[56:59], v[24:27], v[120:123]
    buffer_load_dwordx4 v229, s[16:19], s32 offen offset:1024 lds
    v_mfma_f32_16x16x32_bf16 v[124:127], v[60:63], v[24:27], v[124:127]
    ds_read_b128 v[24:27], v249 offset:4096
    v_mfma_f32_16x16x32_bf16 v[128:131], v[48:51], v[28:31], v[128:131]
    v_mfma_f32_16x16x32_bf16 v[132:135], v[52:55], v[28:31], v[132:135]
    ds_read_b64_tr_b16 v[70:71], v251 offset:9216
    v_mfma_f32_16x16x32_bf16 v[136:139], v[56:59], v[28:31], v[136:139]
    v_mfma_f32_16x16x32_bf16 v[140:143], v[60:63], v[28:31], v[140:143]
    ds_read_b128 v[28:31], v249 offset:6144
    s_waitcnt lgkmcnt(11)
    v_mfma_f32_16x16x32_bf16 v[144:147], v[48:51], v[32:35], v[144:147]
    v_mfma_f32_16x16x32_bf16 v[148:151], v[52:55], v[32:35], v[148:151]
    ds_read_b64_tr_b16 v[72:73], v250 offset:8448
    v_mfma_f32_16x16x32_bf16 v[152:155], v[56:59], v[32:35], v[152:155]
    buffer_load_dwordx4 v230, s[16:19], s32 offen offset:2048 lds
    v_mfma_f32_16x16x32_bf16 v[156:159], v[60:63], v[32:35], v[156:159]
    ds_read_b128 v[32:35], v249 offset:8192
    s_waitcnt lgkmcnt(12)
    v_mfma_f32_16x16x32_bf16 v[160:163], v[48:51], v[36:39], v[160:163]
    v_mfma_f32_16x16x32_bf16 v[164:167], v[52:55], v[36:39], v[164:167]
    ds_read_b64_tr_b16 v[74:75], v250 offset:9472
    v_mfma_f32_16x16x32_bf16 v[168:171], v[56:59], v[36:39], v[168:171]
    v_mfma_f32_16x16x32_bf16 v[172:175], v[60:63], v[36:39], v[172:175]
    ds_read_b128 v[36:39], v249 offset:10240
    s_waitcnt lgkmcnt(13)
    v_mfma_f32_16x16x32_bf16 v[176:179], v[48:51], v[40:43], v[176:179]
    v_mfma_f32_16x16x32_bf16 v[180:183], v[52:55], v[40:43], v[180:183]
    ds_read_b64_tr_b16 v[76:77], v251 offset:8448
    v_mfma_f32_16x16x32_bf16 v[184:187], v[56:59], v[40:43], v[184:187]
    buffer_load_dwordx4 v231, s[16:19], s32 offen offset:3072 lds
    v_mfma_f32_16x16x32_bf16 v[188:191], v[60:63], v[40:43], v[188:191]
    ds_read_b128 v[40:43], v249 offset:12288
    s_waitcnt lgkmcnt(14)
    v_mfma_f32_16x16x32_bf16 v[192:195], v[48:51], v[44:47], v[192:195]
    v_mfma_f32_16x16x32_bf16 v[196:199], v[52:55], v[44:47], v[196:199]
    ds_read_b64_tr_b16 v[78:79], v251 offset:9472
    v_mfma_f32_16x16x32_bf16 v[200:203], v[56:59], v[44:47], v[200:203]
    buffer_load_dword v209, v218, s[52:55], 0 offen
    v_mfma_f32_16x16x32_bf16 v[204:207], v[60:63], v[44:47], v[204:207]
    ds_read_b128 v[44:47], v249 offset:14336
    s_waitcnt lgkmcnt(13)
    v_mfma_f32_16x16x32_bf16 v[80:83], v[64:67], v[16:19], v[80:83]
    s_waitcnt lgkmcnt(9)
    v_mfma_f32_16x16x32_bf16 v[84:87], v[68:71], v[16:19], v[84:87]
    s_waitcnt lgkmcnt(5)
    v_mfma_f32_16x16x32_bf16 v[88:91], v[72:75], v[16:19], v[88:91]
    s_waitcnt lgkmcnt(1)
    v_mfma_f32_16x16x32_bf16 v[92:95], v[76:79], v[16:19], v[92:95]
    v_mfma_f32_16x16x32_bf16 v[96:99], v[64:67], v[20:23], v[96:99]
    v_mfma_f32_16x16x32_bf16 v[100:103], v[68:71], v[20:23], v[100:103]
    v_mfma_f32_16x16x32_bf16 v[104:107], v[72:75], v[20:23], v[104:107]
    v_mfma_f32_16x16x32_bf16 v[108:111], v[76:79], v[20:23], v[108:111]
    s_waitcnt lgkmcnt(0)
    s_waitcnt vmcnt(5)
    s_barrier
    s_add_u32 s28, s34, 131072
    s_add_u32 s29, s35, 0
    v_add_u32 v248, s28, v244
    v_add_u32 v249, s28, v245
    v_add_u32 v250, s29, v246
    v_add_u32 v251, s29, v247
    v_mfma_f32_16x16x32_bf16 v[112:115], v[64:67], v[24:27], v[112:115]
    ds_read_b64_tr_b16 v[48:49], v250 offset:0
    ds_read_b64_tr_b16 v[50:51], v250 offset:1024
    v_mfma_f32_16x16x32_bf16 v[116:119], v[68:71], v[24:27], v[116:119]
    ds_read_b128 v[16:19], v248 offset:0
    ds_read_b64_tr_b16 v[52:53], v251 offset:0
    v_mfma_f32_16x16x32_bf16 v[120:123], v[72:75], v[24:27], v[120:123]
    ds_read_b64_tr_b16 v[54:55], v251 offset:1024
    ds_read_b128 v[20:23], v248 offset:2048
    s_add_u32 m0, s30, 65536
    s_add_u32 s32, s31, 3
    s_and_b32 s32, s32, 7
    s_lshl_b32 s32, s32, 19
    buffer_load_dwordx4 v232, s[20:23], s32 offen offset:0 lds
    v_mfma_f32_16x16x32_bf16 v[124:127], v[76:79], v[24:27], v[124:127]
    ds_read_b128 v[24:27], v248 offset:4096
    v_mfma_f32_16x16x32_bf16 v[128:131], v[64:67], v[28:31], v[128:131]
    ds_read_b64_tr_b16 v[56:57], v250 offset:256
    v_mfma_f32_16x16x32_bf16 v[132:135], v[68:71], v[28:31], v[132:135]
    ds_read_b64_tr_b16 v[58:59], v250 offset:1280
    v_mfma_f32_16x16x32_bf16 v[136:139], v[72:75], v[28:31], v[136:139]
    ds_read_b64_tr_b16 v[60:61], v251 offset:256
    v_mfma_f32_16x16x32_bf16 v[140:143], v[76:79], v[28:31], v[140:143]
    ds_read_b128 v[28:31], v248 offset:6144
    v_mfma_f32_16x16x32_bf16 v[144:147], v[64:67], v[32:35], v[144:147]
    ds_read_b64_tr_b16 v[62:63], v251 offset:1280
    buffer_load_dwordx4 v233, s[20:23], s32 offen offset:1024 lds
    v_mfma_f32_16x16x32_bf16 v[148:151], v[68:71], v[32:35], v[148:151]
    v_mfma_f32_16x16x32_bf16 v[152:155], v[72:75], v[32:35], v[152:155]
    v_mfma_f32_16x16x32_bf16 v[156:159], v[76:79], v[32:35], v[156:159]
    ds_read_b128 v[32:35], v248 offset:8192
    v_mfma_f32_16x16x32_bf16 v[160:163], v[64:67], v[36:39], v[160:163]
    v_mfma_f32_16x16x32_bf16 v[164:167], v[68:71], v[36:39], v[164:167]
    v_mfma_f32_16x16x32_bf16 v[168:171], v[72:75], v[36:39], v[168:171]
    buffer_load_dwordx4 v234, s[20:23], s32 offen offset:2048 lds
    v_mfma_f32_16x16x32_bf16 v[172:175], v[76:79], v[36:39], v[172:175]
    ds_read_b128 v[36:39], v248 offset:10240
    v_mfma_f32_16x16x32_bf16 v[176:179], v[64:67], v[40:43], v[176:179]
    v_mfma_f32_16x16x32_bf16 v[180:183], v[68:71], v[40:43], v[180:183]
    v_mfma_f32_16x16x32_bf16 v[184:187], v[72:75], v[40:43], v[184:187]
    v_mfma_f32_16x16x32_bf16 v[188:191], v[76:79], v[40:43], v[188:191]
    ds_read_b128 v[40:43], v248 offset:12288
    v_mfma_f32_16x16x32_bf16 v[192:195], v[64:67], v[44:47], v[192:195]
    buffer_load_dwordx4 v235, s[20:23], s32 offen offset:3072 lds
    v_mfma_f32_16x16x32_bf16 v[196:199], v[68:71], v[44:47], v[196:199]
    v_mfma_f32_16x16x32_bf16 v[200:203], v[72:75], v[44:47], v[200:203]
    v_mfma_f32_16x16x32_bf16 v[204:207], v[76:79], v[44:47], v[204:207]
    ds_read_b128 v[44:47], v248 offset:14336
    s_waitcnt lgkmcnt(13)
    v_mfma_f32_16x16x32_bf16 v[80:83], v[48:51], v[16:19], v[80:83]
    s_waitcnt lgkmcnt(11)
    v_mfma_f32_16x16x32_bf16 v[84:87], v[52:55], v[16:19], v[84:87]
    ds_read_b64_tr_b16 v[64:65], v250 offset:8192
    s_waitcnt lgkmcnt(8)
    v_mfma_f32_16x16x32_bf16 v[88:91], v[56:59], v[16:19], v[88:91]
    s_add_u32 m0, s30, 98304
    s_add_u32 s32, s31, 4
    s_and_b32 s32, s32, 7
    s_lshl_b32 s32, s32, 7
    buffer_load_dwordx4 v228, s[16:19], s32 offen offset:0 lds
    s_waitcnt lgkmcnt(5)
    v_mfma_f32_16x16x32_bf16 v[92:95], v[60:63], v[16:19], v[92:95]
    ds_read_b128 v[16:19], v249 offset:0
    v_mfma_f32_16x16x32_bf16 v[96:99], v[48:51], v[20:23], v[96:99]
    v_mfma_f32_16x16x32_bf16 v[100:103], v[52:55], v[20:23], v[100:103]
    ds_read_b64_tr_b16 v[66:67], v250 offset:9216
    v_mfma_f32_16x16x32_bf16 v[104:107], v[56:59], v[20:23], v[104:107]
    v_mfma_f32_16x16x32_bf16 v[108:111], v[60:63], v[20:23], v[108:111]
    ds_read_b128 v[20:23], v249 offset:2048
    v_mfma_f32_16x16x32_bf16 v[112:115], v[48:51], v[24:27], v[112:115]
    v_mfma_f32_16x16x32_bf16 v[116:119], v[52:55], v[24:27], v[116:119]
    ds_read_b64_tr_b16 v[68:69], v251 offset:8192
    v_mfma_f32_16x16x32_bf16 v[120:123], v[56:59], v[24:27], v[120:123]
    buffer_load_dwordx4 v229, s[16:19], s32 offen offset:1024 lds
    v_mfma_f32_16x16x32_bf16 v[124:127], v[60:63], v[24:27], v[124:127]
    ds_read_b128 v[24:27], v249 offset:4096
    v_mfma_f32_16x16x32_bf16 v[128:131], v[48:51], v[28:31], v[128:131]
    v_mfma_f32_16x16x32_bf16 v[132:135], v[52:55], v[28:31], v[132:135]
    ds_read_b64_tr_b16 v[70:71], v251 offset:9216
    v_mfma_f32_16x16x32_bf16 v[136:139], v[56:59], v[28:31], v[136:139]
    v_mfma_f32_16x16x32_bf16 v[140:143], v[60:63], v[28:31], v[140:143]
    ds_read_b128 v[28:31], v249 offset:6144
    s_waitcnt lgkmcnt(11)
    v_mfma_f32_16x16x32_bf16 v[144:147], v[48:51], v[32:35], v[144:147]
    v_mfma_f32_16x16x32_bf16 v[148:151], v[52:55], v[32:35], v[148:151]
    ds_read_b64_tr_b16 v[72:73], v250 offset:8448
    v_mfma_f32_16x16x32_bf16 v[152:155], v[56:59], v[32:35], v[152:155]
    buffer_load_dwordx4 v230, s[16:19], s32 offen offset:2048 lds
    v_mfma_f32_16x16x32_bf16 v[156:159], v[60:63], v[32:35], v[156:159]
    ds_read_b128 v[32:35], v249 offset:8192
    s_waitcnt lgkmcnt(12)
    v_mfma_f32_16x16x32_bf16 v[160:163], v[48:51], v[36:39], v[160:163]
    v_mfma_f32_16x16x32_bf16 v[164:167], v[52:55], v[36:39], v[164:167]
    ds_read_b64_tr_b16 v[74:75], v250 offset:9472
    v_mfma_f32_16x16x32_bf16 v[168:171], v[56:59], v[36:39], v[168:171]
    v_mfma_f32_16x16x32_bf16 v[172:175], v[60:63], v[36:39], v[172:175]
    ds_read_b128 v[36:39], v249 offset:10240
    s_waitcnt lgkmcnt(13)
    v_mfma_f32_16x16x32_bf16 v[176:179], v[48:51], v[40:43], v[176:179]
    v_mfma_f32_16x16x32_bf16 v[180:183], v[52:55], v[40:43], v[180:183]
    ds_read_b64_tr_b16 v[76:77], v251 offset:8448
    v_mfma_f32_16x16x32_bf16 v[184:187], v[56:59], v[40:43], v[184:187]
    buffer_load_dwordx4 v231, s[16:19], s32 offen offset:3072 lds
    v_mfma_f32_16x16x32_bf16 v[188:191], v[60:63], v[40:43], v[188:191]
    ds_read_b128 v[40:43], v249 offset:12288
    s_waitcnt lgkmcnt(14)
    v_mfma_f32_16x16x32_bf16 v[192:195], v[48:51], v[44:47], v[192:195]
    v_mfma_f32_16x16x32_bf16 v[196:199], v[52:55], v[44:47], v[196:199]
    ds_read_b64_tr_b16 v[78:79], v251 offset:9472
    v_mfma_f32_16x16x32_bf16 v[200:203], v[56:59], v[44:47], v[200:203]
    s_mov_b32 s101, 512
    buffer_load_dword v211, v218, s[52:55], s101 offen
    v_mfma_f32_16x16x32_bf16 v[204:207], v[60:63], v[44:47], v[204:207]
    ds_read_b128 v[44:47], v249 offset:14336
    s_waitcnt lgkmcnt(13)
    v_mfma_f32_16x16x32_bf16 v[80:83], v[64:67], v[16:19], v[80:83]
    s_waitcnt lgkmcnt(9)
    v_mfma_f32_16x16x32_bf16 v[84:87], v[68:71], v[16:19], v[84:87]
    s_waitcnt lgkmcnt(5)
    v_mfma_f32_16x16x32_bf16 v[88:91], v[72:75], v[16:19], v[88:91]
    s_waitcnt lgkmcnt(1)
    v_mfma_f32_16x16x32_bf16 v[92:95], v[76:79], v[16:19], v[92:95]
    v_mfma_f32_16x16x32_bf16 v[96:99], v[64:67], v[20:23], v[96:99]
    v_mfma_f32_16x16x32_bf16 v[100:103], v[68:71], v[20:23], v[100:103]
    v_mfma_f32_16x16x32_bf16 v[104:107], v[72:75], v[20:23], v[104:107]
    v_mfma_f32_16x16x32_bf16 v[108:111], v[76:79], v[20:23], v[108:111]
    s_waitcnt lgkmcnt(0)
    s_waitcnt vmcnt(5)
    s_barrier
    s_add_u32 s28, s34, 32768
    s_add_u32 s29, s35, 65536
    v_add_u32 v248, s28, v244
    v_add_u32 v249, s28, v245
    v_add_u32 v250, s29, v246
    v_add_u32 v251, s29, v247
    v_mfma_f32_16x16x32_bf16 v[112:115], v[64:67], v[24:27], v[112:115]
    ds_read_b64_tr_b16 v[48:49], v250 offset:0
    ds_read_b64_tr_b16 v[50:51], v250 offset:1024
    v_mfma_f32_16x16x32_bf16 v[116:119], v[68:71], v[24:27], v[116:119]
    ds_read_b128 v[16:19], v248 offset:0
    ds_read_b64_tr_b16 v[52:53], v251 offset:0
    v_mfma_f32_16x16x32_bf16 v[120:123], v[72:75], v[24:27], v[120:123]
    ds_read_b64_tr_b16 v[54:55], v251 offset:1024
    ds_read_b128 v[20:23], v248 offset:2048
    s_add_u32 m0, s30, 131072
    s_add_u32 s32, s31, 4
    s_and_b32 s32, s32, 7
    s_lshl_b32 s32, s32, 19
    buffer_load_dwordx4 v232, s[20:23], s32 offen offset:0 lds
    v_mfma_f32_16x16x32_bf16 v[124:127], v[76:79], v[24:27], v[124:127]
    ds_read_b128 v[24:27], v248 offset:4096
    v_mfma_f32_16x16x32_bf16 v[128:131], v[64:67], v[28:31], v[128:131]
    ds_read_b64_tr_b16 v[56:57], v250 offset:256
    v_mfma_f32_16x16x32_bf16 v[132:135], v[68:71], v[28:31], v[132:135]
    ds_read_b64_tr_b16 v[58:59], v250 offset:1280
    v_mfma_f32_16x16x32_bf16 v[136:139], v[72:75], v[28:31], v[136:139]
    ds_read_b64_tr_b16 v[60:61], v251 offset:256
    v_mfma_f32_16x16x32_bf16 v[140:143], v[76:79], v[28:31], v[140:143]
    ds_read_b128 v[28:31], v248 offset:6144
    v_mfma_f32_16x16x32_bf16 v[144:147], v[64:67], v[32:35], v[144:147]
    ds_read_b64_tr_b16 v[62:63], v251 offset:1280
    buffer_load_dwordx4 v233, s[20:23], s32 offen offset:1024 lds
    v_mfma_f32_16x16x32_bf16 v[148:151], v[68:71], v[32:35], v[148:151]
    v_mfma_f32_16x16x32_bf16 v[152:155], v[72:75], v[32:35], v[152:155]
    v_mfma_f32_16x16x32_bf16 v[156:159], v[76:79], v[32:35], v[156:159]
    ds_read_b128 v[32:35], v248 offset:8192
    v_mfma_f32_16x16x32_bf16 v[160:163], v[64:67], v[36:39], v[160:163]
    v_mfma_f32_16x16x32_bf16 v[164:167], v[68:71], v[36:39], v[164:167]
    v_mfma_f32_16x16x32_bf16 v[168:171], v[72:75], v[36:39], v[168:171]
    buffer_load_dwordx4 v234, s[20:23], s32 offen offset:2048 lds
    v_mfma_f32_16x16x32_bf16 v[172:175], v[76:79], v[36:39], v[172:175]
    ds_read_b128 v[36:39], v248 offset:10240
    v_mfma_f32_16x16x32_bf16 v[176:179], v[64:67], v[40:43], v[176:179]
    v_mfma_f32_16x16x32_bf16 v[180:183], v[68:71], v[40:43], v[180:183]
    v_mfma_f32_16x16x32_bf16 v[184:187], v[72:75], v[40:43], v[184:187]
    v_mfma_f32_16x16x32_bf16 v[188:191], v[76:79], v[40:43], v[188:191]
    ds_read_b128 v[40:43], v248 offset:12288
    v_mfma_f32_16x16x32_bf16 v[192:195], v[64:67], v[44:47], v[192:195]
    buffer_load_dwordx4 v235, s[20:23], s32 offen offset:3072 lds
    v_mfma_f32_16x16x32_bf16 v[196:199], v[68:71], v[44:47], v[196:199]
    v_mfma_f32_16x16x32_bf16 v[200:203], v[72:75], v[44:47], v[200:203]
    v_mfma_f32_16x16x32_bf16 v[204:207], v[76:79], v[44:47], v[204:207]
    ds_read_b128 v[44:47], v248 offset:14336
    s_waitcnt lgkmcnt(13)
    v_mfma_f32_16x16x32_bf16 v[80:83], v[48:51], v[16:19], v[80:83]
    s_waitcnt lgkmcnt(11)
    v_mfma_f32_16x16x32_bf16 v[84:87], v[52:55], v[16:19], v[84:87]
    ds_read_b64_tr_b16 v[64:65], v250 offset:8192
    s_waitcnt lgkmcnt(8)
    v_mfma_f32_16x16x32_bf16 v[88:91], v[56:59], v[16:19], v[88:91]
    s_add_u32 m0, s30, 0
    s_add_u32 s32, s31, 5
    s_and_b32 s32, s32, 7
    s_lshl_b32 s32, s32, 7
    buffer_load_dwordx4 v228, s[16:19], s32 offen offset:0 lds
    s_waitcnt lgkmcnt(5)
    v_mfma_f32_16x16x32_bf16 v[92:95], v[60:63], v[16:19], v[92:95]
    ds_read_b128 v[16:19], v249 offset:0
    v_mfma_f32_16x16x32_bf16 v[96:99], v[48:51], v[20:23], v[96:99]
    v_mfma_f32_16x16x32_bf16 v[100:103], v[52:55], v[20:23], v[100:103]
    ds_read_b64_tr_b16 v[66:67], v250 offset:9216
    v_mfma_f32_16x16x32_bf16 v[104:107], v[56:59], v[20:23], v[104:107]
    v_mfma_f32_16x16x32_bf16 v[108:111], v[60:63], v[20:23], v[108:111]
    ds_read_b128 v[20:23], v249 offset:2048
    v_mfma_f32_16x16x32_bf16 v[112:115], v[48:51], v[24:27], v[112:115]
    v_mfma_f32_16x16x32_bf16 v[116:119], v[52:55], v[24:27], v[116:119]
    ds_read_b64_tr_b16 v[68:69], v251 offset:8192
    v_mfma_f32_16x16x32_bf16 v[120:123], v[56:59], v[24:27], v[120:123]
    buffer_load_dwordx4 v229, s[16:19], s32 offen offset:1024 lds
    v_mfma_f32_16x16x32_bf16 v[124:127], v[60:63], v[24:27], v[124:127]
    ds_read_b128 v[24:27], v249 offset:4096
    v_mfma_f32_16x16x32_bf16 v[128:131], v[48:51], v[28:31], v[128:131]
    v_mfma_f32_16x16x32_bf16 v[132:135], v[52:55], v[28:31], v[132:135]
    ds_read_b64_tr_b16 v[70:71], v251 offset:9216
    v_mfma_f32_16x16x32_bf16 v[136:139], v[56:59], v[28:31], v[136:139]
    v_mfma_f32_16x16x32_bf16 v[140:143], v[60:63], v[28:31], v[140:143]
    ds_read_b128 v[28:31], v249 offset:6144
    s_waitcnt lgkmcnt(11)
    v_mfma_f32_16x16x32_bf16 v[144:147], v[48:51], v[32:35], v[144:147]
    v_mfma_f32_16x16x32_bf16 v[148:151], v[52:55], v[32:35], v[148:151]
    ds_read_b64_tr_b16 v[72:73], v250 offset:8448
    v_mfma_f32_16x16x32_bf16 v[152:155], v[56:59], v[32:35], v[152:155]
    buffer_load_dwordx4 v230, s[16:19], s32 offen offset:2048 lds
    v_mfma_f32_16x16x32_bf16 v[156:159], v[60:63], v[32:35], v[156:159]
    ds_read_b128 v[32:35], v249 offset:8192
    s_waitcnt lgkmcnt(12)
    v_mfma_f32_16x16x32_bf16 v[160:163], v[48:51], v[36:39], v[160:163]
    v_mfma_f32_16x16x32_bf16 v[164:167], v[52:55], v[36:39], v[164:167]
    ds_read_b64_tr_b16 v[74:75], v250 offset:9472
    v_mfma_f32_16x16x32_bf16 v[168:171], v[56:59], v[36:39], v[168:171]
    v_mfma_f32_16x16x32_bf16 v[172:175], v[60:63], v[36:39], v[172:175]
    ds_read_b128 v[36:39], v249 offset:10240
    s_waitcnt lgkmcnt(13)
    v_mfma_f32_16x16x32_bf16 v[176:179], v[48:51], v[40:43], v[176:179]
    v_mfma_f32_16x16x32_bf16 v[180:183], v[52:55], v[40:43], v[180:183]
    ds_read_b64_tr_b16 v[76:77], v251 offset:8448
    v_mfma_f32_16x16x32_bf16 v[184:187], v[56:59], v[40:43], v[184:187]
    buffer_load_dwordx4 v231, s[16:19], s32 offen offset:3072 lds
    v_mfma_f32_16x16x32_bf16 v[188:191], v[60:63], v[40:43], v[188:191]
    ds_read_b128 v[40:43], v249 offset:12288
    s_waitcnt lgkmcnt(14)
    v_mfma_f32_16x16x32_bf16 v[192:195], v[48:51], v[44:47], v[192:195]
    v_mfma_f32_16x16x32_bf16 v[196:199], v[52:55], v[44:47], v[196:199]
    ds_read_b64_tr_b16 v[78:79], v251 offset:9472
    v_mfma_f32_16x16x32_bf16 v[200:203], v[56:59], v[44:47], v[200:203]
    s_mov_b32 s101, 1024
    buffer_load_dword v213, v218, s[52:55], s101 offen
    v_mfma_f32_16x16x32_bf16 v[204:207], v[60:63], v[44:47], v[204:207]
    ds_read_b128 v[44:47], v249 offset:14336
    s_waitcnt lgkmcnt(13)
    v_mfma_f32_16x16x32_bf16 v[80:83], v[64:67], v[16:19], v[80:83]
    s_waitcnt lgkmcnt(9)
    v_mfma_f32_16x16x32_bf16 v[84:87], v[68:71], v[16:19], v[84:87]
    s_waitcnt lgkmcnt(5)
    v_mfma_f32_16x16x32_bf16 v[88:91], v[72:75], v[16:19], v[88:91]
    s_waitcnt lgkmcnt(1)
    v_mfma_f32_16x16x32_bf16 v[92:95], v[76:79], v[16:19], v[92:95]
    v_mfma_f32_16x16x32_bf16 v[96:99], v[64:67], v[20:23], v[96:99]
    v_mfma_f32_16x16x32_bf16 v[100:103], v[68:71], v[20:23], v[100:103]
    v_mfma_f32_16x16x32_bf16 v[104:107], v[72:75], v[20:23], v[104:107]
    v_mfma_f32_16x16x32_bf16 v[108:111], v[76:79], v[20:23], v[108:111]
    s_waitcnt lgkmcnt(0)
    s_waitcnt vmcnt(5)
    s_barrier
    s_add_u32 s28, s34, 98304
    s_add_u32 s29, s35, 131072
    v_add_u32 v248, s28, v244
    v_add_u32 v249, s28, v245
    v_add_u32 v250, s29, v246
    v_add_u32 v251, s29, v247
    v_mfma_f32_16x16x32_bf16 v[112:115], v[64:67], v[24:27], v[112:115]
    ds_read_b64_tr_b16 v[48:49], v250 offset:0
    ds_read_b64_tr_b16 v[50:51], v250 offset:1024
    v_mfma_f32_16x16x32_bf16 v[116:119], v[68:71], v[24:27], v[116:119]
    ds_read_b128 v[16:19], v248 offset:0
    ds_read_b64_tr_b16 v[52:53], v251 offset:0
    v_mfma_f32_16x16x32_bf16 v[120:123], v[72:75], v[24:27], v[120:123]
    ds_read_b64_tr_b16 v[54:55], v251 offset:1024
    ds_read_b128 v[20:23], v248 offset:2048
    s_add_u32 m0, s30, 32768
    s_add_u32 s32, s31, 5
    s_and_b32 s32, s32, 7
    s_lshl_b32 s32, s32, 19
    buffer_load_dwordx4 v232, s[20:23], s32 offen offset:0 lds
    v_mfma_f32_16x16x32_bf16 v[124:127], v[76:79], v[24:27], v[124:127]
    ds_read_b128 v[24:27], v248 offset:4096
    v_mfma_f32_16x16x32_bf16 v[128:131], v[64:67], v[28:31], v[128:131]
    ds_read_b64_tr_b16 v[56:57], v250 offset:256
    v_mfma_f32_16x16x32_bf16 v[132:135], v[68:71], v[28:31], v[132:135]
    ds_read_b64_tr_b16 v[58:59], v250 offset:1280
    v_mfma_f32_16x16x32_bf16 v[136:139], v[72:75], v[28:31], v[136:139]
    ds_read_b64_tr_b16 v[60:61], v251 offset:256
    v_mfma_f32_16x16x32_bf16 v[140:143], v[76:79], v[28:31], v[140:143]
    ds_read_b128 v[28:31], v248 offset:6144
    v_mfma_f32_16x16x32_bf16 v[144:147], v[64:67], v[32:35], v[144:147]
    ds_read_b64_tr_b16 v[62:63], v251 offset:1280
    buffer_load_dwordx4 v233, s[20:23], s32 offen offset:1024 lds
    v_mfma_f32_16x16x32_bf16 v[148:151], v[68:71], v[32:35], v[148:151]
    v_mfma_f32_16x16x32_bf16 v[152:155], v[72:75], v[32:35], v[152:155]
    v_mfma_f32_16x16x32_bf16 v[156:159], v[76:79], v[32:35], v[156:159]
    ds_read_b128 v[32:35], v248 offset:8192
    v_mfma_f32_16x16x32_bf16 v[160:163], v[64:67], v[36:39], v[160:163]
    v_mfma_f32_16x16x32_bf16 v[164:167], v[68:71], v[36:39], v[164:167]
    v_mfma_f32_16x16x32_bf16 v[168:171], v[72:75], v[36:39], v[168:171]
    buffer_load_dwordx4 v234, s[20:23], s32 offen offset:2048 lds
    v_mfma_f32_16x16x32_bf16 v[172:175], v[76:79], v[36:39], v[172:175]
    ds_read_b128 v[36:39], v248 offset:10240
    v_mfma_f32_16x16x32_bf16 v[176:179], v[64:67], v[40:43], v[176:179]
    v_mfma_f32_16x16x32_bf16 v[180:183], v[68:71], v[40:43], v[180:183]
    v_mfma_f32_16x16x32_bf16 v[184:187], v[72:75], v[40:43], v[184:187]
    v_mfma_f32_16x16x32_bf16 v[188:191], v[76:79], v[40:43], v[188:191]
    ds_read_b128 v[40:43], v248 offset:12288
    v_mfma_f32_16x16x32_bf16 v[192:195], v[64:67], v[44:47], v[192:195]
    buffer_load_dwordx4 v235, s[20:23], s32 offen offset:3072 lds
    v_mfma_f32_16x16x32_bf16 v[196:199], v[68:71], v[44:47], v[196:199]
    v_mfma_f32_16x16x32_bf16 v[200:203], v[72:75], v[44:47], v[200:203]
    v_mfma_f32_16x16x32_bf16 v[204:207], v[76:79], v[44:47], v[204:207]
    ds_read_b128 v[44:47], v248 offset:14336
    s_waitcnt lgkmcnt(13)
    v_mfma_f32_16x16x32_bf16 v[80:83], v[48:51], v[16:19], v[80:83]
    s_waitcnt lgkmcnt(11)
    v_mfma_f32_16x16x32_bf16 v[84:87], v[52:55], v[16:19], v[84:87]
    ds_read_b64_tr_b16 v[64:65], v250 offset:8192
    s_waitcnt lgkmcnt(8)
    v_mfma_f32_16x16x32_bf16 v[88:91], v[56:59], v[16:19], v[88:91]
    s_add_u32 m0, s30, 65536
    s_add_u32 s32, s31, 6
    s_and_b32 s32, s32, 7
    s_lshl_b32 s32, s32, 7
    buffer_load_dwordx4 v228, s[16:19], s32 offen offset:0 lds
    s_waitcnt lgkmcnt(5)
    v_mfma_f32_16x16x32_bf16 v[92:95], v[60:63], v[16:19], v[92:95]
    ds_read_b128 v[16:19], v249 offset:0
    v_mfma_f32_16x16x32_bf16 v[96:99], v[48:51], v[20:23], v[96:99]
    v_mfma_f32_16x16x32_bf16 v[100:103], v[52:55], v[20:23], v[100:103]
    ds_read_b64_tr_b16 v[66:67], v250 offset:9216
    v_mfma_f32_16x16x32_bf16 v[104:107], v[56:59], v[20:23], v[104:107]
    v_mfma_f32_16x16x32_bf16 v[108:111], v[60:63], v[20:23], v[108:111]
    ds_read_b128 v[20:23], v249 offset:2048
    v_mfma_f32_16x16x32_bf16 v[112:115], v[48:51], v[24:27], v[112:115]
    v_mfma_f32_16x16x32_bf16 v[116:119], v[52:55], v[24:27], v[116:119]
    ds_read_b64_tr_b16 v[68:69], v251 offset:8192
    v_mfma_f32_16x16x32_bf16 v[120:123], v[56:59], v[24:27], v[120:123]
    buffer_load_dwordx4 v229, s[16:19], s32 offen offset:1024 lds
    v_mfma_f32_16x16x32_bf16 v[124:127], v[60:63], v[24:27], v[124:127]
    ds_read_b128 v[24:27], v249 offset:4096
    v_mfma_f32_16x16x32_bf16 v[128:131], v[48:51], v[28:31], v[128:131]
    v_mfma_f32_16x16x32_bf16 v[132:135], v[52:55], v[28:31], v[132:135]
    ds_read_b64_tr_b16 v[70:71], v251 offset:9216
    v_mfma_f32_16x16x32_bf16 v[136:139], v[56:59], v[28:31], v[136:139]
    v_mfma_f32_16x16x32_bf16 v[140:143], v[60:63], v[28:31], v[140:143]
    ds_read_b128 v[28:31], v249 offset:6144
    s_waitcnt lgkmcnt(11)
    v_mfma_f32_16x16x32_bf16 v[144:147], v[48:51], v[32:35], v[144:147]
    v_mfma_f32_16x16x32_bf16 v[148:151], v[52:55], v[32:35], v[148:151]
    ds_read_b64_tr_b16 v[72:73], v250 offset:8448
    v_mfma_f32_16x16x32_bf16 v[152:155], v[56:59], v[32:35], v[152:155]
    buffer_load_dwordx4 v230, s[16:19], s32 offen offset:2048 lds
    v_mfma_f32_16x16x32_bf16 v[156:159], v[60:63], v[32:35], v[156:159]
    ds_read_b128 v[32:35], v249 offset:8192
    s_waitcnt lgkmcnt(12)
    v_mfma_f32_16x16x32_bf16 v[160:163], v[48:51], v[36:39], v[160:163]
    v_mfma_f32_16x16x32_bf16 v[164:167], v[52:55], v[36:39], v[164:167]
    ds_read_b64_tr_b16 v[74:75], v250 offset:9472
    v_mfma_f32_16x16x32_bf16 v[168:171], v[56:59], v[36:39], v[168:171]
    v_mfma_f32_16x16x32_bf16 v[172:175], v[60:63], v[36:39], v[172:175]
    ds_read_b128 v[36:39], v249 offset:10240
    s_waitcnt lgkmcnt(13)
    v_mfma_f32_16x16x32_bf16 v[176:179], v[48:51], v[40:43], v[176:179]
    v_mfma_f32_16x16x32_bf16 v[180:183], v[52:55], v[40:43], v[180:183]
    ds_read_b64_tr_b16 v[76:77], v251 offset:8448
    v_mfma_f32_16x16x32_bf16 v[184:187], v[56:59], v[40:43], v[184:187]
    buffer_load_dwordx4 v231, s[16:19], s32 offen offset:3072 lds
    v_mfma_f32_16x16x32_bf16 v[188:191], v[60:63], v[40:43], v[188:191]
    ds_read_b128 v[40:43], v249 offset:12288
    s_waitcnt lgkmcnt(14)
    v_mfma_f32_16x16x32_bf16 v[192:195], v[48:51], v[44:47], v[192:195]
    v_mfma_f32_16x16x32_bf16 v[196:199], v[52:55], v[44:47], v[196:199]
    ds_read_b64_tr_b16 v[78:79], v251 offset:9472
    v_mfma_f32_16x16x32_bf16 v[200:203], v[56:59], v[44:47], v[200:203]
    s_mov_b32 s101, 1536
    buffer_load_dword v215, v218, s[52:55], s101 offen
    v_mfma_f32_16x16x32_bf16 v[204:207], v[60:63], v[44:47], v[204:207]
    ds_read_b128 v[44:47], v249 offset:14336
    s_waitcnt lgkmcnt(13)
    v_mfma_f32_16x16x32_bf16 v[80:83], v[64:67], v[16:19], v[80:83]
    s_waitcnt lgkmcnt(9)
    v_mfma_f32_16x16x32_bf16 v[84:87], v[68:71], v[16:19], v[84:87]
    s_waitcnt lgkmcnt(5)
    v_mfma_f32_16x16x32_bf16 v[88:91], v[72:75], v[16:19], v[88:91]
    s_waitcnt lgkmcnt(1)
    v_mfma_f32_16x16x32_bf16 v[92:95], v[76:79], v[16:19], v[92:95]
    v_mfma_f32_16x16x32_bf16 v[96:99], v[64:67], v[20:23], v[96:99]
    v_mfma_f32_16x16x32_bf16 v[100:103], v[68:71], v[20:23], v[100:103]
    v_mfma_f32_16x16x32_bf16 v[104:107], v[72:75], v[20:23], v[104:107]
    v_mfma_f32_16x16x32_bf16 v[108:111], v[76:79], v[20:23], v[108:111]
    s_waitcnt lgkmcnt(0)
    s_waitcnt vmcnt(5)
    s_barrier
    s_add_u32 s28, s34, 0
    s_add_u32 s29, s35, 32768
    v_add_u32 v248, s28, v244
    v_add_u32 v249, s28, v245
    v_add_u32 v250, s29, v246
    v_add_u32 v251, s29, v247
    v_mfma_f32_16x16x32_bf16 v[112:115], v[64:67], v[24:27], v[112:115]
    ds_read_b64_tr_b16 v[48:49], v250 offset:0
    ds_read_b64_tr_b16 v[50:51], v250 offset:1024
    v_mfma_f32_16x16x32_bf16 v[116:119], v[68:71], v[24:27], v[116:119]
    ds_read_b128 v[16:19], v248 offset:0
    ds_read_b64_tr_b16 v[52:53], v251 offset:0
    v_mfma_f32_16x16x32_bf16 v[120:123], v[72:75], v[24:27], v[120:123]
    ds_read_b64_tr_b16 v[54:55], v251 offset:1024
    ds_read_b128 v[20:23], v248 offset:2048
    s_add_u32 m0, s30, 98304
    s_add_u32 s32, s31, 6
    s_and_b32 s32, s32, 7
    s_lshl_b32 s32, s32, 19
    buffer_load_dwordx4 v232, s[20:23], s32 offen offset:0 lds
    v_mfma_f32_16x16x32_bf16 v[124:127], v[76:79], v[24:27], v[124:127]
    ds_read_b128 v[24:27], v248 offset:4096
    v_mfma_f32_16x16x32_bf16 v[128:131], v[64:67], v[28:31], v[128:131]
    ds_read_b64_tr_b16 v[56:57], v250 offset:256
    v_mfma_f32_16x16x32_bf16 v[132:135], v[68:71], v[28:31], v[132:135]
    ds_read_b64_tr_b16 v[58:59], v250 offset:1280
    v_mfma_f32_16x16x32_bf16 v[136:139], v[72:75], v[28:31], v[136:139]
    ds_read_b64_tr_b16 v[60:61], v251 offset:256
    v_mfma_f32_16x16x32_bf16 v[140:143], v[76:79], v[28:31], v[140:143]
    ds_read_b128 v[28:31], v248 offset:6144
    v_mfma_f32_16x16x32_bf16 v[144:147], v[64:67], v[32:35], v[144:147]
    ds_read_b64_tr_b16 v[62:63], v251 offset:1280
    buffer_load_dwordx4 v233, s[20:23], s32 offen offset:1024 lds
    v_mfma_f32_16x16x32_bf16 v[148:151], v[68:71], v[32:35], v[148:151]
    v_mfma_f32_16x16x32_bf16 v[152:155], v[72:75], v[32:35], v[152:155]
    v_mfma_f32_16x16x32_bf16 v[156:159], v[76:79], v[32:35], v[156:159]
    ds_read_b128 v[32:35], v248 offset:8192
    v_mfma_f32_16x16x32_bf16 v[160:163], v[64:67], v[36:39], v[160:163]
    v_mfma_f32_16x16x32_bf16 v[164:167], v[68:71], v[36:39], v[164:167]
    v_mfma_f32_16x16x32_bf16 v[168:171], v[72:75], v[36:39], v[168:171]
    buffer_load_dwordx4 v234, s[20:23], s32 offen offset:2048 lds
    v_mfma_f32_16x16x32_bf16 v[172:175], v[76:79], v[36:39], v[172:175]
    ds_read_b128 v[36:39], v248 offset:10240
    v_mfma_f32_16x16x32_bf16 v[176:179], v[64:67], v[40:43], v[176:179]
    v_mfma_f32_16x16x32_bf16 v[180:183], v[68:71], v[40:43], v[180:183]
    v_mfma_f32_16x16x32_bf16 v[184:187], v[72:75], v[40:43], v[184:187]
    v_mfma_f32_16x16x32_bf16 v[188:191], v[76:79], v[40:43], v[188:191]
    ds_read_b128 v[40:43], v248 offset:12288
    v_mfma_f32_16x16x32_bf16 v[192:195], v[64:67], v[44:47], v[192:195]
    buffer_load_dwordx4 v235, s[20:23], s32 offen offset:3072 lds
    v_mfma_f32_16x16x32_bf16 v[196:199], v[68:71], v[44:47], v[196:199]
    v_mfma_f32_16x16x32_bf16 v[200:203], v[72:75], v[44:47], v[200:203]
    v_mfma_f32_16x16x32_bf16 v[204:207], v[76:79], v[44:47], v[204:207]
    ds_read_b128 v[44:47], v248 offset:14336
    s_waitcnt lgkmcnt(13)
    v_mfma_f32_16x16x32_bf16 v[80:83], v[48:51], v[16:19], v[80:83]
    s_waitcnt lgkmcnt(11)
    v_mfma_f32_16x16x32_bf16 v[84:87], v[52:55], v[16:19], v[84:87]
    ds_read_b64_tr_b16 v[64:65], v250 offset:8192
    s_waitcnt lgkmcnt(8)
    v_mfma_f32_16x16x32_bf16 v[88:91], v[56:59], v[16:19], v[88:91]
    s_add_u32 m0, s30, 131072
    s_add_u32 s32, s31, 7
    s_and_b32 s32, s32, 7
    s_lshl_b32 s32, s32, 7
    buffer_load_dwordx4 v228, s[16:19], s32 offen offset:0 lds
    s_waitcnt lgkmcnt(5)
    v_mfma_f32_16x16x32_bf16 v[92:95], v[60:63], v[16:19], v[92:95]
    ds_read_b128 v[16:19], v249 offset:0
    v_mfma_f32_16x16x32_bf16 v[96:99], v[48:51], v[20:23], v[96:99]
    v_mfma_f32_16x16x32_bf16 v[100:103], v[52:55], v[20:23], v[100:103]
    ds_read_b64_tr_b16 v[66:67], v250 offset:9216
    v_mfma_f32_16x16x32_bf16 v[104:107], v[56:59], v[20:23], v[104:107]
    v_mfma_f32_16x16x32_bf16 v[108:111], v[60:63], v[20:23], v[108:111]
    ds_read_b128 v[20:23], v249 offset:2048
    v_mfma_f32_16x16x32_bf16 v[112:115], v[48:51], v[24:27], v[112:115]
    v_mfma_f32_16x16x32_bf16 v[116:119], v[52:55], v[24:27], v[116:119]
    ds_read_b64_tr_b16 v[68:69], v251 offset:8192
    v_mfma_f32_16x16x32_bf16 v[120:123], v[56:59], v[24:27], v[120:123]
    buffer_load_dwordx4 v229, s[16:19], s32 offen offset:1024 lds
    v_mfma_f32_16x16x32_bf16 v[124:127], v[60:63], v[24:27], v[124:127]
    ds_read_b128 v[24:27], v249 offset:4096
    v_mfma_f32_16x16x32_bf16 v[128:131], v[48:51], v[28:31], v[128:131]
    v_mfma_f32_16x16x32_bf16 v[132:135], v[52:55], v[28:31], v[132:135]
    ds_read_b64_tr_b16 v[70:71], v251 offset:9216
    v_mfma_f32_16x16x32_bf16 v[136:139], v[56:59], v[28:31], v[136:139]
    v_mfma_f32_16x16x32_bf16 v[140:143], v[60:63], v[28:31], v[140:143]
    ds_read_b128 v[28:31], v249 offset:6144
    s_waitcnt lgkmcnt(11)
    v_mfma_f32_16x16x32_bf16 v[144:147], v[48:51], v[32:35], v[144:147]
    v_mfma_f32_16x16x32_bf16 v[148:151], v[52:55], v[32:35], v[148:151]
    ds_read_b64_tr_b16 v[72:73], v250 offset:8448
    v_mfma_f32_16x16x32_bf16 v[152:155], v[56:59], v[32:35], v[152:155]
    buffer_load_dwordx4 v230, s[16:19], s32 offen offset:2048 lds
    v_mfma_f32_16x16x32_bf16 v[156:159], v[60:63], v[32:35], v[156:159]
    ds_read_b128 v[32:35], v249 offset:8192
    s_waitcnt lgkmcnt(12)
    v_mfma_f32_16x16x32_bf16 v[160:163], v[48:51], v[36:39], v[160:163]
    v_mfma_f32_16x16x32_bf16 v[164:167], v[52:55], v[36:39], v[164:167]
    ds_read_b64_tr_b16 v[74:75], v250 offset:9472
    v_mfma_f32_16x16x32_bf16 v[168:171], v[56:59], v[36:39], v[168:171]
    v_mfma_f32_16x16x32_bf16 v[172:175], v[60:63], v[36:39], v[172:175]
    ds_read_b128 v[36:39], v249 offset:10240
    s_waitcnt lgkmcnt(13)
    v_mfma_f32_16x16x32_bf16 v[176:179], v[48:51], v[40:43], v[176:179]
    v_mfma_f32_16x16x32_bf16 v[180:183], v[52:55], v[40:43], v[180:183]
    ds_read_b64_tr_b16 v[76:77], v251 offset:8448
    v_mfma_f32_16x16x32_bf16 v[184:187], v[56:59], v[40:43], v[184:187]
    buffer_load_dwordx4 v231, s[16:19], s32 offen offset:3072 lds
    v_mfma_f32_16x16x32_bf16 v[188:191], v[60:63], v[40:43], v[188:191]
    ds_read_b128 v[40:43], v249 offset:12288
    s_waitcnt lgkmcnt(14)
    v_mfma_f32_16x16x32_bf16 v[192:195], v[48:51], v[44:47], v[192:195]
    v_mfma_f32_16x16x32_bf16 v[196:199], v[52:55], v[44:47], v[196:199]
    ds_read_b64_tr_b16 v[78:79], v251 offset:9472
    v_mfma_f32_16x16x32_bf16 v[200:203], v[56:59], v[44:47], v[200:203]
    s_mov_b32 s101, 2048
    buffer_load_dword v209, v218, s[52:55], s101 offen
    v_mfma_f32_16x16x32_bf16 v[204:207], v[60:63], v[44:47], v[204:207]
    ds_read_b128 v[44:47], v249 offset:14336
    s_waitcnt lgkmcnt(13)
    v_mfma_f32_16x16x32_bf16 v[80:83], v[64:67], v[16:19], v[80:83]
    s_waitcnt lgkmcnt(9)
    v_mfma_f32_16x16x32_bf16 v[84:87], v[68:71], v[16:19], v[84:87]
    s_waitcnt lgkmcnt(5)
    v_mfma_f32_16x16x32_bf16 v[88:91], v[72:75], v[16:19], v[88:91]
    s_waitcnt lgkmcnt(1)
    v_mfma_f32_16x16x32_bf16 v[92:95], v[76:79], v[16:19], v[92:95]
    v_mfma_f32_16x16x32_bf16 v[96:99], v[64:67], v[20:23], v[96:99]
    v_mfma_f32_16x16x32_bf16 v[100:103], v[68:71], v[20:23], v[100:103]
    v_mfma_f32_16x16x32_bf16 v[104:107], v[72:75], v[20:23], v[104:107]
    v_mfma_f32_16x16x32_bf16 v[108:111], v[76:79], v[20:23], v[108:111]
    s_waitcnt lgkmcnt(0)
    s_waitcnt vmcnt(5)
    s_barrier
    s_add_u32 s28, s34, 65536
    s_add_u32 s29, s35, 98304
    v_add_u32 v248, s28, v244
    v_add_u32 v249, s28, v245
    v_add_u32 v250, s29, v246
    v_add_u32 v251, s29, v247
    v_mfma_f32_16x16x32_bf16 v[112:115], v[64:67], v[24:27], v[112:115]
    ds_read_b64_tr_b16 v[48:49], v250 offset:0
    ds_read_b64_tr_b16 v[50:51], v250 offset:1024
    v_mfma_f32_16x16x32_bf16 v[116:119], v[68:71], v[24:27], v[116:119]
    ds_read_b128 v[16:19], v248 offset:0
    ds_read_b64_tr_b16 v[52:53], v251 offset:0
    v_mfma_f32_16x16x32_bf16 v[120:123], v[72:75], v[24:27], v[120:123]
    ds_read_b64_tr_b16 v[54:55], v251 offset:1024
    ds_read_b128 v[20:23], v248 offset:2048
    s_add_u32 m0, s30, 0
    s_add_u32 s32, s31, 7
    s_and_b32 s32, s32, 7
    s_lshl_b32 s32, s32, 19
    buffer_load_dwordx4 v232, s[20:23], s32 offen offset:0 lds
    v_mfma_f32_16x16x32_bf16 v[124:127], v[76:79], v[24:27], v[124:127]
    ds_read_b128 v[24:27], v248 offset:4096
    v_mfma_f32_16x16x32_bf16 v[128:131], v[64:67], v[28:31], v[128:131]
    ds_read_b64_tr_b16 v[56:57], v250 offset:256
    v_mfma_f32_16x16x32_bf16 v[132:135], v[68:71], v[28:31], v[132:135]
    ds_read_b64_tr_b16 v[58:59], v250 offset:1280
    v_mfma_f32_16x16x32_bf16 v[136:139], v[72:75], v[28:31], v[136:139]
    ds_read_b64_tr_b16 v[60:61], v251 offset:256
    v_mfma_f32_16x16x32_bf16 v[140:143], v[76:79], v[28:31], v[140:143]
    ds_read_b128 v[28:31], v248 offset:6144
    v_mfma_f32_16x16x32_bf16 v[144:147], v[64:67], v[32:35], v[144:147]
    ds_read_b64_tr_b16 v[62:63], v251 offset:1280
    buffer_load_dwordx4 v233, s[20:23], s32 offen offset:1024 lds
    v_mfma_f32_16x16x32_bf16 v[148:151], v[68:71], v[32:35], v[148:151]
    v_mfma_f32_16x16x32_bf16 v[152:155], v[72:75], v[32:35], v[152:155]
    v_mfma_f32_16x16x32_bf16 v[156:159], v[76:79], v[32:35], v[156:159]
    ds_read_b128 v[32:35], v248 offset:8192
    v_mfma_f32_16x16x32_bf16 v[160:163], v[64:67], v[36:39], v[160:163]
    v_mfma_f32_16x16x32_bf16 v[164:167], v[68:71], v[36:39], v[164:167]
    v_mfma_f32_16x16x32_bf16 v[168:171], v[72:75], v[36:39], v[168:171]
    buffer_load_dwordx4 v234, s[20:23], s32 offen offset:2048 lds
    v_mfma_f32_16x16x32_bf16 v[172:175], v[76:79], v[36:39], v[172:175]
    ds_read_b128 v[36:39], v248 offset:10240
    v_mfma_f32_16x16x32_bf16 v[176:179], v[64:67], v[40:43], v[176:179]
    v_mfma_f32_16x16x32_bf16 v[180:183], v[68:71], v[40:43], v[180:183]
    v_mfma_f32_16x16x32_bf16 v[184:187], v[72:75], v[40:43], v[184:187]
    v_mfma_f32_16x16x32_bf16 v[188:191], v[76:79], v[40:43], v[188:191]
    ds_read_b128 v[40:43], v248 offset:12288
    v_mfma_f32_16x16x32_bf16 v[192:195], v[64:67], v[44:47], v[192:195]
    buffer_load_dwordx4 v235, s[20:23], s32 offen offset:3072 lds
    v_mfma_f32_16x16x32_bf16 v[196:199], v[68:71], v[44:47], v[196:199]
    v_mfma_f32_16x16x32_bf16 v[200:203], v[72:75], v[44:47], v[200:203]
    v_mfma_f32_16x16x32_bf16 v[204:207], v[76:79], v[44:47], v[204:207]
    ds_read_b128 v[44:47], v248 offset:14336
    s_waitcnt lgkmcnt(13)
    v_mfma_f32_16x16x32_bf16 v[80:83], v[48:51], v[16:19], v[80:83]
    s_waitcnt lgkmcnt(11)
    v_mfma_f32_16x16x32_bf16 v[84:87], v[52:55], v[16:19], v[84:87]
    ds_read_b64_tr_b16 v[64:65], v250 offset:8192
    s_waitcnt lgkmcnt(8)
    v_mfma_f32_16x16x32_bf16 v[88:91], v[56:59], v[16:19], v[88:91]
    s_add_u32 m0, s30, 32768
    s_mov_b32 s32, 0
    buffer_load_dwordx4 v236, s[52:55], s32 offen offset:0 lds
    s_waitcnt lgkmcnt(5)
    v_mfma_f32_16x16x32_bf16 v[92:95], v[60:63], v[16:19], v[92:95]
    ds_read_b128 v[16:19], v249 offset:0
    v_mfma_f32_16x16x32_bf16 v[96:99], v[48:51], v[20:23], v[96:99]
    v_mfma_f32_16x16x32_bf16 v[100:103], v[52:55], v[20:23], v[100:103]
    ds_read_b64_tr_b16 v[66:67], v250 offset:9216
    v_mfma_f32_16x16x32_bf16 v[104:107], v[56:59], v[20:23], v[104:107]
    v_mfma_f32_16x16x32_bf16 v[108:111], v[60:63], v[20:23], v[108:111]
    ds_read_b128 v[20:23], v249 offset:2048
    v_mfma_f32_16x16x32_bf16 v[112:115], v[48:51], v[24:27], v[112:115]
    v_mfma_f32_16x16x32_bf16 v[116:119], v[52:55], v[24:27], v[116:119]
    ds_read_b64_tr_b16 v[68:69], v251 offset:8192
    v_mfma_f32_16x16x32_bf16 v[120:123], v[56:59], v[24:27], v[120:123]
    buffer_load_dwordx4 v237, s[52:55], s32 offen offset:1024 lds
    v_mfma_f32_16x16x32_bf16 v[124:127], v[60:63], v[24:27], v[124:127]
    ds_read_b128 v[24:27], v249 offset:4096
    v_mfma_f32_16x16x32_bf16 v[128:131], v[48:51], v[28:31], v[128:131]
    v_mfma_f32_16x16x32_bf16 v[132:135], v[52:55], v[28:31], v[132:135]
    ds_read_b64_tr_b16 v[70:71], v251 offset:9216
    v_mfma_f32_16x16x32_bf16 v[136:139], v[56:59], v[28:31], v[136:139]
    v_mfma_f32_16x16x32_bf16 v[140:143], v[60:63], v[28:31], v[140:143]
    ds_read_b128 v[28:31], v249 offset:6144
    s_waitcnt lgkmcnt(11)
    v_mfma_f32_16x16x32_bf16 v[144:147], v[48:51], v[32:35], v[144:147]
    v_mfma_f32_16x16x32_bf16 v[148:151], v[52:55], v[32:35], v[148:151]
    ds_read_b64_tr_b16 v[72:73], v250 offset:8448
    v_mfma_f32_16x16x32_bf16 v[152:155], v[56:59], v[32:35], v[152:155]
    buffer_load_dwordx4 v238, s[52:55], s32 offen offset:2048 lds
    v_mfma_f32_16x16x32_bf16 v[156:159], v[60:63], v[32:35], v[156:159]
    ds_read_b128 v[32:35], v249 offset:8192
    s_waitcnt lgkmcnt(12)
    v_mfma_f32_16x16x32_bf16 v[160:163], v[48:51], v[36:39], v[160:163]
    v_mfma_f32_16x16x32_bf16 v[164:167], v[52:55], v[36:39], v[164:167]
    ds_read_b64_tr_b16 v[74:75], v250 offset:9472
    v_mfma_f32_16x16x32_bf16 v[168:171], v[56:59], v[36:39], v[168:171]
    v_mfma_f32_16x16x32_bf16 v[172:175], v[60:63], v[36:39], v[172:175]
    ds_read_b128 v[36:39], v249 offset:10240
    s_waitcnt lgkmcnt(13)
    v_mfma_f32_16x16x32_bf16 v[176:179], v[48:51], v[40:43], v[176:179]
    v_mfma_f32_16x16x32_bf16 v[180:183], v[52:55], v[40:43], v[180:183]
    ds_read_b64_tr_b16 v[76:77], v251 offset:8448
    v_mfma_f32_16x16x32_bf16 v[184:187], v[56:59], v[40:43], v[184:187]
    buffer_load_dwordx4 v239, s[52:55], s32 offen offset:3072 lds
    v_mfma_f32_16x16x32_bf16 v[188:191], v[60:63], v[40:43], v[188:191]
    ds_read_b128 v[40:43], v249 offset:12288
    s_waitcnt lgkmcnt(14)
    v_mfma_f32_16x16x32_bf16 v[192:195], v[48:51], v[44:47], v[192:195]
    v_mfma_f32_16x16x32_bf16 v[196:199], v[52:55], v[44:47], v[196:199]
    ds_read_b64_tr_b16 v[78:79], v251 offset:9472
    v_mfma_f32_16x16x32_bf16 v[200:203], v[56:59], v[44:47], v[200:203]
    v_mfma_f32_16x16x32_bf16 v[204:207], v[60:63], v[44:47], v[204:207]
    ds_read_b128 v[44:47], v249 offset:14336
    s_waitcnt lgkmcnt(13)
    v_mfma_f32_16x16x32_bf16 v[80:83], v[64:67], v[16:19], v[80:83]
    s_waitcnt lgkmcnt(9)
    v_mfma_f32_16x16x32_bf16 v[84:87], v[68:71], v[16:19], v[84:87]
    s_waitcnt lgkmcnt(5)
    v_mfma_f32_16x16x32_bf16 v[88:91], v[72:75], v[16:19], v[88:91]
    s_waitcnt lgkmcnt(1)
    v_mfma_f32_16x16x32_bf16 v[92:95], v[76:79], v[16:19], v[92:95]
    v_mfma_f32_16x16x32_bf16 v[96:99], v[64:67], v[20:23], v[96:99]
    v_mfma_f32_16x16x32_bf16 v[100:103], v[68:71], v[20:23], v[100:103]
    v_mfma_f32_16x16x32_bf16 v[104:107], v[72:75], v[20:23], v[104:107]
    v_mfma_f32_16x16x32_bf16 v[108:111], v[76:79], v[20:23], v[108:111]
    s_waitcnt lgkmcnt(0)
    s_waitcnt vmcnt(4)
    s_barrier
    s_add_u32 s28, s34, 131072
    s_add_u32 s29, s35, 0
    v_add_u32 v248, s28, v244
    v_add_u32 v249, s28, v245
    v_add_u32 v250, s29, v246
    v_add_u32 v251, s29, v247
    v_mfma_f32_16x16x32_bf16 v[112:115], v[64:67], v[24:27], v[112:115]
    ds_read_b64_tr_b16 v[48:49], v250 offset:0
    ds_read_b64_tr_b16 v[50:51], v250 offset:1024
    v_mfma_f32_16x16x32_bf16 v[116:119], v[68:71], v[24:27], v[116:119]
    ds_read_b128 v[16:19], v248 offset:0
    ds_read_b64_tr_b16 v[52:53], v251 offset:0
    v_mfma_f32_16x16x32_bf16 v[120:123], v[72:75], v[24:27], v[120:123]
    ds_read_b64_tr_b16 v[54:55], v251 offset:1024
    ds_read_b128 v[20:23], v248 offset:2048
    s_add_u32 m0, s30, 65536
    s_mov_b32 s32, 0
    buffer_load_dwordx4 v240, s[56:59], s32 offen offset:0 lds
    v_mfma_f32_16x16x32_bf16 v[124:127], v[76:79], v[24:27], v[124:127]
    ds_read_b128 v[24:27], v248 offset:4096
    v_mfma_f32_16x16x32_bf16 v[128:131], v[64:67], v[28:31], v[128:131]
    ds_read_b64_tr_b16 v[56:57], v250 offset:256
    v_mfma_f32_16x16x32_bf16 v[132:135], v[68:71], v[28:31], v[132:135]
    ds_read_b64_tr_b16 v[58:59], v250 offset:1280
    v_mfma_f32_16x16x32_bf16 v[136:139], v[72:75], v[28:31], v[136:139]
    ds_read_b64_tr_b16 v[60:61], v251 offset:256
    v_mfma_f32_16x16x32_bf16 v[140:143], v[76:79], v[28:31], v[140:143]
    ds_read_b128 v[28:31], v248 offset:6144
    v_mfma_f32_16x16x32_bf16 v[144:147], v[64:67], v[32:35], v[144:147]
    ds_read_b64_tr_b16 v[62:63], v251 offset:1280
    buffer_load_dwordx4 v241, s[56:59], s32 offen offset:1024 lds
    v_mfma_f32_16x16x32_bf16 v[148:151], v[68:71], v[32:35], v[148:151]
    v_mfma_f32_16x16x32_bf16 v[152:155], v[72:75], v[32:35], v[152:155]
    v_mfma_f32_16x16x32_bf16 v[156:159], v[76:79], v[32:35], v[156:159]
    ds_read_b128 v[32:35], v248 offset:8192
    v_mfma_f32_16x16x32_bf16 v[160:163], v[64:67], v[36:39], v[160:163]
    v_mfma_f32_16x16x32_bf16 v[164:167], v[68:71], v[36:39], v[164:167]
    v_mfma_f32_16x16x32_bf16 v[168:171], v[72:75], v[36:39], v[168:171]
    buffer_load_dwordx4 v242, s[56:59], s32 offen offset:2048 lds
    v_mfma_f32_16x16x32_bf16 v[172:175], v[76:79], v[36:39], v[172:175]
    ds_read_b128 v[36:39], v248 offset:10240
    v_mfma_f32_16x16x32_bf16 v[176:179], v[64:67], v[40:43], v[176:179]
    v_mfma_f32_16x16x32_bf16 v[180:183], v[68:71], v[40:43], v[180:183]
    v_mfma_f32_16x16x32_bf16 v[184:187], v[72:75], v[40:43], v[184:187]
    v_mfma_f32_16x16x32_bf16 v[188:191], v[76:79], v[40:43], v[188:191]
    ds_read_b128 v[40:43], v248 offset:12288
    v_mfma_f32_16x16x32_bf16 v[192:195], v[64:67], v[44:47], v[192:195]
    buffer_load_dwordx4 v243, s[56:59], s32 offen offset:3072 lds
    v_mfma_f32_16x16x32_bf16 v[196:199], v[68:71], v[44:47], v[196:199]
    v_mfma_f32_16x16x32_bf16 v[200:203], v[72:75], v[44:47], v[200:203]
    v_mfma_f32_16x16x32_bf16 v[204:207], v[76:79], v[44:47], v[204:207]
    ds_read_b128 v[44:47], v248 offset:14336
    s_waitcnt lgkmcnt(13)
    v_mfma_f32_16x16x32_bf16 v[80:83], v[48:51], v[16:19], v[80:83]
    s_waitcnt lgkmcnt(11)
    v_mfma_f32_16x16x32_bf16 v[84:87], v[52:55], v[16:19], v[84:87]
    ds_read_b64_tr_b16 v[64:65], v250 offset:8192
    s_waitcnt lgkmcnt(8)
    v_mfma_f32_16x16x32_bf16 v[88:91], v[56:59], v[16:19], v[88:91]
    s_add_u32 m0, s30, 98304
    s_mov_b32 s32, 128
    buffer_load_dwordx4 v236, s[52:55], s32 offen offset:0 lds
    s_waitcnt lgkmcnt(5)
    v_mfma_f32_16x16x32_bf16 v[92:95], v[60:63], v[16:19], v[92:95]
    ds_read_b128 v[16:19], v249 offset:0
    v_mfma_f32_16x16x32_bf16 v[96:99], v[48:51], v[20:23], v[96:99]
    v_mfma_f32_16x16x32_bf16 v[100:103], v[52:55], v[20:23], v[100:103]
    ds_read_b64_tr_b16 v[66:67], v250 offset:9216
    v_mfma_f32_16x16x32_bf16 v[104:107], v[56:59], v[20:23], v[104:107]
    v_mfma_f32_16x16x32_bf16 v[108:111], v[60:63], v[20:23], v[108:111]
    ds_read_b128 v[20:23], v249 offset:2048
    v_mfma_f32_16x16x32_bf16 v[112:115], v[48:51], v[24:27], v[112:115]
    v_mfma_f32_16x16x32_bf16 v[116:119], v[52:55], v[24:27], v[116:119]
    ds_read_b64_tr_b16 v[68:69], v251 offset:8192
    v_mfma_f32_16x16x32_bf16 v[120:123], v[56:59], v[24:27], v[120:123]
    buffer_load_dwordx4 v237, s[52:55], s32 offen offset:1024 lds
    v_mfma_f32_16x16x32_bf16 v[124:127], v[60:63], v[24:27], v[124:127]
    ds_read_b128 v[24:27], v249 offset:4096
    v_mfma_f32_16x16x32_bf16 v[128:131], v[48:51], v[28:31], v[128:131]
    v_mfma_f32_16x16x32_bf16 v[132:135], v[52:55], v[28:31], v[132:135]
    ds_read_b64_tr_b16 v[70:71], v251 offset:9216
    v_mfma_f32_16x16x32_bf16 v[136:139], v[56:59], v[28:31], v[136:139]
    v_mfma_f32_16x16x32_bf16 v[140:143], v[60:63], v[28:31], v[140:143]
    ds_read_b128 v[28:31], v249 offset:6144
    s_waitcnt lgkmcnt(11)
    v_mfma_f32_16x16x32_bf16 v[144:147], v[48:51], v[32:35], v[144:147]
    v_mfma_f32_16x16x32_bf16 v[148:151], v[52:55], v[32:35], v[148:151]
    ds_read_b64_tr_b16 v[72:73], v250 offset:8448
    v_mfma_f32_16x16x32_bf16 v[152:155], v[56:59], v[32:35], v[152:155]
    buffer_load_dwordx4 v238, s[52:55], s32 offen offset:2048 lds
    v_mfma_f32_16x16x32_bf16 v[156:159], v[60:63], v[32:35], v[156:159]
    ds_read_b128 v[32:35], v249 offset:8192
    s_waitcnt lgkmcnt(12)
    v_mfma_f32_16x16x32_bf16 v[160:163], v[48:51], v[36:39], v[160:163]
    v_mfma_f32_16x16x32_bf16 v[164:167], v[52:55], v[36:39], v[164:167]
    ds_read_b64_tr_b16 v[74:75], v250 offset:9472
    v_mfma_f32_16x16x32_bf16 v[168:171], v[56:59], v[36:39], v[168:171]
    v_mfma_f32_16x16x32_bf16 v[172:175], v[60:63], v[36:39], v[172:175]
    ds_read_b128 v[36:39], v249 offset:10240
    s_waitcnt lgkmcnt(13)
    v_mfma_f32_16x16x32_bf16 v[176:179], v[48:51], v[40:43], v[176:179]
    v_mfma_f32_16x16x32_bf16 v[180:183], v[52:55], v[40:43], v[180:183]
    ds_read_b64_tr_b16 v[76:77], v251 offset:8448
    v_mfma_f32_16x16x32_bf16 v[184:187], v[56:59], v[40:43], v[184:187]
    buffer_load_dwordx4 v239, s[52:55], s32 offen offset:3072 lds
    v_mfma_f32_16x16x32_bf16 v[188:191], v[60:63], v[40:43], v[188:191]
    ds_read_b128 v[40:43], v249 offset:12288
    s_waitcnt lgkmcnt(14)
    v_mfma_f32_16x16x32_bf16 v[192:195], v[48:51], v[44:47], v[192:195]
    v_mfma_f32_16x16x32_bf16 v[196:199], v[52:55], v[44:47], v[196:199]
    ds_read_b64_tr_b16 v[78:79], v251 offset:9472
    v_mfma_f32_16x16x32_bf16 v[200:203], v[56:59], v[44:47], v[200:203]
    v_mfma_f32_16x16x32_bf16 v[204:207], v[60:63], v[44:47], v[204:207]
    ds_read_b128 v[44:47], v249 offset:14336
    s_waitcnt lgkmcnt(13)
    v_mfma_f32_16x16x32_bf16 v[80:83], v[64:67], v[16:19], v[80:83]
    s_waitcnt lgkmcnt(9)
    v_mfma_f32_16x16x32_bf16 v[84:87], v[68:71], v[16:19], v[84:87]
    s_waitcnt lgkmcnt(5)
    v_mfma_f32_16x16x32_bf16 v[88:91], v[72:75], v[16:19], v[88:91]
    s_waitcnt lgkmcnt(1)
    v_mfma_f32_16x16x32_bf16 v[92:95], v[76:79], v[16:19], v[92:95]
    v_mfma_f32_16x16x32_bf16 v[96:99], v[64:67], v[20:23], v[96:99]
    v_mfma_f32_16x16x32_bf16 v[100:103], v[68:71], v[20:23], v[100:103]
    v_mfma_f32_16x16x32_bf16 v[104:107], v[72:75], v[20:23], v[104:107]
    v_mfma_f32_16x16x32_bf16 v[108:111], v[76:79], v[20:23], v[108:111]
    s_waitcnt lgkmcnt(0)
    s_waitcnt vmcnt(4)
    s_barrier
    v_mfma_f32_16x16x32_bf16 v[112:115], v[64:67], v[24:27], v[112:115]
    s_add_u32 m0, s30, 131072
    s_mov_b32 s32, 256
    buffer_load_dwordx4 v236, s[52:55], s32 offen offset:0 lds
    v_mfma_f32_16x16x32_bf16 v[116:119], v[68:71], v[24:27], v[116:119]
    v_mfma_f32_16x16x32_bf16 v[120:123], v[72:75], v[24:27], v[120:123]
    v_mfma_f32_16x16x32_bf16 v[124:127], v[76:79], v[24:27], v[124:127]
    buffer_load_dwordx4 v237, s[52:55], s32 offen offset:1024 lds
    v_mfma_f32_16x16x32_bf16 v[128:131], v[64:67], v[28:31], v[128:131]
    v_mfma_f32_16x16x32_bf16 v[132:135], v[68:71], v[28:31], v[132:135]
    v_mfma_f32_16x16x32_bf16 v[136:139], v[72:75], v[28:31], v[136:139]
    buffer_load_dwordx4 v238, s[52:55], s32 offen offset:2048 lds
    v_mfma_f32_16x16x32_bf16 v[140:143], v[76:79], v[28:31], v[140:143]
    v_mfma_f32_16x16x32_bf16 v[144:147], v[64:67], v[32:35], v[144:147]
    v_mfma_f32_16x16x32_bf16 v[148:151], v[68:71], v[32:35], v[148:151]
    buffer_load_dwordx4 v239, s[52:55], s32 offen offset:3072 lds
    v_mfma_f32_16x16x32_bf16 v[152:155], v[72:75], v[32:35], v[152:155]
    v_mfma_f32_16x16x32_bf16 v[156:159], v[76:79], v[32:35], v[156:159]
    v_mfma_f32_16x16x32_bf16 v[160:163], v[64:67], v[36:39], v[160:163]
    s_add_u32 m0, s30, 0
    s_mov_b32 s32, 1048576
    buffer_load_dwordx4 v240, s[56:59], s32 offen offset:0 lds
    v_mfma_f32_16x16x32_bf16 v[164:167], v[68:71], v[36:39], v[164:167]
    v_mfma_f32_16x16x32_bf16 v[168:171], v[72:75], v[36:39], v[168:171]
    v_mfma_f32_16x16x32_bf16 v[172:175], v[76:79], v[36:39], v[172:175]
    buffer_load_dwordx4 v241, s[56:59], s32 offen offset:1024 lds
    v_mfma_f32_16x16x32_bf16 v[176:179], v[64:67], v[40:43], v[176:179]
    v_mfma_f32_16x16x32_bf16 v[180:183], v[68:71], v[40:43], v[180:183]
    v_mfma_f32_16x16x32_bf16 v[184:187], v[72:75], v[40:43], v[184:187]
    buffer_load_dwordx4 v242, s[56:59], s32 offen offset:2048 lds
    v_mfma_f32_16x16x32_bf16 v[188:191], v[76:79], v[40:43], v[188:191]
    v_mfma_f32_16x16x32_bf16 v[192:195], v[64:67], v[44:47], v[192:195]
    v_mfma_f32_16x16x32_bf16 v[196:199], v[68:71], v[44:47], v[196:199]
    buffer_load_dwordx4 v243, s[56:59], s32 offen offset:3072 lds
    v_mfma_f32_16x16x32_bf16 v[200:203], v[72:75], v[44:47], v[200:203]
    v_mfma_f32_16x16x32_bf16 v[204:207], v[76:79], v[44:47], v[204:207]
    v_cvt_pk_bf16_f32 v16, v80, v81
    v_cvt_pk_bf16_f32 v17, v82, v83
    v_cvt_pk_bf16_f32 v18, v84, v85
    v_cvt_pk_bf16_f32 v19, v86, v87
    v_cvt_pk_bf16_f32 v20, v88, v89
    v_cvt_pk_bf16_f32 v21, v90, v91
    v_cvt_pk_bf16_f32 v22, v92, v93
    v_cvt_pk_bf16_f32 v23, v94, v95
    v_cvt_pk_bf16_f32 v24, v96, v97
    v_cvt_pk_bf16_f32 v25, v98, v99
    v_cvt_pk_bf16_f32 v26, v100, v101
    v_cvt_pk_bf16_f32 v27, v102, v103
    v_cvt_pk_bf16_f32 v28, v104, v105
    v_cvt_pk_bf16_f32 v29, v106, v107
    v_cvt_pk_bf16_f32 v30, v108, v109
    v_cvt_pk_bf16_f32 v31, v110, v111
    v_cvt_pk_bf16_f32 v32, v112, v113
    v_cvt_pk_bf16_f32 v33, v114, v115
    v_cvt_pk_bf16_f32 v34, v116, v117
    v_cvt_pk_bf16_f32 v35, v118, v119
    v_cvt_pk_bf16_f32 v36, v120, v121
    v_cvt_pk_bf16_f32 v37, v122, v123
    v_cvt_pk_bf16_f32 v38, v124, v125
    v_cvt_pk_bf16_f32 v39, v126, v127
    v_cvt_pk_bf16_f32 v40, v128, v129
    v_cvt_pk_bf16_f32 v41, v130, v131
    v_cvt_pk_bf16_f32 v42, v132, v133
    v_cvt_pk_bf16_f32 v43, v134, v135
    v_cvt_pk_bf16_f32 v44, v136, v137
    v_cvt_pk_bf16_f32 v45, v138, v139
    v_cvt_pk_bf16_f32 v46, v140, v141
    v_cvt_pk_bf16_f32 v47, v142, v143
    v_cvt_pk_bf16_f32 v48, v144, v145
    v_cvt_pk_bf16_f32 v49, v146, v147
    v_cvt_pk_bf16_f32 v50, v148, v149
    v_cvt_pk_bf16_f32 v51, v150, v151
    v_cvt_pk_bf16_f32 v52, v152, v153
    v_cvt_pk_bf16_f32 v53, v154, v155
    v_cvt_pk_bf16_f32 v54, v156, v157
    v_cvt_pk_bf16_f32 v55, v158, v159
    v_cvt_pk_bf16_f32 v56, v160, v161
    v_cvt_pk_bf16_f32 v57, v162, v163
    v_cvt_pk_bf16_f32 v58, v164, v165
    v_cvt_pk_bf16_f32 v59, v166, v167
    v_cvt_pk_bf16_f32 v60, v168, v169
    v_cvt_pk_bf16_f32 v61, v170, v171
    v_cvt_pk_bf16_f32 v62, v172, v173
    v_cvt_pk_bf16_f32 v63, v174, v175
    v_cvt_pk_bf16_f32 v64, v176, v177
    v_cvt_pk_bf16_f32 v65, v178, v179
    v_cvt_pk_bf16_f32 v66, v180, v181
    v_cvt_pk_bf16_f32 v67, v182, v183
    v_cvt_pk_bf16_f32 v68, v184, v185
    v_cvt_pk_bf16_f32 v69, v186, v187
    v_cvt_pk_bf16_f32 v70, v188, v189
    v_cvt_pk_bf16_f32 v71, v190, v191
    v_cvt_pk_bf16_f32 v72, v192, v193
    v_cvt_pk_bf16_f32 v73, v194, v195
    v_cvt_pk_bf16_f32 v74, v196, v197
    v_cvt_pk_bf16_f32 v75, v198, v199
    v_cvt_pk_bf16_f32 v76, v200, v201
    v_cvt_pk_bf16_f32 v77, v202, v203
    v_cvt_pk_bf16_f32 v78, v204, v205
    v_cvt_pk_bf16_f32 v79, v206, v207
    s_branch qphase_5
kv_v_4:
    s_waitcnt lgkmcnt(13)
    v_mfma_f32_16x16x32_bf16 v[80:83], v[16:19], v[48:51], 0
    s_waitcnt lgkmcnt(11)
    v_mfma_f32_16x16x32_bf16 v[84:87], v[16:19], v[52:55], 0
    ds_read_b64_tr_b16 v[64:65], v250 offset:8192
    s_waitcnt lgkmcnt(8)
    v_mfma_f32_16x16x32_bf16 v[88:91], v[16:19], v[56:59], 0
    s_add_u32 m0, s30, 131072
    s_add_u32 s32, s31, 2
    s_and_b32 s32, s32, 7
    s_lshl_b32 s32, s32, 7
    buffer_load_dwordx4 v228, s[16:19], s32 offen offset:0 lds
    s_waitcnt lgkmcnt(5)
    v_mfma_f32_16x16x32_bf16 v[92:95], v[16:19], v[60:63], 0
    ds_read_b128 v[16:19], v249 offset:0
    v_mfma_f32_16x16x32_bf16 v[96:99], v[20:23], v[48:51], 0
    v_mfma_f32_16x16x32_bf16 v[100:103], v[20:23], v[52:55], 0
    ds_read_b64_tr_b16 v[66:67], v250 offset:9216
    v_mfma_f32_16x16x32_bf16 v[104:107], v[20:23], v[56:59], 0
    v_mfma_f32_16x16x32_bf16 v[108:111], v[20:23], v[60:63], 0
    ds_read_b128 v[20:23], v249 offset:2048
    v_mfma_f32_16x16x32_bf16 v[112:115], v[24:27], v[48:51], 0
    v_mfma_f32_16x16x32_bf16 v[116:119], v[24:27], v[52:55], 0
    ds_read_b64_tr_b16 v[68:69], v251 offset:8192
    v_mfma_f32_16x16x32_bf16 v[120:123], v[24:27], v[56:59], 0
    buffer_load_dwordx4 v229, s[16:19], s32 offen offset:1024 lds
    v_mfma_f32_16x16x32_bf16 v[124:127], v[24:27], v[60:63], 0
    ds_read_b128 v[24:27], v249 offset:4096
    v_mfma_f32_16x16x32_bf16 v[128:131], v[28:31], v[48:51], 0
    v_mfma_f32_16x16x32_bf16 v[132:135], v[28:31], v[52:55], 0
    ds_read_b64_tr_b16 v[70:71], v251 offset:9216
    v_mfma_f32_16x16x32_bf16 v[136:139], v[28:31], v[56:59], 0
    v_mfma_f32_16x16x32_bf16 v[140:143], v[28:31], v[60:63], 0
    ds_read_b128 v[28:31], v249 offset:6144
    s_waitcnt lgkmcnt(11)
    v_mfma_f32_16x16x32_bf16 v[144:147], v[32:35], v[48:51], 0
    v_mfma_f32_16x16x32_bf16 v[148:151], v[32:35], v[52:55], 0
    ds_read_b64_tr_b16 v[72:73], v250 offset:8448
    v_mfma_f32_16x16x32_bf16 v[152:155], v[32:35], v[56:59], 0
    buffer_load_dwordx4 v230, s[16:19], s32 offen offset:2048 lds
    v_mfma_f32_16x16x32_bf16 v[156:159], v[32:35], v[60:63], 0
    ds_read_b128 v[32:35], v249 offset:8192
    s_waitcnt lgkmcnt(12)
    v_mfma_f32_16x16x32_bf16 v[160:163], v[36:39], v[48:51], 0
    v_mfma_f32_16x16x32_bf16 v[164:167], v[36:39], v[52:55], 0
    ds_read_b64_tr_b16 v[74:75], v250 offset:9472
    v_mfma_f32_16x16x32_bf16 v[168:171], v[36:39], v[56:59], 0
    v_mfma_f32_16x16x32_bf16 v[172:175], v[36:39], v[60:63], 0
    ds_read_b128 v[36:39], v249 offset:10240
    s_waitcnt lgkmcnt(13)
    v_mfma_f32_16x16x32_bf16 v[176:179], v[40:43], v[48:51], 0
    v_mfma_f32_16x16x32_bf16 v[180:183], v[40:43], v[52:55], 0
    ds_read_b64_tr_b16 v[76:77], v251 offset:8448
    v_mfma_f32_16x16x32_bf16 v[184:187], v[40:43], v[56:59], 0
    buffer_load_dwordx4 v231, s[16:19], s32 offen offset:3072 lds
    v_mfma_f32_16x16x32_bf16 v[188:191], v[40:43], v[60:63], 0
    ds_read_b128 v[40:43], v249 offset:12288
    s_waitcnt lgkmcnt(14)
    v_mfma_f32_16x16x32_bf16 v[192:195], v[44:47], v[48:51], 0
    v_mfma_f32_16x16x32_bf16 v[196:199], v[44:47], v[52:55], 0
    ds_read_b64_tr_b16 v[78:79], v251 offset:9472
    v_mfma_f32_16x16x32_bf16 v[200:203], v[44:47], v[56:59], 0
    v_mfma_f32_16x16x32_bf16 v[204:207], v[44:47], v[60:63], 0
    ds_read_b128 v[44:47], v249 offset:14336
    s_waitcnt lgkmcnt(13)
    v_mfma_f32_16x16x32_bf16 v[80:83], v[16:19], v[64:67], v[80:83]
    s_waitcnt lgkmcnt(9)
    v_mfma_f32_16x16x32_bf16 v[84:87], v[16:19], v[68:71], v[84:87]
    s_waitcnt lgkmcnt(5)
    v_mfma_f32_16x16x32_bf16 v[88:91], v[16:19], v[72:75], v[88:91]
    s_waitcnt lgkmcnt(1)
    v_mfma_f32_16x16x32_bf16 v[92:95], v[16:19], v[76:79], v[92:95]
    v_mfma_f32_16x16x32_bf16 v[96:99], v[20:23], v[64:67], v[96:99]
    v_mfma_f32_16x16x32_bf16 v[100:103], v[20:23], v[68:71], v[100:103]
    v_mfma_f32_16x16x32_bf16 v[104:107], v[20:23], v[72:75], v[104:107]
    v_mfma_f32_16x16x32_bf16 v[108:111], v[20:23], v[76:79], v[108:111]
    s_waitcnt lgkmcnt(0)
    s_waitcnt vmcnt(4)
    s_barrier
    s_add_u32 s28, s34, 65536
    s_add_u32 s29, s35, 98304
    v_add_u32 v248, s28, v244
    v_add_u32 v249, s28, v245
    v_add_u32 v250, s29, v246
    v_add_u32 v251, s29, v247
    v_mfma_f32_16x16x32_bf16 v[112:115], v[24:27], v[64:67], v[112:115]
    ds_read_b64_tr_b16 v[48:49], v250 offset:0
    ds_read_b64_tr_b16 v[50:51], v250 offset:1024
    v_mfma_f32_16x16x32_bf16 v[116:119], v[24:27], v[68:71], v[116:119]
    ds_read_b128 v[16:19], v248 offset:0
    ds_read_b64_tr_b16 v[52:53], v251 offset:0
    v_mfma_f32_16x16x32_bf16 v[120:123], v[24:27], v[72:75], v[120:123]
    ds_read_b64_tr_b16 v[54:55], v251 offset:1024
    ds_read_b128 v[20:23], v248 offset:2048
    s_add_u32 m0, s30, 0
    s_add_u32 s32, s31, 2
    s_and_b32 s32, s32, 7
    s_lshl_b32 s32, s32, 19
    buffer_load_dwordx4 v232, s[20:23], s32 offen offset:0 lds
    v_mfma_f32_16x16x32_bf16 v[124:127], v[24:27], v[76:79], v[124:127]
    ds_read_b128 v[24:27], v248 offset:4096
    v_mfma_f32_16x16x32_bf16 v[128:131], v[28:31], v[64:67], v[128:131]
    ds_read_b64_tr_b16 v[56:57], v250 offset:256
    v_mfma_f32_16x16x32_bf16 v[132:135], v[28:31], v[68:71], v[132:135]
    ds_read_b64_tr_b16 v[58:59], v250 offset:1280
    v_mfma_f32_16x16x32_bf16 v[136:139], v[28:31], v[72:75], v[136:139]
    ds_read_b64_tr_b16 v[60:61], v251 offset:256
    v_mfma_f32_16x16x32_bf16 v[140:143], v[28:31], v[76:79], v[140:143]
    ds_read_b128 v[28:31], v248 offset:6144
    v_mfma_f32_16x16x32_bf16 v[144:147], v[32:35], v[64:67], v[144:147]
    ds_read_b64_tr_b16 v[62:63], v251 offset:1280
    buffer_load_dwordx4 v233, s[20:23], s32 offen offset:1024 lds
    v_mfma_f32_16x16x32_bf16 v[148:151], v[32:35], v[68:71], v[148:151]
    v_mfma_f32_16x16x32_bf16 v[152:155], v[32:35], v[72:75], v[152:155]
    v_mfma_f32_16x16x32_bf16 v[156:159], v[32:35], v[76:79], v[156:159]
    ds_read_b128 v[32:35], v248 offset:8192
    v_mfma_f32_16x16x32_bf16 v[160:163], v[36:39], v[64:67], v[160:163]
    v_mfma_f32_16x16x32_bf16 v[164:167], v[36:39], v[68:71], v[164:167]
    v_mfma_f32_16x16x32_bf16 v[168:171], v[36:39], v[72:75], v[168:171]
    buffer_load_dwordx4 v234, s[20:23], s32 offen offset:2048 lds
    v_mfma_f32_16x16x32_bf16 v[172:175], v[36:39], v[76:79], v[172:175]
    ds_read_b128 v[36:39], v248 offset:10240
    v_mfma_f32_16x16x32_bf16 v[176:179], v[40:43], v[64:67], v[176:179]
    v_mfma_f32_16x16x32_bf16 v[180:183], v[40:43], v[68:71], v[180:183]
    v_mfma_f32_16x16x32_bf16 v[184:187], v[40:43], v[72:75], v[184:187]
    v_mfma_f32_16x16x32_bf16 v[188:191], v[40:43], v[76:79], v[188:191]
    ds_read_b128 v[40:43], v248 offset:12288
    v_mfma_f32_16x16x32_bf16 v[192:195], v[44:47], v[64:67], v[192:195]
    buffer_load_dwordx4 v235, s[20:23], s32 offen offset:3072 lds
    v_mfma_f32_16x16x32_bf16 v[196:199], v[44:47], v[68:71], v[196:199]
    v_mfma_f32_16x16x32_bf16 v[200:203], v[44:47], v[72:75], v[200:203]
    v_mfma_f32_16x16x32_bf16 v[204:207], v[44:47], v[76:79], v[204:207]
    ds_read_b128 v[44:47], v248 offset:14336
    s_waitcnt lgkmcnt(13)
    v_mfma_f32_16x16x32_bf16 v[80:83], v[16:19], v[48:51], v[80:83]
    s_waitcnt lgkmcnt(11)
    v_mfma_f32_16x16x32_bf16 v[84:87], v[16:19], v[52:55], v[84:87]
    ds_read_b64_tr_b16 v[64:65], v250 offset:8192
    s_waitcnt lgkmcnt(8)
    v_mfma_f32_16x16x32_bf16 v[88:91], v[16:19], v[56:59], v[88:91]
    s_add_u32 m0, s30, 32768
    s_add_u32 s32, s31, 3
    s_and_b32 s32, s32, 7
    s_lshl_b32 s32, s32, 7
    buffer_load_dwordx4 v228, s[16:19], s32 offen offset:0 lds
    s_waitcnt lgkmcnt(5)
    v_mfma_f32_16x16x32_bf16 v[92:95], v[16:19], v[60:63], v[92:95]
    ds_read_b128 v[16:19], v249 offset:0
    v_mfma_f32_16x16x32_bf16 v[96:99], v[20:23], v[48:51], v[96:99]
    v_mfma_f32_16x16x32_bf16 v[100:103], v[20:23], v[52:55], v[100:103]
    ds_read_b64_tr_b16 v[66:67], v250 offset:9216
    v_mfma_f32_16x16x32_bf16 v[104:107], v[20:23], v[56:59], v[104:107]
    v_mfma_f32_16x16x32_bf16 v[108:111], v[20:23], v[60:63], v[108:111]
    ds_read_b128 v[20:23], v249 offset:2048
    v_mfma_f32_16x16x32_bf16 v[112:115], v[24:27], v[48:51], v[112:115]
    v_mfma_f32_16x16x32_bf16 v[116:119], v[24:27], v[52:55], v[116:119]
    ds_read_b64_tr_b16 v[68:69], v251 offset:8192
    v_mfma_f32_16x16x32_bf16 v[120:123], v[24:27], v[56:59], v[120:123]
    buffer_load_dwordx4 v229, s[16:19], s32 offen offset:1024 lds
    v_mfma_f32_16x16x32_bf16 v[124:127], v[24:27], v[60:63], v[124:127]
    ds_read_b128 v[24:27], v249 offset:4096
    v_mfma_f32_16x16x32_bf16 v[128:131], v[28:31], v[48:51], v[128:131]
    v_mfma_f32_16x16x32_bf16 v[132:135], v[28:31], v[52:55], v[132:135]
    ds_read_b64_tr_b16 v[70:71], v251 offset:9216
    v_mfma_f32_16x16x32_bf16 v[136:139], v[28:31], v[56:59], v[136:139]
    v_mfma_f32_16x16x32_bf16 v[140:143], v[28:31], v[60:63], v[140:143]
    ds_read_b128 v[28:31], v249 offset:6144
    s_waitcnt lgkmcnt(11)
    v_mfma_f32_16x16x32_bf16 v[144:147], v[32:35], v[48:51], v[144:147]
    v_mfma_f32_16x16x32_bf16 v[148:151], v[32:35], v[52:55], v[148:151]
    ds_read_b64_tr_b16 v[72:73], v250 offset:8448
    v_mfma_f32_16x16x32_bf16 v[152:155], v[32:35], v[56:59], v[152:155]
    buffer_load_dwordx4 v230, s[16:19], s32 offen offset:2048 lds
    v_mfma_f32_16x16x32_bf16 v[156:159], v[32:35], v[60:63], v[156:159]
    ds_read_b128 v[32:35], v249 offset:8192
    s_waitcnt lgkmcnt(12)
    v_mfma_f32_16x16x32_bf16 v[160:163], v[36:39], v[48:51], v[160:163]
    v_mfma_f32_16x16x32_bf16 v[164:167], v[36:39], v[52:55], v[164:167]
    ds_read_b64_tr_b16 v[74:75], v250 offset:9472
    v_mfma_f32_16x16x32_bf16 v[168:171], v[36:39], v[56:59], v[168:171]
    v_mfma_f32_16x16x32_bf16 v[172:175], v[36:39], v[60:63], v[172:175]
    ds_read_b128 v[36:39], v249 offset:10240
    s_waitcnt lgkmcnt(13)
    v_mfma_f32_16x16x32_bf16 v[176:179], v[40:43], v[48:51], v[176:179]
    v_mfma_f32_16x16x32_bf16 v[180:183], v[40:43], v[52:55], v[180:183]
    ds_read_b64_tr_b16 v[76:77], v251 offset:8448
    v_mfma_f32_16x16x32_bf16 v[184:187], v[40:43], v[56:59], v[184:187]
    buffer_load_dwordx4 v231, s[16:19], s32 offen offset:3072 lds
    v_mfma_f32_16x16x32_bf16 v[188:191], v[40:43], v[60:63], v[188:191]
    ds_read_b128 v[40:43], v249 offset:12288
    s_waitcnt lgkmcnt(14)
    v_mfma_f32_16x16x32_bf16 v[192:195], v[44:47], v[48:51], v[192:195]
    v_mfma_f32_16x16x32_bf16 v[196:199], v[44:47], v[52:55], v[196:199]
    ds_read_b64_tr_b16 v[78:79], v251 offset:9472
    v_mfma_f32_16x16x32_bf16 v[200:203], v[44:47], v[56:59], v[200:203]
    buffer_load_dword v210, v219, s[56:59], 0 offen
    v_mfma_f32_16x16x32_bf16 v[204:207], v[44:47], v[60:63], v[204:207]
    ds_read_b128 v[44:47], v249 offset:14336
    s_waitcnt lgkmcnt(13)
    v_mfma_f32_16x16x32_bf16 v[80:83], v[16:19], v[64:67], v[80:83]
    s_waitcnt lgkmcnt(9)
    v_mfma_f32_16x16x32_bf16 v[84:87], v[16:19], v[68:71], v[84:87]
    s_waitcnt lgkmcnt(5)
    v_mfma_f32_16x16x32_bf16 v[88:91], v[16:19], v[72:75], v[88:91]
    s_waitcnt lgkmcnt(1)
    v_mfma_f32_16x16x32_bf16 v[92:95], v[16:19], v[76:79], v[92:95]
    v_mfma_f32_16x16x32_bf16 v[96:99], v[20:23], v[64:67], v[96:99]
    v_mfma_f32_16x16x32_bf16 v[100:103], v[20:23], v[68:71], v[100:103]
    v_mfma_f32_16x16x32_bf16 v[104:107], v[20:23], v[72:75], v[104:107]
    v_mfma_f32_16x16x32_bf16 v[108:111], v[20:23], v[76:79], v[108:111]
    s_waitcnt lgkmcnt(0)
    s_waitcnt vmcnt(5)
    s_barrier
    s_add_u32 s28, s34, 131072
    s_add_u32 s29, s35, 0
    v_add_u32 v248, s28, v244
    v_add_u32 v249, s28, v245
    v_add_u32 v250, s29, v246
    v_add_u32 v251, s29, v247
    v_mfma_f32_16x16x32_bf16 v[112:115], v[24:27], v[64:67], v[112:115]
    ds_read_b64_tr_b16 v[48:49], v250 offset:0
    ds_read_b64_tr_b16 v[50:51], v250 offset:1024
    v_mfma_f32_16x16x32_bf16 v[116:119], v[24:27], v[68:71], v[116:119]
    ds_read_b128 v[16:19], v248 offset:0
    ds_read_b64_tr_b16 v[52:53], v251 offset:0
    v_mfma_f32_16x16x32_bf16 v[120:123], v[24:27], v[72:75], v[120:123]
    ds_read_b64_tr_b16 v[54:55], v251 offset:1024
    ds_read_b128 v[20:23], v248 offset:2048
    s_add_u32 m0, s30, 65536
    s_add_u32 s32, s31, 3
    s_and_b32 s32, s32, 7
    s_lshl_b32 s32, s32, 19
    buffer_load_dwordx4 v232, s[20:23], s32 offen offset:0 lds
    v_mfma_f32_16x16x32_bf16 v[124:127], v[24:27], v[76:79], v[124:127]
    ds_read_b128 v[24:27], v248 offset:4096
    v_mfma_f32_16x16x32_bf16 v[128:131], v[28:31], v[64:67], v[128:131]
    ds_read_b64_tr_b16 v[56:57], v250 offset:256
    v_mfma_f32_16x16x32_bf16 v[132:135], v[28:31], v[68:71], v[132:135]
    ds_read_b64_tr_b16 v[58:59], v250 offset:1280
    v_mfma_f32_16x16x32_bf16 v[136:139], v[28:31], v[72:75], v[136:139]
    ds_read_b64_tr_b16 v[60:61], v251 offset:256
    v_mfma_f32_16x16x32_bf16 v[140:143], v[28:31], v[76:79], v[140:143]
    ds_read_b128 v[28:31], v248 offset:6144
    v_mfma_f32_16x16x32_bf16 v[144:147], v[32:35], v[64:67], v[144:147]
    ds_read_b64_tr_b16 v[62:63], v251 offset:1280
    buffer_load_dwordx4 v233, s[20:23], s32 offen offset:1024 lds
    v_mfma_f32_16x16x32_bf16 v[148:151], v[32:35], v[68:71], v[148:151]
    v_mfma_f32_16x16x32_bf16 v[152:155], v[32:35], v[72:75], v[152:155]
    v_mfma_f32_16x16x32_bf16 v[156:159], v[32:35], v[76:79], v[156:159]
    ds_read_b128 v[32:35], v248 offset:8192
    v_mfma_f32_16x16x32_bf16 v[160:163], v[36:39], v[64:67], v[160:163]
    v_mfma_f32_16x16x32_bf16 v[164:167], v[36:39], v[68:71], v[164:167]
    v_mfma_f32_16x16x32_bf16 v[168:171], v[36:39], v[72:75], v[168:171]
    buffer_load_dwordx4 v234, s[20:23], s32 offen offset:2048 lds
    v_mfma_f32_16x16x32_bf16 v[172:175], v[36:39], v[76:79], v[172:175]
    ds_read_b128 v[36:39], v248 offset:10240
    v_mfma_f32_16x16x32_bf16 v[176:179], v[40:43], v[64:67], v[176:179]
    v_mfma_f32_16x16x32_bf16 v[180:183], v[40:43], v[68:71], v[180:183]
    v_mfma_f32_16x16x32_bf16 v[184:187], v[40:43], v[72:75], v[184:187]
    v_mfma_f32_16x16x32_bf16 v[188:191], v[40:43], v[76:79], v[188:191]
    ds_read_b128 v[40:43], v248 offset:12288
    v_mfma_f32_16x16x32_bf16 v[192:195], v[44:47], v[64:67], v[192:195]
    buffer_load_dwordx4 v235, s[20:23], s32 offen offset:3072 lds
    v_mfma_f32_16x16x32_bf16 v[196:199], v[44:47], v[68:71], v[196:199]
    v_mfma_f32_16x16x32_bf16 v[200:203], v[44:47], v[72:75], v[200:203]
    v_mfma_f32_16x16x32_bf16 v[204:207], v[44:47], v[76:79], v[204:207]
    ds_read_b128 v[44:47], v248 offset:14336
    s_waitcnt lgkmcnt(13)
    v_mfma_f32_16x16x32_bf16 v[80:83], v[16:19], v[48:51], v[80:83]
    s_waitcnt lgkmcnt(11)
    v_mfma_f32_16x16x32_bf16 v[84:87], v[16:19], v[52:55], v[84:87]
    ds_read_b64_tr_b16 v[64:65], v250 offset:8192
    s_waitcnt lgkmcnt(8)
    v_mfma_f32_16x16x32_bf16 v[88:91], v[16:19], v[56:59], v[88:91]
    s_add_u32 m0, s30, 98304
    s_add_u32 s32, s31, 4
    s_and_b32 s32, s32, 7
    s_lshl_b32 s32, s32, 7
    buffer_load_dwordx4 v228, s[16:19], s32 offen offset:0 lds
    s_waitcnt lgkmcnt(5)
    v_mfma_f32_16x16x32_bf16 v[92:95], v[16:19], v[60:63], v[92:95]
    ds_read_b128 v[16:19], v249 offset:0
    v_mfma_f32_16x16x32_bf16 v[96:99], v[20:23], v[48:51], v[96:99]
    v_mfma_f32_16x16x32_bf16 v[100:103], v[20:23], v[52:55], v[100:103]
    ds_read_b64_tr_b16 v[66:67], v250 offset:9216
    v_mfma_f32_16x16x32_bf16 v[104:107], v[20:23], v[56:59], v[104:107]
    v_mfma_f32_16x16x32_bf16 v[108:111], v[20:23], v[60:63], v[108:111]
    ds_read_b128 v[20:23], v249 offset:2048
    v_mfma_f32_16x16x32_bf16 v[112:115], v[24:27], v[48:51], v[112:115]
    v_mfma_f32_16x16x32_bf16 v[116:119], v[24:27], v[52:55], v[116:119]
    ds_read_b64_tr_b16 v[68:69], v251 offset:8192
    v_mfma_f32_16x16x32_bf16 v[120:123], v[24:27], v[56:59], v[120:123]
    buffer_load_dwordx4 v229, s[16:19], s32 offen offset:1024 lds
    v_mfma_f32_16x16x32_bf16 v[124:127], v[24:27], v[60:63], v[124:127]
    ds_read_b128 v[24:27], v249 offset:4096
    v_mfma_f32_16x16x32_bf16 v[128:131], v[28:31], v[48:51], v[128:131]
    v_mfma_f32_16x16x32_bf16 v[132:135], v[28:31], v[52:55], v[132:135]
    ds_read_b64_tr_b16 v[70:71], v251 offset:9216
    v_mfma_f32_16x16x32_bf16 v[136:139], v[28:31], v[56:59], v[136:139]
    v_mfma_f32_16x16x32_bf16 v[140:143], v[28:31], v[60:63], v[140:143]
    ds_read_b128 v[28:31], v249 offset:6144
    s_waitcnt lgkmcnt(11)
    v_mfma_f32_16x16x32_bf16 v[144:147], v[32:35], v[48:51], v[144:147]
    v_mfma_f32_16x16x32_bf16 v[148:151], v[32:35], v[52:55], v[148:151]
    ds_read_b64_tr_b16 v[72:73], v250 offset:8448
    v_mfma_f32_16x16x32_bf16 v[152:155], v[32:35], v[56:59], v[152:155]
    buffer_load_dwordx4 v230, s[16:19], s32 offen offset:2048 lds
    v_mfma_f32_16x16x32_bf16 v[156:159], v[32:35], v[60:63], v[156:159]
    ds_read_b128 v[32:35], v249 offset:8192
    s_waitcnt lgkmcnt(12)
    v_mfma_f32_16x16x32_bf16 v[160:163], v[36:39], v[48:51], v[160:163]
    v_mfma_f32_16x16x32_bf16 v[164:167], v[36:39], v[52:55], v[164:167]
    ds_read_b64_tr_b16 v[74:75], v250 offset:9472
    v_mfma_f32_16x16x32_bf16 v[168:171], v[36:39], v[56:59], v[168:171]
    v_mfma_f32_16x16x32_bf16 v[172:175], v[36:39], v[60:63], v[172:175]
    ds_read_b128 v[36:39], v249 offset:10240
    s_waitcnt lgkmcnt(13)
    v_mfma_f32_16x16x32_bf16 v[176:179], v[40:43], v[48:51], v[176:179]
    v_mfma_f32_16x16x32_bf16 v[180:183], v[40:43], v[52:55], v[180:183]
    ds_read_b64_tr_b16 v[76:77], v251 offset:8448
    v_mfma_f32_16x16x32_bf16 v[184:187], v[40:43], v[56:59], v[184:187]
    buffer_load_dwordx4 v231, s[16:19], s32 offen offset:3072 lds
    v_mfma_f32_16x16x32_bf16 v[188:191], v[40:43], v[60:63], v[188:191]
    ds_read_b128 v[40:43], v249 offset:12288
    s_waitcnt lgkmcnt(14)
    v_mfma_f32_16x16x32_bf16 v[192:195], v[44:47], v[48:51], v[192:195]
    v_mfma_f32_16x16x32_bf16 v[196:199], v[44:47], v[52:55], v[196:199]
    ds_read_b64_tr_b16 v[78:79], v251 offset:9472
    v_mfma_f32_16x16x32_bf16 v[200:203], v[44:47], v[56:59], v[200:203]
    s_mov_b32 s101, 32768
    buffer_load_dword v212, v219, s[56:59], s101 offen
    v_mfma_f32_16x16x32_bf16 v[204:207], v[44:47], v[60:63], v[204:207]
    ds_read_b128 v[44:47], v249 offset:14336
    s_waitcnt lgkmcnt(13)
    v_mfma_f32_16x16x32_bf16 v[80:83], v[16:19], v[64:67], v[80:83]
    s_waitcnt lgkmcnt(9)
    v_mfma_f32_16x16x32_bf16 v[84:87], v[16:19], v[68:71], v[84:87]
    s_waitcnt lgkmcnt(5)
    v_mfma_f32_16x16x32_bf16 v[88:91], v[16:19], v[72:75], v[88:91]
    s_waitcnt lgkmcnt(1)
    v_mfma_f32_16x16x32_bf16 v[92:95], v[16:19], v[76:79], v[92:95]
    v_mfma_f32_16x16x32_bf16 v[96:99], v[20:23], v[64:67], v[96:99]
    v_mfma_f32_16x16x32_bf16 v[100:103], v[20:23], v[68:71], v[100:103]
    v_mfma_f32_16x16x32_bf16 v[104:107], v[20:23], v[72:75], v[104:107]
    v_mfma_f32_16x16x32_bf16 v[108:111], v[20:23], v[76:79], v[108:111]
    s_waitcnt lgkmcnt(0)
    s_waitcnt vmcnt(5)
    s_barrier
    s_add_u32 s28, s34, 32768
    s_add_u32 s29, s35, 65536
    v_add_u32 v248, s28, v244
    v_add_u32 v249, s28, v245
    v_add_u32 v250, s29, v246
    v_add_u32 v251, s29, v247
    v_mfma_f32_16x16x32_bf16 v[112:115], v[24:27], v[64:67], v[112:115]
    ds_read_b64_tr_b16 v[48:49], v250 offset:0
    ds_read_b64_tr_b16 v[50:51], v250 offset:1024
    v_mfma_f32_16x16x32_bf16 v[116:119], v[24:27], v[68:71], v[116:119]
    ds_read_b128 v[16:19], v248 offset:0
    ds_read_b64_tr_b16 v[52:53], v251 offset:0
    v_mfma_f32_16x16x32_bf16 v[120:123], v[24:27], v[72:75], v[120:123]
    ds_read_b64_tr_b16 v[54:55], v251 offset:1024
    ds_read_b128 v[20:23], v248 offset:2048
    s_add_u32 m0, s30, 131072
    s_add_u32 s32, s31, 4
    s_and_b32 s32, s32, 7
    s_lshl_b32 s32, s32, 19
    buffer_load_dwordx4 v232, s[20:23], s32 offen offset:0 lds
    v_mfma_f32_16x16x32_bf16 v[124:127], v[24:27], v[76:79], v[124:127]
    ds_read_b128 v[24:27], v248 offset:4096
    v_mfma_f32_16x16x32_bf16 v[128:131], v[28:31], v[64:67], v[128:131]
    ds_read_b64_tr_b16 v[56:57], v250 offset:256
    v_mfma_f32_16x16x32_bf16 v[132:135], v[28:31], v[68:71], v[132:135]
    ds_read_b64_tr_b16 v[58:59], v250 offset:1280
    v_mfma_f32_16x16x32_bf16 v[136:139], v[28:31], v[72:75], v[136:139]
    ds_read_b64_tr_b16 v[60:61], v251 offset:256
    v_mfma_f32_16x16x32_bf16 v[140:143], v[28:31], v[76:79], v[140:143]
    ds_read_b128 v[28:31], v248 offset:6144
    v_mfma_f32_16x16x32_bf16 v[144:147], v[32:35], v[64:67], v[144:147]
    ds_read_b64_tr_b16 v[62:63], v251 offset:1280
    buffer_load_dwordx4 v233, s[20:23], s32 offen offset:1024 lds
    v_mfma_f32_16x16x32_bf16 v[148:151], v[32:35], v[68:71], v[148:151]
    v_mfma_f32_16x16x32_bf16 v[152:155], v[32:35], v[72:75], v[152:155]
    v_mfma_f32_16x16x32_bf16 v[156:159], v[32:35], v[76:79], v[156:159]
    ds_read_b128 v[32:35], v248 offset:8192
    v_mfma_f32_16x16x32_bf16 v[160:163], v[36:39], v[64:67], v[160:163]
    v_mfma_f32_16x16x32_bf16 v[164:167], v[36:39], v[68:71], v[164:167]
    v_mfma_f32_16x16x32_bf16 v[168:171], v[36:39], v[72:75], v[168:171]
    buffer_load_dwordx4 v234, s[20:23], s32 offen offset:2048 lds
    v_mfma_f32_16x16x32_bf16 v[172:175], v[36:39], v[76:79], v[172:175]
    ds_read_b128 v[36:39], v248 offset:10240
    v_mfma_f32_16x16x32_bf16 v[176:179], v[40:43], v[64:67], v[176:179]
    v_mfma_f32_16x16x32_bf16 v[180:183], v[40:43], v[68:71], v[180:183]
    v_mfma_f32_16x16x32_bf16 v[184:187], v[40:43], v[72:75], v[184:187]
    v_mfma_f32_16x16x32_bf16 v[188:191], v[40:43], v[76:79], v[188:191]
    ds_read_b128 v[40:43], v248 offset:12288
    v_mfma_f32_16x16x32_bf16 v[192:195], v[44:47], v[64:67], v[192:195]
    buffer_load_dwordx4 v235, s[20:23], s32 offen offset:3072 lds
    v_mfma_f32_16x16x32_bf16 v[196:199], v[44:47], v[68:71], v[196:199]
    v_mfma_f32_16x16x32_bf16 v[200:203], v[44:47], v[72:75], v[200:203]
    v_mfma_f32_16x16x32_bf16 v[204:207], v[44:47], v[76:79], v[204:207]
    ds_read_b128 v[44:47], v248 offset:14336
    s_waitcnt lgkmcnt(13)
    v_mfma_f32_16x16x32_bf16 v[80:83], v[16:19], v[48:51], v[80:83]
    s_waitcnt lgkmcnt(11)
    v_mfma_f32_16x16x32_bf16 v[84:87], v[16:19], v[52:55], v[84:87]
    ds_read_b64_tr_b16 v[64:65], v250 offset:8192
    s_waitcnt lgkmcnt(8)
    v_mfma_f32_16x16x32_bf16 v[88:91], v[16:19], v[56:59], v[88:91]
    s_add_u32 m0, s30, 0
    s_add_u32 s32, s31, 5
    s_and_b32 s32, s32, 7
    s_lshl_b32 s32, s32, 7
    buffer_load_dwordx4 v228, s[16:19], s32 offen offset:0 lds
    s_waitcnt lgkmcnt(5)
    v_mfma_f32_16x16x32_bf16 v[92:95], v[16:19], v[60:63], v[92:95]
    ds_read_b128 v[16:19], v249 offset:0
    v_mfma_f32_16x16x32_bf16 v[96:99], v[20:23], v[48:51], v[96:99]
    v_mfma_f32_16x16x32_bf16 v[100:103], v[20:23], v[52:55], v[100:103]
    ds_read_b64_tr_b16 v[66:67], v250 offset:9216
    v_mfma_f32_16x16x32_bf16 v[104:107], v[20:23], v[56:59], v[104:107]
    v_mfma_f32_16x16x32_bf16 v[108:111], v[20:23], v[60:63], v[108:111]
    ds_read_b128 v[20:23], v249 offset:2048
    v_mfma_f32_16x16x32_bf16 v[112:115], v[24:27], v[48:51], v[112:115]
    v_mfma_f32_16x16x32_bf16 v[116:119], v[24:27], v[52:55], v[116:119]
    ds_read_b64_tr_b16 v[68:69], v251 offset:8192
    v_mfma_f32_16x16x32_bf16 v[120:123], v[24:27], v[56:59], v[120:123]
    buffer_load_dwordx4 v229, s[16:19], s32 offen offset:1024 lds
    v_mfma_f32_16x16x32_bf16 v[124:127], v[24:27], v[60:63], v[124:127]
    ds_read_b128 v[24:27], v249 offset:4096
    v_mfma_f32_16x16x32_bf16 v[128:131], v[28:31], v[48:51], v[128:131]
    v_mfma_f32_16x16x32_bf16 v[132:135], v[28:31], v[52:55], v[132:135]
    ds_read_b64_tr_b16 v[70:71], v251 offset:9216
    v_mfma_f32_16x16x32_bf16 v[136:139], v[28:31], v[56:59], v[136:139]
    v_mfma_f32_16x16x32_bf16 v[140:143], v[28:31], v[60:63], v[140:143]
    ds_read_b128 v[28:31], v249 offset:6144
    s_waitcnt lgkmcnt(11)
    v_mfma_f32_16x16x32_bf16 v[144:147], v[32:35], v[48:51], v[144:147]
    v_mfma_f32_16x16x32_bf16 v[148:151], v[32:35], v[52:55], v[148:151]
    ds_read_b64_tr_b16 v[72:73], v250 offset:8448
    v_mfma_f32_16x16x32_bf16 v[152:155], v[32:35], v[56:59], v[152:155]
    buffer_load_dwordx4 v230, s[16:19], s32 offen offset:2048 lds
    v_mfma_f32_16x16x32_bf16 v[156:159], v[32:35], v[60:63], v[156:159]
    ds_read_b128 v[32:35], v249 offset:8192
    s_waitcnt lgkmcnt(12)
    v_mfma_f32_16x16x32_bf16 v[160:163], v[36:39], v[48:51], v[160:163]
    v_mfma_f32_16x16x32_bf16 v[164:167], v[36:39], v[52:55], v[164:167]
    ds_read_b64_tr_b16 v[74:75], v250 offset:9472
    v_mfma_f32_16x16x32_bf16 v[168:171], v[36:39], v[56:59], v[168:171]
    v_mfma_f32_16x16x32_bf16 v[172:175], v[36:39], v[60:63], v[172:175]
    ds_read_b128 v[36:39], v249 offset:10240
    s_waitcnt lgkmcnt(13)
    v_mfma_f32_16x16x32_bf16 v[176:179], v[40:43], v[48:51], v[176:179]
    v_mfma_f32_16x16x32_bf16 v[180:183], v[40:43], v[52:55], v[180:183]
    ds_read_b64_tr_b16 v[76:77], v251 offset:8448
    v_mfma_f32_16x16x32_bf16 v[184:187], v[40:43], v[56:59], v[184:187]
    buffer_load_dwordx4 v231, s[16:19], s32 offen offset:3072 lds
    v_mfma_f32_16x16x32_bf16 v[188:191], v[40:43], v[60:63], v[188:191]
    ds_read_b128 v[40:43], v249 offset:12288
    s_waitcnt lgkmcnt(14)
    v_mfma_f32_16x16x32_bf16 v[192:195], v[44:47], v[48:51], v[192:195]
    v_mfma_f32_16x16x32_bf16 v[196:199], v[44:47], v[52:55], v[196:199]
    ds_read_b64_tr_b16 v[78:79], v251 offset:9472
    v_mfma_f32_16x16x32_bf16 v[200:203], v[44:47], v[56:59], v[200:203]
    s_mov_b32 s101, 65536
    buffer_load_dword v214, v219, s[56:59], s101 offen
    v_mfma_f32_16x16x32_bf16 v[204:207], v[44:47], v[60:63], v[204:207]
    ds_read_b128 v[44:47], v249 offset:14336
    s_waitcnt lgkmcnt(13)
    v_mfma_f32_16x16x32_bf16 v[80:83], v[16:19], v[64:67], v[80:83]
    s_waitcnt lgkmcnt(9)
    v_mfma_f32_16x16x32_bf16 v[84:87], v[16:19], v[68:71], v[84:87]
    s_waitcnt lgkmcnt(5)
    v_mfma_f32_16x16x32_bf16 v[88:91], v[16:19], v[72:75], v[88:91]
    s_waitcnt lgkmcnt(1)
    v_mfma_f32_16x16x32_bf16 v[92:95], v[16:19], v[76:79], v[92:95]
    v_mfma_f32_16x16x32_bf16 v[96:99], v[20:23], v[64:67], v[96:99]
    v_mfma_f32_16x16x32_bf16 v[100:103], v[20:23], v[68:71], v[100:103]
    v_mfma_f32_16x16x32_bf16 v[104:107], v[20:23], v[72:75], v[104:107]
    v_mfma_f32_16x16x32_bf16 v[108:111], v[20:23], v[76:79], v[108:111]
    s_waitcnt lgkmcnt(0)
    s_waitcnt vmcnt(5)
    s_barrier
    s_add_u32 s28, s34, 98304
    s_add_u32 s29, s35, 131072
    v_add_u32 v248, s28, v244
    v_add_u32 v249, s28, v245
    v_add_u32 v250, s29, v246
    v_add_u32 v251, s29, v247
    v_mfma_f32_16x16x32_bf16 v[112:115], v[24:27], v[64:67], v[112:115]
    ds_read_b64_tr_b16 v[48:49], v250 offset:0
    ds_read_b64_tr_b16 v[50:51], v250 offset:1024
    v_mfma_f32_16x16x32_bf16 v[116:119], v[24:27], v[68:71], v[116:119]
    ds_read_b128 v[16:19], v248 offset:0
    ds_read_b64_tr_b16 v[52:53], v251 offset:0
    v_mfma_f32_16x16x32_bf16 v[120:123], v[24:27], v[72:75], v[120:123]
    ds_read_b64_tr_b16 v[54:55], v251 offset:1024
    ds_read_b128 v[20:23], v248 offset:2048
    s_add_u32 m0, s30, 32768
    s_add_u32 s32, s31, 5
    s_and_b32 s32, s32, 7
    s_lshl_b32 s32, s32, 19
    buffer_load_dwordx4 v232, s[20:23], s32 offen offset:0 lds
    v_mfma_f32_16x16x32_bf16 v[124:127], v[24:27], v[76:79], v[124:127]
    ds_read_b128 v[24:27], v248 offset:4096
    v_mfma_f32_16x16x32_bf16 v[128:131], v[28:31], v[64:67], v[128:131]
    ds_read_b64_tr_b16 v[56:57], v250 offset:256
    v_mfma_f32_16x16x32_bf16 v[132:135], v[28:31], v[68:71], v[132:135]
    ds_read_b64_tr_b16 v[58:59], v250 offset:1280
    v_mfma_f32_16x16x32_bf16 v[136:139], v[28:31], v[72:75], v[136:139]
    ds_read_b64_tr_b16 v[60:61], v251 offset:256
    v_mfma_f32_16x16x32_bf16 v[140:143], v[28:31], v[76:79], v[140:143]
    ds_read_b128 v[28:31], v248 offset:6144
    v_mfma_f32_16x16x32_bf16 v[144:147], v[32:35], v[64:67], v[144:147]
    ds_read_b64_tr_b16 v[62:63], v251 offset:1280
    buffer_load_dwordx4 v233, s[20:23], s32 offen offset:1024 lds
    v_mfma_f32_16x16x32_bf16 v[148:151], v[32:35], v[68:71], v[148:151]
    v_mfma_f32_16x16x32_bf16 v[152:155], v[32:35], v[72:75], v[152:155]
    v_mfma_f32_16x16x32_bf16 v[156:159], v[32:35], v[76:79], v[156:159]
    ds_read_b128 v[32:35], v248 offset:8192
    v_mfma_f32_16x16x32_bf16 v[160:163], v[36:39], v[64:67], v[160:163]
    v_mfma_f32_16x16x32_bf16 v[164:167], v[36:39], v[68:71], v[164:167]
    v_mfma_f32_16x16x32_bf16 v[168:171], v[36:39], v[72:75], v[168:171]
    buffer_load_dwordx4 v234, s[20:23], s32 offen offset:2048 lds
    v_mfma_f32_16x16x32_bf16 v[172:175], v[36:39], v[76:79], v[172:175]
    ds_read_b128 v[36:39], v248 offset:10240
    v_mfma_f32_16x16x32_bf16 v[176:179], v[40:43], v[64:67], v[176:179]
    v_mfma_f32_16x16x32_bf16 v[180:183], v[40:43], v[68:71], v[180:183]
    v_mfma_f32_16x16x32_bf16 v[184:187], v[40:43], v[72:75], v[184:187]
    v_mfma_f32_16x16x32_bf16 v[188:191], v[40:43], v[76:79], v[188:191]
    ds_read_b128 v[40:43], v248 offset:12288
    v_mfma_f32_16x16x32_bf16 v[192:195], v[44:47], v[64:67], v[192:195]
    buffer_load_dwordx4 v235, s[20:23], s32 offen offset:3072 lds
    v_mfma_f32_16x16x32_bf16 v[196:199], v[44:47], v[68:71], v[196:199]
    v_mfma_f32_16x16x32_bf16 v[200:203], v[44:47], v[72:75], v[200:203]
    v_mfma_f32_16x16x32_bf16 v[204:207], v[44:47], v[76:79], v[204:207]
    ds_read_b128 v[44:47], v248 offset:14336
    s_waitcnt lgkmcnt(13)
    v_mfma_f32_16x16x32_bf16 v[80:83], v[16:19], v[48:51], v[80:83]
    s_waitcnt lgkmcnt(11)
    v_mfma_f32_16x16x32_bf16 v[84:87], v[16:19], v[52:55], v[84:87]
    ds_read_b64_tr_b16 v[64:65], v250 offset:8192
    s_waitcnt lgkmcnt(8)
    v_mfma_f32_16x16x32_bf16 v[88:91], v[16:19], v[56:59], v[88:91]
    s_add_u32 m0, s30, 65536
    s_add_u32 s32, s31, 6
    s_and_b32 s32, s32, 7
    s_lshl_b32 s32, s32, 7
    buffer_load_dwordx4 v228, s[16:19], s32 offen offset:0 lds
    s_waitcnt lgkmcnt(5)
    v_mfma_f32_16x16x32_bf16 v[92:95], v[16:19], v[60:63], v[92:95]
    ds_read_b128 v[16:19], v249 offset:0
    v_mfma_f32_16x16x32_bf16 v[96:99], v[20:23], v[48:51], v[96:99]
    v_mfma_f32_16x16x32_bf16 v[100:103], v[20:23], v[52:55], v[100:103]
    ds_read_b64_tr_b16 v[66:67], v250 offset:9216
    v_mfma_f32_16x16x32_bf16 v[104:107], v[20:23], v[56:59], v[104:107]
    v_mfma_f32_16x16x32_bf16 v[108:111], v[20:23], v[60:63], v[108:111]
    ds_read_b128 v[20:23], v249 offset:2048
    v_mfma_f32_16x16x32_bf16 v[112:115], v[24:27], v[48:51], v[112:115]
    v_mfma_f32_16x16x32_bf16 v[116:119], v[24:27], v[52:55], v[116:119]
    ds_read_b64_tr_b16 v[68:69], v251 offset:8192
    v_mfma_f32_16x16x32_bf16 v[120:123], v[24:27], v[56:59], v[120:123]
    buffer_load_dwordx4 v229, s[16:19], s32 offen offset:1024 lds
    v_mfma_f32_16x16x32_bf16 v[124:127], v[24:27], v[60:63], v[124:127]
    ds_read_b128 v[24:27], v249 offset:4096
    v_mfma_f32_16x16x32_bf16 v[128:131], v[28:31], v[48:51], v[128:131]
    v_mfma_f32_16x16x32_bf16 v[132:135], v[28:31], v[52:55], v[132:135]
    ds_read_b64_tr_b16 v[70:71], v251 offset:9216
    v_mfma_f32_16x16x32_bf16 v[136:139], v[28:31], v[56:59], v[136:139]
    v_mfma_f32_16x16x32_bf16 v[140:143], v[28:31], v[60:63], v[140:143]
    ds_read_b128 v[28:31], v249 offset:6144
    s_waitcnt lgkmcnt(11)
    v_mfma_f32_16x16x32_bf16 v[144:147], v[32:35], v[48:51], v[144:147]
    v_mfma_f32_16x16x32_bf16 v[148:151], v[32:35], v[52:55], v[148:151]
    ds_read_b64_tr_b16 v[72:73], v250 offset:8448
    v_mfma_f32_16x16x32_bf16 v[152:155], v[32:35], v[56:59], v[152:155]
    buffer_load_dwordx4 v230, s[16:19], s32 offen offset:2048 lds
    v_mfma_f32_16x16x32_bf16 v[156:159], v[32:35], v[60:63], v[156:159]
    ds_read_b128 v[32:35], v249 offset:8192
    s_waitcnt lgkmcnt(12)
    v_mfma_f32_16x16x32_bf16 v[160:163], v[36:39], v[48:51], v[160:163]
    v_mfma_f32_16x16x32_bf16 v[164:167], v[36:39], v[52:55], v[164:167]
    ds_read_b64_tr_b16 v[74:75], v250 offset:9472
    v_mfma_f32_16x16x32_bf16 v[168:171], v[36:39], v[56:59], v[168:171]
    v_mfma_f32_16x16x32_bf16 v[172:175], v[36:39], v[60:63], v[172:175]
    ds_read_b128 v[36:39], v249 offset:10240
    s_waitcnt lgkmcnt(13)
    v_mfma_f32_16x16x32_bf16 v[176:179], v[40:43], v[48:51], v[176:179]
    v_mfma_f32_16x16x32_bf16 v[180:183], v[40:43], v[52:55], v[180:183]
    ds_read_b64_tr_b16 v[76:77], v251 offset:8448
    v_mfma_f32_16x16x32_bf16 v[184:187], v[40:43], v[56:59], v[184:187]
    buffer_load_dwordx4 v231, s[16:19], s32 offen offset:3072 lds
    v_mfma_f32_16x16x32_bf16 v[188:191], v[40:43], v[60:63], v[188:191]
    ds_read_b128 v[40:43], v249 offset:12288
    s_waitcnt lgkmcnt(14)
    v_mfma_f32_16x16x32_bf16 v[192:195], v[44:47], v[48:51], v[192:195]
    v_mfma_f32_16x16x32_bf16 v[196:199], v[44:47], v[52:55], v[196:199]
    ds_read_b64_tr_b16 v[78:79], v251 offset:9472
    v_mfma_f32_16x16x32_bf16 v[200:203], v[44:47], v[56:59], v[200:203]
    s_mov_b32 s101, 98304
    buffer_load_dword v208, v219, s[56:59], s101 offen
    v_mfma_f32_16x16x32_bf16 v[204:207], v[44:47], v[60:63], v[204:207]
    ds_read_b128 v[44:47], v249 offset:14336
    s_waitcnt lgkmcnt(13)
    v_mfma_f32_16x16x32_bf16 v[80:83], v[16:19], v[64:67], v[80:83]
    s_waitcnt lgkmcnt(9)
    v_mfma_f32_16x16x32_bf16 v[84:87], v[16:19], v[68:71], v[84:87]
    s_waitcnt lgkmcnt(5)
    v_mfma_f32_16x16x32_bf16 v[88:91], v[16:19], v[72:75], v[88:91]
    s_waitcnt lgkmcnt(1)
    v_mfma_f32_16x16x32_bf16 v[92:95], v[16:19], v[76:79], v[92:95]
    v_mfma_f32_16x16x32_bf16 v[96:99], v[20:23], v[64:67], v[96:99]
    v_mfma_f32_16x16x32_bf16 v[100:103], v[20:23], v[68:71], v[100:103]
    v_mfma_f32_16x16x32_bf16 v[104:107], v[20:23], v[72:75], v[104:107]
    v_mfma_f32_16x16x32_bf16 v[108:111], v[20:23], v[76:79], v[108:111]
    s_waitcnt lgkmcnt(0)
    s_waitcnt vmcnt(5)
    s_barrier
    s_add_u32 s28, s34, 0
    s_add_u32 s29, s35, 32768
    v_add_u32 v248, s28, v244
    v_add_u32 v249, s28, v245
    v_add_u32 v250, s29, v246
    v_add_u32 v251, s29, v247
    v_mfma_f32_16x16x32_bf16 v[112:115], v[24:27], v[64:67], v[112:115]
    ds_read_b64_tr_b16 v[48:49], v250 offset:0
    ds_read_b64_tr_b16 v[50:51], v250 offset:1024
    v_mfma_f32_16x16x32_bf16 v[116:119], v[24:27], v[68:71], v[116:119]
    ds_read_b128 v[16:19], v248 offset:0
    ds_read_b64_tr_b16 v[52:53], v251 offset:0
    v_mfma_f32_16x16x32_bf16 v[120:123], v[24:27], v[72:75], v[120:123]
    ds_read_b64_tr_b16 v[54:55], v251 offset:1024
    ds_read_b128 v[20:23], v248 offset:2048
    s_add_u32 m0, s30, 98304
    s_add_u32 s32, s31, 6
    s_and_b32 s32, s32, 7
    s_lshl_b32 s32, s32, 19
    buffer_load_dwordx4 v232, s[20:23], s32 offen offset:0 lds
    v_mfma_f32_16x16x32_bf16 v[124:127], v[24:27], v[76:79], v[124:127]
    ds_read_b128 v[24:27], v248 offset:4096
    v_mfma_f32_16x16x32_bf16 v[128:131], v[28:31], v[64:67], v[128:131]
    ds_read_b64_tr_b16 v[56:57], v250 offset:256
    v_mfma_f32_16x16x32_bf16 v[132:135], v[28:31], v[68:71], v[132:135]
    ds_read_b64_tr_b16 v[58:59], v250 offset:1280
    v_mfma_f32_16x16x32_bf16 v[136:139], v[28:31], v[72:75], v[136:139]
    ds_read_b64_tr_b16 v[60:61], v251 offset:256
    v_mfma_f32_16x16x32_bf16 v[140:143], v[28:31], v[76:79], v[140:143]
    ds_read_b128 v[28:31], v248 offset:6144
    v_mfma_f32_16x16x32_bf16 v[144:147], v[32:35], v[64:67], v[144:147]
    ds_read_b64_tr_b16 v[62:63], v251 offset:1280
    buffer_load_dwordx4 v233, s[20:23], s32 offen offset:1024 lds
    v_mfma_f32_16x16x32_bf16 v[148:151], v[32:35], v[68:71], v[148:151]
    v_mfma_f32_16x16x32_bf16 v[152:155], v[32:35], v[72:75], v[152:155]
    v_mfma_f32_16x16x32_bf16 v[156:159], v[32:35], v[76:79], v[156:159]
    ds_read_b128 v[32:35], v248 offset:8192
    v_mfma_f32_16x16x32_bf16 v[160:163], v[36:39], v[64:67], v[160:163]
    v_mfma_f32_16x16x32_bf16 v[164:167], v[36:39], v[68:71], v[164:167]
    v_mfma_f32_16x16x32_bf16 v[168:171], v[36:39], v[72:75], v[168:171]
    buffer_load_dwordx4 v234, s[20:23], s32 offen offset:2048 lds
    v_mfma_f32_16x16x32_bf16 v[172:175], v[36:39], v[76:79], v[172:175]
    ds_read_b128 v[36:39], v248 offset:10240
    v_mfma_f32_16x16x32_bf16 v[176:179], v[40:43], v[64:67], v[176:179]
    v_mfma_f32_16x16x32_bf16 v[180:183], v[40:43], v[68:71], v[180:183]
    v_mfma_f32_16x16x32_bf16 v[184:187], v[40:43], v[72:75], v[184:187]
    v_mfma_f32_16x16x32_bf16 v[188:191], v[40:43], v[76:79], v[188:191]
    ds_read_b128 v[40:43], v248 offset:12288
    v_mfma_f32_16x16x32_bf16 v[192:195], v[44:47], v[64:67], v[192:195]
    buffer_load_dwordx4 v235, s[20:23], s32 offen offset:3072 lds
    v_mfma_f32_16x16x32_bf16 v[196:199], v[44:47], v[68:71], v[196:199]
    v_mfma_f32_16x16x32_bf16 v[200:203], v[44:47], v[72:75], v[200:203]
    v_mfma_f32_16x16x32_bf16 v[204:207], v[44:47], v[76:79], v[204:207]
    ds_read_b128 v[44:47], v248 offset:14336
    s_waitcnt lgkmcnt(13)
    v_mfma_f32_16x16x32_bf16 v[80:83], v[16:19], v[48:51], v[80:83]
    s_cmp_lg_u32 s3, 4
    s_cbranch_scc1 noeld_6
    buffer_load_dwordx2 v[222:223], v220, s[60:63], 0 offen sc1
noeld_6:
    s_waitcnt lgkmcnt(11)
    v_mfma_f32_16x16x32_bf16 v[84:87], v[16:19], v[52:55], v[84:87]
    ds_read_b64_tr_b16 v[64:65], v250 offset:8192
    s_waitcnt lgkmcnt(8)
    v_mfma_f32_16x16x32_bf16 v[88:91], v[16:19], v[56:59], v[88:91]
    s_add_u32 m0, s30, 131072
    s_add_u32 s32, s31, 7
    s_and_b32 s32, s32, 7
    s_lshl_b32 s32, s32, 7
    buffer_load_dwordx4 v228, s[16:19], s32 offen offset:0 lds
    s_waitcnt lgkmcnt(5)
    v_mfma_f32_16x16x32_bf16 v[92:95], v[16:19], v[60:63], v[92:95]
    ds_read_b128 v[16:19], v249 offset:0
    v_mfma_f32_16x16x32_bf16 v[96:99], v[20:23], v[48:51], v[96:99]
    v_mfma_f32_16x16x32_bf16 v[100:103], v[20:23], v[52:55], v[100:103]
    ds_read_b64_tr_b16 v[66:67], v250 offset:9216
    v_mfma_f32_16x16x32_bf16 v[104:107], v[20:23], v[56:59], v[104:107]
    v_mfma_f32_16x16x32_bf16 v[108:111], v[20:23], v[60:63], v[108:111]
    ds_read_b128 v[20:23], v249 offset:2048
    v_mfma_f32_16x16x32_bf16 v[112:115], v[24:27], v[48:51], v[112:115]
    v_mfma_f32_16x16x32_bf16 v[116:119], v[24:27], v[52:55], v[116:119]
    ds_read_b64_tr_b16 v[68:69], v251 offset:8192
    v_mfma_f32_16x16x32_bf16 v[120:123], v[24:27], v[56:59], v[120:123]
    buffer_load_dwordx4 v229, s[16:19], s32 offen offset:1024 lds
    v_mfma_f32_16x16x32_bf16 v[124:127], v[24:27], v[60:63], v[124:127]
    ds_read_b128 v[24:27], v249 offset:4096
    v_mfma_f32_16x16x32_bf16 v[128:131], v[28:31], v[48:51], v[128:131]
    v_mfma_f32_16x16x32_bf16 v[132:135], v[28:31], v[52:55], v[132:135]
    ds_read_b64_tr_b16 v[70:71], v251 offset:9216
    v_mfma_f32_16x16x32_bf16 v[136:139], v[28:31], v[56:59], v[136:139]
    v_mfma_f32_16x16x32_bf16 v[140:143], v[28:31], v[60:63], v[140:143]
    ds_read_b128 v[28:31], v249 offset:6144
    s_waitcnt lgkmcnt(11)
    v_mfma_f32_16x16x32_bf16 v[144:147], v[32:35], v[48:51], v[144:147]
    v_mfma_f32_16x16x32_bf16 v[148:151], v[32:35], v[52:55], v[148:151]
    ds_read_b64_tr_b16 v[72:73], v250 offset:8448
    v_mfma_f32_16x16x32_bf16 v[152:155], v[32:35], v[56:59], v[152:155]
    buffer_load_dwordx4 v230, s[16:19], s32 offen offset:2048 lds
    v_mfma_f32_16x16x32_bf16 v[156:159], v[32:35], v[60:63], v[156:159]
    ds_read_b128 v[32:35], v249 offset:8192
    s_waitcnt lgkmcnt(12)
    v_mfma_f32_16x16x32_bf16 v[160:163], v[36:39], v[48:51], v[160:163]
    v_mfma_f32_16x16x32_bf16 v[164:167], v[36:39], v[52:55], v[164:167]
    ds_read_b64_tr_b16 v[74:75], v250 offset:9472
    v_mfma_f32_16x16x32_bf16 v[168:171], v[36:39], v[56:59], v[168:171]
    v_mfma_f32_16x16x32_bf16 v[172:175], v[36:39], v[60:63], v[172:175]
    ds_read_b128 v[36:39], v249 offset:10240
    s_waitcnt lgkmcnt(13)
    v_mfma_f32_16x16x32_bf16 v[176:179], v[40:43], v[48:51], v[176:179]
    v_mfma_f32_16x16x32_bf16 v[180:183], v[40:43], v[52:55], v[180:183]
    ds_read_b64_tr_b16 v[76:77], v251 offset:8448
    v_mfma_f32_16x16x32_bf16 v[184:187], v[40:43], v[56:59], v[184:187]
    buffer_load_dwordx4 v231, s[16:19], s32 offen offset:3072 lds
    v_mfma_f32_16x16x32_bf16 v[188:191], v[40:43], v[60:63], v[188:191]
    ds_read_b128 v[40:43], v249 offset:12288
    s_waitcnt lgkmcnt(14)
    v_mfma_f32_16x16x32_bf16 v[192:195], v[44:47], v[48:51], v[192:195]
    v_mfma_f32_16x16x32_bf16 v[196:199], v[44:47], v[52:55], v[196:199]
    ds_read_b64_tr_b16 v[78:79], v251 offset:9472
    v_mfma_f32_16x16x32_bf16 v[200:203], v[44:47], v[56:59], v[200:203]
    s_mov_b32 s101, 131072
    buffer_load_dword v210, v219, s[56:59], s101 offen
    v_mfma_f32_16x16x32_bf16 v[204:207], v[44:47], v[60:63], v[204:207]
    ds_read_b128 v[44:47], v249 offset:14336
    s_waitcnt lgkmcnt(13)
    v_mfma_f32_16x16x32_bf16 v[80:83], v[16:19], v[64:67], v[80:83]
    s_waitcnt lgkmcnt(9)
    v_mfma_f32_16x16x32_bf16 v[84:87], v[16:19], v[68:71], v[84:87]
    s_waitcnt lgkmcnt(5)
    v_mfma_f32_16x16x32_bf16 v[88:91], v[16:19], v[72:75], v[88:91]
    s_waitcnt lgkmcnt(1)
    v_mfma_f32_16x16x32_bf16 v[92:95], v[16:19], v[76:79], v[92:95]
    v_mfma_f32_16x16x32_bf16 v[96:99], v[20:23], v[64:67], v[96:99]
    v_mfma_f32_16x16x32_bf16 v[100:103], v[20:23], v[68:71], v[100:103]
    v_mfma_f32_16x16x32_bf16 v[104:107], v[20:23], v[72:75], v[104:107]
    v_mfma_f32_16x16x32_bf16 v[108:111], v[20:23], v[76:79], v[108:111]
    s_waitcnt lgkmcnt(0)
    s_waitcnt vmcnt(5)
    s_barrier
    s_add_u32 s28, s34, 65536
    s_add_u32 s29, s35, 98304
    v_add_u32 v248, s28, v244
    v_add_u32 v249, s28, v245
    v_add_u32 v250, s29, v246
    v_add_u32 v251, s29, v247
    v_mfma_f32_16x16x32_bf16 v[112:115], v[24:27], v[64:67], v[112:115]
    ds_read_b64_tr_b16 v[48:49], v250 offset:0
    ds_read_b64_tr_b16 v[50:51], v250 offset:1024
    v_mfma_f32_16x16x32_bf16 v[116:119], v[24:27], v[68:71], v[116:119]
    ds_read_b128 v[16:19], v248 offset:0
    ds_read_b64_tr_b16 v[52:53], v251 offset:0
    v_mfma_f32_16x16x32_bf16 v[120:123], v[24:27], v[72:75], v[120:123]
    ds_read_b64_tr_b16 v[54:55], v251 offset:1024
    ds_read_b128 v[20:23], v248 offset:2048
    s_add_u32 m0, s30, 0
    s_add_u32 s32, s31, 7
    s_and_b32 s32, s32, 7
    s_lshl_b32 s32, s32, 19
    buffer_load_dwordx4 v232, s[20:23], s32 offen offset:0 lds
    v_mfma_f32_16x16x32_bf16 v[124:127], v[24:27], v[76:79], v[124:127]
    ds_read_b128 v[24:27], v248 offset:4096
    v_mfma_f32_16x16x32_bf16 v[128:131], v[28:31], v[64:67], v[128:131]
    ds_read_b64_tr_b16 v[56:57], v250 offset:256
    v_mfma_f32_16x16x32_bf16 v[132:135], v[28:31], v[68:71], v[132:135]
    ds_read_b64_tr_b16 v[58:59], v250 offset:1280
    v_mfma_f32_16x16x32_bf16 v[136:139], v[28:31], v[72:75], v[136:139]
    ds_read_b64_tr_b16 v[60:61], v251 offset:256
    v_mfma_f32_16x16x32_bf16 v[140:143], v[28:31], v[76:79], v[140:143]
    ds_read_b128 v[28:31], v248 offset:6144
    v_mfma_f32_16x16x32_bf16 v[144:147], v[32:35], v[64:67], v[144:147]
    ds_read_b64_tr_b16 v[62:63], v251 offset:1280
    buffer_load_dwordx4 v233, s[20:23], s32 offen offset:1024 lds
    v_mfma_f32_16x16x32_bf16 v[148:151], v[32:35], v[68:71], v[148:151]
    v_mfma_f32_16x16x32_bf16 v[152:155], v[32:35], v[72:75], v[152:155]
    v_mfma_f32_16x16x32_bf16 v[156:159], v[32:35], v[76:79], v[156:159]
    ds_read_b128 v[32:35], v248 offset:8192
    v_mfma_f32_16x16x32_bf16 v[160:163], v[36:39], v[64:67], v[160:163]
    v_mfma_f32_16x16x32_bf16 v[164:167], v[36:39], v[68:71], v[164:167]
    v_mfma_f32_16x16x32_bf16 v[168:171], v[36:39], v[72:75], v[168:171]
    buffer_load_dwordx4 v234, s[20:23], s32 offen offset:2048 lds
    v_mfma_f32_16x16x32_bf16 v[172:175], v[36:39], v[76:79], v[172:175]
    ds_read_b128 v[36:39], v248 offset:10240
    v_mfma_f32_16x16x32_bf16 v[176:179], v[40:43], v[64:67], v[176:179]
    v_mfma_f32_16x16x32_bf16 v[180:183], v[40:43], v[68:71], v[180:183]
    v_mfma_f32_16x16x32_bf16 v[184:187], v[40:43], v[72:75], v[184:187]
    v_mfma_f32_16x16x32_bf16 v[188:191], v[40:43], v[76:79], v[188:191]
    ds_read_b128 v[40:43], v248 offset:12288
    v_mfma_f32_16x16x32_bf16 v[192:195], v[44:47], v[64:67], v[192:195]
    buffer_load_dwordx4 v235, s[20:23], s32 offen offset:3072 lds
    v_mfma_f32_16x16x32_bf16 v[196:199], v[44:47], v[68:71], v[196:199]
    v_mfma_f32_16x16x32_bf16 v[200:203], v[44:47], v[72:75], v[200:203]
    v_mfma_f32_16x16x32_bf16 v[204:207], v[44:47], v[76:79], v[204:207]
    ds_read_b128 v[44:47], v248 offset:14336
    s_waitcnt lgkmcnt(13)
    v_mfma_f32_16x16x32_bf16 v[80:83], v[16:19], v[48:51], v[80:83]
    s_waitcnt lgkmcnt(11)
    v_mfma_f32_16x16x32_bf16 v[84:87], v[16:19], v[52:55], v[84:87]
    ds_read_b64_tr_b16 v[64:65], v250 offset:8192
    s_waitcnt lgkmcnt(8)
    v_mfma_f32_16x16x32_bf16 v[88:91], v[16:19], v[56:59], v[88:91]
    s_add_u32 m0, s30, 32768
    s_mov_b32 s32, 0
    buffer_load_dwordx4 v236, s[52:55], s32 offen offset:0 lds
    s_waitcnt lgkmcnt(5)
    v_mfma_f32_16x16x32_bf16 v[92:95], v[16:19], v[60:63], v[92:95]
    ds_read_b128 v[16:19], v249 offset:0
    v_mfma_f32_16x16x32_bf16 v[96:99], v[20:23], v[48:51], v[96:99]
    v_mfma_f32_16x16x32_bf16 v[100:103], v[20:23], v[52:55], v[100:103]
    ds_read_b64_tr_b16 v[66:67], v250 offset:9216
    v_mfma_f32_16x16x32_bf16 v[104:107], v[20:23], v[56:59], v[104:107]
    v_mfma_f32_16x16x32_bf16 v[108:111], v[20:23], v[60:63], v[108:111]
    ds_read_b128 v[20:23], v249 offset:2048
    v_mfma_f32_16x16x32_bf16 v[112:115], v[24:27], v[48:51], v[112:115]
    v_mfma_f32_16x16x32_bf16 v[116:119], v[24:27], v[52:55], v[116:119]
    ds_read_b64_tr_b16 v[68:69], v251 offset:8192
    v_mfma_f32_16x16x32_bf16 v[120:123], v[24:27], v[56:59], v[120:123]
    buffer_load_dwordx4 v237, s[52:55], s32 offen offset:1024 lds
    v_mfma_f32_16x16x32_bf16 v[124:127], v[24:27], v[60:63], v[124:127]
    ds_read_b128 v[24:27], v249 offset:4096
    v_mfma_f32_16x16x32_bf16 v[128:131], v[28:31], v[48:51], v[128:131]
    v_mfma_f32_16x16x32_bf16 v[132:135], v[28:31], v[52:55], v[132:135]
    ds_read_b64_tr_b16 v[70:71], v251 offset:9216
    v_mfma_f32_16x16x32_bf16 v[136:139], v[28:31], v[56:59], v[136:139]
    v_mfma_f32_16x16x32_bf16 v[140:143], v[28:31], v[60:63], v[140:143]
    ds_read_b128 v[28:31], v249 offset:6144
    s_waitcnt lgkmcnt(11)
    v_mfma_f32_16x16x32_bf16 v[144:147], v[32:35], v[48:51], v[144:147]
    v_mfma_f32_16x16x32_bf16 v[148:151], v[32:35], v[52:55], v[148:151]
    ds_read_b64_tr_b16 v[72:73], v250 offset:8448
    v_mfma_f32_16x16x32_bf16 v[152:155], v[32:35], v[56:59], v[152:155]
    buffer_load_dwordx4 v238, s[52:55], s32 offen offset:2048 lds
    v_mfma_f32_16x16x32_bf16 v[156:159], v[32:35], v[60:63], v[156:159]
    ds_read_b128 v[32:35], v249 offset:8192
    s_waitcnt lgkmcnt(12)
    v_mfma_f32_16x16x32_bf16 v[160:163], v[36:39], v[48:51], v[160:163]
    v_mfma_f32_16x16x32_bf16 v[164:167], v[36:39], v[52:55], v[164:167]
    ds_read_b64_tr_b16 v[74:75], v250 offset:9472
    v_mfma_f32_16x16x32_bf16 v[168:171], v[36:39], v[56:59], v[168:171]
    v_mfma_f32_16x16x32_bf16 v[172:175], v[36:39], v[60:63], v[172:175]
    ds_read_b128 v[36:39], v249 offset:10240
    s_waitcnt lgkmcnt(13)
    v_mfma_f32_16x16x32_bf16 v[176:179], v[40:43], v[48:51], v[176:179]
    v_mfma_f32_16x16x32_bf16 v[180:183], v[40:43], v[52:55], v[180:183]
    ds_read_b64_tr_b16 v[76:77], v251 offset:8448
    v_mfma_f32_16x16x32_bf16 v[184:187], v[40:43], v[56:59], v[184:187]
    buffer_load_dwordx4 v239, s[52:55], s32 offen offset:3072 lds
    v_mfma_f32_16x16x32_bf16 v[188:191], v[40:43], v[60:63], v[188:191]
    ds_read_b128 v[40:43], v249 offset:12288
    s_waitcnt lgkmcnt(14)
    v_mfma_f32_16x16x32_bf16 v[192:195], v[44:47], v[48:51], v[192:195]
    v_mfma_f32_16x16x32_bf16 v[196:199], v[44:47], v[52:55], v[196:199]
    ds_read_b64_tr_b16 v[78:79], v251 offset:9472
    v_mfma_f32_16x16x32_bf16 v[200:203], v[44:47], v[56:59], v[200:203]
    v_mfma_f32_16x16x32_bf16 v[204:207], v[44:47], v[60:63], v[204:207]
    ds_read_b128 v[44:47], v249 offset:14336
    s_waitcnt lgkmcnt(13)
    v_mfma_f32_16x16x32_bf16 v[80:83], v[16:19], v[64:67], v[80:83]
    s_waitcnt lgkmcnt(9)
    v_mfma_f32_16x16x32_bf16 v[84:87], v[16:19], v[68:71], v[84:87]
    s_waitcnt lgkmcnt(5)
    v_mfma_f32_16x16x32_bf16 v[88:91], v[16:19], v[72:75], v[88:91]
    s_waitcnt lgkmcnt(1)
    v_mfma_f32_16x16x32_bf16 v[92:95], v[16:19], v[76:79], v[92:95]
    v_mfma_f32_16x16x32_bf16 v[96:99], v[20:23], v[64:67], v[96:99]
    v_mfma_f32_16x16x32_bf16 v[100:103], v[20:23], v[68:71], v[100:103]
    v_mfma_f32_16x16x32_bf16 v[104:107], v[20:23], v[72:75], v[104:107]
    v_mfma_f32_16x16x32_bf16 v[108:111], v[20:23], v[76:79], v[108:111]
    s_waitcnt lgkmcnt(0)
    s_waitcnt vmcnt(4)
    s_barrier
    s_add_u32 s28, s34, 131072
    s_add_u32 s29, s35, 0
    v_add_u32 v248, s28, v244
    v_add_u32 v249, s28, v245
    v_add_u32 v250, s29, v246
    v_add_u32 v251, s29, v247
    v_mfma_f32_16x16x32_bf16 v[112:115], v[24:27], v[64:67], v[112:115]
    ds_read_b64_tr_b16 v[48:49], v250 offset:0
    ds_read_b64_tr_b16 v[50:51], v250 offset:1024
    v_mfma_f32_16x16x32_bf16 v[116:119], v[24:27], v[68:71], v[116:119]
    ds_read_b128 v[16:19], v248 offset:0
    ds_read_b64_tr_b16 v[52:53], v251 offset:0
    v_mfma_f32_16x16x32_bf16 v[120:123], v[24:27], v[72:75], v[120:123]
    ds_read_b64_tr_b16 v[54:55], v251 offset:1024
    ds_read_b128 v[20:23], v248 offset:2048
    s_add_u32 m0, s30, 65536
    s_mov_b32 s32, 0
    buffer_load_dwordx4 v240, s[56:59], s32 offen offset:0 lds
    v_mfma_f32_16x16x32_bf16 v[124:127], v[24:27], v[76:79], v[124:127]
    ds_read_b128 v[24:27], v248 offset:4096
    v_mfma_f32_16x16x32_bf16 v[128:131], v[28:31], v[64:67], v[128:131]
    ds_read_b64_tr_b16 v[56:57], v250 offset:256
    v_mfma_f32_16x16x32_bf16 v[132:135], v[28:31], v[68:71], v[132:135]
    ds_read_b64_tr_b16 v[58:59], v250 offset:1280
    v_mfma_f32_16x16x32_bf16 v[136:139], v[28:31], v[72:75], v[136:139]
    ds_read_b64_tr_b16 v[60:61], v251 offset:256
    v_mfma_f32_16x16x32_bf16 v[140:143], v[28:31], v[76:79], v[140:143]
    ds_read_b128 v[28:31], v248 offset:6144
    v_mfma_f32_16x16x32_bf16 v[144:147], v[32:35], v[64:67], v[144:147]
    ds_read_b64_tr_b16 v[62:63], v251 offset:1280
    buffer_load_dwordx4 v241, s[56:59], s32 offen offset:1024 lds
    v_mfma_f32_16x16x32_bf16 v[148:151], v[32:35], v[68:71], v[148:151]
    v_mfma_f32_16x16x32_bf16 v[152:155], v[32:35], v[72:75], v[152:155]
    v_mfma_f32_16x16x32_bf16 v[156:159], v[32:35], v[76:79], v[156:159]
    ds_read_b128 v[32:35], v248 offset:8192
    v_mfma_f32_16x16x32_bf16 v[160:163], v[36:39], v[64:67], v[160:163]
    v_mfma_f32_16x16x32_bf16 v[164:167], v[36:39], v[68:71], v[164:167]
    v_mfma_f32_16x16x32_bf16 v[168:171], v[36:39], v[72:75], v[168:171]
    buffer_load_dwordx4 v242, s[56:59], s32 offen offset:2048 lds
    v_mfma_f32_16x16x32_bf16 v[172:175], v[36:39], v[76:79], v[172:175]
    ds_read_b128 v[36:39], v248 offset:10240
    v_mfma_f32_16x16x32_bf16 v[176:179], v[40:43], v[64:67], v[176:179]
    v_mfma_f32_16x16x32_bf16 v[180:183], v[40:43], v[68:71], v[180:183]
    v_mfma_f32_16x16x32_bf16 v[184:187], v[40:43], v[72:75], v[184:187]
    v_mfma_f32_16x16x32_bf16 v[188:191], v[40:43], v[76:79], v[188:191]
    ds_read_b128 v[40:43], v248 offset:12288
    v_mfma_f32_16x16x32_bf16 v[192:195], v[44:47], v[64:67], v[192:195]
    buffer_load_dwordx4 v243, s[56:59], s32 offen offset:3072 lds
    v_mfma_f32_16x16x32_bf16 v[196:199], v[44:47], v[68:71], v[196:199]
    v_mfma_f32_16x16x32_bf16 v[200:203], v[44:47], v[72:75], v[200:203]
    v_mfma_f32_16x16x32_bf16 v[204:207], v[44:47], v[76:79], v[204:207]
    ds_read_b128 v[44:47], v248 offset:14336
    s_waitcnt lgkmcnt(13)
    v_mfma_f32_16x16x32_bf16 v[80:83], v[16:19], v[48:51], v[80:83]
    s_waitcnt lgkmcnt(11)
    v_mfma_f32_16x16x32_bf16 v[84:87], v[16:19], v[52:55], v[84:87]
    ds_read_b64_tr_b16 v[64:65], v250 offset:8192
    s_waitcnt lgkmcnt(8)
    v_mfma_f32_16x16x32_bf16 v[88:91], v[16:19], v[56:59], v[88:91]
    s_add_u32 m0, s30, 98304
    s_mov_b32 s32, 128
    buffer_load_dwordx4 v236, s[52:55], s32 offen offset:0 lds
    s_waitcnt lgkmcnt(5)
    v_mfma_f32_16x16x32_bf16 v[92:95], v[16:19], v[60:63], v[92:95]
    ds_read_b128 v[16:19], v249 offset:0
    v_mfma_f32_16x16x32_bf16 v[96:99], v[20:23], v[48:51], v[96:99]
    v_mfma_f32_16x16x32_bf16 v[100:103], v[20:23], v[52:55], v[100:103]
    ds_read_b64_tr_b16 v[66:67], v250 offset:9216
    v_mfma_f32_16x16x32_bf16 v[104:107], v[20:23], v[56:59], v[104:107]
    v_mfma_f32_16x16x32_bf16 v[108:111], v[20:23], v[60:63], v[108:111]
    ds_read_b128 v[20:23], v249 offset:2048
    v_mfma_f32_16x16x32_bf16 v[112:115], v[24:27], v[48:51], v[112:115]
    v_mfma_f32_16x16x32_bf16 v[116:119], v[24:27], v[52:55], v[116:119]
    ds_read_b64_tr_b16 v[68:69], v251 offset:8192
    v_mfma_f32_16x16x32_bf16 v[120:123], v[24:27], v[56:59], v[120:123]
    buffer_load_dwordx4 v237, s[52:55], s32 offen offset:1024 lds
    v_mfma_f32_16x16x32_bf16 v[124:127], v[24:27], v[60:63], v[124:127]
    ds_read_b128 v[24:27], v249 offset:4096
    v_mfma_f32_16x16x32_bf16 v[128:131], v[28:31], v[48:51], v[128:131]
    v_mfma_f32_16x16x32_bf16 v[132:135], v[28:31], v[52:55], v[132:135]
    ds_read_b64_tr_b16 v[70:71], v251 offset:9216
    v_mfma_f32_16x16x32_bf16 v[136:139], v[28:31], v[56:59], v[136:139]
    v_mfma_f32_16x16x32_bf16 v[140:143], v[28:31], v[60:63], v[140:143]
    ds_read_b128 v[28:31], v249 offset:6144
    s_waitcnt lgkmcnt(11)
    v_mfma_f32_16x16x32_bf16 v[144:147], v[32:35], v[48:51], v[144:147]
    v_mfma_f32_16x16x32_bf16 v[148:151], v[32:35], v[52:55], v[148:151]
    ds_read_b64_tr_b16 v[72:73], v250 offset:8448
    v_mfma_f32_16x16x32_bf16 v[152:155], v[32:35], v[56:59], v[152:155]
    buffer_load_dwordx4 v238, s[52:55], s32 offen offset:2048 lds
    v_mfma_f32_16x16x32_bf16 v[156:159], v[32:35], v[60:63], v[156:159]
    ds_read_b128 v[32:35], v249 offset:8192
    s_waitcnt lgkmcnt(12)
    v_mfma_f32_16x16x32_bf16 v[160:163], v[36:39], v[48:51], v[160:163]
    v_mfma_f32_16x16x32_bf16 v[164:167], v[36:39], v[52:55], v[164:167]
    ds_read_b64_tr_b16 v[74:75], v250 offset:9472
    v_mfma_f32_16x16x32_bf16 v[168:171], v[36:39], v[56:59], v[168:171]
    v_mfma_f32_16x16x32_bf16 v[172:175], v[36:39], v[60:63], v[172:175]
    ds_read_b128 v[36:39], v249 offset:10240
    s_waitcnt lgkmcnt(13)
    v_mfma_f32_16x16x32_bf16 v[176:179], v[40:43], v[48:51], v[176:179]
    v_mfma_f32_16x16x32_bf16 v[180:183], v[40:43], v[52:55], v[180:183]
    ds_read_b64_tr_b16 v[76:77], v251 offset:8448
    v_mfma_f32_16x16x32_bf16 v[184:187], v[40:43], v[56:59], v[184:187]
    buffer_load_dwordx4 v239, s[52:55], s32 offen offset:3072 lds
    v_mfma_f32_16x16x32_bf16 v[188:191], v[40:43], v[60:63], v[188:191]
    ds_read_b128 v[40:43], v249 offset:12288
    s_waitcnt lgkmcnt(14)
    v_mfma_f32_16x16x32_bf16 v[192:195], v[44:47], v[48:51], v[192:195]
    v_mfma_f32_16x16x32_bf16 v[196:199], v[44:47], v[52:55], v[196:199]
    ds_read_b64_tr_b16 v[78:79], v251 offset:9472
    v_mfma_f32_16x16x32_bf16 v[200:203], v[44:47], v[56:59], v[200:203]
    v_mfma_f32_16x16x32_bf16 v[204:207], v[44:47], v[60:63], v[204:207]
    ds_read_b128 v[44:47], v249 offset:14336
    s_waitcnt lgkmcnt(13)
    v_mfma_f32_16x16x32_bf16 v[80:83], v[16:19], v[64:67], v[80:83]
    s_waitcnt lgkmcnt(9)
    v_mfma_f32_16x16x32_bf16 v[84:87], v[16:19], v[68:71], v[84:87]
    s_waitcnt lgkmcnt(5)
    v_mfma_f32_16x16x32_bf16 v[88:91], v[16:19], v[72:75], v[88:91]
    s_waitcnt lgkmcnt(1)
    v_mfma_f32_16x16x32_bf16 v[92:95], v[16:19], v[76:79], v[92:95]
    v_mfma_f32_16x16x32_bf16 v[96:99], v[20:23], v[64:67], v[96:99]
    v_mfma_f32_16x16x32_bf16 v[100:103], v[20:23], v[68:71], v[100:103]
    v_mfma_f32_16x16x32_bf16 v[104:107], v[20:23], v[72:75], v[104:107]
    v_mfma_f32_16x16x32_bf16 v[108:111], v[20:23], v[76:79], v[108:111]
    s_waitcnt lgkmcnt(0)
    s_waitcnt vmcnt(4)
    s_barrier
    v_mfma_f32_16x16x32_bf16 v[112:115], v[24:27], v[64:67], v[112:115]
    s_add_u32 m0, s30, 131072
    s_mov_b32 s32, 256
    buffer_load_dwordx4 v236, s[52:55], s32 offen offset:0 lds
    v_mfma_f32_16x16x32_bf16 v[116:119], v[24:27], v[68:71], v[116:119]
    v_mfma_f32_16x16x32_bf16 v[120:123], v[24:27], v[72:75], v[120:123]
    v_mfma_f32_16x16x32_bf16 v[124:127], v[24:27], v[76:79], v[124:127]
    buffer_load_dwordx4 v237, s[52:55], s32 offen offset:1024 lds
    v_mfma_f32_16x16x32_bf16 v[128:131], v[28:31], v[64:67], v[128:131]
    v_mfma_f32_16x16x32_bf16 v[132:135], v[28:31], v[68:71], v[132:135]
    v_mfma_f32_16x16x32_bf16 v[136:139], v[28:31], v[72:75], v[136:139]
    buffer_load_dwordx4 v238, s[52:55], s32 offen offset:2048 lds
    v_mfma_f32_16x16x32_bf16 v[140:143], v[28:31], v[76:79], v[140:143]
    v_mfma_f32_16x16x32_bf16 v[144:147], v[32:35], v[64:67], v[144:147]
    v_mfma_f32_16x16x32_bf16 v[148:151], v[32:35], v[68:71], v[148:151]
    buffer_load_dwordx4 v239, s[52:55], s32 offen offset:3072 lds
    v_mfma_f32_16x16x32_bf16 v[152:155], v[32:35], v[72:75], v[152:155]
    v_mfma_f32_16x16x32_bf16 v[156:159], v[32:35], v[76:79], v[156:159]
    v_mfma_f32_16x16x32_bf16 v[160:163], v[36:39], v[64:67], v[160:163]
    s_add_u32 m0, s30, 0
    s_mov_b32 s32, 1048576
    buffer_load_dwordx4 v240, s[56:59], s32 offen offset:0 lds
    v_mfma_f32_16x16x32_bf16 v[164:167], v[36:39], v[68:71], v[164:167]
    v_mfma_f32_16x16x32_bf16 v[168:171], v[36:39], v[72:75], v[168:171]
    v_mfma_f32_16x16x32_bf16 v[172:175], v[36:39], v[76:79], v[172:175]
    buffer_load_dwordx4 v241, s[56:59], s32 offen offset:1024 lds
    v_mfma_f32_16x16x32_bf16 v[176:179], v[40:43], v[64:67], v[176:179]
    v_mfma_f32_16x16x32_bf16 v[180:183], v[40:43], v[68:71], v[180:183]
    v_mfma_f32_16x16x32_bf16 v[184:187], v[40:43], v[72:75], v[184:187]
    buffer_load_dwordx4 v242, s[56:59], s32 offen offset:2048 lds
    v_mfma_f32_16x16x32_bf16 v[188:191], v[40:43], v[76:79], v[188:191]
    v_mfma_f32_16x16x32_bf16 v[192:195], v[44:47], v[64:67], v[192:195]
    v_mfma_f32_16x16x32_bf16 v[196:199], v[44:47], v[68:71], v[196:199]
    buffer_load_dwordx4 v243, s[56:59], s32 offen offset:3072 lds
    v_mfma_f32_16x16x32_bf16 v[200:203], v[44:47], v[72:75], v[200:203]
    v_mfma_f32_16x16x32_bf16 v[204:207], v[44:47], v[76:79], v[204:207]
    v_cvt_pk_bf16_f32 v16, v80, v81
    v_cvt_pk_bf16_f32 v17, v82, v83
    v_cvt_pk_bf16_f32 v18, v96, v97
    v_cvt_pk_bf16_f32 v19, v98, v99
    v_cvt_pk_bf16_f32 v20, v84, v85
    v_cvt_pk_bf16_f32 v21, v86, v87
    v_cvt_pk_bf16_f32 v22, v100, v101
    v_cvt_pk_bf16_f32 v23, v102, v103
    v_cvt_pk_bf16_f32 v24, v88, v89
    v_cvt_pk_bf16_f32 v25, v90, v91
    v_cvt_pk_bf16_f32 v26, v104, v105
    v_cvt_pk_bf16_f32 v27, v106, v107
    v_cvt_pk_bf16_f32 v28, v92, v93
    v_cvt_pk_bf16_f32 v29, v94, v95
    v_cvt_pk_bf16_f32 v30, v108, v109
    v_cvt_pk_bf16_f32 v31, v110, v111
    v_cvt_pk_bf16_f32 v32, v112, v113
    v_cvt_pk_bf16_f32 v33, v114, v115
    v_cvt_pk_bf16_f32 v34, v128, v129
    v_cvt_pk_bf16_f32 v35, v130, v131
    v_cvt_pk_bf16_f32 v36, v116, v117
    v_cvt_pk_bf16_f32 v37, v118, v119
    v_cvt_pk_bf16_f32 v38, v132, v133
    v_cvt_pk_bf16_f32 v39, v134, v135
    v_cvt_pk_bf16_f32 v40, v120, v121
    v_cvt_pk_bf16_f32 v41, v122, v123
    v_cvt_pk_bf16_f32 v42, v136, v137
    v_cvt_pk_bf16_f32 v43, v138, v139
    v_cvt_pk_bf16_f32 v44, v124, v125
    v_cvt_pk_bf16_f32 v45, v126, v127
    v_cvt_pk_bf16_f32 v46, v140, v141
    v_cvt_pk_bf16_f32 v47, v142, v143
    v_cvt_pk_bf16_f32 v48, v144, v145
    v_cvt_pk_bf16_f32 v49, v146, v147
    v_cvt_pk_bf16_f32 v50, v160, v161
    v_cvt_pk_bf16_f32 v51, v162, v163
    v_cvt_pk_bf16_f32 v52, v148, v149
    v_cvt_pk_bf16_f32 v53, v150, v151
    v_cvt_pk_bf16_f32 v54, v164, v165
    v_cvt_pk_bf16_f32 v55, v166, v167
    v_cvt_pk_bf16_f32 v56, v152, v153
    v_cvt_pk_bf16_f32 v57, v154, v155
    v_cvt_pk_bf16_f32 v58, v168, v169
    v_cvt_pk_bf16_f32 v59, v170, v171
    v_cvt_pk_bf16_f32 v60, v156, v157
    v_cvt_pk_bf16_f32 v61, v158, v159
    v_cvt_pk_bf16_f32 v62, v172, v173
    v_cvt_pk_bf16_f32 v63, v174, v175
    v_cvt_pk_bf16_f32 v64, v176, v177
    v_cvt_pk_bf16_f32 v65, v178, v179
    v_cvt_pk_bf16_f32 v66, v192, v193
    v_cvt_pk_bf16_f32 v67, v194, v195
    v_cvt_pk_bf16_f32 v68, v180, v181
    v_cvt_pk_bf16_f32 v69, v182, v183
    v_cvt_pk_bf16_f32 v70, v196, v197
    v_cvt_pk_bf16_f32 v71, v198, v199
    v_cvt_pk_bf16_f32 v72, v184, v185
    v_cvt_pk_bf16_f32 v73, v186, v187
    v_cvt_pk_bf16_f32 v74, v200, v201
    v_cvt_pk_bf16_f32 v75, v202, v203
    v_cvt_pk_bf16_f32 v76, v188, v189
    v_cvt_pk_bf16_f32 v77, v190, v191
    v_cvt_pk_bf16_f32 v78, v204, v205
    v_cvt_pk_bf16_f32 v79, v206, v207
qphase_5:
    s_xor_b32 s34, s30, 16384
    s_lshl_b32 s35, s14, 9
    s_add_u32 s28, s30, 32768
    s_add_u32 s29, s34, 32768
    v_add_u32 v248, s28, v244
    v_add_u32 v249, s28, v245
    v_add_u32 v254, s29, v244
    v_add_u32 v255, s29, v245
    s_add_u32 s28, s35, 65536
    v_add_u32 v250, s28, v246
    v_add_u32 v251, s28, v247
    ds_read_b64_tr_b16 v[112:113], v250 offset:0
    ds_read_b64_tr_b16 v[114:115], v250 offset:1024
    ds_read_b128 v[80:83], v248 offset:0
    ds_read_b128 v[84:87], v248 offset:2048
    ds_read_b128 v[88:91], v254 offset:0
    ds_read_b128 v[92:95], v254 offset:2048
    ds_read_b64_tr_b16 v[116:117], v251 offset:0
    ds_read_b64_tr_b16 v[118:119], v251 offset:1024
    ds_read_b64_tr_b16 v[120:121], v250 offset:256
    ds_read_b64_tr_b16 v[122:123], v250 offset:1280
    ds_read_b64_tr_b16 v[124:125], v251 offset:256
    ds_read_b64_tr_b16 v[126:127], v251 offset:1280
    s_movk_i32 s42, 255
    s_lshl_b32 s29, s12, 7
    v_and_b32 v10, 7, v2
    v_lshlrev_b32 v10, 2, v10
    v_add_u32 v10, s29, v10
    s_waitcnt lgkmcnt(9)
    v_mfma_f32_16x16x32_bf16 v[144:147], v[112:115], v[80:83], 0
    ds_read_b128 v[96:99], v249 offset:0
    s_waitcnt lgkmcnt(9)
    v_mfma_f32_16x16x32_bf16 v[148:151], v[112:115], v[84:87], 0
    s_mov_b32 s33, 0
    buffer_store_dwordx4 v[16:19], v252, s[24:27], s33 offen offset:0 sc1
    s_waitcnt lgkmcnt(8)
    v_mfma_f32_16x16x32_bf16 v[152:155], v[112:115], v[88:91], 0
    ds_read_b128 v[100:103], v249 offset:2048
    s_waitcnt lgkmcnt(8)
    v_mfma_f32_16x16x32_bf16 v[156:159], v[112:115], v[92:95], 0
    ds_read_b64_tr_b16 v[112:113], v250 offset:8192
    ds_read_b64_tr_b16 v[114:115], v250 offset:9216
    s_waitcnt lgkmcnt(8)
    v_mfma_f32_16x16x32_bf16 v[160:163], v[116:119], v[80:83], 0
    ds_read_b128 v[104:107], v255 offset:0
    v_mfma_f32_16x16x32_bf16 v[164:167], v[116:119], v[84:87], 0
    s_mov_b32 s33, 0
    buffer_store_dwordx4 v[20:23], v252, s[24:27], s33 offen offset:1024 sc1
    v_mfma_f32_16x16x32_bf16 v[168:171], v[116:119], v[88:91], 0
    ds_read_b128 v[108:111], v255 offset:2048
    v_mfma_f32_16x16x32_bf16 v[172:175], v[116:119], v[92:95], 0
    ds_read_b64_tr_b16 v[116:117], v251 offset:8192
    ds_read_b64_tr_b16 v[118:119], v251 offset:9216
    s_waitcnt lgkmcnt(10)
    v_mfma_f32_16x16x32_bf16 v[176:179], v[120:123], v[80:83], 0
    v_mfma_f32_16x16x32_bf16 v[180:183], v[120:123], v[84:87], 0
    v_mfma_f32_16x16x32_bf16 v[184:187], v[120:123], v[88:91], 0
    s_mov_b32 s33, 0
    buffer_store_dwordx4 v[24:27], v253, s[24:27], s33 offen offset:0 sc1
    v_mfma_f32_16x16x32_bf16 v[188:191], v[120:123], v[92:95], 0
    ds_read_b64_tr_b16 v[120:121], v250 offset:8448
    ds_read_b64_tr_b16 v[122:123], v250 offset:9472
    s_waitcnt lgkmcnt(10)
    v_mfma_f32_16x16x32_bf16 v[192:195], v[124:127], v[80:83], 0
    v_mfma_f32_16x16x32_bf16 v[196:199], v[124:127], v[84:87], 0
    v_mfma_f32_16x16x32_bf16 v[200:203], v[124:127], v[88:91], 0
    v_mfma_f32_16x16x32_bf16 v[204:207], v[124:127], v[92:95], 0
    ds_read_b64_tr_b16 v[124:125], v251 offset:8448
    ds_read_b64_tr_b16 v[126:127], v251 offset:9472
    s_waitcnt lgkmcnt(8)
    v_mfma_f32_16x16x32_bf16 v[144:147], v[112:115], v[96:99], v[144:147]
    v_mfma_f32_16x16x32_bf16 v[148:151], v[112:115], v[100:103], v[148:151]
    s_waitcnt lgkmcnt(7)
    v_mfma_f32_16x16x32_bf16 v[152:155], v[112:115], v[104:107], v[152:155]
    s_waitcnt lgkmcnt(6)
    v_mfma_f32_16x16x32_bf16 v[156:159], v[112:115], v[108:111], v[156:159]
    s_waitcnt lgkmcnt(4)
    v_mfma_f32_16x16x32_bf16 v[160:163], v[116:119], v[96:99], v[160:163]
    s_waitcnt lgkmcnt(0)
    s_waitcnt vmcnt(11)
    s_barrier
    s_add_u32 s28, s30, 98304
    s_add_u32 s29, s34, 98304
    v_add_u32 v248, s28, v244
    v_add_u32 v249, s28, v245
    v_add_u32 v254, s29, v244
    v_add_u32 v255, s29, v245
    v_mfma_f32_16x16x32_bf16 v[164:167], v[116:119], v[100:103], v[164:167]
    ds_read_b64_tr_b16 v[112:113], v250 offset:16384
    ds_read_b64_tr_b16 v[114:115], v250 offset:17408
    v_mfma_f32_16x16x32_bf16 v[168:171], v[116:119], v[104:107], v[168:171]
    ds_read_b128 v[80:83], v248 offset:0
    s_add_u32 m0, s30, 32768
    s_mov_b32 s32, 384
    buffer_load_dwordx4 v236, s[52:55], s32 offen offset:0 lds
    v_mfma_f32_16x16x32_bf16 v[172:175], v[116:119], v[108:111], v[172:175]
    ds_read_b128 v[84:87], v248 offset:2048
    v_mfma_f32_16x16x32_bf16 v[176:179], v[120:123], v[96:99], v[176:179]
    ds_read_b128 v[88:91], v254 offset:0
    ds_read_b64_tr_b16 v[116:117], v251 offset:16384
    ds_read_b64_tr_b16 v[118:119], v251 offset:17408
    buffer_load_dwordx4 v237, s[52:55], s32 offen offset:1024 lds
    v_mfma_f32_16x16x32_bf16 v[180:183], v[120:123], v[100:103], v[180:183]
    ds_read_b128 v[92:95], v254 offset:2048
    v_mfma_f32_16x16x32_bf16 v[184:187], v[120:123], v[104:107], v[184:187]
    v_mfma_f32_16x16x32_bf16 v[188:191], v[120:123], v[108:111], v[188:191]
    ds_read_b64_tr_b16 v[120:121], v250 offset:16640
    ds_read_b64_tr_b16 v[122:123], v250 offset:17664
    buffer_load_dwordx4 v238, s[52:55], s32 offen offset:2048 lds
    v_mfma_f32_16x16x32_bf16 v[192:195], v[124:127], v[96:99], v[192:195]
    v_mfma_f32_16x16x32_bf16 v[196:199], v[124:127], v[100:103], v[196:199]
    buffer_load_dwordx4 v239, s[52:55], s32 offen offset:3072 lds
    v_mfma_f32_16x16x32_bf16 v[200:203], v[124:127], v[104:107], v[200:203]
    v_mfma_f32_16x16x32_bf16 v[204:207], v[124:127], v[108:111], v[204:207]
    ds_read_b64_tr_b16 v[124:125], v251 offset:16640
    ds_read_b64_tr_b16 v[126:127], v251 offset:17664
    s_waitcnt lgkmcnt(9)
    v_mfma_f32_16x16x32_bf16 v[144:147], v[112:115], v[80:83], v[144:147]
    ds_read_b128 v[96:99], v249 offset:0
    s_waitcnt lgkmcnt(9)
    v_mfma_f32_16x16x32_bf16 v[148:151], v[112:115], v[84:87], v[148:151]
    s_mov_b32 s33, 0
    buffer_store_dwordx4 v[28:31], v253, s[24:27], s33 offen offset:1024 sc1
    s_waitcnt lgkmcnt(8)
    v_mfma_f32_16x16x32_bf16 v[152:155], v[112:115], v[88:91], v[152:155]
    ds_read_b128 v[100:103], v249 offset:2048
    s_waitcnt lgkmcnt(6)
    v_mfma_f32_16x16x32_bf16 v[156:159], v[112:115], v[92:95], v[156:159]
    ds_read_b64_tr_b16 v[112:113], v250 offset:24576
    ds_read_b64_tr_b16 v[114:115], v250 offset:25600
    v_mfma_f32_16x16x32_bf16 v[160:163], v[116:119], v[80:83], v[160:163]
    ds_read_b128 v[104:107], v255 offset:0
    v_mfma_f32_16x16x32_bf16 v[164:167], v[116:119], v[84:87], v[164:167]
    s_mov_b32 s33, 16384
    buffer_store_dwordx4 v[32:35], v252, s[24:27], s33 offen offset:0 sc1
    v_mfma_f32_16x16x32_bf16 v[168:171], v[116:119], v[88:91], v[168:171]
    ds_read_b128 v[108:111], v255 offset:2048
    v_mfma_f32_16x16x32_bf16 v[172:175], v[116:119], v[92:95], v[172:175]
    ds_read_b64_tr_b16 v[116:117], v251 offset:24576
    ds_read_b64_tr_b16 v[118:119], v251 offset:25600
    s_waitcnt lgkmcnt(10)
    v_mfma_f32_16x16x32_bf16 v[176:179], v[120:123], v[80:83], v[176:179]
    v_mfma_f32_16x16x32_bf16 v[180:183], v[120:123], v[84:87], v[180:183]
    v_mfma_f32_16x16x32_bf16 v[184:187], v[120:123], v[88:91], v[184:187]
    s_mov_b32 s33, 16384
    buffer_store_dwordx4 v[36:39], v252, s[24:27], s33 offen offset:1024 sc1
    v_mfma_f32_16x16x32_bf16 v[188:191], v[120:123], v[92:95], v[188:191]
    ds_read_b64_tr_b16 v[120:121], v250 offset:24832
    ds_read_b64_tr_b16 v[122:123], v250 offset:25856
    s_waitcnt lgkmcnt(10)
    v_mfma_f32_16x16x32_bf16 v[192:195], v[124:127], v[80:83], v[192:195]
    v_mfma_f32_16x16x32_bf16 v[196:199], v[124:127], v[84:87], v[196:199]
    v_mfma_f32_16x16x32_bf16 v[200:203], v[124:127], v[88:91], v[200:203]
    v_mfma_f32_16x16x32_bf16 v[204:207], v[124:127], v[92:95], v[204:207]
    ds_read_b64_tr_b16 v[124:125], v251 offset:24832
    ds_read_b64_tr_b16 v[126:127], v251 offset:25856
    s_waitcnt lgkmcnt(8)
    v_mfma_f32_16x16x32_bf16 v[144:147], v[112:115], v[96:99], v[144:147]
    v_mfma_f32_16x16x32_bf16 v[148:151], v[112:115], v[100:103], v[148:151]
    s_waitcnt lgkmcnt(7)
    v_mfma_f32_16x16x32_bf16 v[152:155], v[112:115], v[104:107], v[152:155]
    s_waitcnt lgkmcnt(6)
    v_mfma_f32_16x16x32_bf16 v[156:159], v[112:115], v[108:111], v[156:159]
    s_waitcnt lgkmcnt(4)
    v_mfma_f32_16x16x32_bf16 v[160:163], v[116:119], v[96:99], v[160:163]
    s_waitcnt lgkmcnt(0)
    s_waitcnt vmcnt(10)
    s_barrier
    s_add_u32 s28, s30, 131072
    s_add_u32 s29, s34, 131072
    v_add_u32 v248, s28, v244
    v_add_u32 v249, s28, v245
    v_add_u32 v254, s29, v244
    v_add_u32 v255, s29, v245
    s_add_u32 s28, s35, 0
    v_add_u32 v250, s28, v246
    v_add_u32 v251, s28, v247
    v_mfma_f32_16x16x32_bf16 v[164:167], v[116:119], v[100:103], v[164:167]
    ds_read_b64_tr_b16 v[112:113], v250 offset:0
    ds_read_b64_tr_b16 v[114:115], v250 offset:1024
    v_mfma_f32_16x16x32_bf16 v[168:171], v[116:119], v[104:107], v[168:171]
    ds_read_b128 v[80:83], v248 offset:0
    s_add_u32 m0, s30, 65536
    s_mov_b32 s32, 512
    buffer_load_dwordx4 v236, s[52:55], s32 offen offset:0 lds
    v_mfma_f32_16x16x32_bf16 v[172:175], v[116:119], v[108:111], v[172:175]
    ds_read_b128 v[84:87], v248 offset:2048
    buffer_load_dwordx4 v237, s[52:55], s32 offen offset:1024 lds
    v_mfma_f32_16x16x32_bf16 v[176:179], v[120:123], v[96:99], v[176:179]
    ds_read_b128 v[88:91], v254 offset:0
    ds_read_b64_tr_b16 v[116:117], v251 offset:0
    ds_read_b64_tr_b16 v[118:119], v251 offset:1024
    buffer_load_dwordx4 v238, s[52:55], s32 offen offset:2048 lds
    v_mfma_f32_16x16x32_bf16 v[180:183], v[120:123], v[100:103], v[180:183]
    ds_read_b128 v[92:95], v254 offset:2048
    buffer_load_dwordx4 v239, s[52:55], s32 offen offset:3072 lds
    v_mfma_f32_16x16x32_bf16 v[184:187], v[120:123], v[104:107], v[184:187]
    v_mfma_f32_16x16x32_bf16 v[188:191], v[120:123], v[108:111], v[188:191]
    ds_read_b64_tr_b16 v[120:121], v250 offset:256
    ds_read_b64_tr_b16 v[122:123], v250 offset:1280
    s_add_u32 m0, s30, 98304
    s_mov_b32 s32, 2097152
    buffer_load_dwordx4 v240, s[56:59], s32 offen offset:0 lds
    v_mfma_f32_16x16x32_bf16 v[192:195], v[124:127], v[96:99], v[192:195]
    buffer_load_dwordx4 v241, s[56:59], s32 offen offset:1024 lds
    v_mfma_f32_16x16x32_bf16 v[196:199], v[124:127], v[100:103], v[196:199]
    buffer_load_dwordx4 v242, s[56:59], s32 offen offset:2048 lds
    v_mfma_f32_16x16x32_bf16 v[200:203], v[124:127], v[104:107], v[200:203]
    buffer_load_dwordx4 v243, s[56:59], s32 offen offset:3072 lds
    v_mfma_f32_16x16x32_bf16 v[204:207], v[124:127], v[108:111], v[204:207]
    ds_read_b64_tr_b16 v[124:125], v251 offset:256
    ds_read_b64_tr_b16 v[126:127], v251 offset:1280
    s_waitcnt lgkmcnt(9)
    v_mfma_f32_16x16x32_bf16 v[144:147], v[112:115], v[80:83], v[144:147]
    ds_read_b128 v[96:99], v249 offset:0
    s_waitcnt lgkmcnt(9)
    v_mfma_f32_16x16x32_bf16 v[148:151], v[112:115], v[84:87], v[148:151]
    s_mov_b32 s33, 16384
    buffer_store_dwordx4 v[40:43], v253, s[24:27], s33 offen offset:0 sc1
    s_waitcnt lgkmcnt(8)
    v_mfma_f32_16x16x32_bf16 v[152:155], v[112:115], v[88:91], v[152:155]
    ds_read_b128 v[100:103], v249 offset:2048
    s_waitcnt lgkmcnt(6)
    v_mfma_f32_16x16x32_bf16 v[156:159], v[112:115], v[92:95], v[156:159]
    ds_read_b64_tr_b16 v[112:113], v250 offset:8192
    ds_read_b64_tr_b16 v[114:115], v250 offset:9216
    v_mfma_f32_16x16x32_bf16 v[160:163], v[116:119], v[80:83], v[160:163]
    ds_read_b128 v[104:107], v255 offset:0
    v_mfma_f32_16x16x32_bf16 v[164:167], v[116:119], v[84:87], v[164:167]
    s_mov_b32 s33, 16384
    buffer_store_dwordx4 v[44:47], v253, s[24:27], s33 offen offset:1024 sc1
    v_mfma_f32_16x16x32_bf16 v[168:171], v[116:119], v[88:91], v[168:171]
    ds_read_b128 v[108:111], v255 offset:2048
    v_mfma_f32_16x16x32_bf16 v[172:175], v[116:119], v[92:95], v[172:175]
    ds_read_b64_tr_b16 v[116:117], v251 offset:8192
    ds_read_b64_tr_b16 v[118:119], v251 offset:9216
    s_waitcnt lgkmcnt(10)
    v_mfma_f32_16x16x32_bf16 v[176:179], v[120:123], v[80:83], v[176:179]
    v_mfma_f32_16x16x32_bf16 v[180:183], v[120:123], v[84:87], v[180:183]
    v_mfma_f32_16x16x32_bf16 v[184:187], v[120:123], v[88:91], v[184:187]
    s_mov_b32 s33, 32768
    buffer_store_dwordx4 v[48:51], v252, s[24:27], s33 offen offset:0 sc1
    v_mfma_f32_16x16x32_bf16 v[188:191], v[120:123], v[92:95], v[188:191]
    ds_read_b64_tr_b16 v[120:121], v250 offset:8448
    ds_read_b64_tr_b16 v[122:123], v250 offset:9472
    s_waitcnt lgkmcnt(10)
    v_mfma_f32_16x16x32_bf16 v[192:195], v[124:127], v[80:83], v[192:195]
    v_mfma_f32_16x16x32_bf16 v[196:199], v[124:127], v[84:87], v[196:199]
    v_mfma_f32_16x16x32_bf16 v[200:203], v[124:127], v[88:91], v[200:203]
    v_mfma_f32_16x16x32_bf16 v[204:207], v[124:127], v[92:95], v[204:207]
    ds_read_b64_tr_b16 v[124:125], v251 offset:8448
    ds_read_b64_tr_b16 v[126:127], v251 offset:9472
    s_waitcnt lgkmcnt(8)
    v_mfma_f32_16x16x32_bf16 v[144:147], v[112:115], v[96:99], v[144:147]
    v_mfma_f32_16x16x32_bf16 v[148:151], v[112:115], v[100:103], v[148:151]
    s_waitcnt lgkmcnt(7)
    v_mfma_f32_16x16x32_bf16 v[152:155], v[112:115], v[104:107], v[152:155]
    s_waitcnt lgkmcnt(6)
    v_mfma_f32_16x16x32_bf16 v[156:159], v[112:115], v[108:111], v[156:159]
    s_waitcnt lgkmcnt(4)
    v_mfma_f32_16x16x32_bf16 v[160:163], v[116:119], v[96:99], v[160:163]
    s_waitcnt lgkmcnt(0)
    s_waitcnt vmcnt(14)
    s_barrier
    s_add_u32 s28, s30, 32768
    s_add_u32 s29, s34, 32768
    v_add_u32 v248, s28, v244
    v_add_u32 v249, s28, v245
    v_add_u32 v254, s29, v244
    v_add_u32 v255, s29, v245
    v_mfma_f32_16x16x32_bf16 v[164:167], v[116:119], v[100:103], v[164:167]
    ds_read_b64_tr_b16 v[112:113], v250 offset:16384
    ds_read_b64_tr_b16 v[114:115], v250 offset:17408
    v_mfma_f32_16x16x32_bf16 v[168:171], v[116:119], v[104:107], v[168:171]
    ds_read_b128 v[80:83], v248 offset:0
    s_add_u32 m0, s30, 131072
    s_mov_b32 s32, 640
    buffer_load_dwordx4 v236, s[52:55], s32 offen offset:0 lds
    v_mfma_f32_16x16x32_bf16 v[172:175], v[116:119], v[108:111], v[172:175]
    ds_read_b128 v[84:87], v248 offset:2048
    v_mfma_f32_16x16x32_bf16 v[176:179], v[120:123], v[96:99], v[176:179]
    ds_read_b128 v[88:91], v254 offset:0
    ds_read_b64_tr_b16 v[116:117], v251 offset:16384
    ds_read_b64_tr_b16 v[118:119], v251 offset:17408
    buffer_load_dwordx4 v237, s[52:55], s32 offen offset:1024 lds
    v_mfma_f32_16x16x32_bf16 v[180:183], v[120:123], v[100:103], v[180:183]
    ds_read_b128 v[92:95], v254 offset:2048
    v_mfma_f32_16x16x32_bf16 v[184:187], v[120:123], v[104:107], v[184:187]
    v_mfma_f32_16x16x32_bf16 v[188:191], v[120:123], v[108:111], v[188:191]
    ds_read_b64_tr_b16 v[120:121], v250 offset:16640
    ds_read_b64_tr_b16 v[122:123], v250 offset:17664
    buffer_load_dwordx4 v238, s[52:55], s32 offen offset:2048 lds
    v_mfma_f32_16x16x32_bf16 v[192:195], v[124:127], v[96:99], v[192:195]
    v_mfma_f32_16x16x32_bf16 v[196:199], v[124:127], v[100:103], v[196:199]
    buffer_load_dwordx4 v239, s[52:55], s32 offen offset:3072 lds
    v_mfma_f32_16x16x32_bf16 v[200:203], v[124:127], v[104:107], v[200:203]
    v_mfma_f32_16x16x32_bf16 v[204:207], v[124:127], v[108:111], v[204:207]
    ds_read_b64_tr_b16 v[124:125], v251 offset:16640
    ds_read_b64_tr_b16 v[126:127], v251 offset:17664
    s_waitcnt lgkmcnt(9)
    v_mfma_f32_16x16x32_bf16 v[144:147], v[112:115], v[80:83], v[144:147]
    ds_read_b128 v[96:99], v249 offset:0
    s_waitcnt lgkmcnt(9)
    v_mfma_f32_16x16x32_bf16 v[148:151], v[112:115], v[84:87], v[148:151]
    s_mov_b32 s33, 32768
    buffer_store_dwordx4 v[52:55], v252, s[24:27], s33 offen offset:1024 sc1
    s_waitcnt lgkmcnt(8)
    v_mfma_f32_16x16x32_bf16 v[152:155], v[112:115], v[88:91], v[152:155]
    ds_read_b128 v[100:103], v249 offset:2048
    s_waitcnt lgkmcnt(6)
    v_mfma_f32_16x16x32_bf16 v[156:159], v[112:115], v[92:95], v[156:159]
    ds_read_b64_tr_b16 v[112:113], v250 offset:24576
    ds_read_b64_tr_b16 v[114:115], v250 offset:25600
    v_mfma_f32_16x16x32_bf16 v[160:163], v[116:119], v[80:83], v[160:163]
    ds_read_b128 v[104:107], v255 offset:0
    v_mfma_f32_16x16x32_bf16 v[164:167], v[116:119], v[84:87], v[164:167]
    s_mov_b32 s33, 32768
    buffer_store_dwordx4 v[56:59], v253, s[24:27], s33 offen offset:0 sc1
    v_mfma_f32_16x16x32_bf16 v[168:171], v[116:119], v[88:91], v[168:171]
    ds_read_b128 v[108:111], v255 offset:2048
    v_mfma_f32_16x16x32_bf16 v[172:175], v[116:119], v[92:95], v[172:175]
    ds_read_b64_tr_b16 v[116:117], v251 offset:24576
    ds_read_b64_tr_b16 v[118:119], v251 offset:25600
    s_waitcnt lgkmcnt(10)
    v_mfma_f32_16x16x32_bf16 v[176:179], v[120:123], v[80:83], v[176:179]
    v_mfma_f32_16x16x32_bf16 v[180:183], v[120:123], v[84:87], v[180:183]
    v_mfma_f32_16x16x32_bf16 v[184:187], v[120:123], v[88:91], v[184:187]
    s_mov_b32 s33, 32768
    buffer_store_dwordx4 v[60:63], v253, s[24:27], s33 offen offset:1024 sc1
    v_mfma_f32_16x16x32_bf16 v[188:191], v[120:123], v[92:95], v[188:191]
    ds_read_b64_tr_b16 v[120:121], v250 offset:24832
    ds_read_b64_tr_b16 v[122:123], v250 offset:25856
    s_waitcnt lgkmcnt(10)
    v_mfma_f32_16x16x32_bf16 v[192:195], v[124:127], v[80:83], v[192:195]
    v_mfma_f32_16x16x32_bf16 v[196:199], v[124:127], v[84:87], v[196:199]
    v_mfma_f32_16x16x32_bf16 v[200:203], v[124:127], v[88:91], v[200:203]
    v_mfma_f32_16x16x32_bf16 v[204:207], v[124:127], v[92:95], v[204:207]
    ds_read_b64_tr_b16 v[124:125], v251 offset:24832
    ds_read_b64_tr_b16 v[126:127], v251 offset:25856
    s_waitcnt lgkmcnt(8)
    v_mfma_f32_16x16x32_bf16 v[144:147], v[112:115], v[96:99], v[144:147]
    v_mfma_f32_16x16x32_bf16 v[148:151], v[112:115], v[100:103], v[148:151]
    s_waitcnt lgkmcnt(7)
    v_mfma_f32_16x16x32_bf16 v[152:155], v[112:115], v[104:107], v[152:155]
    s_waitcnt lgkmcnt(6)
    v_mfma_f32_16x16x32_bf16 v[156:159], v[112:115], v[108:111], v[156:159]
    s_waitcnt lgkmcnt(4)
    v_mfma_f32_16x16x32_bf16 v[160:163], v[116:119], v[96:99], v[160:163]
    s_waitcnt lgkmcnt(0)
    s_waitcnt vmcnt(10)
    s_barrier
    s_add_u32 s28, s30, 65536
    s_add_u32 s29, s34, 65536
    v_add_u32 v248, s28, v244
    v_add_u32 v249, s28, v245
    v_add_u32 v254, s29, v244
    v_add_u32 v255, s29, v245
    s_add_u32 s28, s35, 98304
    v_add_u32 v250, s28, v246
    v_add_u32 v251, s28, v247
    v_mfma_f32_16x16x32_bf16 v[164:167], v[116:119], v[100:103], v[164:167]
    ds_read_b64_tr_b16 v[112:113], v250 offset:0
    ds_read_b64_tr_b16 v[114:115], v250 offset:1024
    v_mfma_f32_16x16x32_bf16 v[168:171], v[116:119], v[104:107], v[168:171]
    ds_read_b128 v[80:83], v248 offset:0
    s_add_u32 m0, s30, 0
    s_mov_b32 s32, 768
    buffer_load_dwordx4 v236, s[52:55], s32 offen offset:0 lds
    v_mfma_f32_16x16x32_bf16 v[172:175], v[116:119], v[108:111], v[172:175]
    ds_read_b128 v[84:87], v248 offset:2048
    buffer_load_dwordx4 v237, s[52:55], s32 offen offset:1024 lds
    v_mfma_f32_16x16x32_bf16 v[176:179], v[120:123], v[96:99], v[176:179]
    ds_read_b128 v[88:91], v254 offset:0
    ds_read_b64_tr_b16 v[116:117], v251 offset:0
    ds_read_b64_tr_b16 v[118:119], v251 offset:1024
    buffer_load_dwordx4 v238, s[52:55], s32 offen offset:2048 lds
    v_mfma_f32_16x16x32_bf16 v[180:183], v[120:123], v[100:103], v[180:183]
    ds_read_b128 v[92:95], v254 offset:2048
    buffer_load_dwordx4 v239, s[52:55], s32 offen offset:3072 lds
    v_mfma_f32_16x16x32_bf16 v[184:187], v[120:123], v[104:107], v[184:187]
    v_mfma_f32_16x16x32_bf16 v[188:191], v[120:123], v[108:111], v[188:191]
    ds_read_b64_tr_b16 v[120:121], v250 offset:256
    ds_read_b64_tr_b16 v[122:123], v250 offset:1280
    s_add_u32 m0, s30, 32768
    s_mov_b32 s32, 3145728
    buffer_load_dwordx4 v240, s[56:59], s32 offen offset:0 lds
    v_mfma_f32_16x16x32_bf16 v[192:195], v[124:127], v[96:99], v[192:195]
    buffer_load_dwordx4 v241, s[56:59], s32 offen offset:1024 lds
    v_mfma_f32_16x16x32_bf16 v[196:199], v[124:127], v[100:103], v[196:199]
    buffer_load_dwordx4 v242, s[56:59], s32 offen offset:2048 lds
    v_mfma_f32_16x16x32_bf16 v[200:203], v[124:127], v[104:107], v[200:203]
    buffer_load_dwordx4 v243, s[56:59], s32 offen offset:3072 lds
    v_mfma_f32_16x16x32_bf16 v[204:207], v[124:127], v[108:111], v[204:207]
    ds_read_b64_tr_b16 v[124:125], v251 offset:256
    ds_read_b64_tr_b16 v[126:127], v251 offset:1280
    s_waitcnt lgkmcnt(9)
    v_mfma_f32_16x16x32_bf16 v[144:147], v[112:115], v[80:83], v[144:147]
    ds_read_b128 v[96:99], v249 offset:0
    s_waitcnt lgkmcnt(9)
    v_mfma_f32_16x16x32_bf16 v[148:151], v[112:115], v[84:87], v[148:151]
    s_mov_b32 s33, 49152
    buffer_store_dwordx4 v[64:67], v252, s[24:27], s33 offen offset:0 sc1
    s_waitcnt lgkmcnt(8)
    v_mfma_f32_16x16x32_bf16 v[152:155], v[112:115], v[88:91], v[152:155]
    ds_read_b128 v[100:103], v249 offset:2048
    s_waitcnt lgkmcnt(6)
    v_mfma_f32_16x16x32_bf16 v[156:159], v[112:115], v[92:95], v[156:159]
    ds_read_b64_tr_b16 v[112:113], v250 offset:8192
    ds_read_b64_tr_b16 v[114:115], v250 offset:9216
    v_mfma_f32_16x16x32_bf16 v[160:163], v[116:119], v[80:83], v[160:163]
    ds_read_b128 v[104:107], v255 offset:0
    v_mfma_f32_16x16x32_bf16 v[164:167], v[116:119], v[84:87], v[164:167]
    s_mov_b32 s33, 49152
    buffer_store_dwordx4 v[68:71], v252, s[24:27], s33 offen offset:1024 sc1
    v_mfma_f32_16x16x32_bf16 v[168:171], v[116:119], v[88:91], v[168:171]
    ds_read_b128 v[108:111], v255 offset:2048
    v_mfma_f32_16x16x32_bf16 v[172:175], v[116:119], v[92:95], v[172:175]
    ds_read_b64_tr_b16 v[116:117], v251 offset:8192
    ds_read_b64_tr_b16 v[118:119], v251 offset:9216
    s_waitcnt lgkmcnt(10)
    v_mfma_f32_16x16x32_bf16 v[176:179], v[120:123], v[80:83], v[176:179]
    v_mfma_f32_16x16x32_bf16 v[180:183], v[120:123], v[84:87], v[180:183]
    v_mfma_f32_16x16x32_bf16 v[184:187], v[120:123], v[88:91], v[184:187]
    s_mov_b32 s33, 49152
    buffer_store_dwordx4 v[72:75], v253, s[24:27], s33 offen offset:0 sc1
    v_mfma_f32_16x16x32_bf16 v[188:191], v[120:123], v[92:95], v[188:191]
    ds_read_b64_tr_b16 v[120:121], v250 offset:8448
    ds_read_b64_tr_b16 v[122:123], v250 offset:9472
    s_waitcnt lgkmcnt(10)
    v_mfma_f32_16x16x32_bf16 v[192:195], v[124:127], v[80:83], v[192:195]
    v_mfma_f32_16x16x32_bf16 v[196:199], v[124:127], v[84:87], v[196:199]
    v_mfma_f32_16x16x32_bf16 v[200:203], v[124:127], v[88:91], v[200:203]
    v_mfma_f32_16x16x32_bf16 v[204:207], v[124:127], v[92:95], v[204:207]
    ds_read_b64_tr_b16 v[124:125], v251 offset:8448
    ds_read_b64_tr_b16 v[126:127], v251 offset:9472
    s_waitcnt lgkmcnt(8)
    v_mfma_f32_16x16x32_bf16 v[144:147], v[112:115], v[96:99], v[144:147]
    v_mfma_f32_16x16x32_bf16 v[148:151], v[112:115], v[100:103], v[148:151]
    s_waitcnt lgkmcnt(7)
    v_mfma_f32_16x16x32_bf16 v[152:155], v[112:115], v[104:107], v[152:155]
    s_waitcnt lgkmcnt(6)
    v_mfma_f32_16x16x32_bf16 v[156:159], v[112:115], v[108:111], v[156:159]
    s_waitcnt lgkmcnt(4)
    v_mfma_f32_16x16x32_bf16 v[160:163], v[116:119], v[96:99], v[160:163]
    s_waitcnt lgkmcnt(0)
    s_waitcnt vmcnt(14)
    s_barrier
    s_add_u32 s28, s30, 131072
    s_add_u32 s29, s34, 131072
    v_add_u32 v248, s28, v244
    v_add_u32 v249, s28, v245
    v_add_u32 v254, s29, v244
    v_add_u32 v255, s29, v245
    v_mfma_f32_16x16x32_bf16 v[164:167], v[116:119], v[100:103], v[164:167]
    ds_read_b64_tr_b16 v[112:113], v250 offset:16384
    ds_read_b64_tr_b16 v[114:115], v250 offset:17408
    v_mfma_f32_16x16x32_bf16 v[168:171], v[116:119], v[104:107], v[168:171]
    ds_read_b128 v[80:83], v248 offset:0
    s_add_u32 m0, s30, 65536
    s_mov_b32 s32, 896
    buffer_load_dwordx4 v236, s[52:55], s32 offen offset:0 lds
    v_mfma_f32_16x16x32_bf16 v[172:175], v[116:119], v[108:111], v[172:175]
    ds_read_b128 v[84:87], v248 offset:2048
    v_mfma_f32_16x16x32_bf16 v[176:179], v[120:123], v[96:99], v[176:179]
    ds_read_b128 v[88:91], v254 offset:0
    ds_read_b64_tr_b16 v[116:117], v251 offset:16384
    ds_read_b64_tr_b16 v[118:119], v251 offset:17408
    buffer_load_dwordx4 v237, s[52:55], s32 offen offset:1024 lds
    v_mfma_f32_16x16x32_bf16 v[180:183], v[120:123], v[100:103], v[180:183]
    ds_read_b128 v[92:95], v254 offset:2048
    v_mfma_f32_16x16x32_bf16 v[184:187], v[120:123], v[104:107], v[184:187]
    v_mfma_f32_16x16x32_bf16 v[188:191], v[120:123], v[108:111], v[188:191]
    ds_read_b64_tr_b16 v[120:121], v250 offset:16640
    ds_read_b64_tr_b16 v[122:123], v250 offset:17664
    buffer_load_dwordx4 v238, s[52:55], s32 offen offset:2048 lds
    v_mfma_f32_16x16x32_bf16 v[192:195], v[124:127], v[96:99], v[192:195]
    v_mfma_f32_16x16x32_bf16 v[196:199], v[124:127], v[100:103], v[196:199]
    buffer_load_dwordx4 v239, s[52:55], s32 offen offset:3072 lds
    v_mfma_f32_16x16x32_bf16 v[200:203], v[124:127], v[104:107], v[200:203]
    v_mfma_f32_16x16x32_bf16 v[204:207], v[124:127], v[108:111], v[204:207]
    ds_read_b64_tr_b16 v[124:125], v251 offset:16640
    ds_read_b64_tr_b16 v[126:127], v251 offset:17664
    s_waitcnt lgkmcnt(9)
    v_mfma_f32_16x16x32_bf16 v[144:147], v[112:115], v[80:83], v[144:147]
    ds_read_b128 v[96:99], v249 offset:0
    s_waitcnt lgkmcnt(9)
    v_mfma_f32_16x16x32_bf16 v[148:151], v[112:115], v[84:87], v[148:151]
    s_mov_b32 s33, 49152
    buffer_store_dwordx4 v[76:79], v253, s[24:27], s33 offen offset:1024 sc1
    s_waitcnt lgkmcnt(8)
    v_mfma_f32_16x16x32_bf16 v[152:155], v[112:115], v[88:91], v[152:155]
    ds_read_b128 v[100:103], v249 offset:2048
    s_waitcnt lgkmcnt(6)
    v_mfma_f32_16x16x32_bf16 v[156:159], v[112:115], v[92:95], v[156:159]
    ds_read_b64_tr_b16 v[112:113], v250 offset:24576
    ds_read_b64_tr_b16 v[114:115], v250 offset:25600
    v_mfma_f32_16x16x32_bf16 v[160:163], v[116:119], v[80:83], v[160:163]
    ds_read_b128 v[104:107], v255 offset:0
    v_mfma_f32_16x16x32_bf16 v[164:167], v[116:119], v[84:87], v[164:167]
    v_mfma_f32_16x16x32_bf16 v[168:171], v[116:119], v[88:91], v[168:171]
    ds_read_b128 v[108:111], v255 offset:2048
    v_mfma_f32_16x16x32_bf16 v[172:175], v[116:119], v[92:95], v[172:175]
    ds_read_b64_tr_b16 v[116:117], v251 offset:24576
    ds_read_b64_tr_b16 v[118:119], v251 offset:25600
    s_waitcnt lgkmcnt(10)
    v_mfma_f32_16x16x32_bf16 v[176:179], v[120:123], v[80:83], v[176:179]
    v_mfma_f32_16x16x32_bf16 v[180:183], v[120:123], v[84:87], v[180:183]
    v_mfma_f32_16x16x32_bf16 v[184:187], v[120:123], v[88:91], v[184:187]
    v_mfma_f32_16x16x32_bf16 v[188:191], v[120:123], v[92:95], v[188:191]
    ds_read_b64_tr_b16 v[120:121], v250 offset:24832
    ds_read_b64_tr_b16 v[122:123], v250 offset:25856
    s_waitcnt lgkmcnt(10)
    v_mfma_f32_16x16x32_bf16 v[192:195], v[124:127], v[80:83], v[192:195]
    v_mfma_f32_16x16x32_bf16 v[196:199], v[124:127], v[84:87], v[196:199]
    v_mfma_f32_16x16x32_bf16 v[200:203], v[124:127], v[88:91], v[200:203]
    v_mfma_f32_16x16x32_bf16 v[204:207], v[124:127], v[92:95], v[204:207]
    ds_read_b64_tr_b16 v[124:125], v251 offset:24832
    ds_read_b64_tr_b16 v[126:127], v251 offset:25856
    s_waitcnt lgkmcnt(8)
    v_mfma_f32_16x16x32_bf16 v[144:147], v[112:115], v[96:99], v[144:147]
    v_mfma_f32_16x16x32_bf16 v[148:151], v[112:115], v[100:103], v[148:151]
    s_waitcnt lgkmcnt(7)
    v_mfma_f32_16x16x32_bf16 v[152:155], v[112:115], v[104:107], v[152:155]
    s_waitcnt lgkmcnt(6)
    v_mfma_f32_16x16x32_bf16 v[156:159], v[112:115], v[108:111], v[156:159]
    s_waitcnt lgkmcnt(4)
    v_mfma_f32_16x16x32_bf16 v[160:163], v[116:119], v[96:99], v[160:163]
    s_waitcnt lgkmcnt(0)
    s_waitcnt vmcnt(8)
    s_barrier
    s_add_u32 s28, s30, 0
    s_add_u32 s29, s34, 0
    v_add_u32 v248, s28, v244
    v_add_u32 v249, s28, v245
    v_add_u32 v254, s29, v244
    v_add_u32 v255, s29, v245
    s_add_u32 s28, s35, 32768
    v_add_u32 v250, s28, v246
    v_add_u32 v251, s28, v247
    v_mfma_f32_16x16x32_bf16 v[164:167], v[116:119], v[100:103], v[164:167]
    ds_read_b64_tr_b16 v[112:113], v250 offset:0
    ds_read_b64_tr_b16 v[114:115], v250 offset:1024
    v_mfma_f32_16x16x32_bf16 v[168:171], v[116:119], v[104:107], v[168:171]
    ds_read_b128 v[80:83], v248 offset:0
    s_add_u32 m0, s30, 98304
    s_mov_b32 s32, 1024
    buffer_load_dwordx4 v236, s[52:55], s32 offen offset:0 lds
    v_mfma_f32_16x16x32_bf16 v[172:175], v[116:119], v[108:111], v[172:175]
    ds_read_b128 v[84:87], v248 offset:2048
    buffer_load_dwordx4 v237, s[52:55], s32 offen offset:1024 lds
    v_mfma_f32_16x16x32_bf16 v[176:179], v[120:123], v[96:99], v[176:179]
    ds_read_b128 v[88:91], v254 offset:0
    ds_read_b64_tr_b16 v[116:117], v251 offset:0
    ds_read_b64_tr_b16 v[118:119], v251 offset:1024
    buffer_load_dwordx4 v238, s[52:55], s32 offen offset:2048 lds
    v_mfma_f32_16x16x32_bf16 v[180:183], v[120:123], v[100:103], v[180:183]
    ds_read_b128 v[92:95], v254 offset:2048
    buffer_load_dwordx4 v239, s[52:55], s32 offen offset:3072 lds
    v_mfma_f32_16x16x32_bf16 v[184:187], v[120:123], v[104:107], v[184:187]
    v_mfma_f32_16x16x32_bf16 v[188:191], v[120:123], v[108:111], v[188:191]
    ds_read_b64_tr_b16 v[120:121], v250 offset:256
    ds_read_b64_tr_b16 v[122:123], v250 offset:1280
    s_add_u32 m0, s30, 131072
    s_mov_b32 s32, 4194304
    buffer_load_dwordx4 v240, s[56:59], s32 offen offset:0 lds
    v_mfma_f32_16x16x32_bf16 v[192:195], v[124:127], v[96:99], v[192:195]
    buffer_load_dwordx4 v241, s[56:59], s32 offen offset:1024 lds
    v_mfma_f32_16x16x32_bf16 v[196:199], v[124:127], v[100:103], v[196:199]
    buffer_load_dwordx4 v242, s[56:59], s32 offen offset:2048 lds
    v_mfma_f32_16x16x32_bf16 v[200:203], v[124:127], v[104:107], v[200:203]
    buffer_load_dwordx4 v243, s[56:59], s32 offen offset:3072 lds
    v_mfma_f32_16x16x32_bf16 v[204:207], v[124:127], v[108:111], v[204:207]
    ds_read_b64_tr_b16 v[124:125], v251 offset:256
    ds_read_b64_tr_b16 v[126:127], v251 offset:1280
    s_waitcnt lgkmcnt(9)
    v_mfma_f32_16x16x32_bf16 v[144:147], v[112:115], v[80:83], v[144:147]
    ds_read_b128 v[96:99], v249 offset:0
    s_waitcnt lgkmcnt(9)
    v_mfma_f32_16x16x32_bf16 v[148:151], v[112:115], v[84:87], v[148:151]
    s_waitcnt lgkmcnt(8)
    v_mfma_f32_16x16x32_bf16 v[152:155], v[112:115], v[88:91], v[152:155]
    ds_read_b128 v[100:103], v249 offset:2048
    s_waitcnt lgkmcnt(6)
    v_mfma_f32_16x16x32_bf16 v[156:159], v[112:115], v[92:95], v[156:159]
    ds_read_b64_tr_b16 v[112:113], v250 offset:8192
    ds_read_b64_tr_b16 v[114:115], v250 offset:9216
    v_mfma_f32_16x16x32_bf16 v[160:163], v[116:119], v[80:83], v[160:163]
    ds_read_b128 v[104:107], v255 offset:0
    v_mfma_f32_16x16x32_bf16 v[164:167], v[116:119], v[84:87], v[164:167]
    v_mfma_f32_16x16x32_bf16 v[168:171], v[116:119], v[88:91], v[168:171]
    ds_read_b128 v[108:111], v255 offset:2048
    v_mfma_f32_16x16x32_bf16 v[172:175], v[116:119], v[92:95], v[172:175]
    ds_read_b64_tr_b16 v[116:117], v251 offset:8192
    ds_read_b64_tr_b16 v[118:119], v251 offset:9216
    s_waitcnt lgkmcnt(10)
    v_mfma_f32_16x16x32_bf16 v[176:179], v[120:123], v[80:83], v[176:179]
    v_mfma_f32_16x16x32_bf16 v[180:183], v[120:123], v[84:87], v[180:183]
    v_mfma_f32_16x16x32_bf16 v[184:187], v[120:123], v[88:91], v[184:187]
    v_mfma_f32_16x16x32_bf16 v[188:191], v[120:123], v[92:95], v[188:191]
    ds_read_b64_tr_b16 v[120:121], v250 offset:8448
    ds_read_b64_tr_b16 v[122:123], v250 offset:9472
    s_waitcnt lgkmcnt(10)
    v_mfma_f32_16x16x32_bf16 v[192:195], v[124:127], v[80:83], v[192:195]
    v_mfma_f32_16x16x32_bf16 v[196:199], v[124:127], v[84:87], v[196:199]
    v_mfma_f32_16x16x32_bf16 v[200:203], v[124:127], v[88:91], v[200:203]
    v_mfma_f32_16x16x32_bf16 v[204:207], v[124:127], v[92:95], v[204:207]
    ds_read_b64_tr_b16 v[124:125], v251 offset:8448
    ds_read_b64_tr_b16 v[126:127], v251 offset:9472
    s_waitcnt lgkmcnt(8)
    v_mfma_f32_16x16x32_bf16 v[144:147], v[112:115], v[96:99], v[144:147]
    v_mfma_f32_16x16x32_bf16 v[148:151], v[112:115], v[100:103], v[148:151]
    s_waitcnt lgkmcnt(7)
    v_mfma_f32_16x16x32_bf16 v[152:155], v[112:115], v[104:107], v[152:155]
    s_waitcnt lgkmcnt(6)
    v_mfma_f32_16x16x32_bf16 v[156:159], v[112:115], v[108:111], v[156:159]
    s_waitcnt lgkmcnt(4)
    v_mfma_f32_16x16x32_bf16 v[160:163], v[116:119], v[96:99], v[160:163]
    s_waitcnt lgkmcnt(0)
    s_waitcnt vmcnt(9)
    s_barrier
    s_add_u32 s28, s30, 65536
    s_add_u32 s29, s34, 65536
    v_add_u32 v248, s28, v244
    v_add_u32 v249, s28, v245
    v_add_u32 v254, s29, v244
    v_add_u32 v255, s29, v245
    v_mfma_f32_16x16x32_bf16 v[164:167], v[116:119], v[100:103], v[164:167]
    ds_read_b64_tr_b16 v[112:113], v250 offset:16384
    ds_read_b64_tr_b16 v[114:115], v250 offset:17408
    v_mfma_f32_16x16x32_bf16 v[168:171], v[116:119], v[104:107], v[168:171]
    ds_read_b128 v[80:83], v248 offset:0
    s_add_u32 m0, s30, 0
    s_mov_b32 s32, 1152
    buffer_load_dwordx4 v236, s[52:55], s32 offen offset:0 lds
    v_mfma_f32_16x16x32_bf16 v[172:175], v[116:119], v[108:111], v[172:175]
    ds_read_b128 v[84:87], v248 offset:2048
    v_mfma_f32_16x16x32_bf16 v[176:179], v[120:123], v[96:99], v[176:179]
    ds_read_b128 v[88:91], v254 offset:0
    ds_read_b64_tr_b16 v[116:117], v251 offset:16384
    ds_read_b64_tr_b16 v[118:119], v251 offset:17408
    buffer_load_dwordx4 v237, s[52:55], s32 offen offset:1024 lds
    v_mfma_f32_16x16x32_bf16 v[180:183], v[120:123], v[100:103], v[180:183]
    ds_read_b128 v[92:95], v254 offset:2048
    v_mfma_f32_16x16x32_bf16 v[184:187], v[120:123], v[104:107], v[184:187]
    v_mfma_f32_16x16x32_bf16 v[188:191], v[120:123], v[108:111], v[188:191]
    ds_read_b64_tr_b16 v[120:121], v250 offset:16640
    ds_read_b64_tr_b16 v[122:123], v250 offset:17664
    buffer_load_dwordx4 v238, s[52:55], s32 offen offset:2048 lds
    v_mfma_f32_16x16x32_bf16 v[192:195], v[124:127], v[96:99], v[192:195]
    v_mfma_f32_16x16x32_bf16 v[196:199], v[124:127], v[100:103], v[196:199]
    buffer_load_dwordx4 v239, s[52:55], s32 offen offset:3072 lds
    v_mfma_f32_16x16x32_bf16 v[200:203], v[124:127], v[104:107], v[200:203]
    v_mfma_f32_16x16x32_bf16 v[204:207], v[124:127], v[108:111], v[204:207]
    ds_read_b64_tr_b16 v[124:125], v251 offset:16640
    ds_read_b64_tr_b16 v[126:127], v251 offset:17664
    s_waitcnt lgkmcnt(9)
    v_mfma_f32_16x16x32_bf16 v[144:147], v[112:115], v[80:83], v[144:147]
    ds_read_b128 v[96:99], v249 offset:0
    v_mov_b32 v228, 0
    s_waitcnt lgkmcnt(9)
    v_mfma_f32_16x16x32_bf16 v[148:151], v[112:115], v[84:87], v[148:151]
    v_mov_b32 v229, 0
    s_waitcnt lgkmcnt(8)
    v_mfma_f32_16x16x32_bf16 v[152:155], v[112:115], v[88:91], v[152:155]
    ds_read_b128 v[100:103], v249 offset:2048
    v_mov_b32 v230, 0
    s_waitcnt lgkmcnt(6)
    v_mfma_f32_16x16x32_bf16 v[156:159], v[112:115], v[92:95], v[156:159]
    ds_read_b64_tr_b16 v[112:113], v250 offset:24576
    ds_read_b64_tr_b16 v[114:115], v250 offset:25600
    v_mov_b32 v231, 0
    v_mfma_f32_16x16x32_bf16 v[160:163], v[116:119], v[80:83], v[160:163]
    ds_read_b128 v[104:107], v255 offset:0
    v_mov_b32 v232, 0
    v_mfma_f32_16x16x32_bf16 v[164:167], v[116:119], v[84:87], v[164:167]
    v_mov_b32 v233, 0
    v_mfma_f32_16x16x32_bf16 v[168:171], v[116:119], v[88:91], v[168:171]
    ds_read_b128 v[108:111], v255 offset:2048
    v_mov_b32 v234, 0
    v_mfma_f32_16x16x32_bf16 v[172:175], v[116:119], v[92:95], v[172:175]
    ds_read_b64_tr_b16 v[116:117], v251 offset:24576
    ds_read_b64_tr_b16 v[118:119], v251 offset:25600
    v_mov_b32 v235, 0
    s_waitcnt lgkmcnt(10)
    v_mfma_f32_16x16x32_bf16 v[176:179], v[120:123], v[80:83], v[176:179]
    v_mov_b32 v236, 0
    v_mfma_f32_16x16x32_bf16 v[180:183], v[120:123], v[84:87], v[180:183]
    v_mov_b32 v237, 0
    v_mfma_f32_16x16x32_bf16 v[184:187], v[120:123], v[88:91], v[184:187]
    v_mov_b32 v238, 0
    v_mfma_f32_16x16x32_bf16 v[188:191], v[120:123], v[92:95], v[188:191]
    ds_read_b64_tr_b16 v[120:121], v250 offset:24832
    ds_read_b64_tr_b16 v[122:123], v250 offset:25856
    v_mov_b32 v239, 0
    s_waitcnt lgkmcnt(10)
    v_mfma_f32_16x16x32_bf16 v[192:195], v[124:127], v[80:83], v[192:195]
    v_mov_b32 v240, 0
    v_mfma_f32_16x16x32_bf16 v[196:199], v[124:127], v[84:87], v[196:199]
    v_mov_b32 v241, 0
    v_mfma_f32_16x16x32_bf16 v[200:203], v[124:127], v[88:91], v[200:203]
    v_mov_b32 v242, 0
    v_mfma_f32_16x16x32_bf16 v[204:207], v[124:127], v[92:95], v[204:207]
    ds_read_b64_tr_b16 v[124:125], v251 offset:24832
    ds_read_b64_tr_b16 v[126:127], v251 offset:25856
    v_mov_b32 v243, 0
    s_waitcnt lgkmcnt(8)
    v_mfma_f32_16x16x32_bf16 v[144:147], v[112:115], v[96:99], v[144:147]
    v_mfma_f32_16x16x32_bf16 v[148:151], v[112:115], v[100:103], v[148:151]
    s_waitcnt lgkmcnt(7)
    v_mfma_f32_16x16x32_bf16 v[152:155], v[112:115], v[104:107], v[152:155]
    s_waitcnt lgkmcnt(6)
    v_mfma_f32_16x16x32_bf16 v[156:159], v[112:115], v[108:111], v[156:159]
    s_waitcnt lgkmcnt(4)
    v_mfma_f32_16x16x32_bf16 v[160:163], v[116:119], v[96:99], v[160:163]
    s_waitcnt lgkmcnt(0)
    s_waitcnt vmcnt(4)
    s_barrier
    s_cmp_lg_u32 s3, 4
    s_cbranch_scc1 nosig_7
    s_mov_b32 s41, 0
eploop_9:
    v_readfirstlane_b32 s29, v223
    s_nop 0
    s_cmp_eq_u32 s29, 1
    s_cbranch_scc1 epok_8
    s_sleep 8
    buffer_load_dwordx2 v[222:223], v220, s[60:63], 0 offen sc1
    s_waitcnt vmcnt(0)
    s_add_u32 s41, s41, 1
    s_cmp_lt_u32 s41, 524288
    s_cbranch_scc1 eploop_9
epok_8:
    s_lshl_b32 s28, s12, 7
    s_lshl_b32 s29, s13, 2
    s_add_u32 s28, s28, s29
    s_mov_b64 exec, 1
    buffer_store_dword v222, v220, s[92:95], s28 offen sc1
    s_mov_b64 exec, -1
nosig_7:
    s_add_u32 s28, s30, 98304
    s_add_u32 s29, s34, 98304
    v_add_u32 v248, s28, v244
    v_add_u32 v249, s28, v245
    v_add_u32 v254, s29, v244
    v_add_u32 v255, s29, v245
    s_add_u32 s28, s35, 131072
    v_add_u32 v250, s28, v246
    v_add_u32 v251, s28, v247
    v_mfma_f32_16x16x32_bf16 v[164:167], v[116:119], v[100:103], v[164:167]
    ds_read_b64_tr_b16 v[112:113], v250 offset:0
    ds_read_b64_tr_b16 v[114:115], v250 offset:1024
    v_mfma_f32_16x16x32_bf16 v[168:171], v[116:119], v[104:107], v[168:171]
    ds_read_b128 v[80:83], v248 offset:0
    v_mfma_f32_16x16x32_bf16 v[172:175], v[116:119], v[108:111], v[172:175]
    ds_read_b128 v[84:87], v248 offset:2048
    v_mfma_f32_16x16x32_bf16 v[176:179], v[120:123], v[96:99], v[176:179]
    ds_read_b128 v[88:91], v254 offset:0
    ds_read_b64_tr_b16 v[116:117], v251 offset:0
    ds_read_b64_tr_b16 v[118:119], v251 offset:1024
    v_mfma_f32_16x16x32_bf16 v[180:183], v[120:123], v[100:103], v[180:183]
    ds_read_b128 v[92:95], v254 offset:2048
    v_mfma_f32_16x16x32_bf16 v[184:187], v[120:123], v[104:107], v[184:187]
    v_mfma_f32_16x16x32_bf16 v[188:191], v[120:123], v[108:111], v[188:191]
    ds_read_b64_tr_b16 v[120:121], v250 offset:256
    ds_read_b64_tr_b16 v[122:123], v250 offset:1280
    v_mfma_f32_16x16x32_bf16 v[192:195], v[124:127], v[96:99], v[192:195]
    v_mfma_f32_16x16x32_bf16 v[196:199], v[124:127], v[100:103], v[196:199]
    v_mfma_f32_16x16x32_bf16 v[200:203], v[124:127], v[104:107], v[200:203]
    v_mfma_f32_16x16x32_bf16 v[204:207], v[124:127], v[108:111], v[204:207]
    ds_read_b64_tr_b16 v[124:125], v251 offset:256
    ds_read_b64_tr_b16 v[126:127], v251 offset:1280
    s_waitcnt lgkmcnt(9)
    v_mfma_f32_16x16x32_bf16 v[144:147], v[112:115], v[80:83], v[144:147]
    ds_read_b128 v[96:99], v249 offset:0
    v_mov_b32 v16, 0
    v_mov_b32 v17, 0
    s_waitcnt lgkmcnt(9)
    v_mfma_f32_16x16x32_bf16 v[148:151], v[112:115], v[84:87], v[148:151]
    v_mov_b32 v18, 0
    v_mov_b32 v19, 0
    s_waitcnt lgkmcnt(8)
    v_mfma_f32_16x16x32_bf16 v[152:155], v[112:115], v[88:91], v[152:155]
    ds_read_b128 v[100:103], v249 offset:2048
    v_mov_b32 v20, 0
    v_mov_b32 v21, 0
    s_waitcnt lgkmcnt(6)
    v_mfma_f32_16x16x32_bf16 v[156:159], v[112:115], v[92:95], v[156:159]
    ds_read_b64_tr_b16 v[112:113], v250 offset:8192
    ds_read_b64_tr_b16 v[114:115], v250 offset:9216
    v_mov_b32 v22, 0
    v_mov_b32 v23, 0
    v_mfma_f32_16x16x32_bf16 v[160:163], v[116:119], v[80:83], v[160:163]
    ds_read_b128 v[104:107], v255 offset:0
    v_mov_b32 v24, 0
    v_mov_b32 v25, 0
    v_mfma_f32_16x16x32_bf16 v[164:167], v[116:119], v[84:87], v[164:167]
    v_mov_b32 v26, 0
    v_mov_b32 v27, 0
    v_mfma_f32_16x16x32_bf16 v[168:171], v[116:119], v[88:91], v[168:171]
    ds_read_b128 v[108:111], v255 offset:2048
    v_mov_b32 v28, 0
    v_mov_b32 v29, 0
    v_mfma_f32_16x16x32_bf16 v[172:175], v[116:119], v[92:95], v[172:175]
    ds_read_b64_tr_b16 v[116:117], v251 offset:8192
    ds_read_b64_tr_b16 v[118:119], v251 offset:9216
    v_mov_b32 v30, 0
    v_mov_b32 v31, 0
    s_waitcnt lgkmcnt(10)
    v_mfma_f32_16x16x32_bf16 v[176:179], v[120:123], v[80:83], v[176:179]
    v_mov_b32 v32, 0
    v_mov_b32 v33, 0
    v_mfma_f32_16x16x32_bf16 v[180:183], v[120:123], v[84:87], v[180:183]
    v_mov_b32 v34, 0
    v_mov_b32 v35, 0
    v_mfma_f32_16x16x32_bf16 v[184:187], v[120:123], v[88:91], v[184:187]
    v_mov_b32 v36, 0
    v_mov_b32 v37, 0
    v_mfma_f32_16x16x32_bf16 v[188:191], v[120:123], v[92:95], v[188:191]
    ds_read_b64_tr_b16 v[120:121], v250 offset:8448
    ds_read_b64_tr_b16 v[122:123], v250 offset:9472
    v_mov_b32 v38, 0
    v_mov_b32 v39, 0
    s_waitcnt lgkmcnt(10)
    v_mfma_f32_16x16x32_bf16 v[192:195], v[124:127], v[80:83], v[192:195]
    v_mov_b32 v40, 0
    v_mov_b32 v41, 0
    v_mfma_f32_16x16x32_bf16 v[196:199], v[124:127], v[84:87], v[196:199]
    v_mov_b32 v42, 0
    v_mov_b32 v43, 0
    v_mfma_f32_16x16x32_bf16 v[200:203], v[124:127], v[88:91], v[200:203]
    v_mov_b32 v44, 0
    v_mov_b32 v45, 0
    v_mfma_f32_16x16x32_bf16 v[204:207], v[124:127], v[92:95], v[204:207]
    ds_read_b64_tr_b16 v[124:125], v251 offset:8448
    ds_read_b64_tr_b16 v[126:127], v251 offset:9472
    v_mov_b32 v46, 0
    v_mov_b32 v47, 0
    s_waitcnt lgkmcnt(8)
    v_mfma_f32_16x16x32_bf16 v[144:147], v[112:115], v[96:99], v[144:147]
    v_mfma_f32_16x16x32_bf16 v[148:151], v[112:115], v[100:103], v[148:151]
    s_waitcnt lgkmcnt(7)
    v_mfma_f32_16x16x32_bf16 v[152:155], v[112:115], v[104:107], v[152:155]
    s_waitcnt lgkmcnt(6)
    v_mfma_f32_16x16x32_bf16 v[156:159], v[112:115], v[108:111], v[156:159]
    s_waitcnt lgkmcnt(4)
    v_mfma_f32_16x16x32_bf16 v[160:163], v[116:119], v[96:99], v[160:163]
    s_waitcnt lgkmcnt(0)
    s_waitcnt vmcnt(0)
    s_barrier
    s_cmp_lg_u32 s3, 4
    s_cbranch_scc1 nopoll_10
    buffer_load_dword v11, v10, s[92:95], 0 offen sc1
nopoll_10:
    s_add_u32 s28, s30, 0
    s_add_u32 s29, s34, 0
    v_add_u32 v248, s28, v244
    v_add_u32 v249, s28, v245
    v_add_u32 v254, s29, v244
    v_add_u32 v255, s29, v245
    v_mfma_f32_16x16x32_bf16 v[164:167], v[116:119], v[100:103], v[164:167]
    ds_read_b64_tr_b16 v[112:113], v250 offset:16384
    ds_read_b64_tr_b16 v[114:115], v250 offset:17408
    v_mfma_f32_16x16x32_bf16 v[168:171], v[116:119], v[104:107], v[168:171]
    ds_read_b128 v[80:83], v248 offset:0
    v_mfma_f32_16x16x32_bf16 v[172:175], v[116:119], v[108:111], v[172:175]
    ds_read_b128 v[84:87], v248 offset:2048
    v_mfma_f32_16x16x32_bf16 v[176:179], v[120:123], v[96:99], v[176:179]
    ds_read_b128 v[88:91], v254 offset:0
    ds_read_b64_tr_b16 v[116:117], v251 offset:16384
    ds_read_b64_tr_b16 v[118:119], v251 offset:17408
    v_mfma_f32_16x16x32_bf16 v[180:183], v[120:123], v[100:103], v[180:183]
    ds_read_b128 v[92:95], v254 offset:2048
    v_mfma_f32_16x16x32_bf16 v[184:187], v[120:123], v[104:107], v[184:187]
    v_mfma_f32_16x16x32_bf16 v[188:191], v[120:123], v[108:111], v[188:191]
    ds_read_b64_tr_b16 v[120:121], v250 offset:16640
    ds_read_b64_tr_b16 v[122:123], v250 offset:17664
    v_mfma_f32_16x16x32_bf16 v[192:195], v[124:127], v[96:99], v[192:195]
    v_mfma_f32_16x16x32_bf16 v[196:199], v[124:127], v[100:103], v[196:199]
    v_mfma_f32_16x16x32_bf16 v[200:203], v[124:127], v[104:107], v[200:203]
    v_mfma_f32_16x16x32_bf16 v[204:207], v[124:127], v[108:111], v[204:207]
    ds_read_b64_tr_b16 v[124:125], v251 offset:16640
    ds_read_b64_tr_b16 v[126:127], v251 offset:17664
    s_waitcnt lgkmcnt(9)
    v_mfma_f32_16x16x32_bf16 v[144:147], v[112:115], v[80:83], v[144:147]
    ds_read_b128 v[96:99], v249 offset:0
    v_mov_b32 v48, 0
    v_mov_b32 v49, 0
    s_waitcnt lgkmcnt(9)
    v_mfma_f32_16x16x32_bf16 v[148:151], v[112:115], v[84:87], v[148:151]
    v_mov_b32 v50, 0
    v_mov_b32 v51, 0
    s_waitcnt lgkmcnt(8)
    v_mfma_f32_16x16x32_bf16 v[152:155], v[112:115], v[88:91], v[152:155]
    ds_read_b128 v[100:103], v249 offset:2048
    v_mov_b32 v52, 0
    v_mov_b32 v53, 0
    s_waitcnt lgkmcnt(6)
    v_mfma_f32_16x16x32_bf16 v[156:159], v[112:115], v[92:95], v[156:159]
    ds_read_b64_tr_b16 v[112:113], v250 offset:24576
    ds_read_b64_tr_b16 v[114:115], v250 offset:25600
    v_mov_b32 v54, 0
    v_mov_b32 v55, 0
    v_mfma_f32_16x16x32_bf16 v[160:163], v[116:119], v[80:83], v[160:163]
    ds_read_b128 v[104:107], v255 offset:0
    v_mov_b32 v56, 0
    v_mov_b32 v57, 0
    v_mfma_f32_16x16x32_bf16 v[164:167], v[116:119], v[84:87], v[164:167]
    v_mov_b32 v58, 0
    v_mov_b32 v59, 0
    v_mfma_f32_16x16x32_bf16 v[168:171], v[116:119], v[88:91], v[168:171]
    ds_read_b128 v[108:111], v255 offset:2048
    v_mov_b32 v60, 0
    v_mov_b32 v61, 0
    v_mfma_f32_16x16x32_bf16 v[172:175], v[116:119], v[92:95], v[172:175]
    ds_read_b64_tr_b16 v[116:117], v251 offset:24576
    ds_read_b64_tr_b16 v[118:119], v251 offset:25600
    v_mov_b32 v62, 0
    v_mov_b32 v63, 0
    s_waitcnt lgkmcnt(10)
    v_mfma_f32_16x16x32_bf16 v[176:179], v[120:123], v[80:83], v[176:179]
    v_mov_b32 v64, 0
    v_mov_b32 v65, 0
    v_mfma_f32_16x16x32_bf16 v[180:183], v[120:123], v[84:87], v[180:183]
    v_mov_b32 v66, 0
    v_mov_b32 v67, 0
    v_mfma_f32_16x16x32_bf16 v[184:187], v[120:123], v[88:91], v[184:187]
    v_mov_b32 v68, 0
    v_mov_b32 v69, 0
    v_mfma_f32_16x16x32_bf16 v[188:191], v[120:123], v[92:95], v[188:191]
    ds_read_b64_tr_b16 v[120:121], v250 offset:24832
    ds_read_b64_tr_b16 v[122:123], v250 offset:25856
    v_mov_b32 v70, 0
    v_mov_b32 v71, 0
    s_waitcnt lgkmcnt(10)
    v_mfma_f32_16x16x32_bf16 v[192:195], v[124:127], v[80:83], v[192:195]
    v_mov_b32 v72, 0
    v_mov_b32 v73, 0
    v_mfma_f32_16x16x32_bf16 v[196:199], v[124:127], v[84:87], v[196:199]
    v_mov_b32 v74, 0
    v_mov_b32 v75, 0
    v_mfma_f32_16x16x32_bf16 v[200:203], v[124:127], v[88:91], v[200:203]
    v_mov_b32 v76, 0
    v_mov_b32 v77, 0
    v_mfma_f32_16x16x32_bf16 v[204:207], v[124:127], v[92:95], v[204:207]
    ds_read_b64_tr_b16 v[124:125], v251 offset:24832
    ds_read_b64_tr_b16 v[126:127], v251 offset:25856
    v_mov_b32 v78, 0
    v_mov_b32 v79, 0
    s_waitcnt lgkmcnt(8)
    v_mfma_f32_16x16x32_bf16 v[144:147], v[112:115], v[96:99], v[144:147]
    v_mfma_f32_16x16x32_bf16 v[148:151], v[112:115], v[100:103], v[148:151]
    s_waitcnt lgkmcnt(7)
    v_mfma_f32_16x16x32_bf16 v[152:155], v[112:115], v[104:107], v[152:155]
    s_waitcnt lgkmcnt(6)
    v_mfma_f32_16x16x32_bf16 v[156:159], v[112:115], v[108:111], v[156:159]
    s_waitcnt lgkmcnt(4)
    v_mfma_f32_16x16x32_bf16 v[160:163], v[116:119], v[96:99], v[160:163]
    s_waitcnt lgkmcnt(0)
    s_cmp_lg_u32 s3, 4
    s_cbranch_scc1 skip_poll_11
    s_mov_b32 s41, 0
    s_waitcnt vmcnt(0)
poll_12:
    v_cmp_eq_u32 s[28:29], v11, v222
    s_nop 0
    s_and_b32 s29, s28, s42
    s_cmp_eq_u32 s29, s42
    s_cbranch_scc1 skip_poll_11
    s_sleep 4
    buffer_load_dword v11, v10, s[92:95], 0 offen sc1
    s_waitcnt vmcnt(0)
    s_add_u32 s41, s41, 1
    s_cmp_lt_u32 s41, 524288
    s_cbranch_scc1 poll_12
skip_poll_11:
    s_barrier
    v_mfma_f32_16x16x32_bf16 v[164:167], v[116:119], v[100:103], v[164:167]
    s_lshl_b32 s28, s12, 20
    s_lshr_b32 s29, s30, 2
    s_add_u32 s43, s28, s29
    s_add_u32 m0, s29, 122880
    s_add_u32 s28, s28, s30
    buffer_load_dwordx4 v3, s[24:27], s43 offen sc1 lds
    s_add_u32 m0, s30, 0
    s_add_u32 s43, s28, 8192
    buffer_load_dwordx4 v3, s[24:27], s43 offen offset:0 sc1 lds
    v_mfma_f32_16x16x32_bf16 v[168:171], v[116:119], v[104:107], v[168:171]
    buffer_load_dwordx4 v3, s[24:27], s43 offen offset:1024 sc1 lds
    v_mfma_f32_16x16x32_bf16 v[172:175], v[116:119], v[108:111], v[172:175]
    buffer_load_dwordx4 v3, s[24:27], s43 offen offset:2048 sc1 lds
    v_mfma_f32_16x16x32_bf16 v[176:179], v[120:123], v[96:99], v[176:179]
    buffer_load_dwordx4 v3, s[24:27], s43 offen offset:3072 sc1 lds
    s_add_u32 m0, s30, 32768
    s_add_u32 s43, s28, 40960
    buffer_load_dwordx4 v3, s[24:27], s43 offen offset:0 sc1 lds
    v_mfma_f32_16x16x32_bf16 v[180:183], v[120:123], v[100:103], v[180:183]
    buffer_load_dwordx4 v3, s[24:27], s43 offen offset:1024 sc1 lds
    v_mfma_f32_16x16x32_bf16 v[184:187], v[120:123], v[104:107], v[184:187]
    buffer_load_dwordx4 v3, s[24:27], s43 offen offset:2048 sc1 lds
    v_mfma_f32_16x16x32_bf16 v[188:191], v[120:123], v[108:111], v[188:191]
    buffer_load_dwordx4 v3, s[24:27], s43 offen offset:3072 sc1 lds
    s_add_u32 m0, s30, 65536
    s_add_u32 s43, s28, 73728
    buffer_load_dwordx4 v3, s[24:27], s43 offen offset:0 sc1 lds
    v_mfma_f32_16x16x32_bf16 v[192:195], v[124:127], v[96:99], v[192:195]
    buffer_load_dwordx4 v3, s[24:27], s43 offen offset:1024 sc1 lds
    v_mfma_f32_16x16x32_bf16 v[196:199], v[124:127], v[100:103], v[196:199]
    buffer_load_dwordx4 v3, s[24:27], s43 offen offset:2048 sc1 lds
    v_mfma_f32_16x16x32_bf16 v[200:203], v[124:127], v[104:107], v[200:203]
    buffer_load_dwordx4 v3, s[24:27], s43 offen offset:3072 sc1 lds
    v_mfma_f32_16x16x32_bf16 v[204:207], v[124:127], v[108:111], v[204:207]
    s_load_dwordx2 s[8:9], s[0:1], 40
    s_load_dwordx4 s[4:7], s[0:1], 56
    s_load_dwordx2 s[10:11], s[0:1], 80
    v_mov_b32 v12, 0x3e0293ee
    v_mov_b32 v13, 0x3e0293ee
    s_add_u32 s29, s34, 131072
    v_add_u32 v8, s29, v3
    s_add_u32 s29, s30, 131072
    v_add_u32 v9, s29, v3
    v_pk_mul_f32 v[152:153], v[152:153], v[12:13]
    v_pk_mul_f32 v[154:155], v[154:155], v[12:13]
    v_cvt_pk_bf16_f32 v112, v152, v153
    v_cvt_pk_bf16_f32 v113, v154, v155
    v_pk_mul_f32 v[168:169], v[168:169], v[12:13]
    v_pk_mul_f32 v[170:171], v[170:171], v[12:13]
    v_cvt_pk_bf16_f32 v114, v168, v169
    v_cvt_pk_bf16_f32 v115, v170, v171
    ds_write_b128 v8, v[112:115] offset:0
    v_pk_mul_f32 v[184:185], v[184:185], v[12:13]
    v_pk_mul_f32 v[186:187], v[186:187], v[12:13]
    v_cvt_pk_bf16_f32 v116, v184, v185
    v_cvt_pk_bf16_f32 v117, v186, v187
    v_pk_mul_f32 v[200:201], v[200:201], v[12:13]
    v_pk_mul_f32 v[202:203], v[202:203], v[12:13]
    v_cvt_pk_bf16_f32 v118, v200, v201
    v_cvt_pk_bf16_f32 v119, v202, v203
    ds_write_b128 v8, v[116:119] offset:1024
    v_pk_mul_f32 v[156:157], v[156:157], v[12:13]
    v_pk_mul_f32 v[158:159], v[158:159], v[12:13]
    v_cvt_pk_bf16_f32 v120, v156, v157
    v_cvt_pk_bf16_f32 v121, v158, v159
    v_pk_mul_f32 v[172:173], v[172:173], v[12:13]
    v_pk_mul_f32 v[174:175], v[174:175], v[12:13]
    v_cvt_pk_bf16_f32 v122, v172, v173
    v_cvt_pk_bf16_f32 v123, v174, v175
    ds_write_b128 v8, v[120:123] offset:2048
    v_pk_mul_f32 v[188:189], v[188:189], v[12:13]
    v_pk_mul_f32 v[190:191], v[190:191], v[12:13]
    v_cvt_pk_bf16_f32 v124, v188, v189
    v_cvt_pk_bf16_f32 v125, v190, v191
    v_pk_mul_f32 v[204:205], v[204:205], v[12:13]
    v_pk_mul_f32 v[206:207], v[206:207], v[12:13]
    v_cvt_pk_bf16_f32 v126, v204, v205
    v_cvt_pk_bf16_f32 v127, v206, v207
    ds_write_b128 v8, v[124:127] offset:3072
    s_lshl_b32 s28, s12, 20
    s_lshl_b32 s29, s15, 13
    s_add_u32 s28, s28, s29
    s_add_u32 s28, s28, 8192
    v_add_u32 v4, s28, v3
    s_lshl_b32 s30, s15, 13
    s_add_u32 s30, s30, 98304
    s_mov_b32 s32, 98304
    s_lshl_b32 s33, s38, 16
    s_add_u32 s33, s33, 65536
    s_lshl_b32 s38, s38, 1
    s_mov_b32 s39, 0
    s_waitcnt lgkmcnt(0)
    s_cmp_eq_u32 s15, 0
    s_cselect_b32 s56, s4, s6
    s_cselect_b32 s57, s5, s7
    s_cmp_lt_u32 s15, 2
    s_cselect_b32 s56, s56, s8
    s_cselect_b32 s57, s57, s9
    s_mov_b32 s59, 0x20000
    s_mul_i32 s49, s12, 5
    s_add_u32 s49, s49, s13
    s_sub_u32 s49, s49, 3
    s_lshl_b32 s49, s49, 14
    s_cmp_eq_u32 s15, 3
    s_cselect_b32 s28, 0x280000, 0
    s_add_u32 s49, s49, s28
    s_add_u32 s58, s49, 16384
    s_cmp_lt_u32 s13, 3
    s_cselect_b32 s58, 0, s58
    s_cselect_b32 s49, 0, s49
    v_min_u32 v14, 21, v2
    v_lshlrev_b32 v14, 7, v14
    s_mov_b32 s28, 0x3e0293ee
    s_cmp_eq_u32 s14, 0
    s_cbranch_scc0 cv_g1_13
    v_pk_mul_f32 v[144:145], v[144:145], v[12:13]
    v_pk_mul_f32 v[146:147], v[146:147], v[12:13]
    v_cvt_pk_bf16_f32 v80, v144, v145
    v_cvt_pk_bf16_f32 v81, v146, v147
    v_pk_mul_f32 v[160:161], v[160:161], v[12:13]
    v_pk_mul_f32 v[162:163], v[162:163], v[12:13]
    v_cvt_pk_bf16_f32 v82, v160, v161
    v_cvt_pk_bf16_f32 v83, v162, v163
    v_pk_mul_f32 v[176:177], v[176:177], v[12:13]
    v_pk_mul_f32 v[178:179], v[178:179], v[12:13]
    v_cvt_pk_bf16_f32 v84, v176, v177
    v_cvt_pk_bf16_f32 v85, v178, v179
    v_pk_mul_f32 v[192:193], v[192:193], v[12:13]
    v_pk_mul_f32 v[194:195], v[194:195], v[12:13]
    v_cvt_pk_bf16_f32 v86, v192, v193
    v_cvt_pk_bf16_f32 v87, v194, v195
    v_pk_mul_f32 v[148:149], v[148:149], v[12:13]
    v_pk_mul_f32 v[150:151], v[150:151], v[12:13]
    v_cvt_pk_bf16_f32 v96, v148, v149
    v_cvt_pk_bf16_f32 v97, v150, v151
    v_pk_mul_f32 v[164:165], v[164:165], v[12:13]
    v_pk_mul_f32 v[166:167], v[166:167], v[12:13]
    v_cvt_pk_bf16_f32 v98, v164, v165
    v_cvt_pk_bf16_f32 v99, v166, v167
    v_pk_mul_f32 v[180:181], v[180:181], v[12:13]
    v_pk_mul_f32 v[182:183], v[182:183], v[12:13]
    v_cvt_pk_bf16_f32 v100, v180, v181
    v_cvt_pk_bf16_f32 v101, v182, v183
    v_pk_mul_f32 v[196:197], v[196:197], v[12:13]
    v_pk_mul_f32 v[198:199], v[198:199], v[12:13]
    v_cvt_pk_bf16_f32 v102, v196, v197
    v_cvt_pk_bf16_f32 v103, v198, v199
    v_mov_b32 v144, 0
    v_mov_b32 v145, 0
    v_mov_b32 v146, 0
    v_mov_b32 v147, 0
    v_mov_b32 v148, 0
    v_mov_b32 v149, 0
    v_mov_b32 v150, 0
    v_mov_b32 v151, 0
    v_mov_b32 v152, 0
    v_mov_b32 v153, 0
    v_mov_b32 v154, 0
    v_mov_b32 v155, 0
    v_mov_b32 v156, 0
    v_mov_b32 v157, 0
    v_mov_b32 v158, 0
    v_mov_b32 v159, 0
    v_mov_b32 v244, 0x3f803f80
    v_mov_b32 v245, 0x3f803f80
    v_mov_b32 v246, 0x3f803f80
    v_mov_b32 v247, 0x3f803f80
    s_waitcnt vmcnt(8) lgkmcnt(0)
    s_barrier
    ds_read_b128 v[88:91], v9 offset:0
    ds_read_b128 v[92:95], v9 offset:1024
    ds_read_b128 v[104:107], v9 offset:2048
    ds_read_b128 v[108:111], v9 offset:3072
    s_branch cv_done_14
cv_g1_13:
    v_pk_mul_f32 v[144:145], v[144:145], v[12:13]
    v_pk_mul_f32 v[146:147], v[146:147], v[12:13]
    v_cvt_pk_bf16_f32 v88, v144, v145
    v_cvt_pk_bf16_f32 v89, v146, v147
    v_pk_mul_f32 v[160:161], v[160:161], v[12:13]
    v_pk_mul_f32 v[162:163], v[162:163], v[12:13]
    v_cvt_pk_bf16_f32 v90, v160, v161
    v_cvt_pk_bf16_f32 v91, v162, v163
    v_pk_mul_f32 v[176:177], v[176:177], v[12:13]
    v_pk_mul_f32 v[178:179], v[178:179], v[12:13]
    v_cvt_pk_bf16_f32 v92, v176, v177
    v_cvt_pk_bf16_f32 v93, v178, v179
    v_pk_mul_f32 v[192:193], v[192:193], v[12:13]
    v_pk_mul_f32 v[194:195], v[194:195], v[12:13]
    v_cvt_pk_bf16_f32 v94, v192, v193
    v_cvt_pk_bf16_f32 v95, v194, v195
    v_pk_mul_f32 v[148:149], v[148:149], v[12:13]
    v_pk_mul_f32 v[150:151], v[150:151], v[12:13]
    v_cvt_pk_bf16_f32 v104, v148, v149
    v_cvt_pk_bf16_f32 v105, v150, v151
    v_pk_mul_f32 v[164:165], v[164:165], v[12:13]
    v_pk_mul_f32 v[166:167], v[166:167], v[12:13]
    v_cvt_pk_bf16_f32 v106, v164, v165
    v_cvt_pk_bf16_f32 v107, v166, v167
    v_pk_mul_f32 v[180:181], v[180:181], v[12:13]
    v_pk_mul_f32 v[182:183], v[182:183], v[12:13]
    v_cvt_pk_bf16_f32 v108, v180, v181
    v_cvt_pk_bf16_f32 v109, v182, v183
    v_pk_mul_f32 v[196:197], v[196:197], v[12:13]
    v_pk_mul_f32 v[198:199], v[198:199], v[12:13]
    v_cvt_pk_bf16_f32 v110, v196, v197
    v_cvt_pk_bf16_f32 v111, v198, v199
    v_mov_b32 v144, 0
    v_mov_b32 v145, 0
    v_mov_b32 v146, 0
    v_mov_b32 v147, 0
    v_mov_b32 v148, 0
    v_mov_b32 v149, 0
    v_mov_b32 v150, 0
    v_mov_b32 v151, 0
    v_mov_b32 v152, 0
    v_mov_b32 v153, 0
    v_mov_b32 v154, 0
    v_mov_b32 v155, 0
    v_mov_b32 v156, 0
    v_mov_b32 v157, 0
    v_mov_b32 v158, 0
    v_mov_b32 v159, 0
    v_mov_b32 v244, 0x3f803f80
    v_mov_b32 v245, 0x3f803f80
    v_mov_b32 v246, 0x3f803f80
    v_mov_b32 v247, 0x3f803f80
    s_waitcnt vmcnt(8) lgkmcnt(0)
    s_barrier
    ds_read_b128 v[80:83], v9 offset:0
    ds_read_b128 v[84:87], v9 offset:1024
    ds_read_b128 v[96:99], v9 offset:2048
    ds_read_b128 v[100:103], v9 offset:3072
cv_done_14:
    s_lshl_b32 s28, s40, 6
    s_add_u32 s28, s28, s12
    s_lshl_b32 s28, s28, 12
    v_add_u32 v5, s28, v3
    s_mov_b32 s42, 0x53800000
    s_mov_b32 s43, 0xff000000
    v_add_u32 v220, 122880, v3
    s_cmp_lg_u32 s40, 0
    s_cbranch_scc1 nomask0_15
    v_mov_b32 v221, s43
    v_cmp_le_i32 vcc, 0, v6
    v_mov_b32 v152, v221
    s_nop 0
    v_cndmask_b32 v144, v221, v144, vcc
    v_cndmask_b32 v156, v221, v156, vcc
    v_cmp_le_i32 vcc, 1, v6
    v_mov_b32 v153, v221
    s_nop 0
    v_cndmask_b32 v145, v221, v145, vcc
    v_cndmask_b32 v157, v221, v157, vcc
    v_cmp_le_i32 vcc, 2, v6
    v_mov_b32 v154, v221
    s_nop 0
    v_cndmask_b32 v146, v221, v146, vcc
    v_cndmask_b32 v158, v221, v158, vcc
    v_cmp_le_i32 vcc, 3, v6
    v_mov_b32 v155, v221
    s_nop 0
    v_cndmask_b32 v147, v221, v147, vcc
    v_cndmask_b32 v159, v221, v159, vcc
nomask0_15:
    ds_read_b128 v[176:179], v220 offset:0
    ds_read_b128 v[180:183], v220 offset:1024
    ds_read_b128 v[184:187], v220 offset:2048
    ds_read_b128 v[188:191], v220 offset:3072
    ds_read_b128 v[192:195], v220 offset:4096
    ds_read_b128 v[196:199], v220 offset:5120
    ds_read_b128 v[200:203], v220 offset:6144
    ds_read_b128 v[204:207], v220 offset:7168
    s_waitcnt lgkmcnt(0)
    s_barrier
    s_cmp_lg_u32 s3, 4
    s_cbranch_scc1 noepw_16
    v_mov_b32 v8, 163776
    ds_write_b32 v8, v222
    v_mov_b32 v10, 0
    ds_write_b32 v8, v10 offset:4
    ds_write_b32 v8, v10 offset:8
    s_waitcnt lgkmcnt(0)
noepw_16:
    s_cmp_eq_u32 s14, 0
    s_cbranch_scc1 skip_r1_17
    s_add_u32 m0, s30, 0
    s_add_u32 s35, s32, 0
    buffer_load_dwordx4 v4, s[24:27], s35 offen offset:0 sc1 lds
    buffer_load_dwordx4 v4, s[24:27], s35 offen offset:1024 sc1 lds
    buffer_load_dwordx4 v4, s[24:27], s35 offen offset:2048 sc1 lds
    buffer_load_dwordx4 v4, s[24:27], s35 offen offset:3072 sc1 lds
    s_add_u32 m0, s30, 4096
    s_add_u32 s35, s32, 4096
    buffer_load_dwordx4 v4, s[24:27], s35 offen offset:0 sc1 lds
    buffer_load_dwordx4 v4, s[24:27], s35 offen offset:1024 sc1 lds
    buffer_load_dwordx4 v4, s[24:27], s35 offen offset:2048 sc1 lds
    buffer_load_dwordx4 v4, s[24:27], s35 offen offset:3072 sc1 lds
    buffer_load_dword v15, v14, s[56:59], s49 offen
    s_add_u32 s49, s49, 2816
    s_add_u32 s30, s30, 32768
    s_and_b32 s30, s30, 131071
    s_add_u32 s32, s32, 32768
skip_r1_17:
    v_mfma_f32_16x16x32_bf16 v[112:115], v[176:179], v[80:83], v[144:147]
    v_mfma_f32_16x16x32_bf16 v[116:119], v[176:179], v[96:99], v[148:151]
    ds_read_b128 v[176:179], v3 offset:8192
    v_mfma_f32_16x16x32_bf16 v[112:115], v[180:183], v[84:87], v[112:115]
    v_mfma_f32_16x16x32_bf16 v[116:119], v[180:183], v[100:103], v[116:119]
    ds_read_b128 v[180:183], v3 offset:9216
    v_mfma_f32_16x16x32_bf16 v[112:115], v[184:187], v[88:91], v[112:115]
    v_mfma_f32_16x16x32_bf16 v[116:119], v[184:187], v[104:107], v[116:119]
    ds_read_b128 v[184:187], v3 offset:10240
    v_mfma_f32_16x16x32_bf16 v[112:115], v[188:191], v[92:95], v[112:115]
    v_mfma_f32_16x16x32_bf16 v[116:119], v[188:191], v[108:111], v[116:119]
    ds_read_b128 v[188:191], v3 offset:11264
    v_mfma_f32_16x16x32_bf16 v[120:123], v[192:195], v[80:83], v[152:155]
    v_mfma_f32_16x16x32_bf16 v[124:127], v[192:195], v[96:99], v[156:159]
    ds_read_b128 v[192:195], v3 offset:12288
    v_mfma_f32_16x16x32_bf16 v[120:123], v[196:199], v[84:87], v[120:123]
    v_mfma_f32_16x16x32_bf16 v[124:127], v[196:199], v[100:103], v[124:127]
    ds_read_b128 v[196:199], v3 offset:13312
    v_mfma_f32_16x16x32_bf16 v[120:123], v[200:203], v[88:91], v[120:123]
    v_mfma_f32_16x16x32_bf16 v[124:127], v[200:203], v[104:107], v[124:127]
    ds_read_b128 v[200:203], v3 offset:14336
    v_mfma_f32_16x16x32_bf16 v[120:123], v[204:207], v[92:95], v[120:123]
    v_mfma_f32_16x16x32_bf16 v[124:127], v[204:207], v[108:111], v[124:127]
    ds_read_b128 v[204:207], v3 offset:15360
    v_max3_f32 v222, v112, v113, v114
    s_nop 4
    v_max3_f32 v222, v222, v115, v120
    v_max3_f32 v222, v222, v121, v122
    v_max_f32 v222, v222, v123
    v_max3_f32 v223, v116, v117, v118
    v_max3_f32 v223, v223, v119, v124
    v_max3_f32 v223, v223, v125, v126
    v_max_f32 v223, v223, v127
    v_mov_b32 v224, v222
    v_mov_b32 v225, v223
    s_nop 0
    v_permlane32_swap_b32 v222, v224
    v_max_f32 v222, v222, v224
    v_permlane32_swap_b32 v223, v225
    v_max_f32 v223, v223, v225
    v_mov_b32 v224, v222
    v_mov_b32 v225, v223
    s_nop 0
    v_permlane16_swap_b32 v222, v224
    v_max_f32 v222, v222, v224
    v_permlane16_swap_b32 v223, v225
    v_max_f32 v223, v223, v225
    v_sub_f32 v112, v112, v222
    v_sub_f32 v144, 0, v222
    v_sub_f32 v113, v113, v222
    v_sub_f32 v145, 0, v222
    v_sub_f32 v114, v114, v222
    v_sub_f32 v146, 0, v222
    v_sub_f32 v115, v115, v222
    v_sub_f32 v147, 0, v222
    v_sub_f32 v120, v120, v222
    v_sub_f32 v152, 0, v222
    v_sub_f32 v121, v121, v222
    v_sub_f32 v153, 0, v222
    v_sub_f32 v122, v122, v222
    v_sub_f32 v154, 0, v222
    v_sub_f32 v123, v123, v222
    v_sub_f32 v155, 0, v222
    v_sub_f32 v116, v116, v223
    v_sub_f32 v148, 0, v223
    v_sub_f32 v117, v117, v223
    v_sub_f32 v149, 0, v223
    v_sub_f32 v118, v118, v223
    v_sub_f32 v150, 0, v223
    v_sub_f32 v119, v119, v223
    v_sub_f32 v151, 0, v223
    v_sub_f32 v124, v124, v223
    v_sub_f32 v156, 0, v223
    v_sub_f32 v125, v125, v223
    v_sub_f32 v157, 0, v223
    v_sub_f32 v126, v126, v223
    v_sub_f32 v158, 0, v223
    v_sub_f32 v127, v127, v223
    v_sub_f32 v159, 0, v223
    v_exp_f32 v208, v112
    v_exp_f32 v209, v113
    v_exp_f32 v210, v114
    v_exp_f32 v211, v115
    v_cvt_pk_bf16_f32 v160, v208, v209
    v_exp_f32 v212, v116
    v_cvt_pk_bf16_f32 v161, v210, v211
    v_exp_f32 v213, v117
    v_exp_f32 v214, v118
    v_cvt_pk_bf16_f32 v164, v212, v213
    v_exp_f32 v215, v119
    v_exp_f32 v208, v120
    v_cvt_pk_bf16_f32 v165, v214, v215
    v_exp_f32 v209, v121
    v_exp_f32 v210, v122
    v_cvt_pk_bf16_f32 v162, v208, v209
    s_waitcnt lgkmcnt(4)
    s_cmp_eq_u32 s14, 0
    s_cselect_b32 s28, 0, 1
    s_cbranch_scc0 w8_18
    s_waitcnt vmcnt(0)
    s_branch w8b_19
w8_18:
    s_waitcnt vmcnt(9)
w8b_19:
    s_mov_b32 s34, s40
    s_cmp_eq_u32 s14, 0
    s_cbranch_scc0 loopB_24
    s_cmp_lt_u32 s34, 5
    s_cbranch_scc1 attn_slow_25
attn_loop_26:
    v_mfma_f32_16x16x32_bf16 v[128:131], v[176:179], v[80:83], v[144:147]
    v_exp_f32 v211, v123
    v_mfma_f32_16x16x32_bf16 v[132:135], v[176:179], v[96:99], v[148:151]
    ds_read_b128 v[176:179], v3 offset:0
    v_cvt_pk_bf16_f32 v163, v210, v211
    v_mfma_f32_16x16x32_bf16 v[128:131], v[180:183], v[84:87], v[128:131]
    v_exp_f32 v212, v124
    v_mfma_f32_16x16x32_bf16 v[132:135], v[180:183], v[100:103], v[132:135]
    ds_read_b128 v[180:183], v3 offset:1024
    v_mfma_f32_16x16x32_bf16 v[228:231], v[244:247], v[160:163], v[236:239]
    v_exp_f32 v213, v125
    v_mfma_f32_16x16x32_bf16 v[128:131], v[184:187], v[88:91], v[128:131]
    v_exp_f32 v214, v126
    v_mfma_f32_16x16x32_bf16 v[132:135], v[184:187], v[104:107], v[132:135]
    ds_read_b128 v[184:187], v3 offset:2048
    v_cvt_pk_bf16_f32 v166, v212, v213
    v_mfma_f32_16x16x32_bf16 v[128:131], v[188:191], v[92:95], v[128:131]
    s_waitcnt lgkmcnt(3)
    v_exp_f32 v215, v127
    v_mfma_f32_16x16x32_bf16 v[132:135], v[188:191], v[108:111], v[132:135]
    ds_read_b128 v[188:191], v3 offset:3072
    v_cvt_pk_bf16_f32 v167, v214, v215
    v_mfma_f32_16x16x32_bf16 v[136:139], v[192:195], v[80:83], v[152:155]
    s_sub_u32 s34, s34, 4
    v_mfma_f32_16x16x32_bf16 v[232:235], v[244:247], v[164:167], v[240:243]
    v_mfma_f32_16x16x32_bf16 v[140:143], v[192:195], v[96:99], v[156:159]
    ds_read_b128 v[192:195], v3 offset:4096
    v_mfma_f32_16x16x32_bf16 v[136:139], v[196:199], v[84:87], v[136:139]
    v_exp_f32 v208, v128
    v_mfma_f32_16x16x32_bf16 v[140:143], v[196:199], v[100:103], v[140:143]
    ds_read_b128 v[196:199], v3 offset:5120
    v_cmp_nge_f32 s[50:51], s42, v228
    v_mfma_f32_16x16x32_bf16 v[136:139], v[200:203], v[88:91], v[136:139]
    s_waitcnt lgkmcnt(2)
    v_exp_f32 v209, v129
    v_mfma_f32_16x16x32_bf16 v[140:143], v[200:203], v[104:107], v[140:143]
    ds_read_b128 v[200:203], v3 offset:6144
    v_cmp_nge_f32 vcc, s42, v232
    v_mfma_f32_16x16x32_bf16 v[136:139], v[204:207], v[92:95], v[136:139]
    s_or_b64 vcc, vcc, s[50:51]
    v_exp_f32 v210, v130
    v_mfma_f32_16x16x32_bf16 v[140:143], v[204:207], v[108:111], v[140:143]
    ds_read_b128 v[204:207], v3 offset:7168
    s_cbranch_vccnz stub_28
ret_27:
    v_mfma_f32_16x16x32_bf16 v[16:19], v[176:179], v[160:163], v[16:19]
    v_exp_f32 v211, v131
    v_mfma_f32_16x16x32_bf16 v[20:23], v[176:179], v[164:167], v[20:23]
    ds_read_b128 v[176:179], v3 offset:24576
    v_cvt_pk_bf16_f32 v168, v208, v209
    v_mfma_f32_16x16x32_bf16 v[24:27], v[180:183], v[160:163], v[24:27]
    v_exp_f32 v212, v132
    v_mfma_f32_16x16x32_bf16 v[28:31], v[180:183], v[164:167], v[28:31]
    ds_read_b128 v[180:183], v3 offset:25600
    v_cvt_pk_bf16_f32 v169, v210, v211
    v_mfma_f32_16x16x32_bf16 v[32:35], v[184:187], v[160:163], v[32:35]
    v_exp_f32 v213, v133
    v_mfma_f32_16x16x32_bf16 v[36:39], v[184:187], v[164:167], v[36:39]
    ds_read_b128 v[184:187], v3 offset:26624
    v_mfma_f32_16x16x32_bf16 v[40:43], v[188:191], v[160:163], v[40:43]
    s_waitcnt lgkmcnt(3)
    v_exp_f32 v214, v134
    v_mfma_f32_16x16x32_bf16 v[44:47], v[188:191], v[164:167], v[44:47]
    ds_read_b128 v[188:191], v3 offset:27648
    v_cvt_pk_bf16_f32 v172, v212, v213
    v_mfma_f32_16x16x32_bf16 v[48:51], v[192:195], v[160:163], v[48:51]
    v_exp_f32 v215, v135
    v_mfma_f32_16x16x32_bf16 v[52:55], v[192:195], v[164:167], v[52:55]
    ds_read_b128 v[192:195], v3 offset:28672
    v_mfma_f32_16x16x32_bf16 v[56:59], v[196:199], v[160:163], v[56:59]
    v_exp_f32 v208, v136
    v_mfma_f32_16x16x32_bf16 v[60:63], v[196:199], v[164:167], v[60:63]
    ds_read_b128 v[196:199], v3 offset:29696
    v_cvt_pk_bf16_f32 v173, v214, v215
    v_mfma_f32_16x16x32_bf16 v[64:67], v[200:203], v[160:163], v[64:67]
    v_exp_f32 v209, v137
    v_mfma_f32_16x16x32_bf16 v[68:71], v[200:203], v[164:167], v[68:71]
    ds_read_b128 v[200:203], v3 offset:30720
    v_mfma_f32_16x16x32_bf16 v[72:75], v[204:207], v[160:163], v[72:75]
    s_waitcnt lgkmcnt(3)
    v_exp_f32 v210, v138
    v_mfma_f32_16x16x32_bf16 v[76:79], v[204:207], v[164:167], v[76:79]
    ds_read_b128 v[204:207], v3 offset:31744
    v_cvt_pk_bf16_f32 v170, v208, v209
    v_mfma_f32_16x16x32_bf16 v[112:115], v[176:179], v[80:83], v[144:147]
    v_exp_f32 v211, v139
    v_mfma_f32_16x16x32_bf16 v[116:119], v[176:179], v[96:99], v[148:151]
    ds_read_b128 v[176:179], v3 offset:16384
    v_cvt_pk_bf16_f32 v171, v210, v211
    v_mfma_f32_16x16x32_bf16 v[112:115], v[180:183], v[84:87], v[112:115]
    v_exp_f32 v212, v140
    v_mfma_f32_16x16x32_bf16 v[116:119], v[180:183], v[100:103], v[116:119]
    ds_read_b128 v[180:183], v3 offset:17408
    v_mfma_f32_16x16x32_bf16 v[236:239], v[244:247], v[168:171], v[228:231]
    v_exp_f32 v213, v141
    v_mfma_f32_16x16x32_bf16 v[112:115], v[184:187], v[88:91], v[112:115]
    v_exp_f32 v214, v142
    v_mfma_f32_16x16x32_bf16 v[116:119], v[184:187], v[104:107], v[116:119]
    ds_read_b128 v[184:187], v3 offset:18432
    v_cvt_pk_bf16_f32 v174, v212, v213
    v_mfma_f32_16x16x32_bf16 v[112:115], v[188:191], v[92:95], v[112:115]
    s_waitcnt lgkmcnt(3)
    v_exp_f32 v215, v143
    v_mfma_f32_16x16x32_bf16 v[116:119], v[188:191], v[108:111], v[116:119]
    ds_read_b128 v[188:191], v3 offset:19456
    v_cvt_pk_bf16_f32 v175, v214, v215
    v_mfma_f32_16x16x32_bf16 v[120:123], v[192:195], v[80:83], v[152:155]
    s_nop 0
    v_mfma_f32_16x16x32_bf16 v[240:243], v[244:247], v[172:175], v[232:235]
    v_mfma_f32_16x16x32_bf16 v[124:127], v[192:195], v[96:99], v[156:159]
    ds_read_b128 v[192:195], v3 offset:20480
    v_mfma_f32_16x16x32_bf16 v[120:123], v[196:199], v[84:87], v[120:123]
    v_exp_f32 v208, v112
    v_mfma_f32_16x16x32_bf16 v[124:127], v[196:199], v[100:103], v[124:127]
    ds_read_b128 v[196:199], v3 offset:21504
    v_cmp_nge_f32 s[50:51], s42, v236
    v_mfma_f32_16x16x32_bf16 v[120:123], v[200:203], v[88:91], v[120:123]
    s_waitcnt lgkmcnt(2)
    v_exp_f32 v209, v113
    v_mfma_f32_16x16x32_bf16 v[124:127], v[200:203], v[104:107], v[124:127]
    ds_read_b128 v[200:203], v3 offset:22528
    v_cmp_nge_f32 vcc, s42, v240
    v_mfma_f32_16x16x32_bf16 v[120:123], v[204:207], v[92:95], v[120:123]
    s_or_b64 vcc, vcc, s[50:51]
    v_exp_f32 v210, v114
    v_mfma_f32_16x16x32_bf16 v[124:127], v[204:207], v[108:111], v[124:127]
    ds_read_b128 v[204:207], v3 offset:23552
    s_cbranch_vccnz stub_30
ret_29:
    v_mfma_f32_16x16x32_bf16 v[16:19], v[176:179], v[168:171], v[16:19]
    v_exp_f32 v211, v115
    v_mfma_f32_16x16x32_bf16 v[20:23], v[176:179], v[172:175], v[20:23]
    v_cvt_pk_bf16_f32 v160, v208, v209
    v_mfma_f32_16x16x32_bf16 v[24:27], v[180:183], v[168:171], v[24:27]
    v_exp_f32 v212, v116
    v_mfma_f32_16x16x32_bf16 v[28:31], v[180:183], v[172:175], v[28:31]
    v_cvt_pk_bf16_f32 v161, v210, v211
    v_mfma_f32_16x16x32_bf16 v[32:35], v[184:187], v[168:171], v[32:35]
    v_exp_f32 v213, v117
    v_mfma_f32_16x16x32_bf16 v[36:39], v[184:187], v[172:175], v[36:39]
    v_mfma_f32_16x16x32_bf16 v[40:43], v[188:191], v[168:171], v[40:43]
    s_waitcnt lgkmcnt(0)
    s_barrier
    ds_read_b128 v[176:179], v3 offset:40960
    v_exp_f32 v214, v118
    v_mfma_f32_16x16x32_bf16 v[44:47], v[188:191], v[172:175], v[44:47]
    ds_read_b128 v[180:183], v3 offset:41984
    ds_read_b128 v[184:187], v3 offset:43008
    v_cvt_pk_bf16_f32 v164, v212, v213
    v_mfma_f32_16x16x32_bf16 v[48:51], v[192:195], v[168:171], v[48:51]
    v_exp_f32 v215, v119
    v_mfma_f32_16x16x32_bf16 v[52:55], v[192:195], v[172:175], v[52:55]
    ds_read_b128 v[188:191], v3 offset:44032
    ds_read_b128 v[192:195], v3 offset:45056
    v_mfma_f32_16x16x32_bf16 v[56:59], v[196:199], v[168:171], v[56:59]
    v_exp_f32 v208, v120
    v_mfma_f32_16x16x32_bf16 v[60:63], v[196:199], v[172:175], v[60:63]
    ds_read_b128 v[196:199], v3 offset:46080
    v_cvt_pk_bf16_f32 v165, v214, v215
    v_mfma_f32_16x16x32_bf16 v[64:67], v[200:203], v[168:171], v[64:67]
    v_exp_f32 v209, v121
    v_mfma_f32_16x16x32_bf16 v[68:71], v[200:203], v[172:175], v[68:71]
    ds_read_b128 v[200:203], v3 offset:47104
    v_mfma_f32_16x16x32_bf16 v[72:75], v[204:207], v[168:171], v[72:75]
    s_waitcnt lgkmcnt(3)
    v_exp_f32 v210, v122
    v_mfma_f32_16x16x32_bf16 v[76:79], v[204:207], v[172:175], v[76:79]
    ds_read_b128 v[204:207], v3 offset:48128
    v_cvt_pk_bf16_f32 v162, v208, v209
    v_mfma_f32_16x16x32_bf16 v[128:131], v[176:179], v[80:83], v[144:147]
    v_exp_f32 v211, v123
    v_mfma_f32_16x16x32_bf16 v[132:135], v[176:179], v[96:99], v[148:151]
    ds_read_b128 v[176:179], v3 offset:32768
    v_cvt_pk_bf16_f32 v163, v210, v211
    v_mfma_f32_16x16x32_bf16 v[128:131], v[180:183], v[84:87], v[128:131]
    v_exp_f32 v212, v124
    v_mfma_f32_16x16x32_bf16 v[132:135], v[180:183], v[100:103], v[132:135]
    ds_read_b128 v[180:183], v3 offset:33792
    v_mfma_f32_16x16x32_bf16 v[228:231], v[244:247], v[160:163], v[236:239]
    v_exp_f32 v213, v125
    v_mfma_f32_16x16x32_bf16 v[128:131], v[184:187], v[88:91], v[128:131]
    v_exp_f32 v214, v126
    v_mfma_f32_16x16x32_bf16 v[132:135], v[184:187], v[104:107], v[132:135]
    ds_read_b128 v[184:187], v3 offset:34816
    v_cvt_pk_bf16_f32 v166, v212, v213
    v_mfma_f32_16x16x32_bf16 v[128:131], v[188:191], v[92:95], v[128:131]
    s_waitcnt lgkmcnt(3)
    v_exp_f32 v215, v127
    v_mfma_f32_16x16x32_bf16 v[132:135], v[188:191], v[108:111], v[132:135]
    ds_read_b128 v[188:191], v3 offset:35840
    v_cvt_pk_bf16_f32 v167, v214, v215
    v_mfma_f32_16x16x32_bf16 v[136:139], v[192:195], v[80:83], v[152:155]
    s_nop 0
    v_mfma_f32_16x16x32_bf16 v[232:235], v[244:247], v[164:167], v[240:243]
    v_mfma_f32_16x16x32_bf16 v[140:143], v[192:195], v[96:99], v[156:159]
    ds_read_b128 v[192:195], v3 offset:36864
    v_mfma_f32_16x16x32_bf16 v[136:139], v[196:199], v[84:87], v[136:139]
    v_exp_f32 v208, v128
    v_mfma_f32_16x16x32_bf16 v[140:143], v[196:199], v[100:103], v[140:143]
    ds_read_b128 v[196:199], v3 offset:37888
    v_cmp_nge_f32 s[50:51], s42, v228
    v_mfma_f32_16x16x32_bf16 v[136:139], v[200:203], v[88:91], v[136:139]
    s_waitcnt lgkmcnt(2)
    v_exp_f32 v209, v129
    v_mfma_f32_16x16x32_bf16 v[140:143], v[200:203], v[104:107], v[140:143]
    ds_read_b128 v[200:203], v3 offset:38912
    v_cmp_nge_f32 vcc, s42, v232
    v_mfma_f32_16x16x32_bf16 v[136:139], v[204:207], v[92:95], v[136:139]
    s_or_b64 vcc, vcc, s[50:51]
    v_exp_f32 v210, v130
    v_mfma_f32_16x16x32_bf16 v[140:143], v[204:207], v[108:111], v[140:143]
    ds_read_b128 v[204:207], v3 offset:39936
    s_cbranch_vccnz stub_32
ret_31:
    v_mfma_f32_16x16x32_bf16 v[16:19], v[176:179], v[160:163], v[16:19]
    v_exp_f32 v211, v131
    v_mfma_f32_16x16x32_bf16 v[20:23], v[176:179], v[164:167], v[20:23]
    ds_read_b128 v[176:179], v3 offset:57344
    v_cvt_pk_bf16_f32 v168, v208, v209
    v_mfma_f32_16x16x32_bf16 v[24:27], v[180:183], v[160:163], v[24:27]
    v_exp_f32 v212, v132
    v_mfma_f32_16x16x32_bf16 v[28:31], v[180:183], v[164:167], v[28:31]
    ds_read_b128 v[180:183], v3 offset:58368
    v_cvt_pk_bf16_f32 v169, v210, v211
    v_mfma_f32_16x16x32_bf16 v[32:35], v[184:187], v[160:163], v[32:35]
    v_exp_f32 v213, v133
    v_mfma_f32_16x16x32_bf16 v[36:39], v[184:187], v[164:167], v[36:39]
    ds_read_b128 v[184:187], v3 offset:59392
    v_mfma_f32_16x16x32_bf16 v[40:43], v[188:191], v[160:163], v[40:43]
    s_waitcnt lgkmcnt(3)
    v_exp_f32 v214, v134
    v_mfma_f32_16x16x32_bf16 v[44:47], v[188:191], v[164:167], v[44:47]
    ds_read_b128 v[188:191], v3 offset:60416
    v_cvt_pk_bf16_f32 v172, v212, v213
    v_mfma_f32_16x16x32_bf16 v[48:51], v[192:195], v[160:163], v[48:51]
    v_exp_f32 v215, v135
    v_mfma_f32_16x16x32_bf16 v[52:55], v[192:195], v[164:167], v[52:55]
    ds_read_b128 v[192:195], v3 offset:61440
    v_mfma_f32_16x16x32_bf16 v[56:59], v[196:199], v[160:163], v[56:59]
    v_exp_f32 v208, v136
    v_mfma_f32_16x16x32_bf16 v[60:63], v[196:199], v[164:167], v[60:63]
    ds_read_b128 v[196:199], v3 offset:62464
    v_cvt_pk_bf16_f32 v173, v214, v215
    v_mfma_f32_16x16x32_bf16 v[64:67], v[200:203], v[160:163], v[64:67]
    v_exp_f32 v209, v137
    v_mfma_f32_16x16x32_bf16 v[68:71], v[200:203], v[164:167], v[68:71]
    ds_read_b128 v[200:203], v3 offset:63488
    v_mfma_f32_16x16x32_bf16 v[72:75], v[204:207], v[160:163], v[72:75]
    s_waitcnt lgkmcnt(3)
    v_exp_f32 v210, v138
    v_mfma_f32_16x16x32_bf16 v[76:79], v[204:207], v[164:167], v[76:79]
    ds_read_b128 v[204:207], v3 offset:64512
    v_cvt_pk_bf16_f32 v170, v208, v209
    v_mfma_f32_16x16x32_bf16 v[112:115], v[176:179], v[80:83], v[144:147]
    v_exp_f32 v211, v139
    v_mfma_f32_16x16x32_bf16 v[116:119], v[176:179], v[96:99], v[148:151]
    ds_read_b128 v[176:179], v3 offset:49152
    v_cvt_pk_bf16_f32 v171, v210, v211
    v_mfma_f32_16x16x32_bf16 v[112:115], v[180:183], v[84:87], v[112:115]
    v_exp_f32 v212, v140
    v_mfma_f32_16x16x32_bf16 v[116:119], v[180:183], v[100:103], v[116:119]
    ds_read_b128 v[180:183], v3 offset:50176
    v_mfma_f32_16x16x32_bf16 v[236:239], v[244:247], v[168:171], v[228:231]
    v_exp_f32 v213, v141
    v_mfma_f32_16x16x32_bf16 v[112:115], v[184:187], v[88:91], v[112:115]
    v_exp_f32 v214, v142
    v_mfma_f32_16x16x32_bf16 v[116:119], v[184:187], v[104:107], v[116:119]
    ds_read_b128 v[184:187], v3 offset:51200
    v_cvt_pk_bf16_f32 v174, v212, v213
    v_mfma_f32_16x16x32_bf16 v[112:115], v[188:191], v[92:95], v[112:115]
    s_waitcnt lgkmcnt(3)
    v_exp_f32 v215, v143
    v_mfma_f32_16x16x32_bf16 v[116:119], v[188:191], v[108:111], v[116:119]
    ds_read_b128 v[188:191], v3 offset:52224
    v_cvt_pk_bf16_f32 v175, v214, v215
    v_mfma_f32_16x16x32_bf16 v[120:123], v[192:195], v[80:83], v[152:155]
    s_nop 0
    v_mfma_f32_16x16x32_bf16 v[240:243], v[244:247], v[172:175], v[232:235]
    v_mfma_f32_16x16x32_bf16 v[124:127], v[192:195], v[96:99], v[156:159]
    ds_read_b128 v[192:195], v3 offset:53248
    v_mfma_f32_16x16x32_bf16 v[120:123], v[196:199], v[84:87], v[120:123]
    v_exp_f32 v208, v112
    v_mfma_f32_16x16x32_bf16 v[124:127], v[196:199], v[100:103], v[124:127]
    ds_read_b128 v[196:199], v3 offset:54272
    v_cmp_nge_f32 s[50:51], s42, v236
    v_mfma_f32_16x16x32_bf16 v[120:123], v[200:203], v[88:91], v[120:123]
    s_waitcnt lgkmcnt(2)
    v_exp_f32 v209, v113
    v_mfma_f32_16x16x32_bf16 v[124:127], v[200:203], v[104:107], v[124:127]
    ds_read_b128 v[200:203], v3 offset:55296
    v_cmp_nge_f32 vcc, s42, v240
    v_mfma_f32_16x16x32_bf16 v[120:123], v[204:207], v[92:95], v[120:123]
    s_or_b64 vcc, vcc, s[50:51]
    v_exp_f32 v210, v114
    v_mfma_f32_16x16x32_bf16 v[124:127], v[204:207], v[108:111], v[124:127]
    ds_read_b128 v[204:207], v3 offset:56320
    s_cbranch_vccnz stub_34
ret_33:
    v_mfma_f32_16x16x32_bf16 v[16:19], v[176:179], v[168:171], v[16:19]
    v_exp_f32 v211, v115
    v_mfma_f32_16x16x32_bf16 v[20:23], v[176:179], v[172:175], v[20:23]
    v_cvt_pk_bf16_f32 v160, v208, v209
    v_mfma_f32_16x16x32_bf16 v[24:27], v[180:183], v[168:171], v[24:27]
    v_exp_f32 v212, v116
    v_mfma_f32_16x16x32_bf16 v[28:31], v[180:183], v[172:175], v[28:31]
    v_cvt_pk_bf16_f32 v161, v210, v211
    v_mfma_f32_16x16x32_bf16 v[32:35], v[184:187], v[168:171], v[32:35]
    v_exp_f32 v213, v117
    v_mfma_f32_16x16x32_bf16 v[36:39], v[184:187], v[172:175], v[36:39]
    v_mfma_f32_16x16x32_bf16 v[40:43], v[188:191], v[168:171], v[40:43]
    s_waitcnt lgkmcnt(0)
    s_barrier
    v_xor_b32 v3, 65536, v3
    ds_read_b128 v[176:179], v3 offset:8192
    v_exp_f32 v214, v118
    v_mfma_f32_16x16x32_bf16 v[44:47], v[188:191], v[172:175], v[44:47]
    ds_read_b128 v[180:183], v3 offset:9216
    ds_read_b128 v[184:187], v3 offset:10240
    v_cvt_pk_bf16_f32 v164, v212, v213
    v_mfma_f32_16x16x32_bf16 v[48:51], v[192:195], v[168:171], v[48:51]
    v_exp_f32 v215, v119
    v_mfma_f32_16x16x32_bf16 v[52:55], v[192:195], v[172:175], v[52:55]
    ds_read_b128 v[188:191], v3 offset:11264
    ds_read_b128 v[192:195], v3 offset:12288
    v_mfma_f32_16x16x32_bf16 v[56:59], v[196:199], v[168:171], v[56:59]
    v_exp_f32 v208, v120
    v_mfma_f32_16x16x32_bf16 v[60:63], v[196:199], v[172:175], v[60:63]
    ds_read_b128 v[196:199], v3 offset:13312
    v_cvt_pk_bf16_f32 v165, v214, v215
    v_mfma_f32_16x16x32_bf16 v[64:67], v[200:203], v[168:171], v[64:67]
    v_exp_f32 v209, v121
    v_mfma_f32_16x16x32_bf16 v[68:71], v[200:203], v[172:175], v[68:71]
    ds_read_b128 v[200:203], v3 offset:14336
    v_mfma_f32_16x16x32_bf16 v[72:75], v[204:207], v[168:171], v[72:75]
    s_waitcnt lgkmcnt(3)
    v_exp_f32 v210, v122
    v_mfma_f32_16x16x32_bf16 v[76:79], v[204:207], v[172:175], v[76:79]
    ds_read_b128 v[204:207], v3 offset:15360
    v_cvt_pk_bf16_f32 v162, v208, v209
    s_cmp_ge_u32 s34, 5
    s_cbranch_scc1 attn_loop_26
attn_slow_25:
    s_cmp_le_u32 s34, 1
    s_cbranch_scc1 special_35
back_36:
    v_mfma_f32_16x16x32_bf16 v[128:131], v[176:179], v[80:83], v[144:147]
    v_exp_f32 v211, v123
    v_mfma_f32_16x16x32_bf16 v[132:135], v[176:179], v[96:99], v[148:151]
    ds_read_b128 v[176:179], v3 offset:0
    v_cvt_pk_bf16_f32 v163, v210, v211
    v_mfma_f32_16x16x32_bf16 v[128:131], v[180:183], v[84:87], v[128:131]
    v_exp_f32 v212, v124
    v_mfma_f32_16x16x32_bf16 v[132:135], v[180:183], v[100:103], v[132:135]
    ds_read_b128 v[180:183], v3 offset:1024
    v_mfma_f32_16x16x32_bf16 v[228:231], v[244:247], v[160:163], v[236:239]
    v_exp_f32 v213, v125
    v_mfma_f32_16x16x32_bf16 v[128:131], v[184:187], v[88:91], v[128:131]
    v_exp_f32 v214, v126
    v_mfma_f32_16x16x32_bf16 v[132:135], v[184:187], v[104:107], v[132:135]
    ds_read_b128 v[184:187], v3 offset:2048
    v_cvt_pk_bf16_f32 v166, v212, v213
    v_mfma_f32_16x16x32_bf16 v[128:131], v[188:191], v[92:95], v[128:131]
    s_waitcnt lgkmcnt(3)
    v_exp_f32 v215, v127
    v_mfma_f32_16x16x32_bf16 v[132:135], v[188:191], v[108:111], v[132:135]
    ds_read_b128 v[188:191], v3 offset:3072
    v_cvt_pk_bf16_f32 v167, v214, v215
    v_mfma_f32_16x16x32_bf16 v[136:139], v[192:195], v[80:83], v[152:155]
    s_sub_u32 s34, s34, 1
    v_mfma_f32_16x16x32_bf16 v[232:235], v[244:247], v[164:167], v[240:243]
    v_mfma_f32_16x16x32_bf16 v[140:143], v[192:195], v[96:99], v[156:159]
    ds_read_b128 v[192:195], v3 offset:4096
    v_mfma_f32_16x16x32_bf16 v[136:139], v[196:199], v[84:87], v[136:139]
    v_exp_f32 v208, v128
    v_mfma_f32_16x16x32_bf16 v[140:143], v[196:199], v[100:103], v[140:143]
    ds_read_b128 v[196:199], v3 offset:5120
    v_cmp_nge_f32 s[50:51], s42, v228
    v_mfma_f32_16x16x32_bf16 v[136:139], v[200:203], v[88:91], v[136:139]
    s_waitcnt lgkmcnt(2)
    v_exp_f32 v209, v129
    v_mfma_f32_16x16x32_bf16 v[140:143], v[200:203], v[104:107], v[140:143]
    ds_read_b128 v[200:203], v3 offset:6144
    v_cmp_nge_f32 vcc, s42, v232
    v_mfma_f32_16x16x32_bf16 v[136:139], v[204:207], v[92:95], v[136:139]
    s_or_b64 vcc, vcc, s[50:51]
    v_exp_f32 v210, v130
    v_mfma_f32_16x16x32_bf16 v[140:143], v[204:207], v[108:111], v[140:143]
    ds_read_b128 v[204:207], v3 offset:7168
    s_cbranch_vccnz stub_38
ret_37:
    v_mfma_f32_16x16x32_bf16 v[16:19], v[176:179], v[160:163], v[16:19]
    v_exp_f32 v211, v131
    v_mfma_f32_16x16x32_bf16 v[20:23], v[176:179], v[164:167], v[20:23]
    ds_read_b128 v[176:179], v3 offset:24576
    v_cvt_pk_bf16_f32 v168, v208, v209
    v_mfma_f32_16x16x32_bf16 v[24:27], v[180:183], v[160:163], v[24:27]
    v_exp_f32 v212, v132
    v_mfma_f32_16x16x32_bf16 v[28:31], v[180:183], v[164:167], v[28:31]
    ds_read_b128 v[180:183], v3 offset:25600
    v_cvt_pk_bf16_f32 v169, v210, v211
    v_mfma_f32_16x16x32_bf16 v[32:35], v[184:187], v[160:163], v[32:35]
    v_exp_f32 v213, v133
    v_mfma_f32_16x16x32_bf16 v[36:39], v[184:187], v[164:167], v[36:39]
    ds_read_b128 v[184:187], v3 offset:26624
    v_mfma_f32_16x16x32_bf16 v[40:43], v[188:191], v[160:163], v[40:43]
    s_waitcnt lgkmcnt(3)
    v_exp_f32 v214, v134
    v_mfma_f32_16x16x32_bf16 v[44:47], v[188:191], v[164:167], v[44:47]
    ds_read_b128 v[188:191], v3 offset:27648
    v_cvt_pk_bf16_f32 v172, v212, v213
    v_mfma_f32_16x16x32_bf16 v[48:51], v[192:195], v[160:163], v[48:51]
    v_exp_f32 v215, v135
    v_mfma_f32_16x16x32_bf16 v[52:55], v[192:195], v[164:167], v[52:55]
    ds_read_b128 v[192:195], v3 offset:28672
    v_mfma_f32_16x16x32_bf16 v[56:59], v[196:199], v[160:163], v[56:59]
    v_exp_f32 v208, v136
    v_mfma_f32_16x16x32_bf16 v[60:63], v[196:199], v[164:167], v[60:63]
    ds_read_b128 v[196:199], v3 offset:29696
    v_cvt_pk_bf16_f32 v173, v214, v215
    v_mfma_f32_16x16x32_bf16 v[64:67], v[200:203], v[160:163], v[64:67]
    v_exp_f32 v209, v137
    v_mfma_f32_16x16x32_bf16 v[68:71], v[200:203], v[164:167], v[68:71]
    ds_read_b128 v[200:203], v3 offset:30720
    v_mfma_f32_16x16x32_bf16 v[72:75], v[204:207], v[160:163], v[72:75]
    s_waitcnt lgkmcnt(3)
    v_exp_f32 v210, v138
    v_mfma_f32_16x16x32_bf16 v[76:79], v[204:207], v[164:167], v[76:79]
    ds_read_b128 v[204:207], v3 offset:31744
    v_cvt_pk_bf16_f32 v170, v208, v209
    s_cmp_le_u32 s34, 1
    s_cbranch_scc1 special_39
back_40:
    v_mfma_f32_16x16x32_bf16 v[112:115], v[176:179], v[80:83], v[144:147]
    v_exp_f32 v211, v139
    v_mfma_f32_16x16x32_bf16 v[116:119], v[176:179], v[96:99], v[148:151]
    ds_read_b128 v[176:179], v3 offset:16384
    v_cvt_pk_bf16_f32 v171, v210, v211
    v_mfma_f32_16x16x32_bf16 v[112:115], v[180:183], v[84:87], v[112:115]
    v_exp_f32 v212, v140
    v_mfma_f32_16x16x32_bf16 v[116:119], v[180:183], v[100:103], v[116:119]
    ds_read_b128 v[180:183], v3 offset:17408
    v_mfma_f32_16x16x32_bf16 v[236:239], v[244:247], v[168:171], v[228:231]
    v_exp_f32 v213, v141
    v_mfma_f32_16x16x32_bf16 v[112:115], v[184:187], v[88:91], v[112:115]
    v_exp_f32 v214, v142
    v_mfma_f32_16x16x32_bf16 v[116:119], v[184:187], v[104:107], v[116:119]
    ds_read_b128 v[184:187], v3 offset:18432
    v_cvt_pk_bf16_f32 v174, v212, v213
    v_mfma_f32_16x16x32_bf16 v[112:115], v[188:191], v[92:95], v[112:115]
    s_waitcnt lgkmcnt(3)
    v_exp_f32 v215, v143
    v_mfma_f32_16x16x32_bf16 v[116:119], v[188:191], v[108:111], v[116:119]
    ds_read_b128 v[188:191], v3 offset:19456
    v_cvt_pk_bf16_f32 v175, v214, v215
    v_mfma_f32_16x16x32_bf16 v[120:123], v[192:195], v[80:83], v[152:155]
    s_sub_u32 s34, s34, 1
    v_mfma_f32_16x16x32_bf16 v[240:243], v[244:247], v[172:175], v[232:235]
    v_mfma_f32_16x16x32_bf16 v[124:127], v[192:195], v[96:99], v[156:159]
    ds_read_b128 v[192:195], v3 offset:20480
    v_mfma_f32_16x16x32_bf16 v[120:123], v[196:199], v[84:87], v[120:123]
    v_exp_f32 v208, v112
    v_mfma_f32_16x16x32_bf16 v[124:127], v[196:199], v[100:103], v[124:127]
    ds_read_b128 v[196:199], v3 offset:21504
    v_cmp_nge_f32 s[50:51], s42, v236
    v_mfma_f32_16x16x32_bf16 v[120:123], v[200:203], v[88:91], v[120:123]
    s_waitcnt lgkmcnt(2)
    v_exp_f32 v209, v113
    v_mfma_f32_16x16x32_bf16 v[124:127], v[200:203], v[104:107], v[124:127]
    ds_read_b128 v[200:203], v3 offset:22528
    v_cmp_nge_f32 vcc, s42, v240
    v_mfma_f32_16x16x32_bf16 v[120:123], v[204:207], v[92:95], v[120:123]
    s_or_b64 vcc, vcc, s[50:51]
    v_exp_f32 v210, v114
    v_mfma_f32_16x16x32_bf16 v[124:127], v[204:207], v[108:111], v[124:127]
    ds_read_b128 v[204:207], v3 offset:23552
    s_cbranch_vccnz stub_42
ret_41:
    v_mfma_f32_16x16x32_bf16 v[16:19], v[176:179], v[168:171], v[16:19]
    v_exp_f32 v211, v115
    v_mfma_f32_16x16x32_bf16 v[20:23], v[176:179], v[172:175], v[20:23]
    v_cvt_pk_bf16_f32 v160, v208, v209
    v_mfma_f32_16x16x32_bf16 v[24:27], v[180:183], v[168:171], v[24:27]
    v_exp_f32 v212, v116
    v_mfma_f32_16x16x32_bf16 v[28:31], v[180:183], v[172:175], v[28:31]
    v_cvt_pk_bf16_f32 v161, v210, v211
    v_mfma_f32_16x16x32_bf16 v[32:35], v[184:187], v[168:171], v[32:35]
    v_exp_f32 v213, v117
    v_mfma_f32_16x16x32_bf16 v[36:39], v[184:187], v[172:175], v[36:39]
    v_mfma_f32_16x16x32_bf16 v[40:43], v[188:191], v[168:171], v[40:43]
    s_waitcnt lgkmcnt(0)
    s_cmp_lt_u32 s34, 2
    s_cbranch_scc1 nobar_43
    s_barrier
nobar_43:
    ds_read_b128 v[176:179], v3 offset:40960
    v_exp_f32 v214, v118
    v_mfma_f32_16x16x32_bf16 v[44:47], v[188:191], v[172:175], v[44:47]
    ds_read_b128 v[180:183], v3 offset:41984
    ds_read_b128 v[184:187], v3 offset:43008
    v_cvt_pk_bf16_f32 v164, v212, v213
    v_mfma_f32_16x16x32_bf16 v[48:51], v[192:195], v[168:171], v[48:51]
    v_exp_f32 v215, v119
    v_mfma_f32_16x16x32_bf16 v[52:55], v[192:195], v[172:175], v[52:55]
    ds_read_b128 v[188:191], v3 offset:44032
    ds_read_b128 v[192:195], v3 offset:45056
    v_mfma_f32_16x16x32_bf16 v[56:59], v[196:199], v[168:171], v[56:59]
    v_exp_f32 v208, v120
    v_mfma_f32_16x16x32_bf16 v[60:63], v[196:199], v[172:175], v[60:63]
    ds_read_b128 v[196:199], v3 offset:46080
    v_cvt_pk_bf16_f32 v165, v214, v215
    v_mfma_f32_16x16x32_bf16 v[64:67], v[200:203], v[168:171], v[64:67]
    v_exp_f32 v209, v121
    v_mfma_f32_16x16x32_bf16 v[68:71], v[200:203], v[172:175], v[68:71]
    ds_read_b128 v[200:203], v3 offset:47104
    v_mfma_f32_16x16x32_bf16 v[72:75], v[204:207], v[168:171], v[72:75]
    s_waitcnt lgkmcnt(3)
    v_exp_f32 v210, v122
    v_mfma_f32_16x16x32_bf16 v[76:79], v[204:207], v[172:175], v[76:79]
    ds_read_b128 v[204:207], v3 offset:48128
    v_cvt_pk_bf16_f32 v162, v208, v209
    s_cmp_le_u32 s34, 1
    s_cbranch_scc1 special_44
back_45:
    v_mfma_f32_16x16x32_bf16 v[128:131], v[176:179], v[80:83], v[144:147]
    v_exp_f32 v211, v123
    v_mfma_f32_16x16x32_bf16 v[132:135], v[176:179], v[96:99], v[148:151]
    ds_read_b128 v[176:179], v3 offset:32768
    v_cvt_pk_bf16_f32 v163, v210, v211
    v_mfma_f32_16x16x32_bf16 v[128:131], v[180:183], v[84:87], v[128:131]
    v_exp_f32 v212, v124
    v_mfma_f32_16x16x32_bf16 v[132:135], v[180:183], v[100:103], v[132:135]
    ds_read_b128 v[180:183], v3 offset:33792
    v_mfma_f32_16x16x32_bf16 v[228:231], v[244:247], v[160:163], v[236:239]
    v_exp_f32 v213, v125
    v_mfma_f32_16x16x32_bf16 v[128:131], v[184:187], v[88:91], v[128:131]
    v_exp_f32 v214, v126
    v_mfma_f32_16x16x32_bf16 v[132:135], v[184:187], v[104:107], v[132:135]
    ds_read_b128 v[184:187], v3 offset:34816
    v_cvt_pk_bf16_f32 v166, v212, v213
    v_mfma_f32_16x16x32_bf16 v[128:131], v[188:191], v[92:95], v[128:131]
    s_waitcnt lgkmcnt(3)
    v_exp_f32 v215, v127
    v_mfma_f32_16x16x32_bf16 v[132:135], v[188:191], v[108:111], v[132:135]
    ds_read_b128 v[188:191], v3 offset:35840
    v_cvt_pk_bf16_f32 v167, v214, v215
    v_mfma_f32_16x16x32_bf16 v[136:139], v[192:195], v[80:83], v[152:155]
    s_sub_u32 s34, s34, 1
    v_mfma_f32_16x16x32_bf16 v[232:235], v[244:247], v[164:167], v[240:243]
    v_mfma_f32_16x16x32_bf16 v[140:143], v[192:195], v[96:99], v[156:159]
    ds_read_b128 v[192:195], v3 offset:36864
    v_mfma_f32_16x16x32_bf16 v[136:139], v[196:199], v[84:87], v[136:139]
    v_exp_f32 v208, v128
    v_mfma_f32_16x16x32_bf16 v[140:143], v[196:199], v[100:103], v[140:143]
    ds_read_b128 v[196:199], v3 offset:37888
    v_cmp_nge_f32 s[50:51], s42, v228
    v_mfma_f32_16x16x32_bf16 v[136:139], v[200:203], v[88:91], v[136:139]
    s_waitcnt lgkmcnt(2)
    v_exp_f32 v209, v129
    v_mfma_f32_16x16x32_bf16 v[140:143], v[200:203], v[104:107], v[140:143]
    ds_read_b128 v[200:203], v3 offset:38912
    v_cmp_nge_f32 vcc, s42, v232
    v_mfma_f32_16x16x32_bf16 v[136:139], v[204:207], v[92:95], v[136:139]
    s_or_b64 vcc, vcc, s[50:51]
    v_exp_f32 v210, v130
    v_mfma_f32_16x16x32_bf16 v[140:143], v[204:207], v[108:111], v[140:143]
    ds_read_b128 v[204:207], v3 offset:39936
    s_cbranch_vccnz stub_47
ret_46:
    v_mfma_f32_16x16x32_bf16 v[16:19], v[176:179], v[160:163], v[16:19]
    v_exp_f32 v211, v131
    v_mfma_f32_16x16x32_bf16 v[20:23], v[176:179], v[164:167], v[20:23]
    ds_read_b128 v[176:179], v3 offset:57344
    v_cvt_pk_bf16_f32 v168, v208, v209
    v_mfma_f32_16x16x32_bf16 v[24:27], v[180:183], v[160:163], v[24:27]
    v_exp_f32 v212, v132
    v_mfma_f32_16x16x32_bf16 v[28:31], v[180:183], v[164:167], v[28:31]
    ds_read_b128 v[180:183], v3 offset:58368
    v_cvt_pk_bf16_f32 v169, v210, v211
    v_mfma_f32_16x16x32_bf16 v[32:35], v[184:187], v[160:163], v[32:35]
    v_exp_f32 v213, v133
    v_mfma_f32_16x16x32_bf16 v[36:39], v[184:187], v[164:167], v[36:39]
    ds_read_b128 v[184:187], v3 offset:59392
    v_mfma_f32_16x16x32_bf16 v[40:43], v[188:191], v[160:163], v[40:43]
    s_waitcnt lgkmcnt(3)
    v_exp_f32 v214, v134
    v_mfma_f32_16x16x32_bf16 v[44:47], v[188:191], v[164:167], v[44:47]
    ds_read_b128 v[188:191], v3 offset:60416
    v_cvt_pk_bf16_f32 v172, v212, v213
    v_mfma_f32_16x16x32_bf16 v[48:51], v[192:195], v[160:163], v[48:51]
    v_exp_f32 v215, v135
    v_mfma_f32_16x16x32_bf16 v[52:55], v[192:195], v[164:167], v[52:55]
    ds_read_b128 v[192:195], v3 offset:61440
    v_mfma_f32_16x16x32_bf16 v[56:59], v[196:199], v[160:163], v[56:59]
    v_exp_f32 v208, v136
    v_mfma_f32_16x16x32_bf16 v[60:63], v[196:199], v[164:167], v[60:63]
    ds_read_b128 v[196:199], v3 offset:62464
    v_cvt_pk_bf16_f32 v173, v214, v215
    v_mfma_f32_16x16x32_bf16 v[64:67], v[200:203], v[160:163], v[64:67]
    v_exp_f32 v209, v137
    v_mfma_f32_16x16x32_bf16 v[68:71], v[200:203], v[164:167], v[68:71]
    ds_read_b128 v[200:203], v3 offset:63488
    v_mfma_f32_16x16x32_bf16 v[72:75], v[204:207], v[160:163], v[72:75]
    s_waitcnt lgkmcnt(3)
    v_exp_f32 v210, v138
    v_mfma_f32_16x16x32_bf16 v[76:79], v[204:207], v[164:167], v[76:79]
    ds_read_b128 v[204:207], v3 offset:64512
    v_cvt_pk_bf16_f32 v170, v208, v209
    s_cmp_le_u32 s34, 1
    s_cbranch_scc1 special_48
back_49:
    v_mfma_f32_16x16x32_bf16 v[112:115], v[176:179], v[80:83], v[144:147]
    v_exp_f32 v211, v139
    v_mfma_f32_16x16x32_bf16 v[116:119], v[176:179], v[96:99], v[148:151]
    ds_read_b128 v[176:179], v3 offset:49152
    v_cvt_pk_bf16_f32 v171, v210, v211
    v_mfma_f32_16x16x32_bf16 v[112:115], v[180:183], v[84:87], v[112:115]
    v_exp_f32 v212, v140
    v_mfma_f32_16x16x32_bf16 v[116:119], v[180:183], v[100:103], v[116:119]
    ds_read_b128 v[180:183], v3 offset:50176
    v_mfma_f32_16x16x32_bf16 v[236:239], v[244:247], v[168:171], v[228:231]
    v_exp_f32 v213, v141
    v_mfma_f32_16x16x32_bf16 v[112:115], v[184:187], v[88:91], v[112:115]
    v_exp_f32 v214, v142
    v_mfma_f32_16x16x32_bf16 v[116:119], v[184:187], v[104:107], v[116:119]
    ds_read_b128 v[184:187], v3 offset:51200
    v_cvt_pk_bf16_f32 v174, v212, v213
    v_mfma_f32_16x16x32_bf16 v[112:115], v[188:191], v[92:95], v[112:115]
    s_waitcnt lgkmcnt(3)
    v_exp_f32 v215, v143
    v_mfma_f32_16x16x32_bf16 v[116:119], v[188:191], v[108:111], v[116:119]
    ds_read_b128 v[188:191], v3 offset:52224
    v_cvt_pk_bf16_f32 v175, v214, v215
    v_mfma_f32_16x16x32_bf16 v[120:123], v[192:195], v[80:83], v[152:155]
    s_sub_u32 s34, s34, 1
    v_mfma_f32_16x16x32_bf16 v[240:243], v[244:247], v[172:175], v[232:235]
    v_mfma_f32_16x16x32_bf16 v[124:127], v[192:195], v[96:99], v[156:159]
    ds_read_b128 v[192:195], v3 offset:53248
    v_mfma_f32_16x16x32_bf16 v[120:123], v[196:199], v[84:87], v[120:123]
    v_exp_f32 v208, v112
    v_mfma_f32_16x16x32_bf16 v[124:127], v[196:199], v[100:103], v[124:127]
    ds_read_b128 v[196:199], v3 offset:54272
    v_cmp_nge_f32 s[50:51], s42, v236
    v_mfma_f32_16x16x32_bf16 v[120:123], v[200:203], v[88:91], v[120:123]
    s_waitcnt lgkmcnt(2)
    v_exp_f32 v209, v113
    v_mfma_f32_16x16x32_bf16 v[124:127], v[200:203], v[104:107], v[124:127]
    ds_read_b128 v[200:203], v3 offset:55296
    v_cmp_nge_f32 vcc, s42, v240
    v_mfma_f32_16x16x32_bf16 v[120:123], v[204:207], v[92:95], v[120:123]
    s_or_b64 vcc, vcc, s[50:51]
    v_exp_f32 v210, v114
    v_mfma_f32_16x16x32_bf16 v[124:127], v[204:207], v[108:111], v[124:127]
    ds_read_b128 v[204:207], v3 offset:56320
    s_cbranch_vccnz stub_51
ret_50:
    v_mfma_f32_16x16x32_bf16 v[16:19], v[176:179], v[168:171], v[16:19]
    v_exp_f32 v211, v115
    v_mfma_f32_16x16x32_bf16 v[20:23], v[176:179], v[172:175], v[20:23]
    v_cvt_pk_bf16_f32 v160, v208, v209
    v_mfma_f32_16x16x32_bf16 v[24:27], v[180:183], v[168:171], v[24:27]
    v_exp_f32 v212, v116
    v_mfma_f32_16x16x32_bf16 v[28:31], v[180:183], v[172:175], v[28:31]
    v_cvt_pk_bf16_f32 v161, v210, v211
    v_mfma_f32_16x16x32_bf16 v[32:35], v[184:187], v[168:171], v[32:35]
    v_exp_f32 v213, v117
    v_mfma_f32_16x16x32_bf16 v[36:39], v[184:187], v[172:175], v[36:39]
    v_mfma_f32_16x16x32_bf16 v[40:43], v[188:191], v[168:171], v[40:43]
    s_waitcnt lgkmcnt(0)
    s_barrier
    v_xor_b32 v3, 65536, v3
    ds_read_b128 v[176:179], v3 offset:8192
    v_exp_f32 v214, v118
    v_mfma_f32_16x16x32_bf16 v[44:47], v[188:191], v[172:175], v[44:47]
    ds_read_b128 v[180:183], v3 offset:9216
    ds_read_b128 v[184:187], v3 offset:10240
    v_cvt_pk_bf16_f32 v164, v212, v213
    v_mfma_f32_16x16x32_bf16 v[48:51], v[192:195], v[168:171], v[48:51]
    v_exp_f32 v215, v119
    v_mfma_f32_16x16x32_bf16 v[52:55], v[192:195], v[172:175], v[52:55]
    ds_read_b128 v[188:191], v3 offset:11264
    ds_read_b128 v[192:195], v3 offset:12288
    v_mfma_f32_16x16x32_bf16 v[56:59], v[196:199], v[168:171], v[56:59]
    v_exp_f32 v208, v120
    v_mfma_f32_16x16x32_bf16 v[60:63], v[196:199], v[172:175], v[60:63]
    ds_read_b128 v[196:199], v3 offset:13312
    v_cvt_pk_bf16_f32 v165, v214, v215
    v_mfma_f32_16x16x32_bf16 v[64:67], v[200:203], v[168:171], v[64:67]
    v_exp_f32 v209, v121
    v_mfma_f32_16x16x32_bf16 v[68:71], v[200:203], v[172:175], v[68:71]
    ds_read_b128 v[200:203], v3 offset:14336
    v_mfma_f32_16x16x32_bf16 v[72:75], v[204:207], v[168:171], v[72:75]
    s_waitcnt lgkmcnt(3)
    v_exp_f32 v210, v122
    v_mfma_f32_16x16x32_bf16 v[76:79], v[204:207], v[172:175], v[76:79]
    ds_read_b128 v[204:207], v3 offset:15360
    v_cvt_pk_bf16_f32 v162, v208, v209
    s_branch attn_slow_25
loopB_24:
    s_cmp_lt_u32 s34, 5
    s_cbranch_scc1 attn_slow_52
attn_loop_53:
    v_mfma_f32_16x16x32_bf16 v[128:131], v[176:179], v[80:83], v[144:147]
    s_setprio 1
    v_exp_f32 v211, v123
    v_mfma_f32_16x16x32_bf16 v[132:135], v[176:179], v[96:99], v[148:151]
    ds_read_b128 v[176:179], v3 offset:0
    v_cvt_pk_bf16_f32 v163, v210, v211
    v_mfma_f32_16x16x32_bf16 v[128:131], v[180:183], v[84:87], v[128:131]
    v_exp_f32 v212, v124
    v_mfma_f32_16x16x32_bf16 v[132:135], v[180:183], v[100:103], v[132:135]
    ds_read_b128 v[180:183], v3 offset:1024
    v_mfma_f32_16x16x32_bf16 v[228:231], v[244:247], v[160:163], v[236:239]
    v_exp_f32 v213, v125
    v_mfma_f32_16x16x32_bf16 v[128:131], v[184:187], v[88:91], v[128:131]
    v_exp_f32 v214, v126
    v_mfma_f32_16x16x32_bf16 v[132:135], v[184:187], v[104:107], v[132:135]
    ds_read_b128 v[184:187], v3 offset:2048
    v_cvt_pk_bf16_f32 v166, v212, v213
    v_mfma_f32_16x16x32_bf16 v[128:131], v[188:191], v[92:95], v[128:131]
    s_waitcnt lgkmcnt(3)
    v_exp_f32 v215, v127
    v_mfma_f32_16x16x32_bf16 v[132:135], v[188:191], v[108:111], v[132:135]
    ds_read_b128 v[188:191], v3 offset:3072
    v_cvt_pk_bf16_f32 v167, v214, v215
    v_mfma_f32_16x16x32_bf16 v[136:139], v[192:195], v[80:83], v[152:155]
    s_sub_u32 s34, s34, 4
    v_mfma_f32_16x16x32_bf16 v[232:235], v[244:247], v[164:167], v[240:243]
    v_mfma_f32_16x16x32_bf16 v[140:143], v[192:195], v[96:99], v[156:159]
    ds_read_b128 v[192:195], v3 offset:4096
    v_mfma_f32_16x16x32_bf16 v[136:139], v[196:199], v[84:87], v[136:139]
    v_exp_f32 v208, v128
    v_mfma_f32_16x16x32_bf16 v[140:143], v[196:199], v[100:103], v[140:143]
    ds_read_b128 v[196:199], v3 offset:5120
    v_cmp_nge_f32 s[50:51], s42, v228
    v_mfma_f32_16x16x32_bf16 v[136:139], v[200:203], v[88:91], v[136:139]
    s_waitcnt lgkmcnt(2)
    v_exp_f32 v209, v129
    v_mfma_f32_16x16x32_bf16 v[140:143], v[200:203], v[104:107], v[140:143]
    ds_read_b128 v[200:203], v3 offset:6144
    v_cmp_nge_f32 vcc, s42, v232
    v_mfma_f32_16x16x32_bf16 v[136:139], v[204:207], v[92:95], v[136:139]
    s_or_b64 vcc, vcc, s[50:51]
    v_exp_f32 v210, v130
    v_mfma_f32_16x16x32_bf16 v[140:143], v[204:207], v[108:111], v[140:143]
    ds_read_b128 v[204:207], v3 offset:7168
    s_cbranch_vccnz stub_55
ret_54:
    v_mfma_f32_16x16x32_bf16 v[16:19], v[176:179], v[160:163], v[16:19]
    v_exp_f32 v211, v131
    v_mfma_f32_16x16x32_bf16 v[20:23], v[176:179], v[164:167], v[20:23]
    ds_read_b128 v[176:179], v3 offset:24576
    v_cvt_pk_bf16_f32 v168, v208, v209
    v_mfma_f32_16x16x32_bf16 v[24:27], v[180:183], v[160:163], v[24:27]
    v_exp_f32 v212, v132
    v_mfma_f32_16x16x32_bf16 v[28:31], v[180:183], v[164:167], v[28:31]
    ds_read_b128 v[180:183], v3 offset:25600
    v_cvt_pk_bf16_f32 v169, v210, v211
    v_mfma_f32_16x16x32_bf16 v[32:35], v[184:187], v[160:163], v[32:35]
    v_exp_f32 v213, v133
    v_mfma_f32_16x16x32_bf16 v[36:39], v[184:187], v[164:167], v[36:39]
    ds_read_b128 v[184:187], v3 offset:26624
    v_mfma_f32_16x16x32_bf16 v[40:43], v[188:191], v[160:163], v[40:43]
    s_waitcnt lgkmcnt(3)
    v_exp_f32 v214, v134
    v_mfma_f32_16x16x32_bf16 v[44:47], v[188:191], v[164:167], v[44:47]
    ds_read_b128 v[188:191], v3 offset:27648
    v_cvt_pk_bf16_f32 v172, v212, v213
    v_mfma_f32_16x16x32_bf16 v[48:51], v[192:195], v[160:163], v[48:51]
    v_exp_f32 v215, v135
    v_mfma_f32_16x16x32_bf16 v[52:55], v[192:195], v[164:167], v[52:55]
    ds_read_b128 v[192:195], v3 offset:28672
    v_mfma_f32_16x16x32_bf16 v[56:59], v[196:199], v[160:163], v[56:59]
    v_exp_f32 v208, v136
    v_mfma_f32_16x16x32_bf16 v[60:63], v[196:199], v[164:167], v[60:63]
    ds_read_b128 v[196:199], v3 offset:29696
    v_cvt_pk_bf16_f32 v173, v214, v215
    v_mfma_f32_16x16x32_bf16 v[64:67], v[200:203], v[160:163], v[64:67]
    v_exp_f32 v209, v137
    v_mfma_f32_16x16x32_bf16 v[68:71], v[200:203], v[164:167], v[68:71]
    ds_read_b128 v[200:203], v3 offset:30720
    v_mfma_f32_16x16x32_bf16 v[72:75], v[204:207], v[160:163], v[72:75]
    s_waitcnt lgkmcnt(3)
    v_exp_f32 v210, v138
    v_mfma_f32_16x16x32_bf16 v[76:79], v[204:207], v[164:167], v[76:79]
    ds_read_b128 v[204:207], v3 offset:31744
    v_cvt_pk_bf16_f32 v170, v208, v209
    v_mfma_f32_16x16x32_bf16 v[112:115], v[176:179], v[80:83], v[144:147]
    v_exp_f32 v211, v139
    v_mfma_f32_16x16x32_bf16 v[116:119], v[176:179], v[96:99], v[148:151]
    ds_read_b128 v[176:179], v3 offset:16384
    v_cvt_pk_bf16_f32 v171, v210, v211
    v_mfma_f32_16x16x32_bf16 v[112:115], v[180:183], v[84:87], v[112:115]
    v_exp_f32 v212, v140
    v_mfma_f32_16x16x32_bf16 v[116:119], v[180:183], v[100:103], v[116:119]
    ds_read_b128 v[180:183], v3 offset:17408
    v_mfma_f32_16x16x32_bf16 v[236:239], v[244:247], v[168:171], v[228:231]
    v_exp_f32 v213, v141
    v_mfma_f32_16x16x32_bf16 v[112:115], v[184:187], v[88:91], v[112:115]
    v_exp_f32 v214, v142
    v_mfma_f32_16x16x32_bf16 v[116:119], v[184:187], v[104:107], v[116:119]
    ds_read_b128 v[184:187], v3 offset:18432
    v_cvt_pk_bf16_f32 v174, v212, v213
    v_mfma_f32_16x16x32_bf16 v[112:115], v[188:191], v[92:95], v[112:115]
    s_waitcnt lgkmcnt(3)
    v_exp_f32 v215, v143
    v_mfma_f32_16x16x32_bf16 v[116:119], v[188:191], v[108:111], v[116:119]
    ds_read_b128 v[188:191], v3 offset:19456
    v_cvt_pk_bf16_f32 v175, v214, v215
    v_mfma_f32_16x16x32_bf16 v[120:123], v[192:195], v[80:83], v[152:155]
    s_nop 0
    v_mfma_f32_16x16x32_bf16 v[240:243], v[244:247], v[172:175], v[232:235]
    v_mfma_f32_16x16x32_bf16 v[124:127], v[192:195], v[96:99], v[156:159]
    ds_read_b128 v[192:195], v3 offset:20480
    v_mfma_f32_16x16x32_bf16 v[120:123], v[196:199], v[84:87], v[120:123]
    v_exp_f32 v208, v112
    v_mfma_f32_16x16x32_bf16 v[124:127], v[196:199], v[100:103], v[124:127]
    ds_read_b128 v[196:199], v3 offset:21504
    v_cmp_nge_f32 s[50:51], s42, v236
    v_mfma_f32_16x16x32_bf16 v[120:123], v[200:203], v[88:91], v[120:123]
    s_waitcnt lgkmcnt(2)
    v_exp_f32 v209, v113
    v_mfma_f32_16x16x32_bf16 v[124:127], v[200:203], v[104:107], v[124:127]
    ds_read_b128 v[200:203], v3 offset:22528
    v_cmp_nge_f32 vcc, s42, v240
    v_mfma_f32_16x16x32_bf16 v[120:123], v[204:207], v[92:95], v[120:123]
    s_or_b64 vcc, vcc, s[50:51]
    v_exp_f32 v210, v114
    v_mfma_f32_16x16x32_bf16 v[124:127], v[204:207], v[108:111], v[124:127]
    ds_read_b128 v[204:207], v3 offset:23552
    s_cbranch_vccnz stub_57
ret_56:
    v_mfma_f32_16x16x32_bf16 v[16:19], v[176:179], v[168:171], v[16:19]
    v_exp_f32 v211, v115
    v_mfma_f32_16x16x32_bf16 v[20:23], v[176:179], v[172:175], v[20:23]
    v_cvt_pk_bf16_f32 v160, v208, v209
    v_mfma_f32_16x16x32_bf16 v[24:27], v[180:183], v[168:171], v[24:27]
    v_exp_f32 v212, v116
    v_mfma_f32_16x16x32_bf16 v[28:31], v[180:183], v[172:175], v[28:31]
    v_cvt_pk_bf16_f32 v161, v210, v211
    v_mfma_f32_16x16x32_bf16 v[32:35], v[184:187], v[168:171], v[32:35]
    v_exp_f32 v213, v117
    v_mfma_f32_16x16x32_bf16 v[36:39], v[184:187], v[172:175], v[36:39]
    v_mfma_f32_16x16x32_bf16 v[40:43], v[188:191], v[168:171], v[40:43]
    s_waitcnt lgkmcnt(0)
    s_waitcnt vmcnt(19)
    s_barrier
    s_add_u32 s39, s39, 1
    ds_read_b128 v[176:179], v3 offset:40960
    v_exp_f32 v214, v118
    v_mfma_f32_16x16x32_bf16 v[44:47], v[188:191], v[172:175], v[44:47]
    ds_read_b128 v[180:183], v3 offset:41984
    ds_read_b128 v[184:187], v3 offset:43008
    v_cvt_pk_bf16_f32 v164, v212, v213
    v_mfma_f32_16x16x32_bf16 v[48:51], v[192:195], v[168:171], v[48:51]
    s_add_u32 m0, s30, 0
    s_add_u32 s35, s32, 0
    buffer_load_dwordx4 v4, s[24:27], s35 offen offset:0 sc1 lds
    v_exp_f32 v215, v119
    v_mfma_f32_16x16x32_bf16 v[52:55], v[192:195], v[172:175], v[52:55]
    buffer_load_dwordx4 v4, s[24:27], s35 offen offset:1024 sc1 lds
    ds_read_b128 v[188:191], v3 offset:44032
    ds_read_b128 v[192:195], v3 offset:45056
    v_mfma_f32_16x16x32_bf16 v[56:59], v[196:199], v[168:171], v[56:59]
    buffer_load_dwordx4 v4, s[24:27], s35 offen offset:2048 sc1 lds
    v_exp_f32 v208, v120
    v_mfma_f32_16x16x32_bf16 v[60:63], v[196:199], v[172:175], v[60:63]
    buffer_load_dwordx4 v4, s[24:27], s35 offen offset:3072 sc1 lds
    ds_read_b128 v[196:199], v3 offset:46080
    v_cvt_pk_bf16_f32 v165, v214, v215
    v_mfma_f32_16x16x32_bf16 v[64:67], v[200:203], v[168:171], v[64:67]
    s_add_u32 m0, s30, 4096
    s_add_u32 s35, s32, 4096
    buffer_load_dwordx4 v4, s[24:27], s35 offen offset:0 sc1 lds
    v_exp_f32 v209, v121
    v_mfma_f32_16x16x32_bf16 v[68:71], v[200:203], v[172:175], v[68:71]
    buffer_load_dwordx4 v4, s[24:27], s35 offen offset:1024 sc1 lds
    ds_read_b128 v[200:203], v3 offset:47104
    v_mfma_f32_16x16x32_bf16 v[72:75], v[204:207], v[168:171], v[72:75]
    buffer_load_dwordx4 v4, s[24:27], s35 offen offset:2048 sc1 lds
    s_waitcnt lgkmcnt(3)
    v_exp_f32 v210, v122
    v_mfma_f32_16x16x32_bf16 v[76:79], v[204:207], v[172:175], v[76:79]
    buffer_load_dwordx4 v4, s[24:27], s35 offen offset:3072 sc1 lds
    buffer_load_dword v15, v14, s[56:59], s49 offen
    s_add_u32 s49, s49, 2816
    s_add_u32 s30, s30, 32768
    s_and_b32 s30, s30, 131071
    s_add_u32 s32, s32, 32768
    ds_read_b128 v[204:207], v3 offset:48128
    v_cvt_pk_bf16_f32 v162, v208, v209
    v_mfma_f32_16x16x32_bf16 v[128:131], v[176:179], v[80:83], v[144:147]
    v_exp_f32 v211, v123
    v_mfma_f32_16x16x32_bf16 v[132:135], v[176:179], v[96:99], v[148:151]
    ds_read_b128 v[176:179], v3 offset:32768
    v_cvt_pk_bf16_f32 v163, v210, v211
    v_mfma_f32_16x16x32_bf16 v[128:131], v[180:183], v[84:87], v[128:131]
    v_exp_f32 v212, v124
    v_mfma_f32_16x16x32_bf16 v[132:135], v[180:183], v[100:103], v[132:135]
    ds_read_b128 v[180:183], v3 offset:33792
    v_mfma_f32_16x16x32_bf16 v[228:231], v[244:247], v[160:163], v[236:239]
    v_exp_f32 v213, v125
    v_mfma_f32_16x16x32_bf16 v[128:131], v[184:187], v[88:91], v[128:131]
    v_exp_f32 v214, v126
    v_mfma_f32_16x16x32_bf16 v[132:135], v[184:187], v[104:107], v[132:135]
    ds_read_b128 v[184:187], v3 offset:34816
    v_cvt_pk_bf16_f32 v166, v212, v213
    v_mfma_f32_16x16x32_bf16 v[128:131], v[188:191], v[92:95], v[128:131]
    s_waitcnt lgkmcnt(3)
    v_exp_f32 v215, v127
    v_mfma_f32_16x16x32_bf16 v[132:135], v[188:191], v[108:111], v[132:135]
    ds_read_b128 v[188:191], v3 offset:35840
    v_cvt_pk_bf16_f32 v167, v214, v215
    v_mfma_f32_16x16x32_bf16 v[136:139], v[192:195], v[80:83], v[152:155]
    s_nop 0
    v_mfma_f32_16x16x32_bf16 v[232:235], v[244:247], v[164:167], v[240:243]
    v_mfma_f32_16x16x32_bf16 v[140:143], v[192:195], v[96:99], v[156:159]
    ds_read_b128 v[192:195], v3 offset:36864
    v_mfma_f32_16x16x32_bf16 v[136:139], v[196:199], v[84:87], v[136:139]
    v_exp_f32 v208, v128
    v_mfma_f32_16x16x32_bf16 v[140:143], v[196:199], v[100:103], v[140:143]
    ds_read_b128 v[196:199], v3 offset:37888
    v_cmp_nge_f32 s[50:51], s42, v228
    v_mfma_f32_16x16x32_bf16 v[136:139], v[200:203], v[88:91], v[136:139]
    s_waitcnt lgkmcnt(2)
    v_exp_f32 v209, v129
    v_mfma_f32_16x16x32_bf16 v[140:143], v[200:203], v[104:107], v[140:143]
    ds_read_b128 v[200:203], v3 offset:38912
    v_cmp_nge_f32 vcc, s42, v232
    v_mfma_f32_16x16x32_bf16 v[136:139], v[204:207], v[92:95], v[136:139]
    s_or_b64 vcc, vcc, s[50:51]
    v_exp_f32 v210, v130
    v_mfma_f32_16x16x32_bf16 v[140:143], v[204:207], v[108:111], v[140:143]
    ds_read_b128 v[204:207], v3 offset:39936
    s_cbranch_vccnz stub_59
ret_58:
    v_mfma_f32_16x16x32_bf16 v[16:19], v[176:179], v[160:163], v[16:19]
    s_setprio 0
    v_exp_f32 v211, v131
    v_mfma_f32_16x16x32_bf16 v[20:23], v[176:179], v[164:167], v[20:23]
    ds_read_b128 v[176:179], v3 offset:57344
    v_cvt_pk_bf16_f32 v168, v208, v209
    v_mfma_f32_16x16x32_bf16 v[24:27], v[180:183], v[160:163], v[24:27]
    v_exp_f32 v212, v132
    v_mfma_f32_16x16x32_bf16 v[28:31], v[180:183], v[164:167], v[28:31]
    ds_read_b128 v[180:183], v3 offset:58368
    v_cvt_pk_bf16_f32 v169, v210, v211
    v_mfma_f32_16x16x32_bf16 v[32:35], v[184:187], v[160:163], v[32:35]
    v_exp_f32 v213, v133
    v_mfma_f32_16x16x32_bf16 v[36:39], v[184:187], v[164:167], v[36:39]
    ds_read_b128 v[184:187], v3 offset:59392
    v_mfma_f32_16x16x32_bf16 v[40:43], v[188:191], v[160:163], v[40:43]
    s_waitcnt lgkmcnt(3)
    v_exp_f32 v214, v134
    v_mfma_f32_16x16x32_bf16 v[44:47], v[188:191], v[164:167], v[44:47]
    ds_read_b128 v[188:191], v3 offset:60416
    v_cvt_pk_bf16_f32 v172, v212, v213
    v_mfma_f32_16x16x32_bf16 v[48:51], v[192:195], v[160:163], v[48:51]
    v_exp_f32 v215, v135
    v_mfma_f32_16x16x32_bf16 v[52:55], v[192:195], v[164:167], v[52:55]
    ds_read_b128 v[192:195], v3 offset:61440
    v_mfma_f32_16x16x32_bf16 v[56:59], v[196:199], v[160:163], v[56:59]
    v_exp_f32 v208, v136
    v_mfma_f32_16x16x32_bf16 v[60:63], v[196:199], v[164:167], v[60:63]
    ds_read_b128 v[196:199], v3 offset:62464
    v_cvt_pk_bf16_f32 v173, v214, v215
    v_mfma_f32_16x16x32_bf16 v[64:67], v[200:203], v[160:163], v[64:67]
    v_exp_f32 v209, v137
    v_mfma_f32_16x16x32_bf16 v[68:71], v[200:203], v[164:167], v[68:71]
    ds_read_b128 v[200:203], v3 offset:63488
    v_mfma_f32_16x16x32_bf16 v[72:75], v[204:207], v[160:163], v[72:75]
    s_waitcnt lgkmcnt(3)
    v_exp_f32 v210, v138
    v_mfma_f32_16x16x32_bf16 v[76:79], v[204:207], v[164:167], v[76:79]
    ds_read_b128 v[204:207], v3 offset:64512
    v_cvt_pk_bf16_f32 v170, v208, v209
    v_mfma_f32_16x16x32_bf16 v[112:115], v[176:179], v[80:83], v[144:147]
    v_exp_f32 v211, v139
    v_mfma_f32_16x16x32_bf16 v[116:119], v[176:179], v[96:99], v[148:151]
    ds_read_b128 v[176:179], v3 offset:49152
    v_cvt_pk_bf16_f32 v171, v210, v211
    v_mfma_f32_16x16x32_bf16 v[112:115], v[180:183], v[84:87], v[112:115]
    v_exp_f32 v212, v140
    v_mfma_f32_16x16x32_bf16 v[116:119], v[180:183], v[100:103], v[116:119]
    ds_read_b128 v[180:183], v3 offset:50176
    v_mfma_f32_16x16x32_bf16 v[236:239], v[244:247], v[168:171], v[228:231]
    v_exp_f32 v213, v141
    v_mfma_f32_16x16x32_bf16 v[112:115], v[184:187], v[88:91], v[112:115]
    v_exp_f32 v214, v142
    v_mfma_f32_16x16x32_bf16 v[116:119], v[184:187], v[104:107], v[116:119]
    ds_read_b128 v[184:187], v3 offset:51200
    v_cvt_pk_bf16_f32 v174, v212, v213
    v_mfma_f32_16x16x32_bf16 v[112:115], v[188:191], v[92:95], v[112:115]
    s_waitcnt lgkmcnt(3)
    v_exp_f32 v215, v143
    v_mfma_f32_16x16x32_bf16 v[116:119], v[188:191], v[108:111], v[116:119]
    ds_read_b128 v[188:191], v3 offset:52224
    v_cvt_pk_bf16_f32 v175, v214, v215
    v_mfma_f32_16x16x32_bf16 v[120:123], v[192:195], v[80:83], v[152:155]
    s_nop 0
    v_mfma_f32_16x16x32_bf16 v[240:243], v[244:247], v[172:175], v[232:235]
    v_mfma_f32_16x16x32_bf16 v[124:127], v[192:195], v[96:99], v[156:159]
    ds_read_b128 v[192:195], v3 offset:53248
    v_mfma_f32_16x16x32_bf16 v[120:123], v[196:199], v[84:87], v[120:123]
    v_exp_f32 v208, v112
    v_mfma_f32_16x16x32_bf16 v[124:127], v[196:199], v[100:103], v[124:127]
    ds_read_b128 v[196:199], v3 offset:54272
    v_cmp_nge_f32 s[50:51], s42, v236
    v_mfma_f32_16x16x32_bf16 v[120:123], v[200:203], v[88:91], v[120:123]
    s_waitcnt lgkmcnt(2)
    v_exp_f32 v209, v113
    v_mfma_f32_16x16x32_bf16 v[124:127], v[200:203], v[104:107], v[124:127]
    ds_read_b128 v[200:203], v3 offset:55296
    v_cmp_nge_f32 vcc, s42, v240
    v_mfma_f32_16x16x32_bf16 v[120:123], v[204:207], v[92:95], v[120:123]
    s_or_b64 vcc, vcc, s[50:51]
    v_exp_f32 v210, v114
    v_mfma_f32_16x16x32_bf16 v[124:127], v[204:207], v[108:111], v[124:127]
    ds_read_b128 v[204:207], v3 offset:56320
    s_cbranch_vccnz stub_61
ret_60:
    v_mfma_f32_16x16x32_bf16 v[16:19], v[176:179], v[168:171], v[16:19]
    v_exp_f32 v211, v115
    v_mfma_f32_16x16x32_bf16 v[20:23], v[176:179], v[172:175], v[20:23]
    v_cvt_pk_bf16_f32 v160, v208, v209
    v_mfma_f32_16x16x32_bf16 v[24:27], v[180:183], v[168:171], v[24:27]
    v_exp_f32 v212, v116
    v_mfma_f32_16x16x32_bf16 v[28:31], v[180:183], v[172:175], v[28:31]
    v_cvt_pk_bf16_f32 v161, v210, v211
    v_mfma_f32_16x16x32_bf16 v[32:35], v[184:187], v[168:171], v[32:35]
    v_exp_f32 v213, v117
    v_mfma_f32_16x16x32_bf16 v[36:39], v[184:187], v[172:175], v[36:39]
    v_mfma_f32_16x16x32_bf16 v[40:43], v[188:191], v[168:171], v[40:43]
    s_waitcnt lgkmcnt(0)
    s_waitcnt vmcnt(19)
    s_barrier
    s_add_u32 s39, s39, 1
    v_xor_b32 v3, 65536, v3
    ds_read_b128 v[176:179], v3 offset:8192
    v_exp_f32 v214, v118
    v_mfma_f32_16x16x32_bf16 v[44:47], v[188:191], v[172:175], v[44:47]
    ds_read_b128 v[180:183], v3 offset:9216
    ds_read_b128 v[184:187], v3 offset:10240
    v_cvt_pk_bf16_f32 v164, v212, v213
    v_mfma_f32_16x16x32_bf16 v[48:51], v[192:195], v[168:171], v[48:51]
    s_add_u32 m0, s30, 0
    s_add_u32 s35, s32, 0
    buffer_load_dwordx4 v4, s[24:27], s35 offen offset:0 sc1 lds
    v_exp_f32 v215, v119
    v_mfma_f32_16x16x32_bf16 v[52:55], v[192:195], v[172:175], v[52:55]
    buffer_load_dwordx4 v4, s[24:27], s35 offen offset:1024 sc1 lds
    ds_read_b128 v[188:191], v3 offset:11264
    ds_read_b128 v[192:195], v3 offset:12288
    v_mfma_f32_16x16x32_bf16 v[56:59], v[196:199], v[168:171], v[56:59]
    buffer_load_dwordx4 v4, s[24:27], s35 offen offset:2048 sc1 lds
    v_exp_f32 v208, v120
    v_mfma_f32_16x16x32_bf16 v[60:63], v[196:199], v[172:175], v[60:63]
    buffer_load_dwordx4 v4, s[24:27], s35 offen offset:3072 sc1 lds
    ds_read_b128 v[196:199], v3 offset:13312
    v_cvt_pk_bf16_f32 v165, v214, v215
    v_mfma_f32_16x16x32_bf16 v[64:67], v[200:203], v[168:171], v[64:67]
    s_add_u32 m0, s30, 4096
    s_add_u32 s35, s32, 4096
    buffer_load_dwordx4 v4, s[24:27], s35 offen offset:0 sc1 lds
    v_exp_f32 v209, v121
    v_mfma_f32_16x16x32_bf16 v[68:71], v[200:203], v[172:175], v[68:71]
    buffer_load_dwordx4 v4, s[24:27], s35 offen offset:1024 sc1 lds
    ds_read_b128 v[200:203], v3 offset:14336
    v_mfma_f32_16x16x32_bf16 v[72:75], v[204:207], v[168:171], v[72:75]
    buffer_load_dwordx4 v4, s[24:27], s35 offen offset:2048 sc1 lds
    s_waitcnt lgkmcnt(3)
    v_exp_f32 v210, v122
    v_mfma_f32_16x16x32_bf16 v[76:79], v[204:207], v[172:175], v[76:79]
    buffer_load_dwordx4 v4, s[24:27], s35 offen offset:3072 sc1 lds
    buffer_load_dword v15, v14, s[56:59], s49 offen
    s_add_u32 s49, s49, 2816
    s_add_u32 s30, s30, 32768
    s_and_b32 s30, s30, 131071
    s_add_u32 s32, s32, 32768
    ds_read_b128 v[204:207], v3 offset:15360
    v_cvt_pk_bf16_f32 v162, v208, v209
    s_cmp_ge_u32 s34, 5
    s_cbranch_scc1 attn_loop_53
attn_slow_52:
    s_cmp_le_u32 s34, 1
    s_cbranch_scc1 special_62
back_63:
    v_mfma_f32_16x16x32_bf16 v[128:131], v[176:179], v[80:83], v[144:147]
    s_setprio 1
    v_exp_f32 v211, v123
    v_mfma_f32_16x16x32_bf16 v[132:135], v[176:179], v[96:99], v[148:151]
    ds_read_b128 v[176:179], v3 offset:0
    v_cvt_pk_bf16_f32 v163, v210, v211
    v_mfma_f32_16x16x32_bf16 v[128:131], v[180:183], v[84:87], v[128:131]
    v_exp_f32 v212, v124
    v_mfma_f32_16x16x32_bf16 v[132:135], v[180:183], v[100:103], v[132:135]
    ds_read_b128 v[180:183], v3 offset:1024
    v_mfma_f32_16x16x32_bf16 v[228:231], v[244:247], v[160:163], v[236:239]
    v_exp_f32 v213, v125
    v_mfma_f32_16x16x32_bf16 v[128:131], v[184:187], v[88:91], v[128:131]
    v_exp_f32 v214, v126
    v_mfma_f32_16x16x32_bf16 v[132:135], v[184:187], v[104:107], v[132:135]
    ds_read_b128 v[184:187], v3 offset:2048
    v_cvt_pk_bf16_f32 v166, v212, v213
    v_mfma_f32_16x16x32_bf16 v[128:131], v[188:191], v[92:95], v[128:131]
    s_waitcnt lgkmcnt(3)
    v_exp_f32 v215, v127
    v_mfma_f32_16x16x32_bf16 v[132:135], v[188:191], v[108:111], v[132:135]
    ds_read_b128 v[188:191], v3 offset:3072
    v_cvt_pk_bf16_f32 v167, v214, v215
    v_mfma_f32_16x16x32_bf16 v[136:139], v[192:195], v[80:83], v[152:155]
    s_sub_u32 s34, s34, 1
    v_mfma_f32_16x16x32_bf16 v[232:235], v[244:247], v[164:167], v[240:243]
    v_mfma_f32_16x16x32_bf16 v[140:143], v[192:195], v[96:99], v[156:159]
    ds_read_b128 v[192:195], v3 offset:4096
    v_mfma_f32_16x16x32_bf16 v[136:139], v[196:199], v[84:87], v[136:139]
    v_exp_f32 v208, v128
    v_mfma_f32_16x16x32_bf16 v[140:143], v[196:199], v[100:103], v[140:143]
    ds_read_b128 v[196:199], v3 offset:5120
    v_cmp_nge_f32 s[50:51], s42, v228
    v_mfma_f32_16x16x32_bf16 v[136:139], v[200:203], v[88:91], v[136:139]
    s_waitcnt lgkmcnt(2)
    v_exp_f32 v209, v129
    v_mfma_f32_16x16x32_bf16 v[140:143], v[200:203], v[104:107], v[140:143]
    ds_read_b128 v[200:203], v3 offset:6144
    v_cmp_nge_f32 vcc, s42, v232
    v_mfma_f32_16x16x32_bf16 v[136:139], v[204:207], v[92:95], v[136:139]
    s_or_b64 vcc, vcc, s[50:51]
    v_exp_f32 v210, v130
    v_mfma_f32_16x16x32_bf16 v[140:143], v[204:207], v[108:111], v[140:143]
    ds_read_b128 v[204:207], v3 offset:7168
    s_cbranch_vccnz stub_65
ret_64:
    v_mfma_f32_16x16x32_bf16 v[16:19], v[176:179], v[160:163], v[16:19]
    v_exp_f32 v211, v131
    v_mfma_f32_16x16x32_bf16 v[20:23], v[176:179], v[164:167], v[20:23]
    ds_read_b128 v[176:179], v3 offset:24576
    v_cvt_pk_bf16_f32 v168, v208, v209
    v_mfma_f32_16x16x32_bf16 v[24:27], v[180:183], v[160:163], v[24:27]
    v_exp_f32 v212, v132
    v_mfma_f32_16x16x32_bf16 v[28:31], v[180:183], v[164:167], v[28:31]
    ds_read_b128 v[180:183], v3 offset:25600
    v_cvt_pk_bf16_f32 v169, v210, v211
    v_mfma_f32_16x16x32_bf16 v[32:35], v[184:187], v[160:163], v[32:35]
    v_exp_f32 v213, v133
    v_mfma_f32_16x16x32_bf16 v[36:39], v[184:187], v[164:167], v[36:39]
    ds_read_b128 v[184:187], v3 offset:26624
    v_mfma_f32_16x16x32_bf16 v[40:43], v[188:191], v[160:163], v[40:43]
    s_waitcnt lgkmcnt(3)
    v_exp_f32 v214, v134
    v_mfma_f32_16x16x32_bf16 v[44:47], v[188:191], v[164:167], v[44:47]
    ds_read_b128 v[188:191], v3 offset:27648
    v_cvt_pk_bf16_f32 v172, v212, v213
    v_mfma_f32_16x16x32_bf16 v[48:51], v[192:195], v[160:163], v[48:51]
    v_exp_f32 v215, v135
    v_mfma_f32_16x16x32_bf16 v[52:55], v[192:195], v[164:167], v[52:55]
    ds_read_b128 v[192:195], v3 offset:28672
    v_mfma_f32_16x16x32_bf16 v[56:59], v[196:199], v[160:163], v[56:59]
    v_exp_f32 v208, v136
    v_mfma_f32_16x16x32_bf16 v[60:63], v[196:199], v[164:167], v[60:63]
    ds_read_b128 v[196:199], v3 offset:29696
    v_cvt_pk_bf16_f32 v173, v214, v215
    v_mfma_f32_16x16x32_bf16 v[64:67], v[200:203], v[160:163], v[64:67]
    v_exp_f32 v209, v137
    v_mfma_f32_16x16x32_bf16 v[68:71], v[200:203], v[164:167], v[68:71]
    ds_read_b128 v[200:203], v3 offset:30720
    v_mfma_f32_16x16x32_bf16 v[72:75], v[204:207], v[160:163], v[72:75]
    s_waitcnt lgkmcnt(3)
    v_exp_f32 v210, v138
    v_mfma_f32_16x16x32_bf16 v[76:79], v[204:207], v[164:167], v[76:79]
    ds_read_b128 v[204:207], v3 offset:31744
    v_cvt_pk_bf16_f32 v170, v208, v209
    s_cmp_le_u32 s34, 1
    s_cbranch_scc1 special_66
back_67:
    v_mfma_f32_16x16x32_bf16 v[112:115], v[176:179], v[80:83], v[144:147]
    v_exp_f32 v211, v139
    v_mfma_f32_16x16x32_bf16 v[116:119], v[176:179], v[96:99], v[148:151]
    ds_read_b128 v[176:179], v3 offset:16384
    v_cvt_pk_bf16_f32 v171, v210, v211
    v_mfma_f32_16x16x32_bf16 v[112:115], v[180:183], v[84:87], v[112:115]
    v_exp_f32 v212, v140
    v_mfma_f32_16x16x32_bf16 v[116:119], v[180:183], v[100:103], v[116:119]
    ds_read_b128 v[180:183], v3 offset:17408
    v_mfma_f32_16x16x32_bf16 v[236:239], v[244:247], v[168:171], v[228:231]
    v_exp_f32 v213, v141
    v_mfma_f32_16x16x32_bf16 v[112:115], v[184:187], v[88:91], v[112:115]
    v_exp_f32 v214, v142
    v_mfma_f32_16x16x32_bf16 v[116:119], v[184:187], v[104:107], v[116:119]
    ds_read_b128 v[184:187], v3 offset:18432
    v_cvt_pk_bf16_f32 v174, v212, v213
    v_mfma_f32_16x16x32_bf16 v[112:115], v[188:191], v[92:95], v[112:115]
    s_waitcnt lgkmcnt(3)
    v_exp_f32 v215, v143
    v_mfma_f32_16x16x32_bf16 v[116:119], v[188:191], v[108:111], v[116:119]
    ds_read_b128 v[188:191], v3 offset:19456
    v_cvt_pk_bf16_f32 v175, v214, v215
    v_mfma_f32_16x16x32_bf16 v[120:123], v[192:195], v[80:83], v[152:155]
    s_sub_u32 s34, s34, 1
    v_mfma_f32_16x16x32_bf16 v[240:243], v[244:247], v[172:175], v[232:235]
    v_mfma_f32_16x16x32_bf16 v[124:127], v[192:195], v[96:99], v[156:159]
    ds_read_b128 v[192:195], v3 offset:20480
    v_mfma_f32_16x16x32_bf16 v[120:123], v[196:199], v[84:87], v[120:123]
    v_exp_f32 v208, v112
    v_mfma_f32_16x16x32_bf16 v[124:127], v[196:199], v[100:103], v[124:127]
    ds_read_b128 v[196:199], v3 offset:21504
    v_cmp_nge_f32 s[50:51], s42, v236
    v_mfma_f32_16x16x32_bf16 v[120:123], v[200:203], v[88:91], v[120:123]
    s_waitcnt lgkmcnt(2)
    v_exp_f32 v209, v113
    v_mfma_f32_16x16x32_bf16 v[124:127], v[200:203], v[104:107], v[124:127]
    ds_read_b128 v[200:203], v3 offset:22528
    v_cmp_nge_f32 vcc, s42, v240
    v_mfma_f32_16x16x32_bf16 v[120:123], v[204:207], v[92:95], v[120:123]
    s_or_b64 vcc, vcc, s[50:51]
    v_exp_f32 v210, v114
    v_mfma_f32_16x16x32_bf16 v[124:127], v[204:207], v[108:111], v[124:127]
    ds_read_b128 v[204:207], v3 offset:23552
    s_cbranch_vccnz stub_69
ret_68:
    v_mfma_f32_16x16x32_bf16 v[16:19], v[176:179], v[168:171], v[16:19]
    v_exp_f32 v211, v115
    v_mfma_f32_16x16x32_bf16 v[20:23], v[176:179], v[172:175], v[20:23]
    v_cvt_pk_bf16_f32 v160, v208, v209
    v_mfma_f32_16x16x32_bf16 v[24:27], v[180:183], v[168:171], v[24:27]
    v_exp_f32 v212, v116
    v_mfma_f32_16x16x32_bf16 v[28:31], v[180:183], v[172:175], v[28:31]
    v_cvt_pk_bf16_f32 v161, v210, v211
    v_mfma_f32_16x16x32_bf16 v[32:35], v[184:187], v[168:171], v[32:35]
    v_exp_f32 v213, v117
    v_mfma_f32_16x16x32_bf16 v[36:39], v[184:187], v[172:175], v[36:39]
    v_mfma_f32_16x16x32_bf16 v[40:43], v[188:191], v[168:171], v[40:43]
    s_waitcnt lgkmcnt(0)
    s_waitcnt vmcnt(19)
    s_barrier
    s_add_u32 s39, s39, 1
    ds_read_b128 v[176:179], v3 offset:40960
    v_exp_f32 v214, v118
    v_mfma_f32_16x16x32_bf16 v[44:47], v[188:191], v[172:175], v[44:47]
    ds_read_b128 v[180:183], v3 offset:41984
    ds_read_b128 v[184:187], v3 offset:43008
    v_cvt_pk_bf16_f32 v164, v212, v213
    v_mfma_f32_16x16x32_bf16 v[48:51], v[192:195], v[168:171], v[48:51]
    s_add_u32 m0, s30, 0
    s_add_u32 s35, s32, 0
    buffer_load_dwordx4 v4, s[24:27], s35 offen offset:0 sc1 lds
    v_exp_f32 v215, v119
    v_mfma_f32_16x16x32_bf16 v[52:55], v[192:195], v[172:175], v[52:55]
    buffer_load_dwordx4 v4, s[24:27], s35 offen offset:1024 sc1 lds
    ds_read_b128 v[188:191], v3 offset:44032
    ds_read_b128 v[192:195], v3 offset:45056
    v_mfma_f32_16x16x32_bf16 v[56:59], v[196:199], v[168:171], v[56:59]
    buffer_load_dwordx4 v4, s[24:27], s35 offen offset:2048 sc1 lds
    v_exp_f32 v208, v120
    v_mfma_f32_16x16x32_bf16 v[60:63], v[196:199], v[172:175], v[60:63]
    buffer_load_dwordx4 v4, s[24:27], s35 offen offset:3072 sc1 lds
    ds_read_b128 v[196:199], v3 offset:46080
    v_cvt_pk_bf16_f32 v165, v214, v215
    v_mfma_f32_16x16x32_bf16 v[64:67], v[200:203], v[168:171], v[64:67]
    s_add_u32 m0, s30, 4096
    s_add_u32 s35, s32, 4096
    buffer_load_dwordx4 v4, s[24:27], s35 offen offset:0 sc1 lds
    v_exp_f32 v209, v121
    v_mfma_f32_16x16x32_bf16 v[68:71], v[200:203], v[172:175], v[68:71]
    buffer_load_dwordx4 v4, s[24:27], s35 offen offset:1024 sc1 lds
    ds_read_b128 v[200:203], v3 offset:47104
    v_mfma_f32_16x16x32_bf16 v[72:75], v[204:207], v[168:171], v[72:75]
    buffer_load_dwordx4 v4, s[24:27], s35 offen offset:2048 sc1 lds
    s_waitcnt lgkmcnt(3)
    v_exp_f32 v210, v122
    v_mfma_f32_16x16x32_bf16 v[76:79], v[204:207], v[172:175], v[76:79]
    buffer_load_dwordx4 v4, s[24:27], s35 offen offset:3072 sc1 lds
    buffer_load_dword v15, v14, s[56:59], s49 offen
    s_add_u32 s49, s49, 2816
    s_add_u32 s30, s30, 32768
    s_and_b32 s30, s30, 131071
    s_add_u32 s32, s32, 32768
    ds_read_b128 v[204:207], v3 offset:48128
    v_cvt_pk_bf16_f32 v162, v208, v209
    s_cmp_le_u32 s34, 1
    s_cbranch_scc1 special_70
back_71:
    v_mfma_f32_16x16x32_bf16 v[128:131], v[176:179], v[80:83], v[144:147]
    v_exp_f32 v211, v123
    v_mfma_f32_16x16x32_bf16 v[132:135], v[176:179], v[96:99], v[148:151]
    ds_read_b128 v[176:179], v3 offset:32768
    v_cvt_pk_bf16_f32 v163, v210, v211
    v_mfma_f32_16x16x32_bf16 v[128:131], v[180:183], v[84:87], v[128:131]
    v_exp_f32 v212, v124
    v_mfma_f32_16x16x32_bf16 v[132:135], v[180:183], v[100:103], v[132:135]
    ds_read_b128 v[180:183], v3 offset:33792
    v_mfma_f32_16x16x32_bf16 v[228:231], v[244:247], v[160:163], v[236:239]
    v_exp_f32 v213, v125
    v_mfma_f32_16x16x32_bf16 v[128:131], v[184:187], v[88:91], v[128:131]
    v_exp_f32 v214, v126
    v_mfma_f32_16x16x32_bf16 v[132:135], v[184:187], v[104:107], v[132:135]
    ds_read_b128 v[184:187], v3 offset:34816
    v_cvt_pk_bf16_f32 v166, v212, v213
    v_mfma_f32_16x16x32_bf16 v[128:131], v[188:191], v[92:95], v[128:131]
    s_waitcnt lgkmcnt(3)
    v_exp_f32 v215, v127
    v_mfma_f32_16x16x32_bf16 v[132:135], v[188:191], v[108:111], v[132:135]
    ds_read_b128 v[188:191], v3 offset:35840
    v_cvt_pk_bf16_f32 v167, v214, v215
    v_mfma_f32_16x16x32_bf16 v[136:139], v[192:195], v[80:83], v[152:155]
    s_sub_u32 s34, s34, 1
    v_mfma_f32_16x16x32_bf16 v[232:235], v[244:247], v[164:167], v[240:243]
    v_mfma_f32_16x16x32_bf16 v[140:143], v[192:195], v[96:99], v[156:159]
    ds_read_b128 v[192:195], v3 offset:36864
    v_mfma_f32_16x16x32_bf16 v[136:139], v[196:199], v[84:87], v[136:139]
    v_exp_f32 v208, v128
    v_mfma_f32_16x16x32_bf16 v[140:143], v[196:199], v[100:103], v[140:143]
    ds_read_b128 v[196:199], v3 offset:37888
    v_cmp_nge_f32 s[50:51], s42, v228
    v_mfma_f32_16x16x32_bf16 v[136:139], v[200:203], v[88:91], v[136:139]
    s_waitcnt lgkmcnt(2)
    v_exp_f32 v209, v129
    v_mfma_f32_16x16x32_bf16 v[140:143], v[200:203], v[104:107], v[140:143]
    ds_read_b128 v[200:203], v3 offset:38912
    v_cmp_nge_f32 vcc, s42, v232
    v_mfma_f32_16x16x32_bf16 v[136:139], v[204:207], v[92:95], v[136:139]
    s_or_b64 vcc, vcc, s[50:51]
    v_exp_f32 v210, v130
    v_mfma_f32_16x16x32_bf16 v[140:143], v[204:207], v[108:111], v[140:143]
    ds_read_b128 v[204:207], v3 offset:39936
    s_cbranch_vccnz stub_73
ret_72:
    v_mfma_f32_16x16x32_bf16 v[16:19], v[176:179], v[160:163], v[16:19]
    s_setprio 0
    v_exp_f32 v211, v131
    v_mfma_f32_16x16x32_bf16 v[20:23], v[176:179], v[164:167], v[20:23]
    ds_read_b128 v[176:179], v3 offset:57344
    v_cvt_pk_bf16_f32 v168, v208, v209
    v_mfma_f32_16x16x32_bf16 v[24:27], v[180:183], v[160:163], v[24:27]
    v_exp_f32 v212, v132
    v_mfma_f32_16x16x32_bf16 v[28:31], v[180:183], v[164:167], v[28:31]
    ds_read_b128 v[180:183], v3 offset:58368
    v_cvt_pk_bf16_f32 v169, v210, v211
    v_mfma_f32_16x16x32_bf16 v[32:35], v[184:187], v[160:163], v[32:35]
    v_exp_f32 v213, v133
    v_mfma_f32_16x16x32_bf16 v[36:39], v[184:187], v[164:167], v[36:39]
    ds_read_b128 v[184:187], v3 offset:59392
    v_mfma_f32_16x16x32_bf16 v[40:43], v[188:191], v[160:163], v[40:43]
    s_waitcnt lgkmcnt(3)
    v_exp_f32 v214, v134
    v_mfma_f32_16x16x32_bf16 v[44:47], v[188:191], v[164:167], v[44:47]
    ds_read_b128 v[188:191], v3 offset:60416
    v_cvt_pk_bf16_f32 v172, v212, v213
    v_mfma_f32_16x16x32_bf16 v[48:51], v[192:195], v[160:163], v[48:51]
    v_exp_f32 v215, v135
    v_mfma_f32_16x16x32_bf16 v[52:55], v[192:195], v[164:167], v[52:55]
    ds_read_b128 v[192:195], v3 offset:61440
    v_mfma_f32_16x16x32_bf16 v[56:59], v[196:199], v[160:163], v[56:59]
    v_exp_f32 v208, v136
    v_mfma_f32_16x16x32_bf16 v[60:63], v[196:199], v[164:167], v[60:63]
    ds_read_b128 v[196:199], v3 offset:62464
    v_cvt_pk_bf16_f32 v173, v214, v215
    v_mfma_f32_16x16x32_bf16 v[64:67], v[200:203], v[160:163], v[64:67]
    v_exp_f32 v209, v137
    v_mfma_f32_16x16x32_bf16 v[68:71], v[200:203], v[164:167], v[68:71]
    ds_read_b128 v[200:203], v3 offset:63488
    v_mfma_f32_16x16x32_bf16 v[72:75], v[204:207], v[160:163], v[72:75]
    s_waitcnt lgkmcnt(3)
    v_exp_f32 v210, v138
    v_mfma_f32_16x16x32_bf16 v[76:79], v[204:207], v[164:167], v[76:79]
    ds_read_b128 v[204:207], v3 offset:64512
    v_cvt_pk_bf16_f32 v170, v208, v209
    s_cmp_le_u32 s34, 1
    s_cbranch_scc1 special_74
back_75:
    v_mfma_f32_16x16x32_bf16 v[112:115], v[176:179], v[80:83], v[144:147]
    v_exp_f32 v211, v139
    v_mfma_f32_16x16x32_bf16 v[116:119], v[176:179], v[96:99], v[148:151]
    ds_read_b128 v[176:179], v3 offset:49152
    v_cvt_pk_bf16_f32 v171, v210, v211
    v_mfma_f32_16x16x32_bf16 v[112:115], v[180:183], v[84:87], v[112:115]
    v_exp_f32 v212, v140
    v_mfma_f32_16x16x32_bf16 v[116:119], v[180:183], v[100:103], v[116:119]
    ds_read_b128 v[180:183], v3 offset:50176
    v_mfma_f32_16x16x32_bf16 v[236:239], v[244:247], v[168:171], v[228:231]
    v_exp_f32 v213, v141
    v_mfma_f32_16x16x32_bf16 v[112:115], v[184:187], v[88:91], v[112:115]
    v_exp_f32 v214, v142
    v_mfma_f32_16x16x32_bf16 v[116:119], v[184:187], v[104:107], v[116:119]
    ds_read_b128 v[184:187], v3 offset:51200
    v_cvt_pk_bf16_f32 v174, v212, v213
    v_mfma_f32_16x16x32_bf16 v[112:115], v[188:191], v[92:95], v[112:115]
    s_waitcnt lgkmcnt(3)
    v_exp_f32 v215, v143
    v_mfma_f32_16x16x32_bf16 v[116:119], v[188:191], v[108:111], v[116:119]
    ds_read_b128 v[188:191], v3 offset:52224
    v_cvt_pk_bf16_f32 v175, v214, v215
    v_mfma_f32_16x16x32_bf16 v[120:123], v[192:195], v[80:83], v[152:155]
    s_sub_u32 s34, s34, 1
    v_mfma_f32_16x16x32_bf16 v[240:243], v[244:247], v[172:175], v[232:235]
    v_mfma_f32_16x16x32_bf16 v[124:127], v[192:195], v[96:99], v[156:159]
    ds_read_b128 v[192:195], v3 offset:53248
    v_mfma_f32_16x16x32_bf16 v[120:123], v[196:199], v[84:87], v[120:123]
    v_exp_f32 v208, v112
    v_mfma_f32_16x16x32_bf16 v[124:127], v[196:199], v[100:103], v[124:127]
    ds_read_b128 v[196:199], v3 offset:54272
    v_cmp_nge_f32 s[50:51], s42, v236
    v_mfma_f32_16x16x32_bf16 v[120:123], v[200:203], v[88:91], v[120:123]
    s_waitcnt lgkmcnt(2)
    v_exp_f32 v209, v113
    v_mfma_f32_16x16x32_bf16 v[124:127], v[200:203], v[104:107], v[124:127]
    ds_read_b128 v[200:203], v3 offset:55296
    v_cmp_nge_f32 vcc, s42, v240
    v_mfma_f32_16x16x32_bf16 v[120:123], v[204:207], v[92:95], v[120:123]
    s_or_b64 vcc, vcc, s[50:51]
    v_exp_f32 v210, v114
    v_mfma_f32_16x16x32_bf16 v[124:127], v[204:207], v[108:111], v[124:127]
    ds_read_b128 v[204:207], v3 offset:56320
    s_cbranch_vccnz stub_77
ret_76:
    v_mfma_f32_16x16x32_bf16 v[16:19], v[176:179], v[168:171], v[16:19]
    v_exp_f32 v211, v115
    v_mfma_f32_16x16x32_bf16 v[20:23], v[176:179], v[172:175], v[20:23]
    v_cvt_pk_bf16_f32 v160, v208, v209
    v_mfma_f32_16x16x32_bf16 v[24:27], v[180:183], v[168:171], v[24:27]
    v_exp_f32 v212, v116
    v_mfma_f32_16x16x32_bf16 v[28:31], v[180:183], v[172:175], v[28:31]
    v_cvt_pk_bf16_f32 v161, v210, v211
    v_mfma_f32_16x16x32_bf16 v[32:35], v[184:187], v[168:171], v[32:35]
    v_exp_f32 v213, v117
    v_mfma_f32_16x16x32_bf16 v[36:39], v[184:187], v[172:175], v[36:39]
    v_mfma_f32_16x16x32_bf16 v[40:43], v[188:191], v[168:171], v[40:43]
    s_waitcnt lgkmcnt(0)
    s_waitcnt vmcnt(19)
    s_barrier
    s_add_u32 s39, s39, 1
    v_xor_b32 v3, 65536, v3
    ds_read_b128 v[176:179], v3 offset:8192
    v_exp_f32 v214, v118
    v_mfma_f32_16x16x32_bf16 v[44:47], v[188:191], v[172:175], v[44:47]
    ds_read_b128 v[180:183], v3 offset:9216
    ds_read_b128 v[184:187], v3 offset:10240
    v_cvt_pk_bf16_f32 v164, v212, v213
    v_mfma_f32_16x16x32_bf16 v[48:51], v[192:195], v[168:171], v[48:51]
    s_add_u32 m0, s30, 0
    s_add_u32 s35, s32, 0
    buffer_load_dwordx4 v4, s[24:27], s35 offen offset:0 sc1 lds
    v_exp_f32 v215, v119
    v_mfma_f32_16x16x32_bf16 v[52:55], v[192:195], v[172:175], v[52:55]
    buffer_load_dwordx4 v4, s[24:27], s35 offen offset:1024 sc1 lds
    ds_read_b128 v[188:191], v3 offset:11264
    ds_read_b128 v[192:195], v3 offset:12288
    v_mfma_f32_16x16x32_bf16 v[56:59], v[196:199], v[168:171], v[56:59]
    buffer_load_dwordx4 v4, s[24:27], s35 offen offset:2048 sc1 lds
    v_exp_f32 v208, v120
    v_mfma_f32_16x16x32_bf16 v[60:63], v[196:199], v[172:175], v[60:63]
    buffer_load_dwordx4 v4, s[24:27], s35 offen offset:3072 sc1 lds
    ds_read_b128 v[196:199], v3 offset:13312
    v_cvt_pk_bf16_f32 v165, v214, v215
    v_mfma_f32_16x16x32_bf16 v[64:67], v[200:203], v[168:171], v[64:67]
    s_add_u32 m0, s30, 4096
    s_add_u32 s35, s32, 4096
    buffer_load_dwordx4 v4, s[24:27], s35 offen offset:0 sc1 lds
    v_exp_f32 v209, v121
    v_mfma_f32_16x16x32_bf16 v[68:71], v[200:203], v[172:175], v[68:71]
    buffer_load_dwordx4 v4, s[24:27], s35 offen offset:1024 sc1 lds
    ds_read_b128 v[200:203], v3 offset:14336
    v_mfma_f32_16x16x32_bf16 v[72:75], v[204:207], v[168:171], v[72:75]
    buffer_load_dwordx4 v4, s[24:27], s35 offen offset:2048 sc1 lds
    s_waitcnt lgkmcnt(3)
    v_exp_f32 v210, v122
    v_mfma_f32_16x16x32_bf16 v[76:79], v[204:207], v[172:175], v[76:79]
    buffer_load_dwordx4 v4, s[24:27], s35 offen offset:3072 sc1 lds
    buffer_load_dword v15, v14, s[56:59], s49 offen
    s_add_u32 s49, s49, 2816
    s_add_u32 s30, s30, 32768
    s_and_b32 s30, s30, 131071
    s_add_u32 s32, s32, 32768
    ds_read_b128 v[204:207], v3 offset:15360
    v_cvt_pk_bf16_f32 v162, v208, v209
    s_branch attn_slow_52
special_35:
    s_cmp_eq_u32 s34, 0
    s_cbranch_scc1 tail0_20
    v_mov_b32 v221, s43
    v_cmp_le_i32 vcc, 0, v6
    v_mov_b32 v152, v221
    s_nop 0
    v_cndmask_b32 v144, v221, v144, vcc
    v_cndmask_b32 v156, v221, v156, vcc
    v_cmp_le_i32 vcc, 1, v6
    v_mov_b32 v153, v221
    s_nop 0
    v_cndmask_b32 v145, v221, v145, vcc
    v_cndmask_b32 v157, v221, v157, vcc
    v_cmp_le_i32 vcc, 2, v6
    v_mov_b32 v154, v221
    s_nop 0
    v_cndmask_b32 v146, v221, v146, vcc
    v_cndmask_b32 v158, v221, v158, vcc
    v_cmp_le_i32 vcc, 3, v6
    v_mov_b32 v155, v221
    s_nop 0
    v_cndmask_b32 v147, v221, v147, vcc
    v_cndmask_b32 v159, v221, v159, vcc
    s_branch back_36
special_39:
    s_cmp_eq_u32 s34, 0
    s_cbranch_scc1 tail1_21
    v_mov_b32 v221, s43
    v_cmp_le_i32 vcc, 0, v6
    v_mov_b32 v152, v221
    s_nop 0
    v_cndmask_b32 v144, v221, v144, vcc
    v_cndmask_b32 v156, v221, v156, vcc
    v_cmp_le_i32 vcc, 1, v6
    v_mov_b32 v153, v221
    s_nop 0
    v_cndmask_b32 v145, v221, v145, vcc
    v_cndmask_b32 v157, v221, v157, vcc
    v_cmp_le_i32 vcc, 2, v6
    v_mov_b32 v154, v221
    s_nop 0
    v_cndmask_b32 v146, v221, v146, vcc
    v_cndmask_b32 v158, v221, v158, vcc
    v_cmp_le_i32 vcc, 3, v6
    v_mov_b32 v155, v221
    s_nop 0
    v_cndmask_b32 v147, v221, v147, vcc
    v_cndmask_b32 v159, v221, v159, vcc
    s_branch back_40
special_44:
    s_cmp_eq_u32 s34, 0
    s_cbranch_scc1 tail2_22
    v_mov_b32 v221, s43
    v_cmp_le_i32 vcc, 0, v6
    v_mov_b32 v152, v221
    s_nop 0
    v_cndmask_b32 v144, v221, v144, vcc
    v_cndmask_b32 v156, v221, v156, vcc
    v_cmp_le_i32 vcc, 1, v6
    v_mov_b32 v153, v221
    s_nop 0
    v_cndmask_b32 v145, v221, v145, vcc
    v_cndmask_b32 v157, v221, v157, vcc
    v_cmp_le_i32 vcc, 2, v6
    v_mov_b32 v154, v221
    s_nop 0
    v_cndmask_b32 v146, v221, v146, vcc
    v_cndmask_b32 v158, v221, v158, vcc
    v_cmp_le_i32 vcc, 3, v6
    v_mov_b32 v155, v221
    s_nop 0
    v_cndmask_b32 v147, v221, v147, vcc
    v_cndmask_b32 v159, v221, v159, vcc
    s_branch back_45
special_48:
    s_cmp_eq_u32 s34, 0
    s_cbranch_scc1 tail3_23
    v_mov_b32 v221, s43
    v_cmp_le_i32 vcc, 0, v6
    v_mov_b32 v152, v221
    s_nop 0
    v_cndmask_b32 v144, v221, v144, vcc
    v_cndmask_b32 v156, v221, v156, vcc
    v_cmp_le_i32 vcc, 1, v6
    v_mov_b32 v153, v221
    s_nop 0
    v_cndmask_b32 v145, v221, v145, vcc
    v_cndmask_b32 v157, v221, v157, vcc
    v_cmp_le_i32 vcc, 2, v6
    v_mov_b32 v154, v221
    s_nop 0
    v_cndmask_b32 v146, v221, v146, vcc
    v_cndmask_b32 v158, v221, v158, vcc
    v_cmp_le_i32 vcc, 3, v6
    v_mov_b32 v155, v221
    s_nop 0
    v_cndmask_b32 v147, v221, v147, vcc
    v_cndmask_b32 v159, v221, v159, vcc
    s_branch back_49
special_62:
    s_cmp_eq_u32 s34, 0
    s_cbranch_scc1 tail0_20
    v_mov_b32 v221, s43
    v_cmp_le_i32 vcc, 0, v6
    v_mov_b32 v152, v221
    s_nop 0
    v_cndmask_b32 v144, v221, v144, vcc
    v_cndmask_b32 v156, v221, v156, vcc
    v_cmp_le_i32 vcc, 1, v6
    v_mov_b32 v153, v221
    s_nop 0
    v_cndmask_b32 v145, v221, v145, vcc
    v_cndmask_b32 v157, v221, v157, vcc
    v_cmp_le_i32 vcc, 2, v6
    v_mov_b32 v154, v221
    s_nop 0
    v_cndmask_b32 v146, v221, v146, vcc
    v_cndmask_b32 v158, v221, v158, vcc
    v_cmp_le_i32 vcc, 3, v6
    v_mov_b32 v155, v221
    s_nop 0
    v_cndmask_b32 v147, v221, v147, vcc
    v_cndmask_b32 v159, v221, v159, vcc
    s_branch back_63
special_66:
    s_cmp_eq_u32 s34, 0
    s_cbranch_scc1 tail1_21
    v_mov_b32 v221, s43
    v_cmp_le_i32 vcc, 0, v6
    v_mov_b32 v152, v221
    s_nop 0
    v_cndmask_b32 v144, v221, v144, vcc
    v_cndmask_b32 v156, v221, v156, vcc
    v_cmp_le_i32 vcc, 1, v6
    v_mov_b32 v153, v221
    s_nop 0
    v_cndmask_b32 v145, v221, v145, vcc
    v_cndmask_b32 v157, v221, v157, vcc
    v_cmp_le_i32 vcc, 2, v6
    v_mov_b32 v154, v221
    s_nop 0
    v_cndmask_b32 v146, v221, v146, vcc
    v_cndmask_b32 v158, v221, v158, vcc
    v_cmp_le_i32 vcc, 3, v6
    v_mov_b32 v155, v221
    s_nop 0
    v_cndmask_b32 v147, v221, v147, vcc
    v_cndmask_b32 v159, v221, v159, vcc
    s_branch back_67
special_70:
    s_cmp_eq_u32 s34, 0
    s_cbranch_scc1 tail2_22
    v_mov_b32 v221, s43
    v_cmp_le_i32 vcc, 0, v6
    v_mov_b32 v152, v221
    s_nop 0
    v_cndmask_b32 v144, v221, v144, vcc
    v_cndmask_b32 v156, v221, v156, vcc
    v_cmp_le_i32 vcc, 1, v6
    v_mov_b32 v153, v221
    s_nop 0
    v_cndmask_b32 v145, v221, v145, vcc
    v_cndmask_b32 v157, v221, v157, vcc
    v_cmp_le_i32 vcc, 2, v6
    v_mov_b32 v154, v221
    s_nop 0
    v_cndmask_b32 v146, v221, v146, vcc
    v_cndmask_b32 v158, v221, v158, vcc
    v_cmp_le_i32 vcc, 3, v6
    v_mov_b32 v155, v221
    s_nop 0
    v_cndmask_b32 v147, v221, v147, vcc
    v_cndmask_b32 v159, v221, v159, vcc
    s_branch back_71
special_74:
    s_cmp_eq_u32 s34, 0
    s_cbranch_scc1 tail3_23
    v_mov_b32 v221, s43
    v_cmp_le_i32 vcc, 0, v6
    v_mov_b32 v152, v221
    s_nop 0
    v_cndmask_b32 v144, v221, v144, vcc
    v_cndmask_b32 v156, v221, v156, vcc
    v_cmp_le_i32 vcc, 1, v6
    v_mov_b32 v153, v221
    s_nop 0
    v_cndmask_b32 v145, v221, v145, vcc
    v_cndmask_b32 v157, v221, v157, vcc
    v_cmp_le_i32 vcc, 2, v6
    v_mov_b32 v154, v221
    s_nop 0
    v_cndmask_b32 v146, v221, v146, vcc
    v_cndmask_b32 v158, v221, v158, vcc
    v_cmp_le_i32 vcc, 3, v6
    v_mov_b32 v155, v221
    s_nop 0
    v_cndmask_b32 v147, v221, v147, vcc
    v_cndmask_b32 v159, v221, v159, vcc
    s_branch back_75
tail0_20:
    ds_read_b128 v[176:179], v3 offset:0
    ds_read_b128 v[180:183], v3 offset:1024
    ds_read_b128 v[184:187], v3 offset:2048
    ds_read_b128 v[188:191], v3 offset:3072
    ds_read_b128 v[192:195], v3 offset:4096
    ds_read_b128 v[196:199], v3 offset:5120
    ds_read_b128 v[200:203], v3 offset:6144
    ds_read_b128 v[204:207], v3 offset:7168
    v_exp_f32 v211, v123
    s_nop 0
    v_cvt_pk_bf16_f32 v163, v210, v211
    v_exp_f32 v212, v124
    s_nop 0
    v_mfma_f32_16x16x32_bf16 v[228:231], v[244:247], v[160:163], v[236:239]
    v_exp_f32 v213, v125
    v_exp_f32 v214, v126
    v_cvt_pk_bf16_f32 v166, v212, v213
    v_exp_f32 v215, v127
    s_nop 0
    v_cvt_pk_bf16_f32 v167, v214, v215
    s_nop 1
    v_mfma_f32_16x16x32_bf16 v[232:235], v[244:247], v[164:167], v[240:243]
    v_cmp_nge_f32 s[50:51], s42, v228
    s_nop 6
    v_cmp_nge_f32 vcc, s42, v232
    s_nop 0
    s_or_b64 vcc, vcc, s[50:51]
    s_cbranch_vccnz stub_80
ret_79:
    s_waitcnt lgkmcnt(7)
    v_mfma_f32_16x16x32_bf16 v[16:19], v[176:179], v[160:163], v[16:19]
    v_mfma_f32_16x16x32_bf16 v[20:23], v[176:179], v[164:167], v[20:23]
    s_waitcnt lgkmcnt(6)
    v_mfma_f32_16x16x32_bf16 v[24:27], v[180:183], v[160:163], v[24:27]
    v_mfma_f32_16x16x32_bf16 v[28:31], v[180:183], v[164:167], v[28:31]
    s_waitcnt lgkmcnt(5)
    v_mfma_f32_16x16x32_bf16 v[32:35], v[184:187], v[160:163], v[32:35]
    v_mfma_f32_16x16x32_bf16 v[36:39], v[184:187], v[164:167], v[36:39]
    s_waitcnt lgkmcnt(4)
    v_mfma_f32_16x16x32_bf16 v[40:43], v[188:191], v[160:163], v[40:43]
    v_mfma_f32_16x16x32_bf16 v[44:47], v[188:191], v[164:167], v[44:47]
    s_waitcnt lgkmcnt(3)
    v_mfma_f32_16x16x32_bf16 v[48:51], v[192:195], v[160:163], v[48:51]
    v_mfma_f32_16x16x32_bf16 v[52:55], v[192:195], v[164:167], v[52:55]
    s_waitcnt lgkmcnt(2)
    v_mfma_f32_16x16x32_bf16 v[56:59], v[196:199], v[160:163], v[56:59]
    v_mfma_f32_16x16x32_bf16 v[60:63], v[196:199], v[164:167], v[60:63]
    s_waitcnt lgkmcnt(1)
    v_mfma_f32_16x16x32_bf16 v[64:67], v[200:203], v[160:163], v[64:67]
    v_mfma_f32_16x16x32_bf16 v[68:71], v[200:203], v[164:167], v[68:71]
    s_waitcnt lgkmcnt(0)
    v_mfma_f32_16x16x32_bf16 v[72:75], v[204:207], v[160:163], v[72:75]
    v_mfma_f32_16x16x32_bf16 v[76:79], v[204:207], v[164:167], v[76:79]
    v_mov_b32 v216, v228
    v_mov_b32 v217, v232
    s_branch epi_78
tail1_21:
    ds_read_b128 v[176:179], v3 offset:16384
    ds_read_b128 v[180:183], v3 offset:17408
    ds_read_b128 v[184:187], v3 offset:18432
    ds_read_b128 v[188:191], v3 offset:19456
    ds_read_b128 v[192:195], v3 offset:20480
    ds_read_b128 v[196:199], v3 offset:21504
    ds_read_b128 v[200:203], v3 offset:22528
    ds_read_b128 v[204:207], v3 offset:23552
    v_exp_f32 v211, v139
    s_nop 0
    v_cvt_pk_bf16_f32 v171, v210, v211
    v_exp_f32 v212, v140
    s_nop 0
    v_mfma_f32_16x16x32_bf16 v[236:239], v[244:247], v[168:171], v[228:231]
    v_exp_f32 v213, v141
    v_exp_f32 v214, v142
    v_cvt_pk_bf16_f32 v174, v212, v213
    v_exp_f32 v215, v143
    s_nop 0
    v_cvt_pk_bf16_f32 v175, v214, v215
    s_nop 1
    v_mfma_f32_16x16x32_bf16 v[240:243], v[244:247], v[172:175], v[232:235]
    v_cmp_nge_f32 s[50:51], s42, v236
    s_nop 6
    v_cmp_nge_f32 vcc, s42, v240
    s_nop 0
    s_or_b64 vcc, vcc, s[50:51]
    s_cbranch_vccnz stub_82
ret_81:
    s_waitcnt lgkmcnt(7)
    v_mfma_f32_16x16x32_bf16 v[16:19], v[176:179], v[168:171], v[16:19]
    v_mfma_f32_16x16x32_bf16 v[20:23], v[176:179], v[172:175], v[20:23]
    s_waitcnt lgkmcnt(6)
    v_mfma_f32_16x16x32_bf16 v[24:27], v[180:183], v[168:171], v[24:27]
    v_mfma_f32_16x16x32_bf16 v[28:31], v[180:183], v[172:175], v[28:31]
    s_waitcnt lgkmcnt(5)
    v_mfma_f32_16x16x32_bf16 v[32:35], v[184:187], v[168:171], v[32:35]
    v_mfma_f32_16x16x32_bf16 v[36:39], v[184:187], v[172:175], v[36:39]
    s_waitcnt lgkmcnt(4)
    v_mfma_f32_16x16x32_bf16 v[40:43], v[188:191], v[168:171], v[40:43]
    v_mfma_f32_16x16x32_bf16 v[44:47], v[188:191], v[172:175], v[44:47]
    s_waitcnt lgkmcnt(3)
    v_mfma_f32_16x16x32_bf16 v[48:51], v[192:195], v[168:171], v[48:51]
    v_mfma_f32_16x16x32_bf16 v[52:55], v[192:195], v[172:175], v[52:55]
    s_waitcnt lgkmcnt(2)
    v_mfma_f32_16x16x32_bf16 v[56:59], v[196:199], v[168:171], v[56:59]
    v_mfma_f32_16x16x32_bf16 v[60:63], v[196:199], v[172:175], v[60:63]
    s_waitcnt lgkmcnt(1)
    v_mfma_f32_16x16x32_bf16 v[64:67], v[200:203], v[168:171], v[64:67]
    v_mfma_f32_16x16x32_bf16 v[68:71], v[200:203], v[172:175], v[68:71]
    s_waitcnt lgkmcnt(0)
    v_mfma_f32_16x16x32_bf16 v[72:75], v[204:207], v[168:171], v[72:75]
    v_mfma_f32_16x16x32_bf16 v[76:79], v[204:207], v[172:175], v[76:79]
    v_mov_b32 v216, v236
    v_mov_b32 v217, v240
    s_branch epi_78
tail2_22:
    ds_read_b128 v[176:179], v3 offset:32768
    ds_read_b128 v[180:183], v3 offset:33792
    ds_read_b128 v[184:187], v3 offset:34816
    ds_read_b128 v[188:191], v3 offset:35840
    ds_read_b128 v[192:195], v3 offset:36864
    ds_read_b128 v[196:199], v3 offset:37888
    ds_read_b128 v[200:203], v3 offset:38912
    ds_read_b128 v[204:207], v3 offset:39936
    v_exp_f32 v211, v123
    s_nop 0
    v_cvt_pk_bf16_f32 v163, v210, v211
    v_exp_f32 v212, v124
    s_nop 0
    v_mfma_f32_16x16x32_bf16 v[228:231], v[244:247], v[160:163], v[236:239]
    v_exp_f32 v213, v125
    v_exp_f32 v214, v126
    v_cvt_pk_bf16_f32 v166, v212, v213
    v_exp_f32 v215, v127
    s_nop 0
    v_cvt_pk_bf16_f32 v167, v214, v215
    s_nop 1
    v_mfma_f32_16x16x32_bf16 v[232:235], v[244:247], v[164:167], v[240:243]
    v_cmp_nge_f32 s[50:51], s42, v228
    s_nop 6
    v_cmp_nge_f32 vcc, s42, v232
    s_nop 0
    s_or_b64 vcc, vcc, s[50:51]
    s_cbranch_vccnz stub_84
ret_83:
    s_waitcnt lgkmcnt(7)
    v_mfma_f32_16x16x32_bf16 v[16:19], v[176:179], v[160:163], v[16:19]
    v_mfma_f32_16x16x32_bf16 v[20:23], v[176:179], v[164:167], v[20:23]
    s_waitcnt lgkmcnt(6)
    v_mfma_f32_16x16x32_bf16 v[24:27], v[180:183], v[160:163], v[24:27]
    v_mfma_f32_16x16x32_bf16 v[28:31], v[180:183], v[164:167], v[28:31]
    s_waitcnt lgkmcnt(5)
    v_mfma_f32_16x16x32_bf16 v[32:35], v[184:187], v[160:163], v[32:35]
    v_mfma_f32_16x16x32_bf16 v[36:39], v[184:187], v[164:167], v[36:39]
    s_waitcnt lgkmcnt(4)
    v_mfma_f32_16x16x32_bf16 v[40:43], v[188:191], v[160:163], v[40:43]
    v_mfma_f32_16x16x32_bf16 v[44:47], v[188:191], v[164:167], v[44:47]
    s_waitcnt lgkmcnt(3)
    v_mfma_f32_16x16x32_bf16 v[48:51], v[192:195], v[160:163], v[48:51]
    v_mfma_f32_16x16x32_bf16 v[52:55], v[192:195], v[164:167], v[52:55]
    s_waitcnt lgkmcnt(2)
    v_mfma_f32_16x16x32_bf16 v[56:59], v[196:199], v[160:163], v[56:59]
    v_mfma_f32_16x16x32_bf16 v[60:63], v[196:199], v[164:167], v[60:63]
    s_waitcnt lgkmcnt(1)
    v_mfma_f32_16x16x32_bf16 v[64:67], v[200:203], v[160:163], v[64:67]
    v_mfma_f32_16x16x32_bf16 v[68:71], v[200:203], v[164:167], v[68:71]
    s_waitcnt lgkmcnt(0)
    v_mfma_f32_16x16x32_bf16 v[72:75], v[204:207], v[160:163], v[72:75]
    v_mfma_f32_16x16x32_bf16 v[76:79], v[204:207], v[164:167], v[76:79]
    v_mov_b32 v216, v228
    v_mov_b32 v217, v232
    s_branch epi_78
tail3_23:
    ds_read_b128 v[176:179], v3 offset:49152
    ds_read_b128 v[180:183], v3 offset:50176
    ds_read_b128 v[184:187], v3 offset:51200
    ds_read_b128 v[188:191], v3 offset:52224
    ds_read_b128 v[192:195], v3 offset:53248
    ds_read_b128 v[196:199], v3 offset:54272
    ds_read_b128 v[200:203], v3 offset:55296
    ds_read_b128 v[204:207], v3 offset:56320
    v_exp_f32 v211, v139
    s_nop 0
    v_cvt_pk_bf16_f32 v171, v210, v211
    v_exp_f32 v212, v140
    s_nop 0
    v_mfma_f32_16x16x32_bf16 v[236:239], v[244:247], v[168:171], v[228:231]
    v_exp_f32 v213, v141
    v_exp_f32 v214, v142
    v_cvt_pk_bf16_f32 v174, v212, v213
    v_exp_f32 v215, v143
    s_nop 0
    v_cvt_pk_bf16_f32 v175, v214, v215
    s_nop 1
    v_mfma_f32_16x16x32_bf16 v[240:243], v[244:247], v[172:175], v[232:235]
    v_cmp_nge_f32 s[50:51], s42, v236
    s_nop 6
    v_cmp_nge_f32 vcc, s42, v240
    s_nop 0
    s_or_b64 vcc, vcc, s[50:51]
    s_cbranch_vccnz stub_86
ret_85:
    s_waitcnt lgkmcnt(7)
    v_mfma_f32_16x16x32_bf16 v[16:19], v[176:179], v[168:171], v[16:19]
    v_mfma_f32_16x16x32_bf16 v[20:23], v[176:179], v[172:175], v[20:23]
    s_waitcnt lgkmcnt(6)
    v_mfma_f32_16x16x32_bf16 v[24:27], v[180:183], v[168:171], v[24:27]
    v_mfma_f32_16x16x32_bf16 v[28:31], v[180:183], v[172:175], v[28:31]
    s_waitcnt lgkmcnt(5)
    v_mfma_f32_16x16x32_bf16 v[32:35], v[184:187], v[168:171], v[32:35]
    v_mfma_f32_16x16x32_bf16 v[36:39], v[184:187], v[172:175], v[36:39]
    s_waitcnt lgkmcnt(4)
    v_mfma_f32_16x16x32_bf16 v[40:43], v[188:191], v[168:171], v[40:43]
    v_mfma_f32_16x16x32_bf16 v[44:47], v[188:191], v[172:175], v[44:47]
    s_waitcnt lgkmcnt(3)
    v_mfma_f32_16x16x32_bf16 v[48:51], v[192:195], v[168:171], v[48:51]
    v_mfma_f32_16x16x32_bf16 v[52:55], v[192:195], v[172:175], v[52:55]
    s_waitcnt lgkmcnt(2)
    v_mfma_f32_16x16x32_bf16 v[56:59], v[196:199], v[168:171], v[56:59]
    v_mfma_f32_16x16x32_bf16 v[60:63], v[196:199], v[172:175], v[60:63]
    s_waitcnt lgkmcnt(1)
    v_mfma_f32_16x16x32_bf16 v[64:67], v[200:203], v[168:171], v[64:67]
    v_mfma_f32_16x16x32_bf16 v[68:71], v[200:203], v[172:175], v[68:71]
    s_waitcnt lgkmcnt(0)
    v_mfma_f32_16x16x32_bf16 v[72:75], v[204:207], v[168:171], v[72:75]
    v_mfma_f32_16x16x32_bf16 v[76:79], v[204:207], v[172:175], v[76:79]
    v_mov_b32 v216, v236
    v_mov_b32 v217, v240
    s_branch epi_78
stub_28:
    s_mov_b32 s48, 0
    s_branch rare0_87
stub_30:
    s_mov_b32 s48, 1
    s_branch rare1_88
stub_32:
    s_mov_b32 s48, 2
    s_branch rare0_87
stub_34:
    s_mov_b32 s48, 3
    s_branch rare1_88
stub_38:
    s_mov_b32 s48, 4
    s_branch rare0_87
stub_42:
    s_mov_b32 s48, 5
    s_branch rare1_88
stub_47:
    s_mov_b32 s48, 6
    s_branch rare0_87
stub_51:
    s_mov_b32 s48, 7
    s_branch rare1_88
stub_55:
    s_mov_b32 s48, 8
    s_branch rare0_87
stub_57:
    s_mov_b32 s48, 9
    s_branch rare1_88
stub_59:
    s_mov_b32 s48, 10
    s_branch rare0_87
stub_61:
    s_mov_b32 s48, 11
    s_branch rare1_88
stub_65:
    s_mov_b32 s48, 12
    s_branch rare0_87
stub_69:
    s_mov_b32 s48, 13
    s_branch rare1_88
stub_73:
    s_mov_b32 s48, 14
    s_branch rare0_87
stub_77:
    s_mov_b32 s48, 15
    s_branch rare1_88
stub_80:
    s_mov_b32 s48, 16
    s_branch rare0_87
stub_82:
    s_mov_b32 s48, 17
    s_branch rare1_88
stub_84:
    s_mov_b32 s48, 18
    s_branch rare0_87
stub_86:
    s_mov_b32 s48, 19
    s_branch rare1_88
rare0_87:
    s_nop 7
    v_max3_f32 v222, v112, v113, v114
    v_max3_f32 v222, v222, v115, v120
    v_max3_f32 v222, v222, v121, v122
    v_max_f32 v222, v222, v123
    v_max3_f32 v223, v116, v117, v118
    v_max3_f32 v223, v223, v119, v124
    v_max3_f32 v223, v223, v125, v126
    v_max_f32 v223, v223, v127
    v_mov_b32 v224, v222
    v_mov_b32 v225, v223
    s_nop 0
    v_permlane32_swap_b32 v222, v224
    v_max_f32 v222, v222, v224
    v_permlane32_swap_b32 v223, v225
    v_max_f32 v223, v223, v225
    v_mov_b32 v224, v222
    v_mov_b32 v225, v223
    s_nop 0
    v_permlane16_swap_b32 v222, v224
    v_max_f32 v222, v222, v224
    v_permlane16_swap_b32 v223, v225
    v_max_f32 v223, v223, v225
    v_max_f32 v224, 1.0, v236
    v_log_f32 v224, v224
    s_nop 0
    v_max_f32 v222, v224, v222
    v_sub_f32 v224, 0, v222
    v_exp_f32 v224, v224
    v_max_f32 v225, 1.0, v240
    v_log_f32 v225, v225
    s_nop 0
    v_max_f32 v223, v225, v223
    v_sub_f32 v225, 0, v223
    v_exp_f32 v225, v225
    v_mul_f32 v16, v224, v16
    v_mul_f32 v17, v224, v17
    v_mul_f32 v18, v224, v18
    v_mul_f32 v19, v224, v19
    v_mul_f32 v24, v224, v24
    v_mul_f32 v25, v224, v25
    v_mul_f32 v26, v224, v26
    v_mul_f32 v27, v224, v27
    v_mul_f32 v32, v224, v32
    v_mul_f32 v33, v224, v33
    v_mul_f32 v34, v224, v34
    v_mul_f32 v35, v224, v35
    v_mul_f32 v40, v224, v40
    v_mul_f32 v41, v224, v41
    v_mul_f32 v42, v224, v42
    v_mul_f32 v43, v224, v43
    v_mul_f32 v48, v224, v48
    v_mul_f32 v49, v224, v49
    v_mul_f32 v50, v224, v50
    v_mul_f32 v51, v224, v51
    v_mul_f32 v56, v224, v56
    v_mul_f32 v57, v224, v57
    v_mul_f32 v58, v224, v58
    v_mul_f32 v59, v224, v59
    v_mul_f32 v64, v224, v64
    v_mul_f32 v65, v224, v65
    v_mul_f32 v66, v224, v66
    v_mul_f32 v67, v224, v67
    v_mul_f32 v72, v224, v72
    v_mul_f32 v73, v224, v73
    v_mul_f32 v74, v224, v74
    v_mul_f32 v75, v224, v75
    v_mul_f32 v236, v224, v236
    v_mul_f32 v237, v224, v237
    v_mul_f32 v238, v224, v238
    v_mul_f32 v239, v224, v239
    v_sub_f32 v112, v112, v222
    v_sub_f32 v128, v128, v222
    v_sub_f32 v144, v144, v222
    v_sub_f32 v113, v113, v222
    v_sub_f32 v129, v129, v222
    v_sub_f32 v145, v145, v222
    v_sub_f32 v114, v114, v222
    v_sub_f32 v130, v130, v222
    v_sub_f32 v146, v146, v222
    v_sub_f32 v115, v115, v222
    v_sub_f32 v131, v131, v222
    v_sub_f32 v147, v147, v222
    v_sub_f32 v120, v120, v222
    v_sub_f32 v136, v136, v222
    v_sub_f32 v152, v152, v222
    v_sub_f32 v121, v121, v222
    v_sub_f32 v137, v137, v222
    v_sub_f32 v153, v153, v222
    v_sub_f32 v122, v122, v222
    v_sub_f32 v138, v138, v222
    v_sub_f32 v154, v154, v222
    v_sub_f32 v123, v123, v222
    v_sub_f32 v139, v139, v222
    v_sub_f32 v155, v155, v222
    v_mul_f32 v20, v225, v20
    v_mul_f32 v21, v225, v21
    v_mul_f32 v22, v225, v22
    v_mul_f32 v23, v225, v23
    v_mul_f32 v28, v225, v28
    v_mul_f32 v29, v225, v29
    v_mul_f32 v30, v225, v30
    v_mul_f32 v31, v225, v31
    v_mul_f32 v36, v225, v36
    v_mul_f32 v37, v225, v37
    v_mul_f32 v38, v225, v38
    v_mul_f32 v39, v225, v39
    v_mul_f32 v44, v225, v44
    v_mul_f32 v45, v225, v45
    v_mul_f32 v46, v225, v46
    v_mul_f32 v47, v225, v47
    v_mul_f32 v52, v225, v52
    v_mul_f32 v53, v225, v53
    v_mul_f32 v54, v225, v54
    v_mul_f32 v55, v225, v55
    v_mul_f32 v60, v225, v60
    v_mul_f32 v61, v225, v61
    v_mul_f32 v62, v225, v62
    v_mul_f32 v63, v225, v63
    v_mul_f32 v68, v225, v68
    v_mul_f32 v69, v225, v69
    v_mul_f32 v70, v225, v70
    v_mul_f32 v71, v225, v71
    v_mul_f32 v76, v225, v76
    v_mul_f32 v77, v225, v77
    v_mul_f32 v78, v225, v78
    v_mul_f32 v79, v225, v79
    v_mul_f32 v240, v225, v240
    v_mul_f32 v241, v225, v241
    v_mul_f32 v242, v225, v242
    v_mul_f32 v243, v225, v243
    v_sub_f32 v116, v116, v223
    v_sub_f32 v132, v132, v223
    v_sub_f32 v148, v148, v223
    v_sub_f32 v117, v117, v223
    v_sub_f32 v133, v133, v223
    v_sub_f32 v149, v149, v223
    v_sub_f32 v118, v118, v223
    v_sub_f32 v134, v134, v223
    v_sub_f32 v150, v150, v223
    v_sub_f32 v119, v119, v223
    v_sub_f32 v135, v135, v223
    v_sub_f32 v151, v151, v223
    v_sub_f32 v124, v124, v223
    v_sub_f32 v140, v140, v223
    v_sub_f32 v156, v156, v223
    v_sub_f32 v125, v125, v223
    v_sub_f32 v141, v141, v223
    v_sub_f32 v157, v157, v223
    v_sub_f32 v126, v126, v223
    v_sub_f32 v142, v142, v223
    v_sub_f32 v158, v158, v223
    v_sub_f32 v127, v127, v223
    v_sub_f32 v143, v143, v223
    v_sub_f32 v159, v159, v223
    v_exp_f32 v208, v112
    v_exp_f32 v209, v113
    v_exp_f32 v210, v114
    v_exp_f32 v211, v115
    v_cvt_pk_bf16_f32 v160, v208, v209
    v_exp_f32 v212, v116
    v_cvt_pk_bf16_f32 v161, v210, v211
    v_exp_f32 v213, v117
    v_exp_f32 v214, v118
    v_cvt_pk_bf16_f32 v164, v212, v213
    v_exp_f32 v215, v119
    v_exp_f32 v208, v120
    v_cvt_pk_bf16_f32 v165, v214, v215
    v_exp_f32 v209, v121
    v_exp_f32 v210, v122
    v_cvt_pk_bf16_f32 v162, v208, v209
    v_exp_f32 v211, v123
    s_nop 0
    v_cvt_pk_bf16_f32 v163, v210, v211
    v_exp_f32 v212, v124
    s_nop 0
    v_mfma_f32_16x16x32_bf16 v[228:231], v[244:247], v[160:163], v[236:239]
    v_exp_f32 v213, v125
    v_exp_f32 v214, v126
    v_cvt_pk_bf16_f32 v166, v212, v213
    v_exp_f32 v215, v127
    s_nop 0
    v_cvt_pk_bf16_f32 v167, v214, v215
    s_nop 1
    v_mfma_f32_16x16x32_bf16 v[232:235], v[244:247], v[164:167], v[240:243]
    v_exp_f32 v208, v128
    v_exp_f32 v209, v129
    v_exp_f32 v210, v130
    s_nop 7
    s_cmp_eq_u32 s48, 0
    s_cbranch_scc1 ret_27
    s_cmp_eq_u32 s48, 2
    s_cbranch_scc1 ret_31
    s_cmp_eq_u32 s48, 4
    s_cbranch_scc1 ret_37
    s_cmp_eq_u32 s48, 6
    s_cbranch_scc1 ret_46
    s_cmp_eq_u32 s48, 8
    s_cbranch_scc1 ret_54
    s_cmp_eq_u32 s48, 10
    s_cbranch_scc1 ret_58
    s_cmp_eq_u32 s48, 12
    s_cbranch_scc1 ret_64
    s_cmp_eq_u32 s48, 14
    s_cbranch_scc1 ret_72
    s_cmp_eq_u32 s48, 16
    s_cbranch_scc1 ret_79
    s_branch ret_83
rare1_88:
    s_nop 7
    v_max3_f32 v222, v128, v129, v130
    v_max3_f32 v222, v222, v131, v136
    v_max3_f32 v222, v222, v137, v138
    v_max_f32 v222, v222, v139
    v_max3_f32 v223, v132, v133, v134
    v_max3_f32 v223, v223, v135, v140
    v_max3_f32 v223, v223, v141, v142
    v_max_f32 v223, v223, v143
    v_mov_b32 v224, v222
    v_mov_b32 v225, v223
    s_nop 0
    v_permlane32_swap_b32 v222, v224
    v_max_f32 v222, v222, v224
    v_permlane32_swap_b32 v223, v225
    v_max_f32 v223, v223, v225
    v_mov_b32 v224, v222
    v_mov_b32 v225, v223
    s_nop 0
    v_permlane16_swap_b32 v222, v224
    v_max_f32 v222, v222, v224
    v_permlane16_swap_b32 v223, v225
    v_max_f32 v223, v223, v225
    v_max_f32 v224, 1.0, v228
    v_log_f32 v224, v224
    s_nop 0
    v_max_f32 v222, v224, v222
    v_sub_f32 v224, 0, v222
    v_exp_f32 v224, v224
    v_max_f32 v225, 1.0, v232
    v_log_f32 v225, v225
    s_nop 0
    v_max_f32 v223, v225, v223
    v_sub_f32 v225, 0, v223
    v_exp_f32 v225, v225
    v_mul_f32 v16, v224, v16
    v_mul_f32 v17, v224, v17
    v_mul_f32 v18, v224, v18
    v_mul_f32 v19, v224, v19
    v_mul_f32 v24, v224, v24
    v_mul_f32 v25, v224, v25
    v_mul_f32 v26, v224, v26
    v_mul_f32 v27, v224, v27
    v_mul_f32 v32, v224, v32
    v_mul_f32 v33, v224, v33
    v_mul_f32 v34, v224, v34
    v_mul_f32 v35, v224, v35
    v_mul_f32 v40, v224, v40
    v_mul_f32 v41, v224, v41
    v_mul_f32 v42, v224, v42
    v_mul_f32 v43, v224, v43
    v_mul_f32 v48, v224, v48
    v_mul_f32 v49, v224, v49
    v_mul_f32 v50, v224, v50
    v_mul_f32 v51, v224, v51
    v_mul_f32 v56, v224, v56
    v_mul_f32 v57, v224, v57
    v_mul_f32 v58, v224, v58
    v_mul_f32 v59, v224, v59
    v_mul_f32 v64, v224, v64
    v_mul_f32 v65, v224, v65
    v_mul_f32 v66, v224, v66
    v_mul_f32 v67, v224, v67
    v_mul_f32 v72, v224, v72
    v_mul_f32 v73, v224, v73
    v_mul_f32 v74, v224, v74
    v_mul_f32 v75, v224, v75
    v_mul_f32 v228, v224, v228
    v_mul_f32 v229, v224, v229
    v_mul_f32 v230, v224, v230
    v_mul_f32 v231, v224, v231
    v_sub_f32 v128, v128, v222
    v_sub_f32 v112, v112, v222
    v_sub_f32 v144, v144, v222
    v_sub_f32 v129, v129, v222
    v_sub_f32 v113, v113, v222
    v_sub_f32 v145, v145, v222
    v_sub_f32 v130, v130, v222
    v_sub_f32 v114, v114, v222
    v_sub_f32 v146, v146, v222
    v_sub_f32 v131, v131, v222
    v_sub_f32 v115, v115, v222
    v_sub_f32 v147, v147, v222
    v_sub_f32 v136, v136, v222
    v_sub_f32 v120, v120, v222
    v_sub_f32 v152, v152, v222
    v_sub_f32 v137, v137, v222
    v_sub_f32 v121, v121, v222
    v_sub_f32 v153, v153, v222
    v_sub_f32 v138, v138, v222
    v_sub_f32 v122, v122, v222
    v_sub_f32 v154, v154, v222
    v_sub_f32 v139, v139, v222
    v_sub_f32 v123, v123, v222
    v_sub_f32 v155, v155, v222
    v_mul_f32 v20, v225, v20
    v_mul_f32 v21, v225, v21
    v_mul_f32 v22, v225, v22
    v_mul_f32 v23, v225, v23
    v_mul_f32 v28, v225, v28
    v_mul_f32 v29, v225, v29
    v_mul_f32 v30, v225, v30
    v_mul_f32 v31, v225, v31
    v_mul_f32 v36, v225, v36
    v_mul_f32 v37, v225, v37
    v_mul_f32 v38, v225, v38
    v_mul_f32 v39, v225, v39
    v_mul_f32 v44, v225, v44
    v_mul_f32 v45, v225, v45
    v_mul_f32 v46, v225, v46
    v_mul_f32 v47, v225, v47
    v_mul_f32 v52, v225, v52
    v_mul_f32 v53, v225, v53
    v_mul_f32 v54, v225, v54
    v_mul_f32 v55, v225, v55
    v_mul_f32 v60, v225, v60
    v_mul_f32 v61, v225, v61
    v_mul_f32 v62, v225, v62
    v_mul_f32 v63, v225, v63
    v_mul_f32 v68, v225, v68
    v_mul_f32 v69, v225, v69
    v_mul_f32 v70, v225, v70
    v_mul_f32 v71, v225, v71
    v_mul_f32 v76, v225, v76
    v_mul_f32 v77, v225, v77
    v_mul_f32 v78, v225, v78
    v_mul_f32 v79, v225, v79
    v_mul_f32 v232, v225, v232
    v_mul_f32 v233, v225, v233
    v_mul_f32 v234, v225, v234
    v_mul_f32 v235, v225, v235
    v_sub_f32 v132, v132, v223
    v_sub_f32 v116, v116, v223
    v_sub_f32 v148, v148, v223
    v_sub_f32 v133, v133, v223
    v_sub_f32 v117, v117, v223
    v_sub_f32 v149, v149, v223
    v_sub_f32 v134, v134, v223
    v_sub_f32 v118, v118, v223
    v_sub_f32 v150, v150, v223
    v_sub_f32 v135, v135, v223
    v_sub_f32 v119, v119, v223
    v_sub_f32 v151, v151, v223
    v_sub_f32 v140, v140, v223
    v_sub_f32 v124, v124, v223
    v_sub_f32 v156, v156, v223
    v_sub_f32 v141, v141, v223
    v_sub_f32 v125, v125, v223
    v_sub_f32 v157, v157, v223
    v_sub_f32 v142, v142, v223
    v_sub_f32 v126, v126, v223
    v_sub_f32 v158, v158, v223
    v_sub_f32 v143, v143, v223
    v_sub_f32 v127, v127, v223
    v_sub_f32 v159, v159, v223
    v_exp_f32 v208, v128
    v_exp_f32 v209, v129
    v_exp_f32 v210, v130
    v_exp_f32 v211, v131
    v_cvt_pk_bf16_f32 v168, v208, v209
    v_exp_f32 v212, v132
    v_cvt_pk_bf16_f32 v169, v210, v211
    v_exp_f32 v213, v133
    v_exp_f32 v214, v134
    v_cvt_pk_bf16_f32 v172, v212, v213
    v_exp_f32 v215, v135
    v_exp_f32 v208, v136
    v_cvt_pk_bf16_f32 v173, v214, v215
    v_exp_f32 v209, v137
    v_exp_f32 v210, v138
    v_cvt_pk_bf16_f32 v170, v208, v209
    v_exp_f32 v211, v139
    s_nop 0
    v_cvt_pk_bf16_f32 v171, v210, v211
    v_exp_f32 v212, v140
    s_nop 0
    v_mfma_f32_16x16x32_bf16 v[236:239], v[244:247], v[168:171], v[228:231]
    v_exp_f32 v213, v141
    v_exp_f32 v214, v142
    v_cvt_pk_bf16_f32 v174, v212, v213
    v_exp_f32 v215, v143
    s_nop 0
    v_cvt_pk_bf16_f32 v175, v214, v215
    s_nop 1
    v_mfma_f32_16x16x32_bf16 v[240:243], v[244:247], v[172:175], v[232:235]
    v_exp_f32 v208, v112
    v_exp_f32 v209, v113
    v_exp_f32 v210, v114
    s_nop 7
    s_cmp_eq_u32 s48, 1
    s_cbranch_scc1 ret_29
    s_cmp_eq_u32 s48, 3
    s_cbranch_scc1 ret_33
    s_cmp_eq_u32 s48, 5
    s_cbranch_scc1 ret_41
    s_cmp_eq_u32 s48, 7
    s_cbranch_scc1 ret_50
    s_cmp_eq_u32 s48, 9
    s_cbranch_scc1 ret_56
    s_cmp_eq_u32 s48, 11
    s_cbranch_scc1 ret_60
    s_cmp_eq_u32 s48, 13
    s_cbranch_scc1 ret_68
    s_cmp_eq_u32 s48, 15
    s_cbranch_scc1 ret_76
    s_cmp_eq_u32 s48, 17
    s_cbranch_scc1 ret_81
    s_branch ret_85
epi_78:
    s_setprio 0
    s_cmp_lg_u32 s14, 0
    s_cbranch_scc1 epi_b_89
    s_waitcnt vmcnt(0)
epi_b_89:
    v_rcp_f32 v216, v216
    v_rcp_f32 v217, v217
    s_mov_b32 s28, 0
    s_mov_b32 s29, 131072
    v_mul_f32 v16, v216, v16
    v_mul_f32 v17, v216, v17
    v_mul_f32 v18, v216, v18
    v_mul_f32 v19, v216, v19
    v_cvt_pk_bf16_f32 v176, v16, v17
    v_cvt_pk_bf16_f32 v177, v18, v19
    v_mul_f32 v24, v216, v24
    v_mul_f32 v25, v216, v25
    v_mul_f32 v26, v216, v26
    v_mul_f32 v27, v216, v27
    v_cvt_pk_bf16_f32 v178, v24, v25
    v_cvt_pk_bf16_f32 v179, v26, v27
    buffer_store_dwordx4 v[176:179], v5, s[44:47], s28 offen offset:0 sc1
    v_mul_f32 v32, v216, v32
    v_mul_f32 v33, v216, v33
    v_mul_f32 v34, v216, v34
    v_mul_f32 v35, v216, v35
    v_cvt_pk_bf16_f32 v180, v32, v33
    v_cvt_pk_bf16_f32 v181, v34, v35
    v_mul_f32 v40, v216, v40
    v_mul_f32 v41, v216, v41
    v_mul_f32 v42, v216, v42
    v_mul_f32 v43, v216, v43
    v_cvt_pk_bf16_f32 v182, v40, v41
    v_cvt_pk_bf16_f32 v183, v42, v43
    buffer_store_dwordx4 v[180:183], v5, s[44:47], s28 offen offset:1024 sc1
    v_mul_f32 v48, v216, v48
    v_mul_f32 v49, v216, v49
    v_mul_f32 v50, v216, v50
    v_mul_f32 v51, v216, v51
    v_cvt_pk_bf16_f32 v184, v48, v49
    v_cvt_pk_bf16_f32 v185, v50, v51
    v_mul_f32 v56, v216, v56
    v_mul_f32 v57, v216, v57
    v_mul_f32 v58, v216, v58
    v_mul_f32 v59, v216, v59
    v_cvt_pk_bf16_f32 v186, v56, v57
    v_cvt_pk_bf16_f32 v187, v58, v59
    buffer_store_dwordx4 v[184:187], v5, s[44:47], s28 offen offset:2048 sc1
    v_mul_f32 v64, v216, v64
    v_mul_f32 v65, v216, v65
    v_mul_f32 v66, v216, v66
    v_mul_f32 v67, v216, v67
    v_cvt_pk_bf16_f32 v188, v64, v65
    v_cvt_pk_bf16_f32 v189, v66, v67
    v_mul_f32 v72, v216, v72
    v_mul_f32 v73, v216, v73
    v_mul_f32 v74, v216, v74
    v_mul_f32 v75, v216, v75
    v_cvt_pk_bf16_f32 v190, v72, v73
    v_cvt_pk_bf16_f32 v191, v74, v75
    buffer_store_dwordx4 v[188:191], v5, s[44:47], s28 offen offset:3072 sc1
    v_mul_f32 v20, v217, v20
    v_mul_f32 v21, v217, v21
    v_mul_f32 v22, v217, v22
    v_mul_f32 v23, v217, v23
    v_cvt_pk_bf16_f32 v192, v20, v21
    v_cvt_pk_bf16_f32 v193, v22, v23
    v_mul_f32 v28, v217, v28
    v_mul_f32 v29, v217, v29
    v_mul_f32 v30, v217, v30
    v_mul_f32 v31, v217, v31
    v_cvt_pk_bf16_f32 v194, v28, v29
    v_cvt_pk_bf16_f32 v195, v30, v31
    buffer_store_dwordx4 v[192:195], v5, s[44:47], s29 offen offset:0 sc1
    v_mul_f32 v36, v217, v36
    v_mul_f32 v37, v217, v37
    v_mul_f32 v38, v217, v38
    v_mul_f32 v39, v217, v39
    v_cvt_pk_bf16_f32 v196, v36, v37
    v_cvt_pk_bf16_f32 v197, v38, v39
    v_mul_f32 v44, v217, v44
    v_mul_f32 v45, v217, v45
    v_mul_f32 v46, v217, v46
    v_mul_f32 v47, v217, v47
    v_cvt_pk_bf16_f32 v198, v44, v45
    v_cvt_pk_bf16_f32 v199, v46, v47
    buffer_store_dwordx4 v[196:199], v5, s[44:47], s29 offen offset:1024 sc1
    v_mul_f32 v52, v217, v52
    v_mul_f32 v53, v217, v53
    v_mul_f32 v54, v217, v54
    v_mul_f32 v55, v217, v55
    v_cvt_pk_bf16_f32 v200, v52, v53
    v_cvt_pk_bf16_f32 v201, v54, v55
    v_mul_f32 v60, v217, v60
    v_mul_f32 v61, v217, v61
    v_mul_f32 v62, v217, v62
    v_mul_f32 v63, v217, v63
    v_cvt_pk_bf16_f32 v202, v60, v61
    v_cvt_pk_bf16_f32 v203, v62, v63
    buffer_store_dwordx4 v[200:203], v5, s[44:47], s29 offen offset:2048 sc1
    v_mul_f32 v68, v217, v68
    v_mul_f32 v69, v217, v69
    v_mul_f32 v70, v217, v70
    v_mul_f32 v71, v217, v71
    v_cvt_pk_bf16_f32 v204, v68, v69
    v_cvt_pk_bf16_f32 v205, v70, v71
    v_mul_f32 v76, v217, v76
    v_mul_f32 v77, v217, v77
    v_mul_f32 v78, v217, v78
    v_mul_f32 v79, v217, v79
    v_cvt_pk_bf16_f32 v206, v76, v77
    v_cvt_pk_bf16_f32 v207, v78, v79
    buffer_store_dwordx4 v[204:207], v5, s[44:47], s29 offen offset:3072 sc1
    s_cmp_eq_u32 s14, 0
    s_cbranch_scc1 fin_90
    s_mov_b32 s41, 0
    v_mov_b32 v208, 0
    v_mov_b32 v209, 0
    v_mov_b32 v210, 0
    v_mov_b32 v211, 0
    v_mov_b32 v212, 0
    s_mov_b64 s[50:51], s[24:25]
    s_mul_i32 s19, s12, 5
    s_add_u32 s19, s19, s13
    s_sub_u32 s19, s19, 1
    s_lshl_b32 s19, s19, 2
    s_add_u32 s19, s19, s15
    s_lshl_b32 s16, s12, 3
    s_and_b32 s28, s13, 4
    s_add_u32 s16, s16, s28
    s_add_u32 s16, s16, s15
    s_mul_i32 s22, s15, 6144
    s_add_u32 s22, s22, 131072
    v_mov_b32 v9, 163776
    ds_read_b32 v13, v9
    s_load_dwordx2 s[8:9], s[0:1], 40
    s_load_dwordx4 s[4:7], s[0:1], 56
    s_load_dwordx2 s[10:11], s[0:1], 72
    s_load_dwordx2 s[36:37], s[0:1], 96
    v_mov_b32 v12, 0
    s_waitcnt lgkmcnt(0)
    s_mov_b32 s23, 0
    s_mov_b32 s20, 0
    s_lshl_b32 s21, s13, 1
    s_sub_u32 s21, 16, s21
loader_94:
    s_cmp_lt_u32 s41, 3
    s_cbranch_scc1 loader_early_93
    s_waitcnt vmcnt(16)
loader_early_93:
    s_waitcnt vmcnt(24)
loader2_92:
    s_add_u32 s39, s39, 1
    s_cmp_lt_u32 s39, s38
    s_cbranch_scc0 loader3_91
    s_barrier
    s_cmp_lt_u32 s32, s33
    s_cselect_b32 s26, s26, 0
    s_add_u32 m0, s30, 0
    s_add_u32 s35, s32, 0
    buffer_load_dwordx4 v4, s[24:27], s35 offen offset:0 sc1 lds
    buffer_load_dwordx4 v4, s[24:27], s35 offen offset:1024 sc1 lds
    buffer_load_dwordx4 v4, s[24:27], s35 offen offset:2048 sc1 lds
    buffer_load_dwordx4 v4, s[24:27], s35 offen offset:3072 sc1 lds
    s_add_u32 m0, s30, 4096
    s_add_u32 s35, s32, 4096
    buffer_load_dwordx4 v4, s[24:27], s35 offen offset:0 sc1 lds
    buffer_load_dwordx4 v4, s[24:27], s35 offen offset:1024 sc1 lds
    buffer_load_dwordx4 v4, s[24:27], s35 offen offset:2048 sc1 lds
    buffer_load_dwordx4 v4, s[24:27], s35 offen offset:3072 sc1 lds
    s_add_u32 s30, s30, 32768
    s_and_b32 s30, s30, 131071
    s_add_u32 s32, s32, 32768
    s_add_u32 s41, s41, 1
    s_cmp_lt_u32 s39, s21
    s_cbranch_scc1 loader_94
    s_add_u32 s20, s20, 1
    s_cmp_eq_u32 s13, 7
    s_cbranch_scc1 loader_94
    s_sub_u32 s28, s13, 1
    s_cmp_gt_u32 s28, 4
    s_cbranch_scc1 plan_gate_95
    s_cmp_eq_u32 s20, 1
    s_cbranch_scc1 pstep0_96
    s_cmp_eq_u32 s20, 2
    s_cbranch_scc1 pstep1_97
    s_cmp_eq_u32 s20, 3
    s_cbranch_scc1 pstep2_98
    s_cmp_eq_u32 s20, 4
    s_cbranch_scc1 pstep3_99
    s_cmp_eq_u32 s20, 5
    s_cbranch_scc1 pstep4_100
    s_cmp_eq_u32 s20, 6
    s_cbranch_scc1 pstep5_101
    s_cmp_eq_u32 s20, 7
    s_cbranch_scc1 pstep6_102
    s_cmp_eq_u32 s20, 8
    s_cbranch_scc1 pstep7_103
    s_cmp_eq_u32 s20, 9
    s_cbranch_scc1 pstep8_104
    s_branch loader_94
pstep0_96:
    s_setprio 3
    s_mul_i32 s88, s19, 6554
    s_lshr_b32 s88, s88, 16
    s_mul_i32 s89, s88, 10
    s_sub_u32 s89, s19, s89
    v_lshrrev_b32 v208, 3, v2
    v_lshlrev_b32 v208, 2, v208
    s_lshl_b32 s90, s88, 5
    v_add_u32 v208, s90, v208
    v_and_b32 v209, 7, v2
    v_lshlrev_b32 v209, 3, v209
    s_lshl_b32 s90, s89, 6
    v_add_u32 v209, s90, v209
    v_mul_u32_u24 v210, 1280, v208
    v_lshl_add_u32 v210, v209, 1, v210
    v_subrev_u32 v211, 3840, v210
    v_cmp_eq_u32 vcc, 0, v208
    v_mov_b32 v212, 0x7f000000
    s_nop 0
    v_cndmask_b32 v211, v211, v212, vcc
    v_lshlrev_b32 v212, 3, v209
    s_mov_b32 s96, s4
    s_mov_b32 s97, s5
    s_mov_b32 s98, 0x280000
    s_mov_b32 s99, 0x20000
    buffer_load_dwordx4 v[28:31], v210, s[96:99], 0 offen offset:0
    buffer_load_dwordx4 v[32:35], v210, s[96:99], 0 offen offset:1280
    s_mov_b32 s96, s10
    s_mov_b32 s97, s11
    s_mov_b32 s98, 0x1400
    s_mov_b32 s99, 0x20000
    buffer_load_dwordx4 v[60:63], v212, s[96:99], 0 offen offset:0
    s_mov_b32 s96, s4
    s_mov_b32 s97, s5
    s_mov_b32 s98, 0x280000
    s_mov_b32 s99, 0x20000
    buffer_load_dwordx4 v[36:39], v210, s[96:99], 0 offen offset:2560
    buffer_load_dwordx4 v[40:43], v210, s[96:99], 0 offen offset:3840
    s_mov_b32 s96, s10
    s_mov_b32 s97, s11
    s_mov_b32 s98, 0x1400
    s_mov_b32 s99, 0x20000
    buffer_load_dwordx4 v[64:67], v212, s[96:99], 0 offen offset:16
    s_mov_b32 s96, s6
    s_mov_b32 s97, s7
    s_mov_b32 s98, 0x280000
    s_mov_b32 s99, 0x20000
    buffer_load_dwordx4 v[44:47], v210, s[96:99], 0 offen offset:0
    buffer_load_dwordx4 v[48:51], v210, s[96:99], 0 offen offset:1280
    s_mov_b32 s96, s10
    s_mov_b32 s97, s11
    s_mov_b32 s98, 0x1400
    s_mov_b32 s99, 0x20000
    buffer_load_dwordx4 v[68:71], v212, s[96:99], 0 offen offset:32
    s_mov_b32 s96, s6
    s_mov_b32 s97, s7
    s_mov_b32 s98, 0x280000
    s_mov_b32 s99, 0x20000
    buffer_load_dwordx4 v[52:55], v210, s[96:99], 0 offen offset:2560
    buffer_load_dwordx4 v[56:59], v210, s[96:99], 0 offen offset:3840
    s_mov_b32 s96, s10
    s_mov_b32 s97, s11
    s_mov_b32 s98, 0x1400
    s_mov_b32 s99, 0x20000
    buffer_load_dwordx4 v[72:75], v212, s[96:99], 0 offen offset:48
    s_mov_b32 s96, s4
    s_mov_b32 s97, s5
    s_mov_b32 s98, 0x280000
    s_mov_b32 s99, 0x20000
    buffer_load_dwordx4 v[16:19], v211, s[96:99], 0 offen offset:0
    buffer_load_dwordx4 v[20:23], v211, s[96:99], 0 offen offset:1280
    buffer_load_dwordx4 v[24:27], v211, s[96:99], 0 offen offset:2560
    s_setprio 0
    s_waitcnt vmcnt(31)
    s_branch loader2_92
pstep1_97:
    s_waitcnt vmcnt(31)
    s_branch loader2_92
pstep2_98:
    s_setprio 3
    s_waitcnt vmcnt(16)
    v_and_b32 v208, 7, v2
    v_mul_u32_u24 v208, 528, v208
    v_lshrrev_b32 v209, 3, v2
    v_lshlrev_b32 v209, 3, v209
    v_sub_u32 v208, v208, v209
    s_add_u32 s90, s22, 56
    v_add_u32 v208, s90, v208
    v_lshlrev_b32 v112, 16, v16
    v_and_b32 v119, 0xffff0000, v16
    v_lshlrev_b32 v113, 16, v20
    v_and_b32 v120, 0xffff0000, v20
    v_lshlrev_b32 v114, 16, v24
    v_and_b32 v121, 0xffff0000, v24
    v_lshlrev_b32 v115, 16, v28
    v_and_b32 v122, 0xffff0000, v28
    v_lshlrev_b32 v116, 16, v32
    v_and_b32 v123, 0xffff0000, v32
    v_lshlrev_b32 v117, 16, v36
    v_and_b32 v124, 0xffff0000, v36
    v_lshlrev_b32 v118, 16, v40
    v_and_b32 v125, 0xffff0000, v40
    v_lshlrev_b32 v126, 16, v60
    v_and_b32 v127, 0xffff0000, v60
    v_lshlrev_b32 v128, 16, v61
    v_and_b32 v129, 0xffff0000, v61
    v_lshlrev_b32 v130, 16, v62
    v_and_b32 v131, 0xffff0000, v62
    v_lshlrev_b32 v132, 16, v63
    v_and_b32 v133, 0xffff0000, v63
    v_mul_f32 v134, v112, v129
    v_mul_f32 v135, v113, v129
    v_mul_f32 v136, v114, v129
    v_mul_f32 v137, v115, v129
    v_fmac_f32 v134, v113, v128
    v_fmac_f32 v135, v114, v128
    v_fmac_f32 v136, v115, v128
    v_fmac_f32 v137, v116, v128
    v_fmac_f32 v134, v114, v127
    v_fmac_f32 v135, v115, v127
    v_fmac_f32 v136, v116, v127
    v_fmac_f32 v137, v117, v127
    v_fmac_f32 v134, v115, v126
    v_fmac_f32 v135, v116, v126
    v_fmac_f32 v136, v117, v126
    v_fmac_f32 v137, v118, v126
    v_lshlrev_b32 v138, 16, v44
    v_mul_f32 v134, v134, v138
    v_lshlrev_b32 v139, 16, v48
    v_mul_f32 v135, v135, v139
    v_lshlrev_b32 v140, 16, v52
    v_mul_f32 v136, v136, v140
    v_lshlrev_b32 v141, 16, v56
    v_mul_f32 v137, v137, v141
    v_cvt_pk_bf16_f32 v160, v137, v136
    v_cvt_pk_bf16_f32 v161, v135, v134
    ds_write_b64 v208, v[160:161] offset:0
    v_mul_f32 v134, v119, v133
    v_mul_f32 v135, v120, v133
    v_mul_f32 v136, v121, v133
    v_mul_f32 v137, v122, v133
    v_fmac_f32 v134, v120, v132
    v_fmac_f32 v135, v121, v132
    v_fmac_f32 v136, v122, v132
    v_fmac_f32 v137, v123, v132
    v_fmac_f32 v134, v121, v131
    v_fmac_f32 v135, v122, v131
    v_fmac_f32 v136, v123, v131
    v_fmac_f32 v137, v124, v131
    v_fmac_f32 v134, v122, v130
    v_fmac_f32 v135, v123, v130
    v_fmac_f32 v136, v124, v130
    v_fmac_f32 v137, v125, v130
    v_and_b32 v138, 0xffff0000, v44
    v_mul_f32 v134, v134, v138
    v_and_b32 v139, 0xffff0000, v48
    v_mul_f32 v135, v135, v139
    v_and_b32 v140, 0xffff0000, v52
    v_mul_f32 v136, v136, v140
    v_and_b32 v141, 0xffff0000, v56
    v_mul_f32 v137, v137, v141
    v_cvt_pk_bf16_f32 v162, v137, v136
    v_cvt_pk_bf16_f32 v163, v135, v134
    ds_write_b64 v208, v[162:163] offset:64
    s_setprio 0
    s_waitcnt vmcnt(31)
    s_branch loader2_92
pstep3_99:
    s_setprio 3
    v_lshlrev_b32 v112, 16, v17
    v_and_b32 v119, 0xffff0000, v17
    v_lshlrev_b32 v113, 16, v21
    v_and_b32 v120, 0xffff0000, v21
    v_lshlrev_b32 v114, 16, v25
    v_and_b32 v121, 0xffff0000, v25
    v_lshlrev_b32 v115, 16, v29
    v_and_b32 v122, 0xffff0000, v29
    v_lshlrev_b32 v116, 16, v33
    v_and_b32 v123, 0xffff0000, v33
    v_lshlrev_b32 v117, 16, v37
    v_and_b32 v124, 0xffff0000, v37
    v_lshlrev_b32 v118, 16, v41
    v_and_b32 v125, 0xffff0000, v41
    v_lshlrev_b32 v126, 16, v64
    v_and_b32 v127, 0xffff0000, v64
    v_lshlrev_b32 v128, 16, v65
    v_and_b32 v129, 0xffff0000, v65
    v_lshlrev_b32 v130, 16, v66
    v_and_b32 v131, 0xffff0000, v66
    v_lshlrev_b32 v132, 16, v67
    v_and_b32 v133, 0xffff0000, v67
    v_mul_f32 v134, v112, v129
    v_mul_f32 v135, v113, v129
    v_mul_f32 v136, v114, v129
    v_mul_f32 v137, v115, v129
    v_fmac_f32 v134, v113, v128
    v_fmac_f32 v135, v114, v128
    v_fmac_f32 v136, v115, v128
    v_fmac_f32 v137, v116, v128
    v_fmac_f32 v134, v114, v127
    v_fmac_f32 v135, v115, v127
    v_fmac_f32 v136, v116, v127
    v_fmac_f32 v137, v117, v127
    v_fmac_f32 v134, v115, v126
    v_fmac_f32 v135, v116, v126
    v_fmac_f32 v136, v117, v126
    v_fmac_f32 v137, v118, v126
    v_lshlrev_b32 v138, 16, v45
    v_mul_f32 v134, v134, v138
    v_lshlrev_b32 v139, 16, v49
    v_mul_f32 v135, v135, v139
    v_lshlrev_b32 v140, 16, v53
    v_mul_f32 v136, v136, v140
    v_lshlrev_b32 v141, 16, v57
    v_mul_f32 v137, v137, v141
    v_cvt_pk_bf16_f32 v164, v137, v136
    v_cvt_pk_bf16_f32 v165, v135, v134
    ds_write_b64 v208, v[164:165] offset:128
    v_mul_f32 v134, v119, v133
    v_mul_f32 v135, v120, v133
    v_mul_f32 v136, v121, v133
    v_mul_f32 v137, v122, v133
    v_fmac_f32 v134, v120, v132
    v_fmac_f32 v135, v121, v132
    v_fmac_f32 v136, v122, v132
    v_fmac_f32 v137, v123, v132
    v_fmac_f32 v134, v121, v131
    v_fmac_f32 v135, v122, v131
    v_fmac_f32 v136, v123, v131
    v_fmac_f32 v137, v124, v131
    v_fmac_f32 v134, v122, v130
    v_fmac_f32 v135, v123, v130
    v_fmac_f32 v136, v124, v130
    v_fmac_f32 v137, v125, v130
    v_and_b32 v138, 0xffff0000, v45
    v_mul_f32 v134, v134, v138
    v_and_b32 v139, 0xffff0000, v49
    v_mul_f32 v135, v135, v139
    v_and_b32 v140, 0xffff0000, v53
    v_mul_f32 v136, v136, v140
    v_and_b32 v141, 0xffff0000, v57
    v_mul_f32 v137, v137, v141
    v_cvt_pk_bf16_f32 v166, v137, v136
    v_cvt_pk_bf16_f32 v167, v135, v134
    ds_write_b64 v208, v[166:167] offset:192
    s_setprio 0
    s_waitcnt vmcnt(16)
    s_branch loader2_92
pstep4_100:
    s_setprio 3
    v_lshlrev_b32 v112, 16, v18
    v_and_b32 v119, 0xffff0000, v18
    v_lshlrev_b32 v113, 16, v22
    v_and_b32 v120, 0xffff0000, v22
    v_lshlrev_b32 v114, 16, v26
    v_and_b32 v121, 0xffff0000, v26
    v_lshlrev_b32 v115, 16, v30
    v_and_b32 v122, 0xffff0000, v30
    v_lshlrev_b32 v116, 16, v34
    v_and_b32 v123, 0xffff0000, v34
    v_lshlrev_b32 v117, 16, v38
    v_and_b32 v124, 0xffff0000, v38
    v_lshlrev_b32 v118, 16, v42
    v_and_b32 v125, 0xffff0000, v42
    v_lshlrev_b32 v126, 16, v68
    v_and_b32 v127, 0xffff0000, v68
    v_lshlrev_b32 v128, 16, v69
    v_and_b32 v129, 0xffff0000, v69
    v_lshlrev_b32 v130, 16, v70
    v_and_b32 v131, 0xffff0000, v70
    v_lshlrev_b32 v132, 16, v71
    v_and_b32 v133, 0xffff0000, v71
    v_mul_f32 v134, v112, v129
    v_mul_f32 v135, v113, v129
    v_mul_f32 v136, v114, v129
    v_mul_f32 v137, v115, v129
    v_fmac_f32 v134, v113, v128
    v_fmac_f32 v135, v114, v128
    v_fmac_f32 v136, v115, v128
    v_fmac_f32 v137, v116, v128
    v_fmac_f32 v134, v114, v127
    v_fmac_f32 v135, v115, v127
    v_fmac_f32 v136, v116, v127
    v_fmac_f32 v137, v117, v127
    v_fmac_f32 v134, v115, v126
    v_fmac_f32 v135, v116, v126
    v_fmac_f32 v136, v117, v126
    v_fmac_f32 v137, v118, v126
    v_lshlrev_b32 v138, 16, v46
    v_mul_f32 v134, v134, v138
    v_lshlrev_b32 v139, 16, v50
    v_mul_f32 v135, v135, v139
    v_lshlrev_b32 v140, 16, v54
    v_mul_f32 v136, v136, v140
    v_lshlrev_b32 v141, 16, v58
    v_mul_f32 v137, v137, v141
    v_cvt_pk_bf16_f32 v160, v137, v136
    v_cvt_pk_bf16_f32 v161, v135, v134
    ds_write_b64 v208, v[160:161] offset:256
    v_mul_f32 v134, v119, v133
    v_mul_f32 v135, v120, v133
    v_mul_f32 v136, v121, v133
    v_mul_f32 v137, v122, v133
    v_fmac_f32 v134, v120, v132
    v_fmac_f32 v135, v121, v132
    v_fmac_f32 v136, v122, v132
    v_fmac_f32 v137, v123, v132
    v_fmac_f32 v134, v121, v131
    v_fmac_f32 v135, v122, v131
    v_fmac_f32 v136, v123, v131
    v_fmac_f32 v137, v124, v131
    v_fmac_f32 v134, v122, v130
    v_fmac_f32 v135, v123, v130
    v_fmac_f32 v136, v124, v130
    v_fmac_f32 v137, v125, v130
    v_and_b32 v138, 0xffff0000, v46
    v_mul_f32 v134, v134, v138
    v_and_b32 v139, 0xffff0000, v50
    v_mul_f32 v135, v135, v139
    v_and_b32 v140, 0xffff0000, v54
    v_mul_f32 v136, v136, v140
    v_and_b32 v141, 0xffff0000, v58
    v_mul_f32 v137, v137, v141
    v_cvt_pk_bf16_f32 v162, v137, v136
    v_cvt_pk_bf16_f32 v163, v135, v134
    ds_write_b64 v208, v[162:163] offset:320
    s_setprio 0
    s_waitcnt vmcnt(16)
    s_branch loader2_92
pstep5_101:
    s_setprio 3
    v_lshlrev_b32 v112, 16, v19
    v_and_b32 v119, 0xffff0000, v19
    v_lshlrev_b32 v113, 16, v23
    v_and_b32 v120, 0xffff0000, v23
    v_lshlrev_b32 v114, 16, v27
    v_and_b32 v121, 0xffff0000, v27
    v_lshlrev_b32 v115, 16, v31
    v_and_b32 v122, 0xffff0000, v31
    v_lshlrev_b32 v116, 16, v35
    v_and_b32 v123, 0xffff0000, v35
    v_lshlrev_b32 v117, 16, v39
    v_and_b32 v124, 0xffff0000, v39
    v_lshlrev_b32 v118, 16, v43
    v_and_b32 v125, 0xffff0000, v43
    v_lshlrev_b32 v126, 16, v72
    v_and_b32 v127, 0xffff0000, v72
    v_lshlrev_b32 v128, 16, v73
    v_and_b32 v129, 0xffff0000, v73
    v_lshlrev_b32 v130, 16, v74
    v_and_b32 v131, 0xffff0000, v74
    v_lshlrev_b32 v132, 16, v75
    v_and_b32 v133, 0xffff0000, v75
    v_mul_f32 v134, v112, v129
    v_mul_f32 v135, v113, v129
    v_mul_f32 v136, v114, v129
    v_mul_f32 v137, v115, v129
    v_fmac_f32 v134, v113, v128
    v_fmac_f32 v135, v114, v128
    v_fmac_f32 v136, v115, v128
    v_fmac_f32 v137, v116, v128
    v_fmac_f32 v134, v114, v127
    v_fmac_f32 v135, v115, v127
    v_fmac_f32 v136, v116, v127
    v_fmac_f32 v137, v117, v127
    v_fmac_f32 v134, v115, v126
    v_fmac_f32 v135, v116, v126
    v_fmac_f32 v136, v117, v126
    v_fmac_f32 v137, v118, v126
    v_lshlrev_b32 v138, 16, v47
    v_mul_f32 v134, v134, v138
    v_lshlrev_b32 v139, 16, v51
    v_mul_f32 v135, v135, v139
    v_lshlrev_b32 v140, 16, v55
    v_mul_f32 v136, v136, v140
    v_lshlrev_b32 v141, 16, v59
    v_mul_f32 v137, v137, v141
    v_cvt_pk_bf16_f32 v164, v137, v136
    v_cvt_pk_bf16_f32 v165, v135, v134
    ds_write_b64 v208, v[164:165] offset:384
    v_mul_f32 v134, v119, v133
    v_mul_f32 v135, v120, v133
    v_mul_f32 v136, v121, v133
    v_mul_f32 v137, v122, v133
    v_fmac_f32 v134, v120, v132
    v_fmac_f32 v135, v121, v132
    v_fmac_f32 v136, v122, v132
    v_fmac_f32 v137, v123, v132
    v_fmac_f32 v134, v121, v131
    v_fmac_f32 v135, v122, v131
    v_fmac_f32 v136, v123, v131
    v_fmac_f32 v137, v124, v131
    v_fmac_f32 v134, v122, v130
    v_fmac_f32 v135, v123, v130
    v_fmac_f32 v136, v124, v130
    v_fmac_f32 v137, v125, v130
    v_and_b32 v138, 0xffff0000, v47
    v_mul_f32 v134, v134, v138
    v_and_b32 v139, 0xffff0000, v51
    v_mul_f32 v135, v135, v139
    v_and_b32 v140, 0xffff0000, v55
    v_mul_f32 v136, v136, v140
    v_and_b32 v141, 0xffff0000, v59
    v_mul_f32 v137, v137, v141
    v_cvt_pk_bf16_f32 v166, v137, v136
    v_cvt_pk_bf16_f32 v167, v135, v134
    ds_write_b64 v208, v[166:167] offset:448
    s_add_u32 s96, s50, 0x4800000
    s_addc_u32 s97, s51, 0
    s_mov_b32 s98, 0x280000
    s_mov_b32 s99, 0x20000
    s_mul_i32 s88, s19, 6554
    s_lshr_b32 s88, s88, 16
    s_mul_i32 s89, s88, 10
    s_sub_u32 s89, s19, s89
    v_lshlrev_b32 v209, 4, v2
    v_lshrrev_b32 v210, 5, v2
    v_lshl_add_u32 v209, v210, 4, v209
    v_add_u32 v209, s22, v209
    v_lshrrev_b32 v210, 2, v2
    v_lshlrev_b32 v210, 12, v210
    v_and_b32 v211, 3, v2
    v_lshl_add_u32 v210, v211, 4, v210
    s_lshl_b32 s90, s89, 18
    s_lshl_b32 s91, s88, 6
    s_sub_u32 s90, s90, s91
    s_add_u32 s90, s90, 4032
    s_waitcnt lgkmcnt(0)
    ds_read_b128 v[16:19], v209 offset:0
    ds_read_b128 v[20:23], v209 offset:1056
    ds_read_b128 v[24:27], v209 offset:2112
    ds_read_b128 v[28:31], v209 offset:3168
    s_waitcnt lgkmcnt(3)
    buffer_store_dwordx4 v[16:19], v210, s[96:99], s90 offen sc1
    s_add_u32 s90, s90, 65536
    s_waitcnt lgkmcnt(2)
    buffer_store_dwordx4 v[20:23], v210, s[96:99], s90 offen sc1
    s_add_u32 s90, s90, 65536
    s_waitcnt lgkmcnt(1)
    buffer_store_dwordx4 v[24:27], v210, s[96:99], s90 offen sc1
    s_add_u32 s90, s90, 65536
    s_waitcnt lgkmcnt(0)
    buffer_store_dwordx4 v[28:31], v210, s[96:99], s90 offen sc1
    s_add_u32 s90, s90, 65536
    s_setprio 0
    s_waitcnt vmcnt(20)
    s_branch loader2_92
pstep6_102:
    s_waitcnt vmcnt(20)
    s_branch loader2_92
pstep7_103:
    s_waitcnt vmcnt(20)
    s_branch loader2_92
pstep8_104:
    s_setprio 3
    s_waitcnt vmcnt(24)
    s_mul_i32 s88, s19, 6554
    s_lshr_b32 s88, s88, 16
    s_mul_i32 s89, s88, 10
    s_sub_u32 s89, s19, s89
    s_lshl_b32 s28, s89, 8
    s_lshl_b32 s29, s88, 2
    s_add_u32 s28, s28, s29
    s_add_u32 s28, s28, 4096
    s_mov_b64 exec, 1
    buffer_store_dword v13, v12, s[92:95], s28 offen sc1
    s_mov_b64 exec, -1
    s_mov_b32 s13, 7
    s_setprio 0
    s_waitcnt vmcnt(17)
    s_branch loader2_92
plan_gate_95:
    s_cmp_eq_u32 s20, 1
    s_cbranch_scc1 pstep0_105
    s_cmp_eq_u32 s20, 2
    s_cbranch_scc1 pstep1_106
    s_cmp_eq_u32 s20, 3
    s_cbranch_scc1 pstep2_107
    s_branch loader_94
pstep0_105:
    s_setprio 3
    s_mov_b32 s96, s36
    s_mov_b32 s97, s37
    s_mov_b32 s98, 0x500
    s_mov_b32 s99, 0x20000
    v_lshrrev_b32 v208, 4, v2
    s_lshl_b32 s88, s16, 3
    v_add_u32 v208, s88, v208
    v_mul_u32_u24 v209, 1280, v208
    v_and_b32 v210, 15, v2
    v_lshlrev_b32 v210, 4, v210
    v_add_u32 v209, v209, v210
    s_movk_i32 s88, 5120
    buffer_load_dwordx4 v[16:19], v209, s[52:55], 0 offen offset:0
    buffer_load_dwordx4 v[36:39], v209, s[52:55], s88 offen offset:0
    buffer_load_dwordx4 v[56:59], v210, s[96:99], 0 offen offset:0
    buffer_load_dwordx4 v[20:23], v209, s[52:55], 0 offen offset:256
    buffer_load_dwordx4 v[40:43], v209, s[52:55], s88 offen offset:256
    buffer_load_dwordx4 v[60:63], v210, s[96:99], 0 offen offset:256
    buffer_load_dwordx4 v[24:27], v209, s[52:55], 0 offen offset:512
    buffer_load_dwordx4 v[44:47], v209, s[52:55], s88 offen offset:512
    buffer_load_dwordx4 v[64:67], v210, s[96:99], 0 offen offset:512
    buffer_load_dwordx4 v[28:31], v209, s[52:55], 0 offen offset:768
    buffer_load_dwordx4 v[48:51], v209, s[52:55], s88 offen offset:768
    buffer_load_dwordx4 v[68:71], v210, s[96:99], 0 offen offset:768
    buffer_load_dwordx4 v[32:35], v209, s[52:55], 0 offen offset:1024
    buffer_load_dwordx4 v[52:55], v209, s[52:55], s88 offen offset:1024
    buffer_load_dwordx4 v[72:75], v210, s[96:99], 0 offen offset:1024
    s_setprio 0
    s_waitcnt vmcnt(31)
    s_branch loader2_92
pstep1_106:
    s_waitcnt vmcnt(31)
    s_branch loader2_92
pstep2_107:
    s_setprio 3
    s_waitcnt vmcnt(16)
    s_add_u32 s96, s50, 0x5000000
    s_addc_u32 s97, s51, 0
    s_mov_b32 s98, 0x2000
    s_mov_b32 s99, 0x20000
    v_mov_b32 v210, 0
    v_mov_b32 v211, 0
    v_mov_b32 v212, 0
    v_mov_b32 v213, 0
    v_dot2c_f32_bf16 v210, v16, v56
    v_dot2c_f32_bf16 v212, v36, v56
    v_dot2c_f32_bf16 v211, v17, v57
    v_dot2c_f32_bf16 v213, v37, v57
    v_dot2c_f32_bf16 v210, v18, v58
    v_dot2c_f32_bf16 v212, v38, v58
    v_dot2c_f32_bf16 v211, v19, v59
    v_dot2c_f32_bf16 v213, v39, v59
    v_dot2c_f32_bf16 v210, v20, v60
    v_dot2c_f32_bf16 v212, v40, v60
    v_dot2c_f32_bf16 v211, v21, v61
    v_dot2c_f32_bf16 v213, v41, v61
    v_dot2c_f32_bf16 v210, v22, v62
    v_dot2c_f32_bf16 v212, v42, v62
    v_dot2c_f32_bf16 v211, v23, v63
    v_dot2c_f32_bf16 v213, v43, v63
    v_dot2c_f32_bf16 v210, v24, v64
    v_dot2c_f32_bf16 v212, v44, v64
    v_dot2c_f32_bf16 v211, v25, v65
    v_dot2c_f32_bf16 v213, v45, v65
    v_dot2c_f32_bf16 v210, v26, v66
    v_dot2c_f32_bf16 v212, v46, v66
    v_dot2c_f32_bf16 v211, v27, v67
    v_dot2c_f32_bf16 v213, v47, v67
    v_dot2c_f32_bf16 v210, v28, v68
    v_dot2c_f32_bf16 v212, v48, v68
    v_dot2c_f32_bf16 v211, v29, v69
    v_dot2c_f32_bf16 v213, v49, v69
    v_dot2c_f32_bf16 v210, v30, v70
    v_dot2c_f32_bf16 v212, v50, v70
    v_dot2c_f32_bf16 v211, v31, v71
    v_dot2c_f32_bf16 v213, v51, v71
    v_dot2c_f32_bf16 v210, v32, v72
    v_dot2c_f32_bf16 v212, v52, v72
    v_dot2c_f32_bf16 v211, v33, v73
    v_dot2c_f32_bf16 v213, v53, v73
    v_dot2c_f32_bf16 v210, v34, v74
    v_dot2c_f32_bf16 v212, v54, v74
    v_dot2c_f32_bf16 v211, v35, v75
    v_dot2c_f32_bf16 v213, v55, v75
    s_nop 3
    v_add_f32 v210, v210, v211
    v_add_f32 v211, v212, v213
    ds_swizzle_b32 v214, v210 offset:0x41f
    ds_swizzle_b32 v215, v211 offset:0x41f
    s_waitcnt lgkmcnt(0)
    v_add_f32 v210, v210, v214
    v_add_f32 v211, v211, v215
    ds_swizzle_b32 v214, v210 offset:0x81f
    ds_swizzle_b32 v215, v211 offset:0x81f
    s_waitcnt lgkmcnt(0)
    v_add_f32 v210, v210, v214
    v_add_f32 v211, v211, v215
    ds_swizzle_b32 v214, v210 offset:0x101f
    ds_swizzle_b32 v215, v211 offset:0x101f
    s_waitcnt lgkmcnt(0)
    v_add_f32 v210, v210, v214
    v_add_f32 v211, v211, v215
    ds_swizzle_b32 v214, v210 offset:0x201f
    ds_swizzle_b32 v215, v211 offset:0x201f
    s_waitcnt lgkmcnt(0)
    v_add_f32 v210, v210, v214
    v_add_f32 v211, v211, v215
    v_cvt_pk_bf16_f32 v214, v210, v211
    v_lshlrev_b32 v210, 16, v214
    v_and_b32 v211, 0xffff0000, v214
    v_mul_f32 v210, 0xbfb8aa3b, v210
    v_exp_f32 v210, v210
    s_nop 0
    v_add_f32 v210, 1.0, v210
    v_rcp_f32 v210, v210
    v_mul_f32 v211, 0xbfb8aa3b, v211
    v_exp_f32 v211, v211
    s_nop 0
    v_add_f32 v211, 1.0, v211
    v_rcp_f32 v211, v211
    s_nop 0
    v_cvt_pk_bf16_f32 v214, v210, v211
    v_lshlrev_b32 v210, 16, v214
    v_and_b32 v211, 0xffff0000, v214
    v_lshlrev_b32 v208, 2, v208
    buffer_store_dword v210, v208, s[96:99], 0 offen sc1
    buffer_store_dword v211, v208, s[96:99], 0 offen offset:16 sc1
    s_setprio 0
    s_waitcnt vmcnt(33)
    s_branch loader2_92
loader3_91:
    s_waitcnt vmcnt(0)
    s_barrier
    s_cmp_eq_u32 s13, 7
    s_cbranch_scc1 nogflag_108
    s_sub_u32 s28, s13, 1
    s_cmp_gt_u32 s28, 4
    s_cbranch_scc1 gflag_109
    s_mul_i32 s88, s19, 6554
    s_lshr_b32 s88, s88, 16
    s_mul_i32 s89, s88, 10
    s_sub_u32 s89, s19, s89
    s_lshl_b32 s28, s89, 8
    s_lshl_b32 s29, s88, 2
    s_add_u32 s28, s28, s29
    s_add_u32 s28, s28, 4096
    s_mov_b64 exec, 1
    buffer_store_dword v13, v12, s[92:95], s28 offen sc1
    s_mov_b64 exec, -1
    s_branch nogflag_108
gflag_109:
    s_lshl_b32 s28, s16, 2
    s_add_u32 s28, s28, 28672
    s_mov_b64 exec, 1
    buffer_store_dword v13, v12, s[92:95], s28 offen sc1
    s_mov_b64 exec, -1
nogflag_108:
fin_90:
    s_load_dwordx2 s[4:5], s[0:1], 0
    s_load_dwordx2 s[6:7], s[0:1], 120
    s_load_dwordx2 s[8:9], s[0:1], 104
    s_load_dwordx2 s[10:11], s[0:1], 40
    s_load_dwordx4 s[48:51], s[0:1], 80
    s_getpc_b64 s[28:29]
p4_pc_110:
    s_add_u32 s28, s28, p4_table-p4_pc_110
    s_addc_u32 s29, s29, 0
    s_lshl_b32 s30, s2, 2
    s_load_dword s13, s[28:29], s30
    v_mov_b32 v14, 163776
    ds_read_b32 v13, v14
    v_lshlrev_b32 v3, 4, v2
    s_lshl_b32 s41, s40, 7
    s_lshl_b32 s31, s12, 2
    s_add_u32 s41, s41, s31
    s_add_u32 s41, s41, 16384
    s_and_b32 s58, s38, 2
    s_lshl_b32 s58, s58, 15
    s_xor_b32 s57, s58, 65536
    v_mov_b32 v12, 0
    s_waitcnt lgkmcnt(0)
    s_add_u32 s36, s6, 0x4c00000
    s_addc_u32 s37, s7, 0
    s_mov_b32 s38, 0x280000
    s_mov_b32 s39, 0x20000
    s_cmp_ge_u32 s3, 4
    s_cbranch_scc1 p4_conv_111
    v_mov_b32 v1, 1
    s_mov_b64 exec, 1
    ds_add_u32 v14, v1 offset:8
    s_mov_b64 exec, -1
    s_setprio 2
    s_and_b32 s14, s13, 255
    s_lshr_b32 s15, s13, 16
    s_bfe_u32 s28, s13, 0x80008
    s_add_u32 s28, s28, s14
    s_sub_u32 s28, s28, 1
    s_lshr_b32 s28, s28, 1
    s_lshr_b32 s29, s14, 1
    v_lshrrev_b32 v15, 3, v2
    v_add_u32 v15, s29, v15
    v_min_u32 v15, s28, v15
    v_lshlrev_b32 v15, 7, v15
    v_and_b32 v1, 7, v2
    v_lshl_add_u32 v15, v1, 2, v15
    s_lshl_b32 s42, s3, 5
    s_add_u32 s42, s42, 16384
    buffer_load_dword v10, v15, s[92:95], s42 offen sc1
    s_add_u32 s16, s6, 0x2800000
    s_addc_u32 s17, s7, 0
    s_mov_b32 s18, 0x1000000
    s_mov_b32 s19, 0x20000
    s_mov_b32 s20, s10
    s_mov_b32 s21, s11
    s_mov_b32 s22, 0x500000
    s_mov_b32 s23, 0x20000
    s_mov_b32 s24, s4
    s_mov_b32 s25, s5
    s_mov_b32 s26, 0x280000
    s_mov_b32 s27, 0x20000
    s_mov_b32 s60, s8
    s_mov_b32 s61, s9
    s_mov_b32 s62, 0x280000
    s_mov_b32 s63, 0x20000
    s_add_u32 s44, s6, 0x5000000
    s_addc_u32 s45, s7, 0
    s_mov_b32 s46, 0x2000
    s_mov_b32 s47, 0x20000
    s_lshl_b32 s28, s3, 15
    s_lshl_b32 s29, s14, 17
    s_add_u32 s29, s29, s28
    v_add_u32 v4, s29, v3
    v_lshrrev_b32 v5, 3, v2
    s_lshl_b32 s28, s3, 10
    v_add_u32 v5, s28, v5
    v_mul_u32_u24 v5, 1280, v5
    v_lshrrev_b32 v1, 4, v2
    v_lshlrev_b32 v1, 1, v1
    v_and_b32 v11, 7, v2
    v_xor_b32 v1, v1, v11
    v_lshl_add_u32 v5, v1, 4, v5
    s_lshl_b32 s28, s15, 7
    v_add_u32 v5, s28, v5
    s_lshl_b32 s59, s3, 14
    s_add_u32 s59, s59, s58
    v_lshrrev_b32 v1, 2, v2
    v_lshlrev_b32 v11, 7, v1
    v_and_b32 v6, 3, v2
    v_lshl_add_u32 v11, v6, 3, v11
    v_add_u32 v11, s59, v11
    v_bfe_u32 v1, v2, 3, 2
    v_xor_b32 v6, 0, v1
    v_lshl_add_u32 v6, v6, 5, v11
    v_xor_b32 v7, 1, v1
    v_lshl_add_u32 v7, v7, 5, v11
    v_xor_b32 v8, 2, v1
    v_lshl_add_u32 v8, v8, 5, v11
    v_xor_b32 v9, 3, v1
    v_lshl_add_u32 v9, v9, 5, v11
    v_and_b32 v240, 15, v2
    s_lshl_b32 s28, s14, 4
    v_add_u32 v240, s28, v240
    v_lshrrev_b32 v241, 4, v2
    v_lshlrev_b32 v241, 2, v241
    s_lshl_b32 s28, s15, 6
    s_lshl_b32 s29, s3, 4
    s_add_u32 s28, s28, s29
    v_add_u32 v241, s28, v241
    v_mul_u32_u24 v242, 1280, v240
    v_lshl_add_u32 v242, v241, 1, v242
    v_lshlrev_b32 v243, 12, v241
    v_lshl_add_u32 v243, v240, 1, v243
    v_lshlrev_b32 v240, 2, v240
    s_lshl_b32 s28, s28, 2
    s_add_u32 s28, s28, 10240
    v_lshlrev_b32 v244, 2, v2
    v_add_u32 v244, s28, v244
    s_bfe_u32 s28, s13, 0x80008
    s_add_u32 s28, s28, s14
    s_lshl_b32 s28, s28, 1
    s_sub_u32 s28, s28, 1
    s_lshl_b32 s29, s14, 1
    s_sub_u32 s29, s29, 16
    v_add_u32 v1, s29, v2
    v_min_u32 v1, s28, v1
    v_lshlrev_b32 v1, 2, v1
    v_add_u32 v1, 28672, v1
    v_cmp_gt_u32 vcc, 16, v2
    s_nop 1
    v_cndmask_b32 v244, v1, v244, vcc
    s_mov_b32 s33, 0
    s_mov_b32 s30, 0
    s_mov_b32 s31, 0
p4_gw_112:
    ds_read_b32 v11, v14 offset:8
    s_waitcnt lgkmcnt(0)
    v_readfirstlane_b32 s28, v11
    s_nop 0
    s_cmp_ge_u32 s28, 4
    s_cbranch_scc1 p4_gok_113
    s_sleep 2
    s_add_u32 s31, s31, 1
    s_cmp_lt_u32 s31, 524288
    s_cbranch_scc1 p4_gw_112
p4_gok_113:
    s_add_u32 m0, s59, 0
    s_add_u32 s35, s33, 0
    buffer_load_dwordx4 v5, s[20:23], s35 offen offset:0 lds
    s_add_u32 s35, s33, 9216
    buffer_load_dwordx4 v5, s[20:23], s35 offen offset:1024 lds
    s_add_u32 s35, s33, 18432
    buffer_load_dwordx4 v5, s[20:23], s35 offen offset:2048 lds
    s_add_u32 s35, s33, 27648
    buffer_load_dwordx4 v5, s[20:23], s35 offen offset:3072 lds
    s_add_u32 m0, s59, 4096
    s_add_u32 s35, s33, 40960
    buffer_load_dwordx4 v5, s[20:23], s35 offen offset:0 lds
    s_add_u32 s35, s33, 50176
    buffer_load_dwordx4 v5, s[20:23], s35 offen offset:1024 lds
    s_add_u32 s35, s33, 59392
    buffer_load_dwordx4 v5, s[20:23], s35 offen offset:2048 lds
    s_add_u32 s35, s33, 68608
    buffer_load_dwordx4 v5, s[20:23], s35 offen offset:3072 lds
    s_add_u32 m0, s59, 8192
    s_add_u32 s35, s33, 81920
    buffer_load_dwordx4 v5, s[20:23], s35 offen offset:0 lds
    s_add_u32 s35, s33, 91136
    buffer_load_dwordx4 v5, s[20:23], s35 offen offset:1024 lds
    s_add_u32 s35, s33, 100352
    buffer_load_dwordx4 v5, s[20:23], s35 offen offset:2048 lds
    s_add_u32 s35, s33, 109568
    buffer_load_dwordx4 v5, s[20:23], s35 offen offset:3072 lds
    s_add_u32 m0, s59, 12288
    s_add_u32 s35, s33, 122880
    buffer_load_dwordx4 v5, s[20:23], s35 offen offset:0 lds
    s_add_u32 s35, s33, 132096
    buffer_load_dwordx4 v5, s[20:23], s35 offen offset:1024 lds
    s_add_u32 s35, s33, 141312
    buffer_load_dwordx4 v5, s[20:23], s35 offen offset:2048 lds
    s_add_u32 s35, s33, 150528
    buffer_load_dwordx4 v5, s[20:23], s35 offen offset:3072 lds
    s_waitcnt vmcnt(16)
    s_mov_b64 exec, 1
    buffer_store_dword v13, v12, s[92:95], s41 offen sc1
    s_mov_b64 exec, -1
    v_mov_b32 v1, 1
    s_mov_b64 exec, 1
    ds_add_u32 v14, v1 offset:4
    s_mov_b64 exec, -1
    s_mov_b32 s31, 0
p4_cpoll_114:
    v_cmp_ne_u32 vcc, v10, v13
    s_cbranch_vccz p4_cok_115
    s_sleep 12
    buffer_load_dword v10, v15, s[92:95], s42 offen sc1
    s_waitcnt vmcnt(0)
    s_add_u32 s31, s31, 1
    s_cmp_lt_u32 s31, 524288
    s_cbranch_scc1 p4_cpoll_114
p4_cok_115:
    s_mov_b32 s31, 0
p4_gw_116:
    ds_read_b32 v11, v14 offset:4
    s_waitcnt lgkmcnt(0)
    v_readfirstlane_b32 s28, v11
    s_nop 0
    s_cmp_ge_u32 s28, 4
    s_cbranch_scc1 p4_gok_117
    s_sleep 2
    s_add_u32 s31, s31, 1
    s_cmp_lt_u32 s31, 524288
    s_cbranch_scc1 p4_gw_116
p4_gok_117:
    s_bitcmp1_b32 s13, 9
    s_cbranch_scc1 p4_nq6_119
    s_mov_b32 s96, 0
    s_mov_b32 s97, 131072
    s_mov_b32 s98, 262144
    s_mov_b32 s99, 393216
    s_mov_b32 s54, 524288
    buffer_load_dwordx4 v[96:99], v4, s[16:19], s96 offen offset:0 sc1
    buffer_load_dwordx4 v[100:103], v4, s[16:19], s97 offen offset:0 sc1
    buffer_load_dwordx4 v[104:107], v4, s[16:19], s98 offen offset:0 sc1
    buffer_load_dwordx4 v[108:111], v4, s[16:19], s99 offen offset:0 sc1
    buffer_load_dwordx4 v[112:115], v4, s[16:19], s54 offen offset:0 sc1
    buffer_load_dwordx4 v[116:119], v4, s[16:19], s96 offen offset:1024 sc1
    buffer_load_dwordx4 v[120:123], v4, s[16:19], s97 offen offset:1024 sc1
    buffer_load_dwordx4 v[124:127], v4, s[16:19], s98 offen offset:1024 sc1
    buffer_load_dwordx4 v[128:131], v4, s[16:19], s99 offen offset:1024 sc1
    buffer_load_dwordx4 v[132:135], v4, s[16:19], s54 offen offset:1024 sc1
    buffer_load_dwordx4 v[136:139], v4, s[16:19], s96 offen offset:2048 sc1
    buffer_load_dwordx4 v[140:143], v4, s[16:19], s97 offen offset:2048 sc1
    buffer_load_dwordx4 v[144:147], v4, s[16:19], s98 offen offset:2048 sc1
    buffer_load_dwordx4 v[148:151], v4, s[16:19], s99 offen offset:2048 sc1
    buffer_load_dwordx4 v[152:155], v4, s[16:19], s54 offen offset:2048 sc1
    buffer_load_dwordx4 v[156:159], v4, s[16:19], s96 offen offset:3072 sc1
    buffer_load_dwordx4 v[160:163], v4, s[16:19], s97 offen offset:3072 sc1
    buffer_load_dwordx4 v[164:167], v4, s[16:19], s98 offen offset:3072 sc1
    buffer_load_dwordx4 v[168:171], v4, s[16:19], s99 offen offset:3072 sc1
    buffer_load_dwordx4 v[172:175], v4, s[16:19], s54 offen offset:3072 sc1
    s_waitcnt vmcnt(20)
    ds_read_b64_tr_b16 v[176:177], v6 offset:0
    ds_read_b64_tr_b16 v[178:179], v6 offset:2048
    ds_read_b64_tr_b16 v[180:181], v7 offset:0
    ds_read_b64_tr_b16 v[182:183], v7 offset:2048
    ds_read_b64_tr_b16 v[184:185], v8 offset:0
    ds_read_b64_tr_b16 v[186:187], v8 offset:2048
    ds_read_b64_tr_b16 v[188:189], v9 offset:0
    ds_read_b64_tr_b16 v[190:191], v9 offset:2048
    s_mov_b32 s31, 0
    v_add_u32 v4, 4096, v4
    s_add_u32 s33, s33, 163840
    s_waitcnt vmcnt(15)
    s_waitcnt lgkmcnt(0)
    v_mfma_f32_16x16x32_bf16 v[16:19], v[176:179], v[96:99], 0
    ds_read_b64_tr_b16 v[192:193], v6 offset:4096
    ds_read_b64_tr_b16 v[194:195], v6 offset:6144
    v_mfma_f32_16x16x32_bf16 v[20:23], v[176:179], v[100:103], 0
    v_mfma_f32_16x16x32_bf16 v[24:27], v[176:179], v[104:107], 0
    s_add_u32 m0, s59, 0
    s_add_u32 s35, s33, 0
    buffer_load_dwordx4 v5, s[20:23], s35 offen offset:0 lds
    v_mfma_f32_16x16x32_bf16 v[28:31], v[176:179], v[108:111], 0
    v_mfma_f32_16x16x32_bf16 v[32:35], v[176:179], v[112:115], 0
    s_add_u32 s35, s33, 9216
    buffer_load_dwordx4 v5, s[20:23], s35 offen offset:1024 lds
    v_mfma_f32_16x16x32_bf16 v[36:39], v[180:183], v[96:99], 0
    ds_read_b64_tr_b16 v[196:197], v7 offset:4096
    ds_read_b64_tr_b16 v[198:199], v7 offset:6144
    v_mfma_f32_16x16x32_bf16 v[40:43], v[180:183], v[100:103], 0
    v_mfma_f32_16x16x32_bf16 v[44:47], v[180:183], v[104:107], 0
    s_add_u32 s35, s33, 18432
    buffer_load_dwordx4 v5, s[20:23], s35 offen offset:2048 lds
    v_mfma_f32_16x16x32_bf16 v[48:51], v[180:183], v[108:111], 0
    v_mfma_f32_16x16x32_bf16 v[52:55], v[180:183], v[112:115], 0
    s_add_u32 s35, s33, 27648
    buffer_load_dwordx4 v5, s[20:23], s35 offen offset:3072 lds
    v_mfma_f32_16x16x32_bf16 v[56:59], v[184:187], v[96:99], 0
    ds_read_b64_tr_b16 v[200:201], v8 offset:4096
    ds_read_b64_tr_b16 v[202:203], v8 offset:6144
    v_mfma_f32_16x16x32_bf16 v[60:63], v[184:187], v[100:103], 0
    v_mfma_f32_16x16x32_bf16 v[64:67], v[184:187], v[104:107], 0
    v_mfma_f32_16x16x32_bf16 v[68:71], v[184:187], v[108:111], 0
    v_mfma_f32_16x16x32_bf16 v[72:75], v[184:187], v[112:115], 0
    v_mfma_f32_16x16x32_bf16 v[76:79], v[188:191], v[96:99], 0
    ds_read_b64_tr_b16 v[204:205], v9 offset:4096
    ds_read_b64_tr_b16 v[206:207], v9 offset:6144
    buffer_load_dwordx4 v[96:99], v4, s[16:19], s96 offen offset:0 sc1
    v_mfma_f32_16x16x32_bf16 v[80:83], v[188:191], v[100:103], 0
    buffer_load_dwordx4 v[100:103], v4, s[16:19], s97 offen offset:0 sc1
    v_mfma_f32_16x16x32_bf16 v[84:87], v[188:191], v[104:107], 0
    buffer_load_dwordx4 v[104:107], v4, s[16:19], s98 offen offset:0 sc1
    v_mfma_f32_16x16x32_bf16 v[88:91], v[188:191], v[108:111], 0
    buffer_load_dwordx4 v[108:111], v4, s[16:19], s99 offen offset:0 sc1
    v_mfma_f32_16x16x32_bf16 v[92:95], v[188:191], v[112:115], 0
    buffer_load_dwordx4 v[112:115], v4, s[16:19], s54 offen offset:0 sc1
    s_waitcnt vmcnt(19)
    s_waitcnt lgkmcnt(0)
    v_mfma_f32_16x16x32_bf16 v[16:19], v[192:195], v[116:119], v[16:19]
    ds_read_b64_tr_b16 v[176:177], v6 offset:8192
    ds_read_b64_tr_b16 v[178:179], v6 offset:10240
    v_mfma_f32_16x16x32_bf16 v[20:23], v[192:195], v[120:123], v[20:23]
    v_mfma_f32_16x16x32_bf16 v[24:27], v[192:195], v[124:127], v[24:27]
    s_add_u32 m0, s59, 4096
    s_add_u32 s35, s33, 40960
    buffer_load_dwordx4 v5, s[20:23], s35 offen offset:0 lds
    v_mfma_f32_16x16x32_bf16 v[28:31], v[192:195], v[128:131], v[28:31]
    v_mfma_f32_16x16x32_bf16 v[32:35], v[192:195], v[132:135], v[32:35]
    s_add_u32 s35, s33, 50176
    buffer_load_dwordx4 v5, s[20:23], s35 offen offset:1024 lds
    v_mfma_f32_16x16x32_bf16 v[36:39], v[196:199], v[116:119], v[36:39]
    ds_read_b64_tr_b16 v[180:181], v7 offset:8192
    ds_read_b64_tr_b16 v[182:183], v7 offset:10240
    v_mfma_f32_16x16x32_bf16 v[40:43], v[196:199], v[120:123], v[40:43]
    v_mfma_f32_16x16x32_bf16 v[44:47], v[196:199], v[124:127], v[44:47]
    s_add_u32 s35, s33, 59392
    buffer_load_dwordx4 v5, s[20:23], s35 offen offset:2048 lds
    v_mfma_f32_16x16x32_bf16 v[48:51], v[196:199], v[128:131], v[48:51]
    v_mfma_f32_16x16x32_bf16 v[52:55], v[196:199], v[132:135], v[52:55]
    s_add_u32 s35, s33, 68608
    buffer_load_dwordx4 v5, s[20:23], s35 offen offset:3072 lds
    v_mfma_f32_16x16x32_bf16 v[56:59], v[200:203], v[116:119], v[56:59]
    ds_read_b64_tr_b16 v[184:185], v8 offset:8192
    ds_read_b64_tr_b16 v[186:187], v8 offset:10240
    v_mfma_f32_16x16x32_bf16 v[60:63], v[200:203], v[120:123], v[60:63]
    v_mfma_f32_16x16x32_bf16 v[64:67], v[200:203], v[124:127], v[64:67]
    v_mfma_f32_16x16x32_bf16 v[68:71], v[200:203], v[128:131], v[68:71]
    v_mfma_f32_16x16x32_bf16 v[72:75], v[200:203], v[132:135], v[72:75]
    v_mfma_f32_16x16x32_bf16 v[76:79], v[204:207], v[116:119], v[76:79]
    ds_read_b64_tr_b16 v[188:189], v9 offset:8192
    ds_read_b64_tr_b16 v[190:191], v9 offset:10240
    buffer_load_dwordx4 v[116:119], v4, s[16:19], s96 offen offset:1024 sc1
    v_mfma_f32_16x16x32_bf16 v[80:83], v[204:207], v[120:123], v[80:83]
    buffer_load_dwordx4 v[120:123], v4, s[16:19], s97 offen offset:1024 sc1
    v_mfma_f32_16x16x32_bf16 v[84:87], v[204:207], v[124:127], v[84:87]
    buffer_load_dwordx4 v[124:127], v4, s[16:19], s98 offen offset:1024 sc1
    v_mfma_f32_16x16x32_bf16 v[88:91], v[204:207], v[128:131], v[88:91]
    buffer_load_dwordx4 v[128:131], v4, s[16:19], s99 offen offset:1024 sc1
    v_mfma_f32_16x16x32_bf16 v[92:95], v[204:207], v[132:135], v[92:95]
    buffer_load_dwordx4 v[132:135], v4, s[16:19], s54 offen offset:1024 sc1
    s_waitcnt vmcnt(23)
    s_waitcnt lgkmcnt(0)
    v_mfma_f32_16x16x32_bf16 v[16:19], v[176:179], v[136:139], v[16:19]
    ds_read_b64_tr_b16 v[192:193], v6 offset:12288
    ds_read_b64_tr_b16 v[194:195], v6 offset:14336
    v_mfma_f32_16x16x32_bf16 v[20:23], v[176:179], v[140:143], v[20:23]
    v_mfma_f32_16x16x32_bf16 v[24:27], v[176:179], v[144:147], v[24:27]
    s_add_u32 m0, s59, 8192
    s_add_u32 s35, s33, 81920
    buffer_load_dwordx4 v5, s[20:23], s35 offen offset:0 lds
    v_mfma_f32_16x16x32_bf16 v[28:31], v[176:179], v[148:151], v[28:31]
    v_mfma_f32_16x16x32_bf16 v[32:35], v[176:179], v[152:155], v[32:35]
    s_add_u32 s35, s33, 91136
    buffer_load_dwordx4 v5, s[20:23], s35 offen offset:1024 lds
    v_mfma_f32_16x16x32_bf16 v[36:39], v[180:183], v[136:139], v[36:39]
    ds_read_b64_tr_b16 v[196:197], v7 offset:12288
    ds_read_b64_tr_b16 v[198:199], v7 offset:14336
    v_mfma_f32_16x16x32_bf16 v[40:43], v[180:183], v[140:143], v[40:43]
    v_mfma_f32_16x16x32_bf16 v[44:47], v[180:183], v[144:147], v[44:47]
    s_add_u32 s35, s33, 100352
    buffer_load_dwordx4 v5, s[20:23], s35 offen offset:2048 lds
    v_mfma_f32_16x16x32_bf16 v[48:51], v[180:183], v[148:151], v[48:51]
    v_mfma_f32_16x16x32_bf16 v[52:55], v[180:183], v[152:155], v[52:55]
    s_add_u32 s35, s33, 109568
    buffer_load_dwordx4 v5, s[20:23], s35 offen offset:3072 lds
    v_mfma_f32_16x16x32_bf16 v[56:59], v[184:187], v[136:139], v[56:59]
    ds_read_b64_tr_b16 v[200:201], v8 offset:12288
    ds_read_b64_tr_b16 v[202:203], v8 offset:14336
    v_mfma_f32_16x16x32_bf16 v[60:63], v[184:187], v[140:143], v[60:63]
    v_mfma_f32_16x16x32_bf16 v[64:67], v[184:187], v[144:147], v[64:67]
    v_mfma_f32_16x16x32_bf16 v[68:71], v[184:187], v[148:151], v[68:71]
    v_mfma_f32_16x16x32_bf16 v[72:75], v[184:187], v[152:155], v[72:75]
    v_mfma_f32_16x16x32_bf16 v[76:79], v[188:191], v[136:139], v[76:79]
    ds_read_b64_tr_b16 v[204:205], v9 offset:12288
    ds_read_b64_tr_b16 v[206:207], v9 offset:14336
    buffer_load_dwordx4 v[136:139], v4, s[16:19], s96 offen offset:2048 sc1
    v_mfma_f32_16x16x32_bf16 v[80:83], v[188:191], v[140:143], v[80:83]
    buffer_load_dwordx4 v[140:143], v4, s[16:19], s97 offen offset:2048 sc1
    v_mfma_f32_16x16x32_bf16 v[84:87], v[188:191], v[144:147], v[84:87]
    buffer_load_dwordx4 v[144:147], v4, s[16:19], s98 offen offset:2048 sc1
    v_mfma_f32_16x16x32_bf16 v[88:91], v[188:191], v[148:151], v[88:91]
    buffer_load_dwordx4 v[148:151], v4, s[16:19], s99 offen offset:2048 sc1
    v_mfma_f32_16x16x32_bf16 v[92:95], v[188:191], v[152:155], v[92:95]
    buffer_load_dwordx4 v[152:155], v4, s[16:19], s54 offen offset:2048 sc1
    s_waitcnt vmcnt(23)
    s_waitcnt lgkmcnt(0)
    v_mfma_f32_16x16x32_bf16 v[16:19], v[192:195], v[156:159], v[16:19]
    ds_read_b64_tr_b16 v[176:177], v6 offset:0
    ds_read_b64_tr_b16 v[178:179], v6 offset:2048
    v_mfma_f32_16x16x32_bf16 v[20:23], v[192:195], v[160:163], v[20:23]
    v_mfma_f32_16x16x32_bf16 v[24:27], v[192:195], v[164:167], v[24:27]
    s_add_u32 m0, s59, 12288
    s_add_u32 s35, s33, 122880
    buffer_load_dwordx4 v5, s[20:23], s35 offen offset:0 lds
    v_mfma_f32_16x16x32_bf16 v[28:31], v[192:195], v[168:171], v[28:31]
    v_mfma_f32_16x16x32_bf16 v[32:35], v[192:195], v[172:175], v[32:35]
    s_add_u32 s35, s33, 132096
    buffer_load_dwordx4 v5, s[20:23], s35 offen offset:1024 lds
    v_mfma_f32_16x16x32_bf16 v[36:39], v[196:199], v[156:159], v[36:39]
    ds_read_b64_tr_b16 v[180:181], v7 offset:0
    ds_read_b64_tr_b16 v[182:183], v7 offset:2048
    v_mfma_f32_16x16x32_bf16 v[40:43], v[196:199], v[160:163], v[40:43]
    v_mfma_f32_16x16x32_bf16 v[44:47], v[196:199], v[164:167], v[44:47]
    s_add_u32 s35, s33, 141312
    buffer_load_dwordx4 v5, s[20:23], s35 offen offset:2048 lds
    v_mfma_f32_16x16x32_bf16 v[48:51], v[196:199], v[168:171], v[48:51]
    v_mfma_f32_16x16x32_bf16 v[52:55], v[196:199], v[172:175], v[52:55]
    s_add_u32 s35, s33, 150528
    buffer_load_dwordx4 v5, s[20:23], s35 offen offset:3072 lds
    v_mfma_f32_16x16x32_bf16 v[56:59], v[200:203], v[156:159], v[56:59]
    ds_read_b64_tr_b16 v[184:185], v8 offset:0
    ds_read_b64_tr_b16 v[186:187], v8 offset:2048
    v_mfma_f32_16x16x32_bf16 v[60:63], v[200:203], v[160:163], v[60:63]
    v_mfma_f32_16x16x32_bf16 v[64:67], v[200:203], v[164:167], v[64:67]
    v_mfma_f32_16x16x32_bf16 v[68:71], v[200:203], v[168:171], v[68:71]
    v_mfma_f32_16x16x32_bf16 v[72:75], v[200:203], v[172:175], v[72:75]
    v_mfma_f32_16x16x32_bf16 v[76:79], v[204:207], v[156:159], v[76:79]
    ds_read_b64_tr_b16 v[188:189], v9 offset:0
    ds_read_b64_tr_b16 v[190:191], v9 offset:2048
    buffer_load_dwordx4 v[156:159], v4, s[16:19], s96 offen offset:3072 sc1
    v_mfma_f32_16x16x32_bf16 v[80:83], v[204:207], v[160:163], v[80:83]
    buffer_load_dwordx4 v[160:163], v4, s[16:19], s97 offen offset:3072 sc1
    v_mfma_f32_16x16x32_bf16 v[84:87], v[204:207], v[164:167], v[84:87]
    buffer_load_dwordx4 v[164:167], v4, s[16:19], s98 offen offset:3072 sc1
    v_mfma_f32_16x16x32_bf16 v[88:91], v[204:207], v[168:171], v[88:91]
    buffer_load_dwordx4 v[168:171], v4, s[16:19], s99 offen offset:3072 sc1
    v_mfma_f32_16x16x32_bf16 v[92:95], v[204:207], v[172:175], v[92:95]
    buffer_load_dwordx4 v[172:175], v4, s[16:19], s54 offen offset:3072 sc1
p4_loop_122:
    v_add_u32 v4, 4096, v4
    s_add_u32 s33, s33, 163840
    s_waitcnt vmcnt(23)
    s_waitcnt lgkmcnt(0)
    v_mfma_f32_16x16x32_bf16 v[16:19], v[176:179], v[96:99], v[16:19]
    ds_read_b64_tr_b16 v[192:193], v6 offset:4096
    ds_read_b64_tr_b16 v[194:195], v6 offset:6144
    v_mfma_f32_16x16x32_bf16 v[20:23], v[176:179], v[100:103], v[20:23]
    v_mfma_f32_16x16x32_bf16 v[24:27], v[176:179], v[104:107], v[24:27]
    s_add_u32 m0, s59, 0
    s_add_u32 s35, s33, 0
    buffer_load_dwordx4 v5, s[20:23], s35 offen offset:0 lds
    v_mfma_f32_16x16x32_bf16 v[28:31], v[176:179], v[108:111], v[28:31]
    v_mfma_f32_16x16x32_bf16 v[32:35], v[176:179], v[112:115], v[32:35]
    s_add_u32 s35, s33, 9216
    buffer_load_dwordx4 v5, s[20:23], s35 offen offset:1024 lds
    v_mfma_f32_16x16x32_bf16 v[36:39], v[180:183], v[96:99], v[36:39]
    ds_read_b64_tr_b16 v[196:197], v7 offset:4096
    ds_read_b64_tr_b16 v[198:199], v7 offset:6144
    v_mfma_f32_16x16x32_bf16 v[40:43], v[180:183], v[100:103], v[40:43]
    v_mfma_f32_16x16x32_bf16 v[44:47], v[180:183], v[104:107], v[44:47]
    s_add_u32 s35, s33, 18432
    buffer_load_dwordx4 v5, s[20:23], s35 offen offset:2048 lds
    v_mfma_f32_16x16x32_bf16 v[48:51], v[180:183], v[108:111], v[48:51]
    v_mfma_f32_16x16x32_bf16 v[52:55], v[180:183], v[112:115], v[52:55]
    s_add_u32 s35, s33, 27648
    buffer_load_dwordx4 v5, s[20:23], s35 offen offset:3072 lds
    v_mfma_f32_16x16x32_bf16 v[56:59], v[184:187], v[96:99], v[56:59]
    ds_read_b64_tr_b16 v[200:201], v8 offset:4096
    ds_read_b64_tr_b16 v[202:203], v8 offset:6144
    v_mfma_f32_16x16x32_bf16 v[60:63], v[184:187], v[100:103], v[60:63]
    v_mfma_f32_16x16x32_bf16 v[64:67], v[184:187], v[104:107], v[64:67]
    v_mfma_f32_16x16x32_bf16 v[68:71], v[184:187], v[108:111], v[68:71]
    v_mfma_f32_16x16x32_bf16 v[72:75], v[184:187], v[112:115], v[72:75]
    v_mfma_f32_16x16x32_bf16 v[76:79], v[188:191], v[96:99], v[76:79]
    ds_read_b64_tr_b16 v[204:205], v9 offset:4096
    ds_read_b64_tr_b16 v[206:207], v9 offset:6144
    buffer_load_dwordx4 v[96:99], v4, s[16:19], s96 offen offset:0 sc1
    v_mfma_f32_16x16x32_bf16 v[80:83], v[188:191], v[100:103], v[80:83]
    buffer_load_dwordx4 v[100:103], v4, s[16:19], s97 offen offset:0 sc1
    v_mfma_f32_16x16x32_bf16 v[84:87], v[188:191], v[104:107], v[84:87]
    buffer_load_dwordx4 v[104:107], v4, s[16:19], s98 offen offset:0 sc1
    v_mfma_f32_16x16x32_bf16 v[88:91], v[188:191], v[108:111], v[88:91]
    buffer_load_dwordx4 v[108:111], v4, s[16:19], s99 offen offset:0 sc1
    v_mfma_f32_16x16x32_bf16 v[92:95], v[188:191], v[112:115], v[92:95]
    buffer_load_dwordx4 v[112:115], v4, s[16:19], s54 offen offset:0 sc1
    s_waitcnt vmcnt(23)
    s_waitcnt lgkmcnt(0)
    v_mfma_f32_16x16x32_bf16 v[16:19], v[192:195], v[116:119], v[16:19]
    ds_read_b64_tr_b16 v[176:177], v6 offset:8192
    ds_read_b64_tr_b16 v[178:179], v6 offset:10240
    v_mfma_f32_16x16x32_bf16 v[20:23], v[192:195], v[120:123], v[20:23]
    v_mfma_f32_16x16x32_bf16 v[24:27], v[192:195], v[124:127], v[24:27]
    s_add_u32 m0, s59, 4096
    s_add_u32 s35, s33, 40960
    buffer_load_dwordx4 v5, s[20:23], s35 offen offset:0 lds
    v_mfma_f32_16x16x32_bf16 v[28:31], v[192:195], v[128:131], v[28:31]
    v_mfma_f32_16x16x32_bf16 v[32:35], v[192:195], v[132:135], v[32:35]
    s_add_u32 s35, s33, 50176
    buffer_load_dwordx4 v5, s[20:23], s35 offen offset:1024 lds
    v_mfma_f32_16x16x32_bf16 v[36:39], v[196:199], v[116:119], v[36:39]
    ds_read_b64_tr_b16 v[180:181], v7 offset:8192
    ds_read_b64_tr_b16 v[182:183], v7 offset:10240
    v_mfma_f32_16x16x32_bf16 v[40:43], v[196:199], v[120:123], v[40:43]
    v_mfma_f32_16x16x32_bf16 v[44:47], v[196:199], v[124:127], v[44:47]
    s_add_u32 s35, s33, 59392
    buffer_load_dwordx4 v5, s[20:23], s35 offen offset:2048 lds
    v_mfma_f32_16x16x32_bf16 v[48:51], v[196:199], v[128:131], v[48:51]
    v_mfma_f32_16x16x32_bf16 v[52:55], v[196:199], v[132:135], v[52:55]
    s_add_u32 s35, s33, 68608
    buffer_load_dwordx4 v5, s[20:23], s35 offen offset:3072 lds
    v_mfma_f32_16x16x32_bf16 v[56:59], v[200:203], v[116:119], v[56:59]
    ds_read_b64_tr_b16 v[184:185], v8 offset:8192
    ds_read_b64_tr_b16 v[186:187], v8 offset:10240
    v_mfma_f32_16x16x32_bf16 v[60:63], v[200:203], v[120:123], v[60:63]
    v_mfma_f32_16x16x32_bf16 v[64:67], v[200:203], v[124:127], v[64:67]
    v_mfma_f32_16x16x32_bf16 v[68:71], v[200:203], v[128:131], v[68:71]
    v_mfma_f32_16x16x32_bf16 v[72:75], v[200:203], v[132:135], v[72:75]
    v_mfma_f32_16x16x32_bf16 v[76:79], v[204:207], v[116:119], v[76:79]
    ds_read_b64_tr_b16 v[188:189], v9 offset:8192
    ds_read_b64_tr_b16 v[190:191], v9 offset:10240
    buffer_load_dwordx4 v[116:119], v4, s[16:19], s96 offen offset:1024 sc1
    v_mfma_f32_16x16x32_bf16 v[80:83], v[204:207], v[120:123], v[80:83]
    buffer_load_dwordx4 v[120:123], v4, s[16:19], s97 offen offset:1024 sc1
    v_mfma_f32_16x16x32_bf16 v[84:87], v[204:207], v[124:127], v[84:87]
    buffer_load_dwordx4 v[124:127], v4, s[16:19], s98 offen offset:1024 sc1
    v_mfma_f32_16x16x32_bf16 v[88:91], v[204:207], v[128:131], v[88:91]
    buffer_load_dwordx4 v[128:131], v4, s[16:19], s99 offen offset:1024 sc1
    v_mfma_f32_16x16x32_bf16 v[92:95], v[204:207], v[132:135], v[92:95]
    buffer_load_dwordx4 v[132:135], v4, s[16:19], s54 offen offset:1024 sc1
    s_waitcnt vmcnt(23)
    s_waitcnt lgkmcnt(0)
    v_mfma_f32_16x16x32_bf16 v[16:19], v[176:179], v[136:139], v[16:19]
    ds_read_b64_tr_b16 v[192:193], v6 offset:12288
    ds_read_b64_tr_b16 v[194:195], v6 offset:14336
    v_mfma_f32_16x16x32_bf16 v[20:23], v[176:179], v[140:143], v[20:23]
    v_mfma_f32_16x16x32_bf16 v[24:27], v[176:179], v[144:147], v[24:27]
    s_add_u32 m0, s59, 8192
    s_add_u32 s35, s33, 81920
    buffer_load_dwordx4 v5, s[20:23], s35 offen offset:0 lds
    v_mfma_f32_16x16x32_bf16 v[28:31], v[176:179], v[148:151], v[28:31]
    v_mfma_f32_16x16x32_bf16 v[32:35], v[176:179], v[152:155], v[32:35]
    s_add_u32 s35, s33, 91136
    buffer_load_dwordx4 v5, s[20:23], s35 offen offset:1024 lds
    v_mfma_f32_16x16x32_bf16 v[36:39], v[180:183], v[136:139], v[36:39]
    ds_read_b64_tr_b16 v[196:197], v7 offset:12288
    ds_read_b64_tr_b16 v[198:199], v7 offset:14336
    v_mfma_f32_16x16x32_bf16 v[40:43], v[180:183], v[140:143], v[40:43]
    v_mfma_f32_16x16x32_bf16 v[44:47], v[180:183], v[144:147], v[44:47]
    s_add_u32 s35, s33, 100352
    buffer_load_dwordx4 v5, s[20:23], s35 offen offset:2048 lds
    v_mfma_f32_16x16x32_bf16 v[48:51], v[180:183], v[148:151], v[48:51]
    v_mfma_f32_16x16x32_bf16 v[52:55], v[180:183], v[152:155], v[52:55]
    s_add_u32 s35, s33, 109568
    buffer_load_dwordx4 v5, s[20:23], s35 offen offset:3072 lds
    v_mfma_f32_16x16x32_bf16 v[56:59], v[184:187], v[136:139], v[56:59]
    ds_read_b64_tr_b16 v[200:201], v8 offset:12288
    ds_read_b64_tr_b16 v[202:203], v8 offset:14336
    v_mfma_f32_16x16x32_bf16 v[60:63], v[184:187], v[140:143], v[60:63]
    v_mfma_f32_16x16x32_bf16 v[64:67], v[184:187], v[144:147], v[64:67]
    v_mfma_f32_16x16x32_bf16 v[68:71], v[184:187], v[148:151], v[68:71]
    v_mfma_f32_16x16x32_bf16 v[72:75], v[184:187], v[152:155], v[72:75]
    v_mfma_f32_16x16x32_bf16 v[76:79], v[188:191], v[136:139], v[76:79]
    ds_read_b64_tr_b16 v[204:205], v9 offset:12288
    ds_read_b64_tr_b16 v[206:207], v9 offset:14336
    buffer_load_dwordx4 v[136:139], v4, s[16:19], s96 offen offset:2048 sc1
    v_mfma_f32_16x16x32_bf16 v[80:83], v[188:191], v[140:143], v[80:83]
    buffer_load_dwordx4 v[140:143], v4, s[16:19], s97 offen offset:2048 sc1
    v_mfma_f32_16x16x32_bf16 v[84:87], v[188:191], v[144:147], v[84:87]
    buffer_load_dwordx4 v[144:147], v4, s[16:19], s98 offen offset:2048 sc1
    v_mfma_f32_16x16x32_bf16 v[88:91], v[188:191], v[148:151], v[88:91]
    buffer_load_dwordx4 v[148:151], v4, s[16:19], s99 offen offset:2048 sc1
    v_mfma_f32_16x16x32_bf16 v[92:95], v[188:191], v[152:155], v[92:95]
    buffer_load_dwordx4 v[152:155], v4, s[16:19], s54 offen offset:2048 sc1
    s_waitcnt vmcnt(23)
    s_waitcnt lgkmcnt(0)
    v_mfma_f32_16x16x32_bf16 v[16:19], v[192:195], v[156:159], v[16:19]
    ds_read_b64_tr_b16 v[176:177], v6 offset:0
    ds_read_b64_tr_b16 v[178:179], v6 offset:2048
    v_mfma_f32_16x16x32_bf16 v[20:23], v[192:195], v[160:163], v[20:23]
    v_mfma_f32_16x16x32_bf16 v[24:27], v[192:195], v[164:167], v[24:27]
    s_add_u32 m0, s59, 12288
    s_add_u32 s35, s33, 122880
    buffer_load_dwordx4 v5, s[20:23], s35 offen offset:0 lds
    v_mfma_f32_16x16x32_bf16 v[28:31], v[192:195], v[168:171], v[28:31]
    v_mfma_f32_16x16x32_bf16 v[32:35], v[192:195], v[172:175], v[32:35]
    s_add_u32 s35, s33, 132096
    buffer_load_dwordx4 v5, s[20:23], s35 offen offset:1024 lds
    v_mfma_f32_16x16x32_bf16 v[36:39], v[196:199], v[156:159], v[36:39]
    ds_read_b64_tr_b16 v[180:181], v7 offset:0
    ds_read_b64_tr_b16 v[182:183], v7 offset:2048
    v_mfma_f32_16x16x32_bf16 v[40:43], v[196:199], v[160:163], v[40:43]
    v_mfma_f32_16x16x32_bf16 v[44:47], v[196:199], v[164:167], v[44:47]
    s_add_u32 s35, s33, 141312
    buffer_load_dwordx4 v5, s[20:23], s35 offen offset:2048 lds
    v_mfma_f32_16x16x32_bf16 v[48:51], v[196:199], v[168:171], v[48:51]
    v_mfma_f32_16x16x32_bf16 v[52:55], v[196:199], v[172:175], v[52:55]
    s_add_u32 s35, s33, 150528
    buffer_load_dwordx4 v5, s[20:23], s35 offen offset:3072 lds
    v_mfma_f32_16x16x32_bf16 v[56:59], v[200:203], v[156:159], v[56:59]
    ds_read_b64_tr_b16 v[184:185], v8 offset:0
    ds_read_b64_tr_b16 v[186:187], v8 offset:2048
    v_mfma_f32_16x16x32_bf16 v[60:63], v[200:203], v[160:163], v[60:63]
    v_mfma_f32_16x16x32_bf16 v[64:67], v[200:203], v[164:167], v[64:67]
    v_mfma_f32_16x16x32_bf16 v[68:71], v[200:203], v[168:171], v[68:71]
    v_mfma_f32_16x16x32_bf16 v[72:75], v[200:203], v[172:175], v[72:75]
    v_mfma_f32_16x16x32_bf16 v[76:79], v[204:207], v[156:159], v[76:79]
    ds_read_b64_tr_b16 v[188:189], v9 offset:0
    ds_read_b64_tr_b16 v[190:191], v9 offset:2048
    buffer_load_dwordx4 v[156:159], v4, s[16:19], s96 offen offset:3072 sc1
    v_mfma_f32_16x16x32_bf16 v[80:83], v[204:207], v[160:163], v[80:83]
    buffer_load_dwordx4 v[160:163], v4, s[16:19], s97 offen offset:3072 sc1
    v_mfma_f32_16x16x32_bf16 v[84:87], v[204:207], v[164:167], v[84:87]
    buffer_load_dwordx4 v[164:167], v4, s[16:19], s98 offen offset:3072 sc1
    v_mfma_f32_16x16x32_bf16 v[88:91], v[204:207], v[168:171], v[88:91]
    buffer_load_dwordx4 v[168:171], v4, s[16:19], s99 offen offset:3072 sc1
    v_mfma_f32_16x16x32_bf16 v[92:95], v[204:207], v[172:175], v[92:95]
    buffer_load_dwordx4 v[172:175], v4, s[16:19], s54 offen offset:3072 sc1
    s_add_u32 s31, s31, 1
    s_cmp_lt_u32 s31, 5
    s_cbranch_scc1 p4_loop_122
    v_add_u32 v4, 4096, v4
    s_add_u32 s33, s33, 163840
    s_waitcnt vmcnt(23)
    s_waitcnt lgkmcnt(0)
    v_mfma_f32_16x16x32_bf16 v[16:19], v[176:179], v[96:99], v[16:19]
    ds_read_b64_tr_b16 v[192:193], v6 offset:4096
    ds_read_b64_tr_b16 v[194:195], v6 offset:6144
    v_mfma_f32_16x16x32_bf16 v[20:23], v[176:179], v[100:103], v[20:23]
    v_mfma_f32_16x16x32_bf16 v[24:27], v[176:179], v[104:107], v[24:27]
    s_add_u32 m0, s59, 0
    s_add_u32 s35, s33, 0
    buffer_load_dwordx4 v5, s[20:23], s35 offen offset:0 lds
    v_mfma_f32_16x16x32_bf16 v[28:31], v[176:179], v[108:111], v[28:31]
    v_mfma_f32_16x16x32_bf16 v[32:35], v[176:179], v[112:115], v[32:35]
    s_add_u32 s35, s33, 9216
    buffer_load_dwordx4 v5, s[20:23], s35 offen offset:1024 lds
    v_mfma_f32_16x16x32_bf16 v[36:39], v[180:183], v[96:99], v[36:39]
    ds_read_b64_tr_b16 v[196:197], v7 offset:4096
    ds_read_b64_tr_b16 v[198:199], v7 offset:6144
    v_mfma_f32_16x16x32_bf16 v[40:43], v[180:183], v[100:103], v[40:43]
    v_mfma_f32_16x16x32_bf16 v[44:47], v[180:183], v[104:107], v[44:47]
    s_add_u32 s35, s33, 18432
    buffer_load_dwordx4 v5, s[20:23], s35 offen offset:2048 lds
    v_mfma_f32_16x16x32_bf16 v[48:51], v[180:183], v[108:111], v[48:51]
    v_mfma_f32_16x16x32_bf16 v[52:55], v[180:183], v[112:115], v[52:55]
    s_add_u32 s35, s33, 27648
    buffer_load_dwordx4 v5, s[20:23], s35 offen offset:3072 lds
    v_mfma_f32_16x16x32_bf16 v[56:59], v[184:187], v[96:99], v[56:59]
    ds_read_b64_tr_b16 v[200:201], v8 offset:4096
    ds_read_b64_tr_b16 v[202:203], v8 offset:6144
    v_mfma_f32_16x16x32_bf16 v[60:63], v[184:187], v[100:103], v[60:63]
    v_mfma_f32_16x16x32_bf16 v[64:67], v[184:187], v[104:107], v[64:67]
    v_mfma_f32_16x16x32_bf16 v[68:71], v[184:187], v[108:111], v[68:71]
    v_mfma_f32_16x16x32_bf16 v[72:75], v[184:187], v[112:115], v[72:75]
    v_mfma_f32_16x16x32_bf16 v[76:79], v[188:191], v[96:99], v[76:79]
    ds_read_b64_tr_b16 v[204:205], v9 offset:4096
    ds_read_b64_tr_b16 v[206:207], v9 offset:6144
    buffer_load_dwordx4 v[96:99], v4, s[16:19], s96 offen offset:0 sc1
    v_mfma_f32_16x16x32_bf16 v[80:83], v[188:191], v[100:103], v[80:83]
    buffer_load_dwordx4 v[100:103], v4, s[16:19], s97 offen offset:0 sc1
    v_mfma_f32_16x16x32_bf16 v[84:87], v[188:191], v[104:107], v[84:87]
    buffer_load_dwordx4 v[104:107], v4, s[16:19], s98 offen offset:0 sc1
    v_mfma_f32_16x16x32_bf16 v[88:91], v[188:191], v[108:111], v[88:91]
    buffer_load_dwordx4 v[108:111], v4, s[16:19], s99 offen offset:0 sc1
    v_mfma_f32_16x16x32_bf16 v[92:95], v[188:191], v[112:115], v[92:95]
    buffer_load_dwordx4 v[112:115], v4, s[16:19], s54 offen offset:0 sc1
    s_waitcnt vmcnt(23)
    s_waitcnt lgkmcnt(0)
    v_mfma_f32_16x16x32_bf16 v[16:19], v[192:195], v[116:119], v[16:19]
    ds_read_b64_tr_b16 v[176:177], v6 offset:8192
    ds_read_b64_tr_b16 v[178:179], v6 offset:10240
    v_mfma_f32_16x16x32_bf16 v[20:23], v[192:195], v[120:123], v[20:23]
    v_mfma_f32_16x16x32_bf16 v[24:27], v[192:195], v[124:127], v[24:27]
    s_add_u32 m0, s59, 4096
    s_add_u32 s35, s33, 40960
    buffer_load_dwordx4 v5, s[20:23], s35 offen offset:0 lds
    v_mfma_f32_16x16x32_bf16 v[28:31], v[192:195], v[128:131], v[28:31]
    v_mfma_f32_16x16x32_bf16 v[32:35], v[192:195], v[132:135], v[32:35]
    s_add_u32 s35, s33, 50176
    buffer_load_dwordx4 v5, s[20:23], s35 offen offset:1024 lds
    v_mfma_f32_16x16x32_bf16 v[36:39], v[196:199], v[116:119], v[36:39]
    ds_read_b64_tr_b16 v[180:181], v7 offset:8192
    ds_read_b64_tr_b16 v[182:183], v7 offset:10240
    v_mfma_f32_16x16x32_bf16 v[40:43], v[196:199], v[120:123], v[40:43]
    v_mfma_f32_16x16x32_bf16 v[44:47], v[196:199], v[124:127], v[44:47]
    s_add_u32 s35, s33, 59392
    buffer_load_dwordx4 v5, s[20:23], s35 offen offset:2048 lds
    v_mfma_f32_16x16x32_bf16 v[48:51], v[196:199], v[128:131], v[48:51]
    v_mfma_f32_16x16x32_bf16 v[52:55], v[196:199], v[132:135], v[52:55]
    s_add_u32 s35, s33, 68608
    buffer_load_dwordx4 v5, s[20:23], s35 offen offset:3072 lds
    v_mfma_f32_16x16x32_bf16 v[56:59], v[200:203], v[116:119], v[56:59]
    ds_read_b64_tr_b16 v[184:185], v8 offset:8192
    ds_read_b64_tr_b16 v[186:187], v8 offset:10240
    v_mfma_f32_16x16x32_bf16 v[60:63], v[200:203], v[120:123], v[60:63]
    v_mfma_f32_16x16x32_bf16 v[64:67], v[200:203], v[124:127], v[64:67]
    v_mfma_f32_16x16x32_bf16 v[68:71], v[200:203], v[128:131], v[68:71]
    v_mfma_f32_16x16x32_bf16 v[72:75], v[200:203], v[132:135], v[72:75]
    v_mfma_f32_16x16x32_bf16 v[76:79], v[204:207], v[116:119], v[76:79]
    ds_read_b64_tr_b16 v[188:189], v9 offset:8192
    ds_read_b64_tr_b16 v[190:191], v9 offset:10240
    buffer_load_dwordx4 v[116:119], v4, s[16:19], s96 offen offset:1024 sc1
    v_mfma_f32_16x16x32_bf16 v[80:83], v[204:207], v[120:123], v[80:83]
    buffer_load_dwordx4 v[120:123], v4, s[16:19], s97 offen offset:1024 sc1
    v_mfma_f32_16x16x32_bf16 v[84:87], v[204:207], v[124:127], v[84:87]
    buffer_load_dwordx4 v[124:127], v4, s[16:19], s98 offen offset:1024 sc1
    v_mfma_f32_16x16x32_bf16 v[88:91], v[204:207], v[128:131], v[88:91]
    buffer_load_dwordx4 v[128:131], v4, s[16:19], s99 offen offset:1024 sc1
    v_mfma_f32_16x16x32_bf16 v[92:95], v[204:207], v[132:135], v[92:95]
    buffer_load_dwordx4 v[132:135], v4, s[16:19], s54 offen offset:1024 sc1
    s_waitcnt vmcnt(23)
    s_waitcnt lgkmcnt(0)
    v_mfma_f32_16x16x32_bf16 v[16:19], v[176:179], v[136:139], v[16:19]
    ds_read_b64_tr_b16 v[192:193], v6 offset:12288
    ds_read_b64_tr_b16 v[194:195], v6 offset:14336
    v_mfma_f32_16x16x32_bf16 v[20:23], v[176:179], v[140:143], v[20:23]
    v_mfma_f32_16x16x32_bf16 v[24:27], v[176:179], v[144:147], v[24:27]
    s_add_u32 m0, s59, 8192
    s_add_u32 s35, s33, 81920
    buffer_load_dwordx4 v5, s[20:23], s35 offen offset:0 lds
    v_mfma_f32_16x16x32_bf16 v[28:31], v[176:179], v[148:151], v[28:31]
    v_mfma_f32_16x16x32_bf16 v[32:35], v[176:179], v[152:155], v[32:35]
    s_add_u32 s35, s33, 91136
    buffer_load_dwordx4 v5, s[20:23], s35 offen offset:1024 lds
    v_mfma_f32_16x16x32_bf16 v[36:39], v[180:183], v[136:139], v[36:39]
    ds_read_b64_tr_b16 v[196:197], v7 offset:12288
    ds_read_b64_tr_b16 v[198:199], v7 offset:14336
    v_mfma_f32_16x16x32_bf16 v[40:43], v[180:183], v[140:143], v[40:43]
    v_mfma_f32_16x16x32_bf16 v[44:47], v[180:183], v[144:147], v[44:47]
    s_add_u32 s35, s33, 100352
    buffer_load_dwordx4 v5, s[20:23], s35 offen offset:2048 lds
    v_mfma_f32_16x16x32_bf16 v[48:51], v[180:183], v[148:151], v[48:51]
    v_mfma_f32_16x16x32_bf16 v[52:55], v[180:183], v[152:155], v[52:55]
    s_add_u32 s35, s33, 109568
    buffer_load_dwordx4 v5, s[20:23], s35 offen offset:3072 lds
    v_mfma_f32_16x16x32_bf16 v[56:59], v[184:187], v[136:139], v[56:59]
    ds_read_b64_tr_b16 v[200:201], v8 offset:12288
    ds_read_b64_tr_b16 v[202:203], v8 offset:14336
    v_mfma_f32_16x16x32_bf16 v[60:63], v[184:187], v[140:143], v[60:63]
    v_mfma_f32_16x16x32_bf16 v[64:67], v[184:187], v[144:147], v[64:67]
    v_mfma_f32_16x16x32_bf16 v[68:71], v[184:187], v[148:151], v[68:71]
    v_mfma_f32_16x16x32_bf16 v[72:75], v[184:187], v[152:155], v[72:75]
    v_mfma_f32_16x16x32_bf16 v[76:79], v[188:191], v[136:139], v[76:79]
    ds_read_b64_tr_b16 v[204:205], v9 offset:12288
    ds_read_b64_tr_b16 v[206:207], v9 offset:14336
    buffer_load_dwordx4 v[136:139], v4, s[16:19], s96 offen offset:2048 sc1
    v_mfma_f32_16x16x32_bf16 v[80:83], v[188:191], v[140:143], v[80:83]
    buffer_load_dwordx4 v[140:143], v4, s[16:19], s97 offen offset:2048 sc1
    v_mfma_f32_16x16x32_bf16 v[84:87], v[188:191], v[144:147], v[84:87]
    buffer_load_dwordx4 v[144:147], v4, s[16:19], s98 offen offset:2048 sc1
    v_mfma_f32_16x16x32_bf16 v[88:91], v[188:191], v[148:151], v[88:91]
    buffer_load_dwordx4 v[148:151], v4, s[16:19], s99 offen offset:2048 sc1
    v_mfma_f32_16x16x32_bf16 v[92:95], v[188:191], v[152:155], v[92:95]
    buffer_load_dwordx4 v[152:155], v4, s[16:19], s54 offen offset:2048 sc1
    s_waitcnt vmcnt(23)
    s_waitcnt lgkmcnt(0)
    v_mfma_f32_16x16x32_bf16 v[16:19], v[192:195], v[156:159], v[16:19]
    ds_read_b64_tr_b16 v[176:177], v6 offset:0
    ds_read_b64_tr_b16 v[178:179], v6 offset:2048
    v_mfma_f32_16x16x32_bf16 v[20:23], v[192:195], v[160:163], v[20:23]
    v_mfma_f32_16x16x32_bf16 v[24:27], v[192:195], v[164:167], v[24:27]
    s_add_u32 m0, s59, 12288
    s_add_u32 s35, s33, 122880
    buffer_load_dwordx4 v5, s[20:23], s35 offen offset:0 lds
    v_mfma_f32_16x16x32_bf16 v[28:31], v[192:195], v[168:171], v[28:31]
    v_mfma_f32_16x16x32_bf16 v[32:35], v[192:195], v[172:175], v[32:35]
    s_add_u32 s35, s33, 132096
    buffer_load_dwordx4 v5, s[20:23], s35 offen offset:1024 lds
    v_mfma_f32_16x16x32_bf16 v[36:39], v[196:199], v[156:159], v[36:39]
    ds_read_b64_tr_b16 v[180:181], v7 offset:0
    ds_read_b64_tr_b16 v[182:183], v7 offset:2048
    v_mfma_f32_16x16x32_bf16 v[40:43], v[196:199], v[160:163], v[40:43]
    v_mfma_f32_16x16x32_bf16 v[44:47], v[196:199], v[164:167], v[44:47]
    s_add_u32 s35, s33, 141312
    buffer_load_dwordx4 v5, s[20:23], s35 offen offset:2048 lds
    v_mfma_f32_16x16x32_bf16 v[48:51], v[196:199], v[168:171], v[48:51]
    v_mfma_f32_16x16x32_bf16 v[52:55], v[196:199], v[172:175], v[52:55]
    s_add_u32 s35, s33, 150528
    buffer_load_dwordx4 v5, s[20:23], s35 offen offset:3072 lds
    v_mfma_f32_16x16x32_bf16 v[56:59], v[200:203], v[156:159], v[56:59]
    ds_read_b64_tr_b16 v[184:185], v8 offset:0
    ds_read_b64_tr_b16 v[186:187], v8 offset:2048
    v_mfma_f32_16x16x32_bf16 v[60:63], v[200:203], v[160:163], v[60:63]
    v_mfma_f32_16x16x32_bf16 v[64:67], v[200:203], v[164:167], v[64:67]
    v_mfma_f32_16x16x32_bf16 v[68:71], v[200:203], v[168:171], v[68:71]
    v_mfma_f32_16x16x32_bf16 v[72:75], v[200:203], v[172:175], v[72:75]
    v_mfma_f32_16x16x32_bf16 v[76:79], v[204:207], v[156:159], v[76:79]
    ds_read_b64_tr_b16 v[188:189], v9 offset:0
    ds_read_b64_tr_b16 v[190:191], v9 offset:2048
    buffer_load_dwordx4 v[156:159], v4, s[16:19], s96 offen offset:3072 sc1
    v_mfma_f32_16x16x32_bf16 v[80:83], v[204:207], v[160:163], v[80:83]
    buffer_load_dwordx4 v[160:163], v4, s[16:19], s97 offen offset:3072 sc1
    v_mfma_f32_16x16x32_bf16 v[84:87], v[204:207], v[164:167], v[84:87]
    buffer_load_dwordx4 v[164:167], v4, s[16:19], s98 offen offset:3072 sc1
    v_mfma_f32_16x16x32_bf16 v[88:91], v[204:207], v[168:171], v[88:91]
    buffer_load_dwordx4 v[168:171], v4, s[16:19], s99 offen offset:3072 sc1
    v_mfma_f32_16x16x32_bf16 v[92:95], v[204:207], v[172:175], v[92:95]
    buffer_load_dwordx4 v[172:175], v4, s[16:19], s54 offen offset:3072 sc1
    buffer_load_dword v10, v244, s[92:95], 0 offen sc1
    s_waitcnt vmcnt(24)
    s_waitcnt lgkmcnt(0)
    v_mfma_f32_16x16x32_bf16 v[16:19], v[176:179], v[96:99], v[16:19]
    ds_read_b64_tr_b16 v[192:193], v6 offset:4096
    ds_read_b64_tr_b16 v[194:195], v6 offset:6144
    v_mfma_f32_16x16x32_bf16 v[20:23], v[176:179], v[100:103], v[20:23]
    v_mfma_f32_16x16x32_bf16 v[24:27], v[176:179], v[104:107], v[24:27]
    v_mfma_f32_16x16x32_bf16 v[28:31], v[176:179], v[108:111], v[28:31]
    v_mfma_f32_16x16x32_bf16 v[32:35], v[176:179], v[112:115], v[32:35]
    v_mfma_f32_16x16x32_bf16 v[36:39], v[180:183], v[96:99], v[36:39]
    ds_read_b64_tr_b16 v[196:197], v7 offset:4096
    ds_read_b64_tr_b16 v[198:199], v7 offset:6144
    v_mfma_f32_16x16x32_bf16 v[40:43], v[180:183], v[100:103], v[40:43]
    v_mfma_f32_16x16x32_bf16 v[44:47], v[180:183], v[104:107], v[44:47]
    v_mfma_f32_16x16x32_bf16 v[48:51], v[180:183], v[108:111], v[48:51]
    v_mfma_f32_16x16x32_bf16 v[52:55], v[180:183], v[112:115], v[52:55]
    v_mfma_f32_16x16x32_bf16 v[56:59], v[184:187], v[96:99], v[56:59]
    ds_read_b64_tr_b16 v[200:201], v8 offset:4096
    ds_read_b64_tr_b16 v[202:203], v8 offset:6144
    v_mfma_f32_16x16x32_bf16 v[60:63], v[184:187], v[100:103], v[60:63]
    v_mfma_f32_16x16x32_bf16 v[64:67], v[184:187], v[104:107], v[64:67]
    v_mfma_f32_16x16x32_bf16 v[68:71], v[184:187], v[108:111], v[68:71]
    v_mfma_f32_16x16x32_bf16 v[72:75], v[184:187], v[112:115], v[72:75]
    v_mfma_f32_16x16x32_bf16 v[76:79], v[188:191], v[96:99], v[76:79]
    ds_read_b64_tr_b16 v[204:205], v9 offset:4096
    ds_read_b64_tr_b16 v[206:207], v9 offset:6144
    v_mfma_f32_16x16x32_bf16 v[80:83], v[188:191], v[100:103], v[80:83]
    v_mfma_f32_16x16x32_bf16 v[84:87], v[188:191], v[104:107], v[84:87]
    v_mfma_f32_16x16x32_bf16 v[88:91], v[188:191], v[108:111], v[88:91]
    v_mfma_f32_16x16x32_bf16 v[92:95], v[188:191], v[112:115], v[92:95]
    s_waitcnt vmcnt(15)
    s_waitcnt lgkmcnt(0)
    v_mfma_f32_16x16x32_bf16 v[16:19], v[192:195], v[116:119], v[16:19]
    ds_read_b64_tr_b16 v[176:177], v6 offset:8192
    ds_read_b64_tr_b16 v[178:179], v6 offset:10240
    v_mfma_f32_16x16x32_bf16 v[20:23], v[192:195], v[120:123], v[20:23]
    v_mfma_f32_16x16x32_bf16 v[24:27], v[192:195], v[124:127], v[24:27]
    v_mfma_f32_16x16x32_bf16 v[28:31], v[192:195], v[128:131], v[28:31]
    v_mfma_f32_16x16x32_bf16 v[32:35], v[192:195], v[132:135], v[32:35]
    v_mfma_f32_16x16x32_bf16 v[36:39], v[196:199], v[116:119], v[36:39]
    ds_read_b64_tr_b16 v[180:181], v7 offset:8192
    ds_read_b64_tr_b16 v[182:183], v7 offset:10240
    v_mfma_f32_16x16x32_bf16 v[40:43], v[196:199], v[120:123], v[40:43]
    v_mfma_f32_16x16x32_bf16 v[44:47], v[196:199], v[124:127], v[44:47]
    v_mfma_f32_16x16x32_bf16 v[48:51], v[196:199], v[128:131], v[48:51]
    v_mfma_f32_16x16x32_bf16 v[52:55], v[196:199], v[132:135], v[52:55]
    v_mfma_f32_16x16x32_bf16 v[56:59], v[200:203], v[116:119], v[56:59]
    ds_read_b64_tr_b16 v[184:185], v8 offset:8192
    ds_read_b64_tr_b16 v[186:187], v8 offset:10240
    v_mfma_f32_16x16x32_bf16 v[60:63], v[200:203], v[120:123], v[60:63]
    v_mfma_f32_16x16x32_bf16 v[64:67], v[200:203], v[124:127], v[64:67]
    v_mfma_f32_16x16x32_bf16 v[68:71], v[200:203], v[128:131], v[68:71]
    v_mfma_f32_16x16x32_bf16 v[72:75], v[200:203], v[132:135], v[72:75]
    v_mfma_f32_16x16x32_bf16 v[76:79], v[204:207], v[116:119], v[76:79]
    ds_read_b64_tr_b16 v[188:189], v9 offset:8192
    ds_read_b64_tr_b16 v[190:191], v9 offset:10240
    v_mfma_f32_16x16x32_bf16 v[80:83], v[204:207], v[120:123], v[80:83]
    v_mfma_f32_16x16x32_bf16 v[84:87], v[204:207], v[124:127], v[84:87]
    v_mfma_f32_16x16x32_bf16 v[88:91], v[204:207], v[128:131], v[88:91]
    v_mfma_f32_16x16x32_bf16 v[92:95], v[204:207], v[132:135], v[92:95]
    s_waitcnt vmcnt(6)
    s_waitcnt lgkmcnt(0)
    v_mfma_f32_16x16x32_bf16 v[16:19], v[176:179], v[136:139], v[16:19]
    ds_read_b64_tr_b16 v[192:193], v6 offset:12288
    ds_read_b64_tr_b16 v[194:195], v6 offset:14336
    v_mfma_f32_16x16x32_bf16 v[20:23], v[176:179], v[140:143], v[20:23]
    v_mfma_f32_16x16x32_bf16 v[24:27], v[176:179], v[144:147], v[24:27]
    v_mfma_f32_16x16x32_bf16 v[28:31], v[176:179], v[148:151], v[28:31]
    v_mfma_f32_16x16x32_bf16 v[32:35], v[176:179], v[152:155], v[32:35]
    v_mfma_f32_16x16x32_bf16 v[36:39], v[180:183], v[136:139], v[36:39]
    ds_read_b64_tr_b16 v[196:197], v7 offset:12288
    ds_read_b64_tr_b16 v[198:199], v7 offset:14336
    v_mfma_f32_16x16x32_bf16 v[40:43], v[180:183], v[140:143], v[40:43]
    v_mfma_f32_16x16x32_bf16 v[44:47], v[180:183], v[144:147], v[44:47]
    v_mfma_f32_16x16x32_bf16 v[48:51], v[180:183], v[148:151], v[48:51]
    v_mfma_f32_16x16x32_bf16 v[52:55], v[180:183], v[152:155], v[52:55]
    v_mfma_f32_16x16x32_bf16 v[56:59], v[184:187], v[136:139], v[56:59]
    ds_read_b64_tr_b16 v[200:201], v8 offset:12288
    ds_read_b64_tr_b16 v[202:203], v8 offset:14336
    v_mfma_f32_16x16x32_bf16 v[60:63], v[184:187], v[140:143], v[60:63]
    v_mfma_f32_16x16x32_bf16 v[64:67], v[184:187], v[144:147], v[64:67]
    v_mfma_f32_16x16x32_bf16 v[68:71], v[184:187], v[148:151], v[68:71]
    v_mfma_f32_16x16x32_bf16 v[72:75], v[184:187], v[152:155], v[72:75]
    v_mfma_f32_16x16x32_bf16 v[76:79], v[188:191], v[136:139], v[76:79]
    ds_read_b64_tr_b16 v[204:205], v9 offset:12288
    ds_read_b64_tr_b16 v[206:207], v9 offset:14336
    v_mfma_f32_16x16x32_bf16 v[80:83], v[188:191], v[140:143], v[80:83]
    v_mfma_f32_16x16x32_bf16 v[84:87], v[188:191], v[144:147], v[84:87]
    v_mfma_f32_16x16x32_bf16 v[88:91], v[188:191], v[148:151], v[88:91]
    v_mfma_f32_16x16x32_bf16 v[92:95], v[188:191], v[152:155], v[92:95]
    s_waitcnt vmcnt(0)
    v_cmp_ne_u32 vcc, v10, v13
    s_cbranch_vccnz p4_slowpoll_120
p4_pollok_121:
    s_mov_b32 s28, 0
    buffer_load_dwordx2 v[96:97], v242, s[24:27], s28 offen
    buffer_load_dword v126, v240, s[44:47], 0 offen offset:0 sc1
    s_mov_b32 s28, 20480
    buffer_load_dwordx2 v[98:99], v242, s[24:27], s28 offen
    buffer_load_dword v127, v240, s[44:47], 0 offen offset:64 sc1
    s_mov_b32 s28, 40960
    buffer_load_dwordx2 v[100:101], v242, s[24:27], s28 offen
    buffer_load_dword v128, v240, s[44:47], 0 offen offset:128 sc1
    s_mov_b32 s28, 61440
    buffer_load_dwordx2 v[102:103], v242, s[24:27], s28 offen
    buffer_load_dword v129, v240, s[44:47], 0 offen offset:192 sc1
    s_mov_b32 s28, 81920
    buffer_load_dwordx2 v[104:105], v242, s[24:27], s28 offen
    buffer_load_dword v130, v240, s[44:47], 0 offen offset:256 sc1
    s_mov_b32 s28, 0
    buffer_load_ushort v106, v243, s[36:39], s28 offen offset:0 sc1
    buffer_load_ushort v110, v243, s[36:39], s28 offen offset:32 sc1
    buffer_load_ushort v114, v243, s[36:39], s28 offen offset:64 sc1
    buffer_load_ushort v118, v243, s[36:39], s28 offen offset:96 sc1
    buffer_load_ushort v122, v243, s[36:39], s28 offen offset:128 sc1
    s_mov_b32 s28, 4096
    buffer_load_ushort v107, v243, s[36:39], s28 offen offset:0 sc1
    buffer_load_ushort v111, v243, s[36:39], s28 offen offset:32 sc1
    buffer_load_ushort v115, v243, s[36:39], s28 offen offset:64 sc1
    buffer_load_ushort v119, v243, s[36:39], s28 offen offset:96 sc1
    buffer_load_ushort v123, v243, s[36:39], s28 offen offset:128 sc1
    s_mov_b32 s28, 8192
    buffer_load_ushort v108, v243, s[36:39], s28 offen offset:0 sc1
    buffer_load_ushort v112, v243, s[36:39], s28 offen offset:32 sc1
    buffer_load_ushort v116, v243, s[36:39], s28 offen offset:64 sc1
    buffer_load_ushort v120, v243, s[36:39], s28 offen offset:96 sc1
    buffer_load_ushort v124, v243, s[36:39], s28 offen offset:128 sc1
    s_mov_b32 s28, 12288
    buffer_load_ushort v109, v243, s[36:39], s28 offen offset:0 sc1
    buffer_load_ushort v113, v243, s[36:39], s28 offen offset:32 sc1
    buffer_load_ushort v117, v243, s[36:39], s28 offen offset:64 sc1
    buffer_load_ushort v121, v243, s[36:39], s28 offen offset:96 sc1
    buffer_load_ushort v125, v243, s[36:39], s28 offen offset:128 sc1
    s_waitcnt lgkmcnt(0)
    v_mfma_f32_16x16x32_bf16 v[16:19], v[192:195], v[156:159], v[16:19]
    v_mfma_f32_16x16x32_bf16 v[20:23], v[192:195], v[160:163], v[20:23]
    v_mfma_f32_16x16x32_bf16 v[24:27], v[192:195], v[164:167], v[24:27]
    v_mfma_f32_16x16x32_bf16 v[28:31], v[192:195], v[168:171], v[28:31]
    v_mfma_f32_16x16x32_bf16 v[32:35], v[192:195], v[172:175], v[32:35]
    v_mfma_f32_16x16x32_bf16 v[36:39], v[196:199], v[156:159], v[36:39]
    v_mfma_f32_16x16x32_bf16 v[40:43], v[196:199], v[160:163], v[40:43]
    v_mfma_f32_16x16x32_bf16 v[44:47], v[196:199], v[164:167], v[44:47]
    v_mfma_f32_16x16x32_bf16 v[48:51], v[196:199], v[168:171], v[48:51]
    v_mfma_f32_16x16x32_bf16 v[52:55], v[196:199], v[172:175], v[52:55]
    v_mfma_f32_16x16x32_bf16 v[56:59], v[200:203], v[156:159], v[56:59]
    v_mfma_f32_16x16x32_bf16 v[60:63], v[200:203], v[160:163], v[60:63]
    v_mfma_f32_16x16x32_bf16 v[64:67], v[200:203], v[164:167], v[64:67]
    v_mfma_f32_16x16x32_bf16 v[68:71], v[200:203], v[168:171], v[68:71]
    v_mfma_f32_16x16x32_bf16 v[72:75], v[200:203], v[172:175], v[72:75]
    v_mfma_f32_16x16x32_bf16 v[76:79], v[204:207], v[156:159], v[76:79]
    v_mfma_f32_16x16x32_bf16 v[80:83], v[204:207], v[160:163], v[80:83]
    v_mfma_f32_16x16x32_bf16 v[84:87], v[204:207], v[164:167], v[84:87]
    v_mfma_f32_16x16x32_bf16 v[88:91], v[204:207], v[168:171], v[88:91]
    v_mfma_f32_16x16x32_bf16 v[92:95], v[204:207], v[172:175], v[92:95]
    s_barrier
    s_mul_i32 s28, s3, 20480
    v_add_u32 v8, s28, v3
    ds_write_b128 v8, v[16:19] offset:0
    ds_write_b128 v8, v[20:23] offset:1024
    ds_write_b128 v8, v[24:27] offset:2048
    ds_write_b128 v8, v[28:31] offset:3072
    ds_write_b128 v8, v[32:35] offset:4096
    ds_write_b128 v8, v[36:39] offset:5120
    ds_write_b128 v8, v[40:43] offset:6144
    ds_write_b128 v8, v[44:47] offset:7168
    ds_write_b128 v8, v[48:51] offset:8192
    ds_write_b128 v8, v[52:55] offset:9216
    ds_write_b128 v8, v[56:59] offset:10240
    ds_write_b128 v8, v[60:63] offset:11264
    ds_write_b128 v8, v[64:67] offset:12288
    ds_write_b128 v8, v[68:71] offset:13312
    ds_write_b128 v8, v[72:75] offset:14336
    ds_write_b128 v8, v[76:79] offset:15360
    ds_write_b128 v8, v[80:83] offset:16384
    ds_write_b128 v8, v[84:87] offset:17408
    ds_write_b128 v8, v[88:91] offset:18432
    ds_write_b128 v8, v[92:95] offset:19456
    s_waitcnt vmcnt(0)
    v_sub_f32 v192, 1.0, v126
    v_cvt_pk_bf16_f32 v176, v192, v177
    v_lshlrev_b32 v192, 16, v176
    v_and_b32 v177, 0xffff0000, v176
    v_lshlrev_b32 v106, 16, v106
    v_lshlrev_b32 v193, 16, v96
    v_mul_f32 v136, v193, v106
    v_lshlrev_b32 v107, 16, v107
    v_and_b32 v193, 0xffff0000, v96
    v_mul_f32 v137, v193, v107
    v_lshlrev_b32 v108, 16, v108
    v_lshlrev_b32 v193, 16, v97
    v_mul_f32 v138, v193, v108
    v_lshlrev_b32 v109, 16, v109
    v_and_b32 v193, 0xffff0000, v97
    v_mul_f32 v139, v193, v109
    v_cvt_pk_bf16_f32 v176, v136, v137
    v_lshlrev_b32 v136, 16, v176
    v_and_b32 v137, 0xffff0000, v176
    v_cvt_pk_bf16_f32 v177, v138, v139
    v_lshlrev_b32 v138, 16, v177
    v_and_b32 v139, 0xffff0000, v177
    v_mul_f32 v136, v136, v192
    v_mul_f32 v137, v137, v192
    v_mul_f32 v138, v138, v192
    v_mul_f32 v139, v139, v192
    v_cvt_pk_bf16_f32 v176, v136, v137
    v_lshlrev_b32 v136, 16, v176
    v_and_b32 v137, 0xffff0000, v176
    v_cvt_pk_bf16_f32 v177, v138, v139
    v_lshlrev_b32 v138, 16, v177
    v_and_b32 v139, 0xffff0000, v177
    v_sub_f32 v192, 1.0, v127
    v_cvt_pk_bf16_f32 v176, v192, v177
    v_lshlrev_b32 v192, 16, v176
    v_and_b32 v177, 0xffff0000, v176
    v_lshlrev_b32 v110, 16, v110
    v_lshlrev_b32 v193, 16, v98
    v_mul_f32 v140, v193, v110
    v_lshlrev_b32 v111, 16, v111
    v_and_b32 v193, 0xffff0000, v98
    v_mul_f32 v141, v193, v111
    v_lshlrev_b32 v112, 16, v112
    v_lshlrev_b32 v193, 16, v99
    v_mul_f32 v142, v193, v112
    v_lshlrev_b32 v113, 16, v113
    v_and_b32 v193, 0xffff0000, v99
    v_mul_f32 v143, v193, v113
    v_cvt_pk_bf16_f32 v176, v140, v141
    v_lshlrev_b32 v140, 16, v176
    v_and_b32 v141, 0xffff0000, v176
    v_cvt_pk_bf16_f32 v177, v142, v143
    v_lshlrev_b32 v142, 16, v177
    v_and_b32 v143, 0xffff0000, v177
    v_mul_f32 v140, v140, v192
    v_mul_f32 v141, v141, v192
    v_mul_f32 v142, v142, v192
    v_mul_f32 v143, v143, v192
    v_cvt_pk_bf16_f32 v176, v140, v141
    v_lshlrev_b32 v140, 16, v176
    v_and_b32 v141, 0xffff0000, v176
    v_cvt_pk_bf16_f32 v177, v142, v143
    v_lshlrev_b32 v142, 16, v177
    v_and_b32 v143, 0xffff0000, v177
    v_sub_f32 v192, 1.0, v128
    v_cvt_pk_bf16_f32 v176, v192, v177
    v_lshlrev_b32 v192, 16, v176
    v_and_b32 v177, 0xffff0000, v176
    v_lshlrev_b32 v114, 16, v114
    v_lshlrev_b32 v193, 16, v100
    v_mul_f32 v144, v193, v114
    v_lshlrev_b32 v115, 16, v115
    v_and_b32 v193, 0xffff0000, v100
    v_mul_f32 v145, v193, v115
    v_lshlrev_b32 v116, 16, v116
    v_lshlrev_b32 v193, 16, v101
    v_mul_f32 v146, v193, v116
    v_lshlrev_b32 v117, 16, v117
    v_and_b32 v193, 0xffff0000, v101
    v_mul_f32 v147, v193, v117
    v_cvt_pk_bf16_f32 v176, v144, v145
    v_lshlrev_b32 v144, 16, v176
    v_and_b32 v145, 0xffff0000, v176
    v_cvt_pk_bf16_f32 v177, v146, v147
    v_lshlrev_b32 v146, 16, v177
    v_and_b32 v147, 0xffff0000, v177
    v_mul_f32 v144, v144, v192
    v_mul_f32 v145, v145, v192
    v_mul_f32 v146, v146, v192
    v_mul_f32 v147, v147, v192
    v_cvt_pk_bf16_f32 v176, v144, v145
    v_lshlrev_b32 v144, 16, v176
    v_and_b32 v145, 0xffff0000, v176
    v_cvt_pk_bf16_f32 v177, v146, v147
    v_lshlrev_b32 v146, 16, v177
    v_and_b32 v147, 0xffff0000, v177
    v_sub_f32 v192, 1.0, v129
    v_cvt_pk_bf16_f32 v176, v192, v177
    v_lshlrev_b32 v192, 16, v176
    v_and_b32 v177, 0xffff0000, v176
    v_lshlrev_b32 v118, 16, v118
    v_lshlrev_b32 v193, 16, v102
    v_mul_f32 v148, v193, v118
    v_lshlrev_b32 v119, 16, v119
    v_and_b32 v193, 0xffff0000, v102
    v_mul_f32 v149, v193, v119
    v_lshlrev_b32 v120, 16, v120
    v_lshlrev_b32 v193, 16, v103
    v_mul_f32 v150, v193, v120
    v_lshlrev_b32 v121, 16, v121
    v_and_b32 v193, 0xffff0000, v103
    v_mul_f32 v151, v193, v121
    v_cvt_pk_bf16_f32 v176, v148, v149
    v_lshlrev_b32 v148, 16, v176
    v_and_b32 v149, 0xffff0000, v176
    v_cvt_pk_bf16_f32 v177, v150, v151
    v_lshlrev_b32 v150, 16, v177
    v_and_b32 v151, 0xffff0000, v177
    v_mul_f32 v148, v148, v192
    v_mul_f32 v149, v149, v192
    v_mul_f32 v150, v150, v192
    v_mul_f32 v151, v151, v192
    v_cvt_pk_bf16_f32 v176, v148, v149
    v_lshlrev_b32 v148, 16, v176
    v_and_b32 v149, 0xffff0000, v176
    v_cvt_pk_bf16_f32 v177, v150, v151
    v_lshlrev_b32 v150, 16, v177
    v_and_b32 v151, 0xffff0000, v177
    v_sub_f32 v192, 1.0, v130
    v_cvt_pk_bf16_f32 v176, v192, v177
    v_lshlrev_b32 v192, 16, v176
    v_and_b32 v177, 0xffff0000, v176
    v_lshlrev_b32 v122, 16, v122
    v_lshlrev_b32 v193, 16, v104
    v_mul_f32 v152, v193, v122
    v_lshlrev_b32 v123, 16, v123
    v_and_b32 v193, 0xffff0000, v104
    v_mul_f32 v153, v193, v123
    v_lshlrev_b32 v124, 16, v124
    v_lshlrev_b32 v193, 16, v105
    v_mul_f32 v154, v193, v124
    v_lshlrev_b32 v125, 16, v125
    v_and_b32 v193, 0xffff0000, v105
    v_mul_f32 v155, v193, v125
    v_cvt_pk_bf16_f32 v176, v152, v153
    v_lshlrev_b32 v152, 16, v176
    v_and_b32 v153, 0xffff0000, v176
    v_cvt_pk_bf16_f32 v177, v154, v155
    v_lshlrev_b32 v154, 16, v177
    v_and_b32 v155, 0xffff0000, v177
    v_mul_f32 v152, v152, v192
    v_mul_f32 v153, v153, v192
    v_mul_f32 v154, v154, v192
    v_mul_f32 v155, v155, v192
    v_cvt_pk_bf16_f32 v176, v152, v153
    v_lshlrev_b32 v152, 16, v176
    v_and_b32 v153, 0xffff0000, v176
    v_cvt_pk_bf16_f32 v177, v154, v155
    v_lshlrev_b32 v154, 16, v177
    v_and_b32 v155, 0xffff0000, v177
    s_waitcnt lgkmcnt(0)
    s_barrier
    s_mul_i32 s28, s3, 5120
    v_add_u32 v8, s28, v3
    v_add_u32 v9, 40960, v8
    ds_read_b128 v[16:19], v8 offset:0
    ds_read_b128 v[36:39], v8 offset:20480
    ds_read_b128 v[56:59], v9 offset:0
    ds_read_b128 v[76:79], v9 offset:20480
    ds_read_b128 v[20:23], v8 offset:1024
    ds_read_b128 v[40:43], v8 offset:21504
    ds_read_b128 v[60:63], v9 offset:1024
    ds_read_b128 v[80:83], v9 offset:21504
    ds_read_b128 v[24:27], v8 offset:2048
    ds_read_b128 v[44:47], v8 offset:22528
    ds_read_b128 v[64:67], v9 offset:2048
    ds_read_b128 v[84:87], v9 offset:22528
    ds_read_b128 v[28:31], v8 offset:3072
    ds_read_b128 v[48:51], v8 offset:23552
    ds_read_b128 v[68:71], v9 offset:3072
    ds_read_b128 v[88:91], v9 offset:23552
    ds_read_b128 v[32:35], v8 offset:4096
    ds_read_b128 v[52:55], v8 offset:24576
    ds_read_b128 v[72:75], v9 offset:4096
    ds_read_b128 v[92:95], v9 offset:24576
    s_waitcnt lgkmcnt(15)
    v_add_f32 v16, v16, v36
    v_add_f32 v56, v56, v76
    v_add_f32 v16, v16, v56
    v_add_f32 v17, v17, v37
    v_add_f32 v57, v57, v77
    v_add_f32 v17, v17, v57
    v_add_f32 v18, v18, v38
    v_add_f32 v58, v58, v78
    v_add_f32 v18, v18, v58
    v_add_f32 v19, v19, v39
    v_add_f32 v59, v59, v79
    v_add_f32 v19, v19, v59
    v_cvt_pk_bf16_f32 v176, v16, v17
    v_lshlrev_b32 v16, 16, v176
    v_and_b32 v17, 0xffff0000, v176
    v_cvt_pk_bf16_f32 v177, v18, v19
    v_lshlrev_b32 v18, 16, v177
    v_and_b32 v19, 0xffff0000, v177
    v_mul_f32 v16, v16, v126
    v_mul_f32 v17, v17, v126
    v_mul_f32 v18, v18, v126
    v_mul_f32 v19, v19, v126
    v_cvt_pk_bf16_f32 v176, v16, v17
    v_lshlrev_b32 v16, 16, v176
    v_and_b32 v17, 0xffff0000, v176
    v_cvt_pk_bf16_f32 v177, v18, v19
    v_lshlrev_b32 v18, 16, v177
    v_and_b32 v19, 0xffff0000, v177
    v_add_f32 v16, v16, v136
    v_add_f32 v17, v17, v137
    v_add_f32 v18, v18, v138
    v_add_f32 v19, v19, v139
    v_cvt_pk_bf16_f32 v178, v16, v17
    v_cvt_pk_bf16_f32 v179, v18, v19
    s_mov_b32 s28, 0
    buffer_store_dwordx2 v[178:179], v242, s[60:63], s28 offen
    s_waitcnt lgkmcnt(12)
    v_add_f32 v20, v20, v40
    v_add_f32 v60, v60, v80
    v_add_f32 v20, v20, v60
    v_add_f32 v21, v21, v41
    v_add_f32 v61, v61, v81
    v_add_f32 v21, v21, v61
    v_add_f32 v22, v22, v42
    v_add_f32 v62, v62, v82
    v_add_f32 v22, v22, v62
    v_add_f32 v23, v23, v43
    v_add_f32 v63, v63, v83
    v_add_f32 v23, v23, v63
    v_cvt_pk_bf16_f32 v176, v20, v21
    v_lshlrev_b32 v20, 16, v176
    v_and_b32 v21, 0xffff0000, v176
    v_cvt_pk_bf16_f32 v177, v22, v23
    v_lshlrev_b32 v22, 16, v177
    v_and_b32 v23, 0xffff0000, v177
    v_mul_f32 v20, v20, v127
    v_mul_f32 v21, v21, v127
    v_mul_f32 v22, v22, v127
    v_mul_f32 v23, v23, v127
    v_cvt_pk_bf16_f32 v176, v20, v21
    v_lshlrev_b32 v20, 16, v176
    v_and_b32 v21, 0xffff0000, v176
    v_cvt_pk_bf16_f32 v177, v22, v23
    v_lshlrev_b32 v22, 16, v177
    v_and_b32 v23, 0xffff0000, v177
    v_add_f32 v20, v20, v140
    v_add_f32 v21, v21, v141
    v_add_f32 v22, v22, v142
    v_add_f32 v23, v23, v143
    v_cvt_pk_bf16_f32 v180, v20, v21
    v_cvt_pk_bf16_f32 v181, v22, v23
    s_mov_b32 s28, 20480
    buffer_store_dwordx2 v[180:181], v242, s[60:63], s28 offen
    s_waitcnt lgkmcnt(8)
    v_add_f32 v24, v24, v44
    v_add_f32 v64, v64, v84
    v_add_f32 v24, v24, v64
    v_add_f32 v25, v25, v45
    v_add_f32 v65, v65, v85
    v_add_f32 v25, v25, v65
    v_add_f32 v26, v26, v46
    v_add_f32 v66, v66, v86
    v_add_f32 v26, v26, v66
    v_add_f32 v27, v27, v47
    v_add_f32 v67, v67, v87
    v_add_f32 v27, v27, v67
    v_cvt_pk_bf16_f32 v176, v24, v25
    v_lshlrev_b32 v24, 16, v176
    v_and_b32 v25, 0xffff0000, v176
    v_cvt_pk_bf16_f32 v177, v26, v27
    v_lshlrev_b32 v26, 16, v177
    v_and_b32 v27, 0xffff0000, v177
    v_mul_f32 v24, v24, v128
    v_mul_f32 v25, v25, v128
    v_mul_f32 v26, v26, v128
    v_mul_f32 v27, v27, v128
    v_cvt_pk_bf16_f32 v176, v24, v25
    v_lshlrev_b32 v24, 16, v176
    v_and_b32 v25, 0xffff0000, v176
    v_cvt_pk_bf16_f32 v177, v26, v27
    v_lshlrev_b32 v26, 16, v177
    v_and_b32 v27, 0xffff0000, v177
    v_add_f32 v24, v24, v144
    v_add_f32 v25, v25, v145
    v_add_f32 v26, v26, v146
    v_add_f32 v27, v27, v147
    v_cvt_pk_bf16_f32 v182, v24, v25
    v_cvt_pk_bf16_f32 v183, v26, v27
    s_mov_b32 s28, 40960
    buffer_store_dwordx2 v[182:183], v242, s[60:63], s28 offen
    s_waitcnt lgkmcnt(4)
    v_add_f32 v28, v28, v48
    v_add_f32 v68, v68, v88
    v_add_f32 v28, v28, v68
    v_add_f32 v29, v29, v49
    v_add_f32 v69, v69, v89
    v_add_f32 v29, v29, v69
    v_add_f32 v30, v30, v50
    v_add_f32 v70, v70, v90
    v_add_f32 v30, v30, v70
    v_add_f32 v31, v31, v51
    v_add_f32 v71, v71, v91
    v_add_f32 v31, v31, v71
    v_cvt_pk_bf16_f32 v176, v28, v29
    v_lshlrev_b32 v28, 16, v176
    v_and_b32 v29, 0xffff0000, v176
    v_cvt_pk_bf16_f32 v177, v30, v31
    v_lshlrev_b32 v30, 16, v177
    v_and_b32 v31, 0xffff0000, v177
    v_mul_f32 v28, v28, v129
    v_mul_f32 v29, v29, v129
    v_mul_f32 v30, v30, v129
    v_mul_f32 v31, v31, v129
    v_cvt_pk_bf16_f32 v176, v28, v29
    v_lshlrev_b32 v28, 16, v176
    v_and_b32 v29, 0xffff0000, v176
    v_cvt_pk_bf16_f32 v177, v30, v31
    v_lshlrev_b32 v30, 16, v177
    v_and_b32 v31, 0xffff0000, v177
    v_add_f32 v28, v28, v148
    v_add_f32 v29, v29, v149
    v_add_f32 v30, v30, v150
    v_add_f32 v31, v31, v151
    v_cvt_pk_bf16_f32 v184, v28, v29
    v_cvt_pk_bf16_f32 v185, v30, v31
    s_mov_b32 s28, 61440
    buffer_store_dwordx2 v[184:185], v242, s[60:63], s28 offen
    s_waitcnt lgkmcnt(0)
    v_add_f32 v32, v32, v52
    v_add_f32 v72, v72, v92
    v_add_f32 v32, v32, v72
    v_add_f32 v33, v33, v53
    v_add_f32 v73, v73, v93
    v_add_f32 v33, v33, v73
    v_add_f32 v34, v34, v54
    v_add_f32 v74, v74, v94
    v_add_f32 v34, v34, v74
    v_add_f32 v35, v35, v55
    v_add_f32 v75, v75, v95
    v_add_f32 v35, v35, v75
    v_cvt_pk_bf16_f32 v176, v32, v33
    v_lshlrev_b32 v32, 16, v176
    v_and_b32 v33, 0xffff0000, v176
    v_cvt_pk_bf16_f32 v177, v34, v35
    v_lshlrev_b32 v34, 16, v177
    v_and_b32 v35, 0xffff0000, v177
    v_mul_f32 v32, v32, v130
    v_mul_f32 v33, v33, v130
    v_mul_f32 v34, v34, v130
    v_mul_f32 v35, v35, v130
    v_cvt_pk_bf16_f32 v176, v32, v33
    v_lshlrev_b32 v32, 16, v176
    v_and_b32 v33, 0xffff0000, v176
    v_cvt_pk_bf16_f32 v177, v34, v35
    v_lshlrev_b32 v34, 16, v177
    v_and_b32 v35, 0xffff0000, v177
    v_add_f32 v32, v32, v152
    v_add_f32 v33, v33, v153
    v_add_f32 v34, v34, v154
    v_add_f32 v35, v35, v155
    v_cvt_pk_bf16_f32 v186, v32, v33
    v_cvt_pk_bf16_f32 v187, v34, v35
    s_mov_b32 s28, 81920
    buffer_store_dwordx2 v[186:187], v242, s[60:63], s28 offen
    s_branch p4_fin_118
p4_slowpoll_120:
    s_mov_b32 s31, 0
p4_pl_123:
    s_sleep 8
    buffer_load_dword v10, v244, s[92:95], 0 offen sc1
    s_waitcnt vmcnt(0)
    v_cmp_ne_u32 vcc, v10, v13
    s_cbranch_vccz p4_pollok_121
    s_add_u32 s31, s31, 1
    s_cmp_lt_u32 s31, 524288
    s_cbranch_scc1 p4_pl_123
    s_branch p4_pollok_121
p4_nq6_119:
    s_mov_b32 s96, 0
    s_mov_b32 s97, 131072
    s_mov_b32 s98, 262144
    s_mov_b32 s99, 393216
    s_mov_b32 s54, 524288
    s_mov_b32 s55, 655360
    buffer_load_dwordx4 v[112:115], v4, s[16:19], s96 offen offset:0 sc1
    buffer_load_dwordx4 v[116:119], v4, s[16:19], s97 offen offset:0 sc1
    buffer_load_dwordx4 v[120:123], v4, s[16:19], s98 offen offset:0 sc1
    buffer_load_dwordx4 v[124:127], v4, s[16:19], s99 offen offset:0 sc1
    buffer_load_dwordx4 v[128:131], v4, s[16:19], s54 offen offset:0 sc1
    buffer_load_dwordx4 v[132:135], v4, s[16:19], s55 offen offset:0 sc1
    buffer_load_dwordx4 v[136:139], v4, s[16:19], s96 offen offset:1024 sc1
    buffer_load_dwordx4 v[140:143], v4, s[16:19], s97 offen offset:1024 sc1
    buffer_load_dwordx4 v[144:147], v4, s[16:19], s98 offen offset:1024 sc1
    buffer_load_dwordx4 v[148:151], v4, s[16:19], s99 offen offset:1024 sc1
    buffer_load_dwordx4 v[152:155], v4, s[16:19], s54 offen offset:1024 sc1
    buffer_load_dwordx4 v[156:159], v4, s[16:19], s55 offen offset:1024 sc1
    buffer_load_dwordx4 v[160:163], v4, s[16:19], s96 offen offset:2048 sc1
    buffer_load_dwordx4 v[164:167], v4, s[16:19], s97 offen offset:2048 sc1
    buffer_load_dwordx4 v[168:171], v4, s[16:19], s98 offen offset:2048 sc1
    buffer_load_dwordx4 v[172:175], v4, s[16:19], s99 offen offset:2048 sc1
    buffer_load_dwordx4 v[176:179], v4, s[16:19], s54 offen offset:2048 sc1
    buffer_load_dwordx4 v[180:183], v4, s[16:19], s55 offen offset:2048 sc1
    buffer_load_dwordx4 v[184:187], v4, s[16:19], s96 offen offset:3072 sc1
    buffer_load_dwordx4 v[188:191], v4, s[16:19], s97 offen offset:3072 sc1
    buffer_load_dwordx4 v[192:195], v4, s[16:19], s98 offen offset:3072 sc1
    buffer_load_dwordx4 v[196:199], v4, s[16:19], s99 offen offset:3072 sc1
    buffer_load_dwordx4 v[200:203], v4, s[16:19], s54 offen offset:3072 sc1
    buffer_load_dwordx4 v[204:207], v4, s[16:19], s55 offen offset:3072 sc1
    s_waitcnt vmcnt(24)
    ds_read_b64_tr_b16 v[208:209], v6 offset:0
    ds_read_b64_tr_b16 v[210:211], v6 offset:2048
    ds_read_b64_tr_b16 v[212:213], v7 offset:0
    ds_read_b64_tr_b16 v[214:215], v7 offset:2048
    ds_read_b64_tr_b16 v[216:217], v8 offset:0
    ds_read_b64_tr_b16 v[218:219], v8 offset:2048
    ds_read_b64_tr_b16 v[220:221], v9 offset:0
    ds_read_b64_tr_b16 v[222:223], v9 offset:2048
    s_mov_b32 s31, 0
    v_add_u32 v4, 4096, v4
    s_add_u32 s33, s33, 163840
    s_waitcnt vmcnt(18)
    s_waitcnt lgkmcnt(0)
    v_mfma_f32_16x16x32_bf16 v[16:19], v[208:211], v[112:115], 0
    ds_read_b64_tr_b16 v[224:225], v6 offset:4096
    ds_read_b64_tr_b16 v[226:227], v6 offset:6144
    v_mfma_f32_16x16x32_bf16 v[20:23], v[208:211], v[116:119], 0
    v_mfma_f32_16x16x32_bf16 v[24:27], v[208:211], v[120:123], 0
    s_add_u32 m0, s59, 0
    s_add_u32 s35, s33, 0
    buffer_load_dwordx4 v5, s[20:23], s35 offen offset:0 lds
    v_mfma_f32_16x16x32_bf16 v[28:31], v[208:211], v[124:127], 0
    v_mfma_f32_16x16x32_bf16 v[32:35], v[208:211], v[128:131], 0
    s_add_u32 s35, s33, 9216
    buffer_load_dwordx4 v5, s[20:23], s35 offen offset:1024 lds
    v_mfma_f32_16x16x32_bf16 v[36:39], v[208:211], v[132:135], 0
    v_mfma_f32_16x16x32_bf16 v[40:43], v[212:215], v[112:115], 0
    ds_read_b64_tr_b16 v[228:229], v7 offset:4096
    ds_read_b64_tr_b16 v[230:231], v7 offset:6144
    v_mfma_f32_16x16x32_bf16 v[44:47], v[212:215], v[116:119], 0
    v_mfma_f32_16x16x32_bf16 v[48:51], v[212:215], v[120:123], 0
    s_add_u32 s35, s33, 18432
    buffer_load_dwordx4 v5, s[20:23], s35 offen offset:2048 lds
    v_mfma_f32_16x16x32_bf16 v[52:55], v[212:215], v[124:127], 0
    v_mfma_f32_16x16x32_bf16 v[56:59], v[212:215], v[128:131], 0
    s_add_u32 s35, s33, 27648
    buffer_load_dwordx4 v5, s[20:23], s35 offen offset:3072 lds
    v_mfma_f32_16x16x32_bf16 v[60:63], v[212:215], v[132:135], 0
    v_mfma_f32_16x16x32_bf16 v[64:67], v[216:219], v[112:115], 0
    ds_read_b64_tr_b16 v[232:233], v8 offset:4096
    ds_read_b64_tr_b16 v[234:235], v8 offset:6144
    v_mfma_f32_16x16x32_bf16 v[68:71], v[216:219], v[116:119], 0
    v_mfma_f32_16x16x32_bf16 v[72:75], v[216:219], v[120:123], 0
    v_mfma_f32_16x16x32_bf16 v[76:79], v[216:219], v[124:127], 0
    v_mfma_f32_16x16x32_bf16 v[80:83], v[216:219], v[128:131], 0
    v_mfma_f32_16x16x32_bf16 v[84:87], v[216:219], v[132:135], 0
    v_mfma_f32_16x16x32_bf16 v[88:91], v[220:223], v[112:115], 0
    ds_read_b64_tr_b16 v[236:237], v9 offset:4096
    ds_read_b64_tr_b16 v[238:239], v9 offset:6144
    buffer_load_dwordx4 v[112:115], v4, s[16:19], s96 offen offset:0 sc1
    v_mfma_f32_16x16x32_bf16 v[92:95], v[220:223], v[116:119], 0
    buffer_load_dwordx4 v[116:119], v4, s[16:19], s97 offen offset:0 sc1
    v_mfma_f32_16x16x32_bf16 v[96:99], v[220:223], v[120:123], 0
    buffer_load_dwordx4 v[120:123], v4, s[16:19], s98 offen offset:0 sc1
    v_mfma_f32_16x16x32_bf16 v[100:103], v[220:223], v[124:127], 0
    buffer_load_dwordx4 v[124:127], v4, s[16:19], s99 offen offset:0 sc1
    v_mfma_f32_16x16x32_bf16 v[104:107], v[220:223], v[128:131], 0
    buffer_load_dwordx4 v[128:131], v4, s[16:19], s54 offen offset:0 sc1
    v_mfma_f32_16x16x32_bf16 v[108:111], v[220:223], v[132:135], 0
    buffer_load_dwordx4 v[132:135], v4, s[16:19], s55 offen offset:0 sc1
    s_waitcnt vmcnt(22)
    s_waitcnt lgkmcnt(0)
    v_mfma_f32_16x16x32_bf16 v[16:19], v[224:227], v[136:139], v[16:19]
    ds_read_b64_tr_b16 v[208:209], v6 offset:8192
    ds_read_b64_tr_b16 v[210:211], v6 offset:10240
    v_mfma_f32_16x16x32_bf16 v[20:23], v[224:227], v[140:143], v[20:23]
    v_mfma_f32_16x16x32_bf16 v[24:27], v[224:227], v[144:147], v[24:27]
    s_add_u32 m0, s59, 4096
    s_add_u32 s35, s33, 40960
    buffer_load_dwordx4 v5, s[20:23], s35 offen offset:0 lds
    v_mfma_f32_16x16x32_bf16 v[28:31], v[224:227], v[148:151], v[28:31]
    v_mfma_f32_16x16x32_bf16 v[32:35], v[224:227], v[152:155], v[32:35]
    s_add_u32 s35, s33, 50176
    buffer_load_dwordx4 v5, s[20:23], s35 offen offset:1024 lds
    v_mfma_f32_16x16x32_bf16 v[36:39], v[224:227], v[156:159], v[36:39]
    v_mfma_f32_16x16x32_bf16 v[40:43], v[228:231], v[136:139], v[40:43]
    ds_read_b64_tr_b16 v[212:213], v7 offset:8192
    ds_read_b64_tr_b16 v[214:215], v7 offset:10240
    v_mfma_f32_16x16x32_bf16 v[44:47], v[228:231], v[140:143], v[44:47]
    v_mfma_f32_16x16x32_bf16 v[48:51], v[228:231], v[144:147], v[48:51]
    s_add_u32 s35, s33, 59392
    buffer_load_dwordx4 v5, s[20:23], s35 offen offset:2048 lds
    v_mfma_f32_16x16x32_bf16 v[52:55], v[228:231], v[148:151], v[52:55]
    v_mfma_f32_16x16x32_bf16 v[56:59], v[228:231], v[152:155], v[56:59]
    s_add_u32 s35, s33, 68608
    buffer_load_dwordx4 v5, s[20:23], s35 offen offset:3072 lds
    v_mfma_f32_16x16x32_bf16 v[60:63], v[228:231], v[156:159], v[60:63]
    v_mfma_f32_16x16x32_bf16 v[64:67], v[232:235], v[136:139], v[64:67]
    ds_read_b64_tr_b16 v[216:217], v8 offset:8192
    ds_read_b64_tr_b16 v[218:219], v8 offset:10240
    v_mfma_f32_16x16x32_bf16 v[68:71], v[232:235], v[140:143], v[68:71]
    v_mfma_f32_16x16x32_bf16 v[72:75], v[232:235], v[144:147], v[72:75]
    v_mfma_f32_16x16x32_bf16 v[76:79], v[232:235], v[148:151], v[76:79]
    v_mfma_f32_16x16x32_bf16 v[80:83], v[232:235], v[152:155], v[80:83]
    v_mfma_f32_16x16x32_bf16 v[84:87], v[232:235], v[156:159], v[84:87]
    v_mfma_f32_16x16x32_bf16 v[88:91], v[236:239], v[136:139], v[88:91]
    ds_read_b64_tr_b16 v[220:221], v9 offset:8192
    ds_read_b64_tr_b16 v[222:223], v9 offset:10240
    buffer_load_dwordx4 v[136:139], v4, s[16:19], s96 offen offset:1024 sc1
    v_mfma_f32_16x16x32_bf16 v[92:95], v[236:239], v[140:143], v[92:95]
    buffer_load_dwordx4 v[140:143], v4, s[16:19], s97 offen offset:1024 sc1
    v_mfma_f32_16x16x32_bf16 v[96:99], v[236:239], v[144:147], v[96:99]
    buffer_load_dwordx4 v[144:147], v4, s[16:19], s98 offen offset:1024 sc1
    v_mfma_f32_16x16x32_bf16 v[100:103], v[236:239], v[148:151], v[100:103]
    buffer_load_dwordx4 v[148:151], v4, s[16:19], s99 offen offset:1024 sc1
    v_mfma_f32_16x16x32_bf16 v[104:107], v[236:239], v[152:155], v[104:107]
    buffer_load_dwordx4 v[152:155], v4, s[16:19], s54 offen offset:1024 sc1
    v_mfma_f32_16x16x32_bf16 v[108:111], v[236:239], v[156:159], v[108:111]
    buffer_load_dwordx4 v[156:159], v4, s[16:19], s55 offen offset:1024 sc1
    s_waitcnt vmcnt(26)
    s_waitcnt lgkmcnt(0)
    v_mfma_f32_16x16x32_bf16 v[16:19], v[208:211], v[160:163], v[16:19]
    ds_read_b64_tr_b16 v[224:225], v6 offset:12288
    ds_read_b64_tr_b16 v[226:227], v6 offset:14336
    v_mfma_f32_16x16x32_bf16 v[20:23], v[208:211], v[164:167], v[20:23]
    v_mfma_f32_16x16x32_bf16 v[24:27], v[208:211], v[168:171], v[24:27]
    s_add_u32 m0, s59, 8192
    s_add_u32 s35, s33, 81920
    buffer_load_dwordx4 v5, s[20:23], s35 offen offset:0 lds
    v_mfma_f32_16x16x32_bf16 v[28:31], v[208:211], v[172:175], v[28:31]
    v_mfma_f32_16x16x32_bf16 v[32:35], v[208:211], v[176:179], v[32:35]
    s_add_u32 s35, s33, 91136
    buffer_load_dwordx4 v5, s[20:23], s35 offen offset:1024 lds
    v_mfma_f32_16x16x32_bf16 v[36:39], v[208:211], v[180:183], v[36:39]
    v_mfma_f32_16x16x32_bf16 v[40:43], v[212:215], v[160:163], v[40:43]
    ds_read_b64_tr_b16 v[228:229], v7 offset:12288
    ds_read_b64_tr_b16 v[230:231], v7 offset:14336
    v_mfma_f32_16x16x32_bf16 v[44:47], v[212:215], v[164:167], v[44:47]
    v_mfma_f32_16x16x32_bf16 v[48:51], v[212:215], v[168:171], v[48:51]
    s_add_u32 s35, s33, 100352
    buffer_load_dwordx4 v5, s[20:23], s35 offen offset:2048 lds
    v_mfma_f32_16x16x32_bf16 v[52:55], v[212:215], v[172:175], v[52:55]
    v_mfma_f32_16x16x32_bf16 v[56:59], v[212:215], v[176:179], v[56:59]
    s_add_u32 s35, s33, 109568
    buffer_load_dwordx4 v5, s[20:23], s35 offen offset:3072 lds
    v_mfma_f32_16x16x32_bf16 v[60:63], v[212:215], v[180:183], v[60:63]
    v_mfma_f32_16x16x32_bf16 v[64:67], v[216:219], v[160:163], v[64:67]
    ds_read_b64_tr_b16 v[232:233], v8 offset:12288
    ds_read_b64_tr_b16 v[234:235], v8 offset:14336
    v_mfma_f32_16x16x32_bf16 v[68:71], v[216:219], v[164:167], v[68:71]
    v_mfma_f32_16x16x32_bf16 v[72:75], v[216:219], v[168:171], v[72:75]
    v_mfma_f32_16x16x32_bf16 v[76:79], v[216:219], v[172:175], v[76:79]
    v_mfma_f32_16x16x32_bf16 v[80:83], v[216:219], v[176:179], v[80:83]
    v_mfma_f32_16x16x32_bf16 v[84:87], v[216:219], v[180:183], v[84:87]
    v_mfma_f32_16x16x32_bf16 v[88:91], v[220:223], v[160:163], v[88:91]
    ds_read_b64_tr_b16 v[236:237], v9 offset:12288
    ds_read_b64_tr_b16 v[238:239], v9 offset:14336
    buffer_load_dwordx4 v[160:163], v4, s[16:19], s96 offen offset:2048 sc1
    v_mfma_f32_16x16x32_bf16 v[92:95], v[220:223], v[164:167], v[92:95]
    buffer_load_dwordx4 v[164:167], v4, s[16:19], s97 offen offset:2048 sc1
    v_mfma_f32_16x16x32_bf16 v[96:99], v[220:223], v[168:171], v[96:99]
    buffer_load_dwordx4 v[168:171], v4, s[16:19], s98 offen offset:2048 sc1
    v_mfma_f32_16x16x32_bf16 v[100:103], v[220:223], v[172:175], v[100:103]
    buffer_load_dwordx4 v[172:175], v4, s[16:19], s99 offen offset:2048 sc1
    v_mfma_f32_16x16x32_bf16 v[104:107], v[220:223], v[176:179], v[104:107]
    buffer_load_dwordx4 v[176:179], v4, s[16:19], s54 offen offset:2048 sc1
    v_mfma_f32_16x16x32_bf16 v[108:111], v[220:223], v[180:183], v[108:111]
    buffer_load_dwordx4 v[180:183], v4, s[16:19], s55 offen offset:2048 sc1
    s_waitcnt vmcnt(26)
    s_waitcnt lgkmcnt(0)
    v_mfma_f32_16x16x32_bf16 v[16:19], v[224:227], v[184:187], v[16:19]
    ds_read_b64_tr_b16 v[208:209], v6 offset:0
    ds_read_b64_tr_b16 v[210:211], v6 offset:2048
    v_mfma_f32_16x16x32_bf16 v[20:23], v[224:227], v[188:191], v[20:23]
    v_mfma_f32_16x16x32_bf16 v[24:27], v[224:227], v[192:195], v[24:27]
    s_add_u32 m0, s59, 12288
    s_add_u32 s35, s33, 122880
    buffer_load_dwordx4 v5, s[20:23], s35 offen offset:0 lds
    v_mfma_f32_16x16x32_bf16 v[28:31], v[224:227], v[196:199], v[28:31]
    v_mfma_f32_16x16x32_bf16 v[32:35], v[224:227], v[200:203], v[32:35]
    s_add_u32 s35, s33, 132096
    buffer_load_dwordx4 v5, s[20:23], s35 offen offset:1024 lds
    v_mfma_f32_16x16x32_bf16 v[36:39], v[224:227], v[204:207], v[36:39]
    v_mfma_f32_16x16x32_bf16 v[40:43], v[228:231], v[184:187], v[40:43]
    ds_read_b64_tr_b16 v[212:213], v7 offset:0
    ds_read_b64_tr_b16 v[214:215], v7 offset:2048
    v_mfma_f32_16x16x32_bf16 v[44:47], v[228:231], v[188:191], v[44:47]
    v_mfma_f32_16x16x32_bf16 v[48:51], v[228:231], v[192:195], v[48:51]
    s_add_u32 s35, s33, 141312
    buffer_load_dwordx4 v5, s[20:23], s35 offen offset:2048 lds
    v_mfma_f32_16x16x32_bf16 v[52:55], v[228:231], v[196:199], v[52:55]
    v_mfma_f32_16x16x32_bf16 v[56:59], v[228:231], v[200:203], v[56:59]
    s_add_u32 s35, s33, 150528
    buffer_load_dwordx4 v5, s[20:23], s35 offen offset:3072 lds
    v_mfma_f32_16x16x32_bf16 v[60:63], v[228:231], v[204:207], v[60:63]
    v_mfma_f32_16x16x32_bf16 v[64:67], v[232:235], v[184:187], v[64:67]
    ds_read_b64_tr_b16 v[216:217], v8 offset:0
    ds_read_b64_tr_b16 v[218:219], v8 offset:2048
    v_mfma_f32_16x16x32_bf16 v[68:71], v[232:235], v[188:191], v[68:71]
    v_mfma_f32_16x16x32_bf16 v[72:75], v[232:235], v[192:195], v[72:75]
    v_mfma_f32_16x16x32_bf16 v[76:79], v[232:235], v[196:199], v[76:79]
    v_mfma_f32_16x16x32_bf16 v[80:83], v[232:235], v[200:203], v[80:83]
    v_mfma_f32_16x16x32_bf16 v[84:87], v[232:235], v[204:207], v[84:87]
    v_mfma_f32_16x16x32_bf16 v[88:91], v[236:239], v[184:187], v[88:91]
    ds_read_b64_tr_b16 v[220:221], v9 offset:0
    ds_read_b64_tr_b16 v[222:223], v9 offset:2048
    buffer_load_dwordx4 v[184:187], v4, s[16:19], s96 offen offset:3072 sc1
    v_mfma_f32_16x16x32_bf16 v[92:95], v[236:239], v[188:191], v[92:95]
    buffer_load_dwordx4 v[188:191], v4, s[16:19], s97 offen offset:3072 sc1
    v_mfma_f32_16x16x32_bf16 v[96:99], v[236:239], v[192:195], v[96:99]
    buffer_load_dwordx4 v[192:195], v4, s[16:19], s98 offen offset:3072 sc1
    v_mfma_f32_16x16x32_bf16 v[100:103], v[236:239], v[196:199], v[100:103]
    buffer_load_dwordx4 v[196:199], v4, s[16:19], s99 offen offset:3072 sc1
    v_mfma_f32_16x16x32_bf16 v[104:107], v[236:239], v[200:203], v[104:107]
    buffer_load_dwordx4 v[200:203], v4, s[16:19], s54 offen offset:3072 sc1
    v_mfma_f32_16x16x32_bf16 v[108:111], v[236:239], v[204:207], v[108:111]
    buffer_load_dwordx4 v[204:207], v4, s[16:19], s55 offen offset:3072 sc1
p4_loop_126:
    v_add_u32 v4, 4096, v4
    s_add_u32 s33, s33, 163840
    s_waitcnt vmcnt(26)
    s_waitcnt lgkmcnt(0)
    v_mfma_f32_16x16x32_bf16 v[16:19], v[208:211], v[112:115], v[16:19]
    ds_read_b64_tr_b16 v[224:225], v6 offset:4096
    ds_read_b64_tr_b16 v[226:227], v6 offset:6144
    v_mfma_f32_16x16x32_bf16 v[20:23], v[208:211], v[116:119], v[20:23]
    v_mfma_f32_16x16x32_bf16 v[24:27], v[208:211], v[120:123], v[24:27]
    s_add_u32 m0, s59, 0
    s_add_u32 s35, s33, 0
    buffer_load_dwordx4 v5, s[20:23], s35 offen offset:0 lds
    v_mfma_f32_16x16x32_bf16 v[28:31], v[208:211], v[124:127], v[28:31]
    v_mfma_f32_16x16x32_bf16 v[32:35], v[208:211], v[128:131], v[32:35]
    s_add_u32 s35, s33, 9216
    buffer_load_dwordx4 v5, s[20:23], s35 offen offset:1024 lds
    v_mfma_f32_16x16x32_bf16 v[36:39], v[208:211], v[132:135], v[36:39]
    v_mfma_f32_16x16x32_bf16 v[40:43], v[212:215], v[112:115], v[40:43]
    ds_read_b64_tr_b16 v[228:229], v7 offset:4096
    ds_read_b64_tr_b16 v[230:231], v7 offset:6144
    v_mfma_f32_16x16x32_bf16 v[44:47], v[212:215], v[116:119], v[44:47]
    v_mfma_f32_16x16x32_bf16 v[48:51], v[212:215], v[120:123], v[48:51]
    s_add_u32 s35, s33, 18432
    buffer_load_dwordx4 v5, s[20:23], s35 offen offset:2048 lds
    v_mfma_f32_16x16x32_bf16 v[52:55], v[212:215], v[124:127], v[52:55]
    v_mfma_f32_16x16x32_bf16 v[56:59], v[212:215], v[128:131], v[56:59]
    s_add_u32 s35, s33, 27648
    buffer_load_dwordx4 v5, s[20:23], s35 offen offset:3072 lds
    v_mfma_f32_16x16x32_bf16 v[60:63], v[212:215], v[132:135], v[60:63]
    v_mfma_f32_16x16x32_bf16 v[64:67], v[216:219], v[112:115], v[64:67]
    ds_read_b64_tr_b16 v[232:233], v8 offset:4096
    ds_read_b64_tr_b16 v[234:235], v8 offset:6144
    v_mfma_f32_16x16x32_bf16 v[68:71], v[216:219], v[116:119], v[68:71]
    v_mfma_f32_16x16x32_bf16 v[72:75], v[216:219], v[120:123], v[72:75]
    v_mfma_f32_16x16x32_bf16 v[76:79], v[216:219], v[124:127], v[76:79]
    v_mfma_f32_16x16x32_bf16 v[80:83], v[216:219], v[128:131], v[80:83]
    v_mfma_f32_16x16x32_bf16 v[84:87], v[216:219], v[132:135], v[84:87]
    v_mfma_f32_16x16x32_bf16 v[88:91], v[220:223], v[112:115], v[88:91]
    ds_read_b64_tr_b16 v[236:237], v9 offset:4096
    ds_read_b64_tr_b16 v[238:239], v9 offset:6144
    buffer_load_dwordx4 v[112:115], v4, s[16:19], s96 offen offset:0 sc1
    v_mfma_f32_16x16x32_bf16 v[92:95], v[220:223], v[116:119], v[92:95]
    buffer_load_dwordx4 v[116:119], v4, s[16:19], s97 offen offset:0 sc1
    v_mfma_f32_16x16x32_bf16 v[96:99], v[220:223], v[120:123], v[96:99]
    buffer_load_dwordx4 v[120:123], v4, s[16:19], s98 offen offset:0 sc1
    v_mfma_f32_16x16x32_bf16 v[100:103], v[220:223], v[124:127], v[100:103]
    buffer_load_dwordx4 v[124:127], v4, s[16:19], s99 offen offset:0 sc1
    v_mfma_f32_16x16x32_bf16 v[104:107], v[220:223], v[128:131], v[104:107]
    buffer_load_dwordx4 v[128:131], v4, s[16:19], s54 offen offset:0 sc1
    v_mfma_f32_16x16x32_bf16 v[108:111], v[220:223], v[132:135], v[108:111]
    buffer_load_dwordx4 v[132:135], v4, s[16:19], s55 offen offset:0 sc1
    s_waitcnt vmcnt(26)
    s_waitcnt lgkmcnt(0)
    v_mfma_f32_16x16x32_bf16 v[16:19], v[224:227], v[136:139], v[16:19]
    ds_read_b64_tr_b16 v[208:209], v6 offset:8192
    ds_read_b64_tr_b16 v[210:211], v6 offset:10240
    v_mfma_f32_16x16x32_bf16 v[20:23], v[224:227], v[140:143], v[20:23]
    v_mfma_f32_16x16x32_bf16 v[24:27], v[224:227], v[144:147], v[24:27]
    s_add_u32 m0, s59, 4096
    s_add_u32 s35, s33, 40960
    buffer_load_dwordx4 v5, s[20:23], s35 offen offset:0 lds
    v_mfma_f32_16x16x32_bf16 v[28:31], v[224:227], v[148:151], v[28:31]
    v_mfma_f32_16x16x32_bf16 v[32:35], v[224:227], v[152:155], v[32:35]
    s_add_u32 s35, s33, 50176
    buffer_load_dwordx4 v5, s[20:23], s35 offen offset:1024 lds
    v_mfma_f32_16x16x32_bf16 v[36:39], v[224:227], v[156:159], v[36:39]
    v_mfma_f32_16x16x32_bf16 v[40:43], v[228:231], v[136:139], v[40:43]
    ds_read_b64_tr_b16 v[212:213], v7 offset:8192
    ds_read_b64_tr_b16 v[214:215], v7 offset:10240
    v_mfma_f32_16x16x32_bf16 v[44:47], v[228:231], v[140:143], v[44:47]
    v_mfma_f32_16x16x32_bf16 v[48:51], v[228:231], v[144:147], v[48:51]
    s_add_u32 s35, s33, 59392
    buffer_load_dwordx4 v5, s[20:23], s35 offen offset:2048 lds
    v_mfma_f32_16x16x32_bf16 v[52:55], v[228:231], v[148:151], v[52:55]
    v_mfma_f32_16x16x32_bf16 v[56:59], v[228:231], v[152:155], v[56:59]
    s_add_u32 s35, s33, 68608
    buffer_load_dwordx4 v5, s[20:23], s35 offen offset:3072 lds
    v_mfma_f32_16x16x32_bf16 v[60:63], v[228:231], v[156:159], v[60:63]
    v_mfma_f32_16x16x32_bf16 v[64:67], v[232:235], v[136:139], v[64:67]
    ds_read_b64_tr_b16 v[216:217], v8 offset:8192
    ds_read_b64_tr_b16 v[218:219], v8 offset:10240
    v_mfma_f32_16x16x32_bf16 v[68:71], v[232:235], v[140:143], v[68:71]
    v_mfma_f32_16x16x32_bf16 v[72:75], v[232:235], v[144:147], v[72:75]
    v_mfma_f32_16x16x32_bf16 v[76:79], v[232:235], v[148:151], v[76:79]
    v_mfma_f32_16x16x32_bf16 v[80:83], v[232:235], v[152:155], v[80:83]
    v_mfma_f32_16x16x32_bf16 v[84:87], v[232:235], v[156:159], v[84:87]
    v_mfma_f32_16x16x32_bf16 v[88:91], v[236:239], v[136:139], v[88:91]
    ds_read_b64_tr_b16 v[220:221], v9 offset:8192
    ds_read_b64_tr_b16 v[222:223], v9 offset:10240
    buffer_load_dwordx4 v[136:139], v4, s[16:19], s96 offen offset:1024 sc1
    v_mfma_f32_16x16x32_bf16 v[92:95], v[236:239], v[140:143], v[92:95]
    buffer_load_dwordx4 v[140:143], v4, s[16:19], s97 offen offset:1024 sc1
    v_mfma_f32_16x16x32_bf16 v[96:99], v[236:239], v[144:147], v[96:99]
    buffer_load_dwordx4 v[144:147], v4, s[16:19], s98 offen offset:1024 sc1
    v_mfma_f32_16x16x32_bf16 v[100:103], v[236:239], v[148:151], v[100:103]
    buffer_load_dwordx4 v[148:151], v4, s[16:19], s99 offen offset:1024 sc1
    v_mfma_f32_16x16x32_bf16 v[104:107], v[236:239], v[152:155], v[104:107]
    buffer_load_dwordx4 v[152:155], v4, s[16:19], s54 offen offset:1024 sc1
    v_mfma_f32_16x16x32_bf16 v[108:111], v[236:239], v[156:159], v[108:111]
    buffer_load_dwordx4 v[156:159], v4, s[16:19], s55 offen offset:1024 sc1
    s_waitcnt vmcnt(26)
    s_waitcnt lgkmcnt(0)
    v_mfma_f32_16x16x32_bf16 v[16:19], v[208:211], v[160:163], v[16:19]
    ds_read_b64_tr_b16 v[224:225], v6 offset:12288
    ds_read_b64_tr_b16 v[226:227], v6 offset:14336
    v_mfma_f32_16x16x32_bf16 v[20:23], v[208:211], v[164:167], v[20:23]
    v_mfma_f32_16x16x32_bf16 v[24:27], v[208:211], v[168:171], v[24:27]
    s_add_u32 m0, s59, 8192
    s_add_u32 s35, s33, 81920
    buffer_load_dwordx4 v5, s[20:23], s35 offen offset:0 lds
    v_mfma_f32_16x16x32_bf16 v[28:31], v[208:211], v[172:175], v[28:31]
    v_mfma_f32_16x16x32_bf16 v[32:35], v[208:211], v[176:179], v[32:35]
    s_add_u32 s35, s33, 91136
    buffer_load_dwordx4 v5, s[20:23], s35 offen offset:1024 lds
    v_mfma_f32_16x16x32_bf16 v[36:39], v[208:211], v[180:183], v[36:39]
    v_mfma_f32_16x16x32_bf16 v[40:43], v[212:215], v[160:163], v[40:43]
    ds_read_b64_tr_b16 v[228:229], v7 offset:12288
    ds_read_b64_tr_b16 v[230:231], v7 offset:14336
    v_mfma_f32_16x16x32_bf16 v[44:47], v[212:215], v[164:167], v[44:47]
    v_mfma_f32_16x16x32_bf16 v[48:51], v[212:215], v[168:171], v[48:51]
    s_add_u32 s35, s33, 100352
    buffer_load_dwordx4 v5, s[20:23], s35 offen offset:2048 lds
    v_mfma_f32_16x16x32_bf16 v[52:55], v[212:215], v[172:175], v[52:55]
    v_mfma_f32_16x16x32_bf16 v[56:59], v[212:215], v[176:179], v[56:59]
    s_add_u32 s35, s33, 109568
    buffer_load_dwordx4 v5, s[20:23], s35 offen offset:3072 lds
    v_mfma_f32_16x16x32_bf16 v[60:63], v[212:215], v[180:183], v[60:63]
    v_mfma_f32_16x16x32_bf16 v[64:67], v[216:219], v[160:163], v[64:67]
    ds_read_b64_tr_b16 v[232:233], v8 offset:12288
    ds_read_b64_tr_b16 v[234:235], v8 offset:14336
    v_mfma_f32_16x16x32_bf16 v[68:71], v[216:219], v[164:167], v[68:71]
    v_mfma_f32_16x16x32_bf16 v[72:75], v[216:219], v[168:171], v[72:75]
    v_mfma_f32_16x16x32_bf16 v[76:79], v[216:219], v[172:175], v[76:79]
    v_mfma_f32_16x16x32_bf16 v[80:83], v[216:219], v[176:179], v[80:83]
    v_mfma_f32_16x16x32_bf16 v[84:87], v[216:219], v[180:183], v[84:87]
    v_mfma_f32_16x16x32_bf16 v[88:91], v[220:223], v[160:163], v[88:91]
    ds_read_b64_tr_b16 v[236:237], v9 offset:12288
    ds_read_b64_tr_b16 v[238:239], v9 offset:14336
    buffer_load_dwordx4 v[160:163], v4, s[16:19], s96 offen offset:2048 sc1
    v_mfma_f32_16x16x32_bf16 v[92:95], v[220:223], v[164:167], v[92:95]
    buffer_load_dwordx4 v[164:167], v4, s[16:19], s97 offen offset:2048 sc1
    v_mfma_f32_16x16x32_bf16 v[96:99], v[220:223], v[168:171], v[96:99]
    buffer_load_dwordx4 v[168:171], v4, s[16:19], s98 offen offset:2048 sc1
    v_mfma_f32_16x16x32_bf16 v[100:103], v[220:223], v[172:175], v[100:103]
    buffer_load_dwordx4 v[172:175], v4, s[16:19], s99 offen offset:2048 sc1
    v_mfma_f32_16x16x32_bf16 v[104:107], v[220:223], v[176:179], v[104:107]
    buffer_load_dwordx4 v[176:179], v4, s[16:19], s54 offen offset:2048 sc1
    v_mfma_f32_16x16x32_bf16 v[108:111], v[220:223], v[180:183], v[108:111]
    buffer_load_dwordx4 v[180:183], v4, s[16:19], s55 offen offset:2048 sc1
    s_waitcnt vmcnt(26)
    s_waitcnt lgkmcnt(0)
    v_mfma_f32_16x16x32_bf16 v[16:19], v[224:227], v[184:187], v[16:19]
    ds_read_b64_tr_b16 v[208:209], v6 offset:0
    ds_read_b64_tr_b16 v[210:211], v6 offset:2048
    v_mfma_f32_16x16x32_bf16 v[20:23], v[224:227], v[188:191], v[20:23]
    v_mfma_f32_16x16x32_bf16 v[24:27], v[224:227], v[192:195], v[24:27]
    s_add_u32 m0, s59, 12288
    s_add_u32 s35, s33, 122880
    buffer_load_dwordx4 v5, s[20:23], s35 offen offset:0 lds
    v_mfma_f32_16x16x32_bf16 v[28:31], v[224:227], v[196:199], v[28:31]
    v_mfma_f32_16x16x32_bf16 v[32:35], v[224:227], v[200:203], v[32:35]
    s_add_u32 s35, s33, 132096
    buffer_load_dwordx4 v5, s[20:23], s35 offen offset:1024 lds
    v_mfma_f32_16x16x32_bf16 v[36:39], v[224:227], v[204:207], v[36:39]
    v_mfma_f32_16x16x32_bf16 v[40:43], v[228:231], v[184:187], v[40:43]
    ds_read_b64_tr_b16 v[212:213], v7 offset:0
    ds_read_b64_tr_b16 v[214:215], v7 offset:2048
    v_mfma_f32_16x16x32_bf16 v[44:47], v[228:231], v[188:191], v[44:47]
    v_mfma_f32_16x16x32_bf16 v[48:51], v[228:231], v[192:195], v[48:51]
    s_add_u32 s35, s33, 141312
    buffer_load_dwordx4 v5, s[20:23], s35 offen offset:2048 lds
    v_mfma_f32_16x16x32_bf16 v[52:55], v[228:231], v[196:199], v[52:55]
    v_mfma_f32_16x16x32_bf16 v[56:59], v[228:231], v[200:203], v[56:59]
    s_add_u32 s35, s33, 150528
    buffer_load_dwordx4 v5, s[20:23], s35 offen offset:3072 lds
    v_mfma_f32_16x16x32_bf16 v[60:63], v[228:231], v[204:207], v[60:63]
    v_mfma_f32_16x16x32_bf16 v[64:67], v[232:235], v[184:187], v[64:67]
    ds_read_b64_tr_b16 v[216:217], v8 offset:0
    ds_read_b64_tr_b16 v[218:219], v8 offset:2048
    v_mfma_f32_16x16x32_bf16 v[68:71], v[232:235], v[188:191], v[68:71]
    v_mfma_f32_16x16x32_bf16 v[72:75], v[232:235], v[192:195], v[72:75]
    v_mfma_f32_16x16x32_bf16 v[76:79], v[232:235], v[196:199], v[76:79]
    v_mfma_f32_16x16x32_bf16 v[80:83], v[232:235], v[200:203], v[80:83]
    v_mfma_f32_16x16x32_bf16 v[84:87], v[232:235], v[204:207], v[84:87]
    v_mfma_f32_16x16x32_bf16 v[88:91], v[236:239], v[184:187], v[88:91]
    ds_read_b64_tr_b16 v[220:221], v9 offset:0
    ds_read_b64_tr_b16 v[222:223], v9 offset:2048
    buffer_load_dwordx4 v[184:187], v4, s[16:19], s96 offen offset:3072 sc1
    v_mfma_f32_16x16x32_bf16 v[92:95], v[236:239], v[188:191], v[92:95]
    buffer_load_dwordx4 v[188:191], v4, s[16:19], s97 offen offset:3072 sc1
    v_mfma_f32_16x16x32_bf16 v[96:99], v[236:239], v[192:195], v[96:99]
    buffer_load_dwordx4 v[192:195], v4, s[16:19], s98 offen offset:3072 sc1
    v_mfma_f32_16x16x32_bf16 v[100:103], v[236:239], v[196:199], v[100:103]
    buffer_load_dwordx4 v[196:199], v4, s[16:19], s99 offen offset:3072 sc1
    v_mfma_f32_16x16x32_bf16 v[104:107], v[236:239], v[200:203], v[104:107]
    buffer_load_dwordx4 v[200:203], v4, s[16:19], s54 offen offset:3072 sc1
    v_mfma_f32_16x16x32_bf16 v[108:111], v[236:239], v[204:207], v[108:111]
    buffer_load_dwordx4 v[204:207], v4, s[16:19], s55 offen offset:3072 sc1
    s_add_u32 s31, s31, 1
    s_cmp_lt_u32 s31, 5
    s_cbranch_scc1 p4_loop_126
    v_add_u32 v4, 4096, v4
    s_add_u32 s33, s33, 163840
    s_waitcnt vmcnt(26)
    s_waitcnt lgkmcnt(0)
    v_mfma_f32_16x16x32_bf16 v[16:19], v[208:211], v[112:115], v[16:19]
    ds_read_b64_tr_b16 v[224:225], v6 offset:4096
    ds_read_b64_tr_b16 v[226:227], v6 offset:6144
    v_mfma_f32_16x16x32_bf16 v[20:23], v[208:211], v[116:119], v[20:23]
    v_mfma_f32_16x16x32_bf16 v[24:27], v[208:211], v[120:123], v[24:27]
    s_add_u32 m0, s59, 0
    s_add_u32 s35, s33, 0
    buffer_load_dwordx4 v5, s[20:23], s35 offen offset:0 lds
    v_mfma_f32_16x16x32_bf16 v[28:31], v[208:211], v[124:127], v[28:31]
    v_mfma_f32_16x16x32_bf16 v[32:35], v[208:211], v[128:131], v[32:35]
    s_add_u32 s35, s33, 9216
    buffer_load_dwordx4 v5, s[20:23], s35 offen offset:1024 lds
    v_mfma_f32_16x16x32_bf16 v[36:39], v[208:211], v[132:135], v[36:39]
    v_mfma_f32_16x16x32_bf16 v[40:43], v[212:215], v[112:115], v[40:43]
    ds_read_b64_tr_b16 v[228:229], v7 offset:4096
    ds_read_b64_tr_b16 v[230:231], v7 offset:6144
    v_mfma_f32_16x16x32_bf16 v[44:47], v[212:215], v[116:119], v[44:47]
    v_mfma_f32_16x16x32_bf16 v[48:51], v[212:215], v[120:123], v[48:51]
    s_add_u32 s35, s33, 18432
    buffer_load_dwordx4 v5, s[20:23], s35 offen offset:2048 lds
    v_mfma_f32_16x16x32_bf16 v[52:55], v[212:215], v[124:127], v[52:55]
    v_mfma_f32_16x16x32_bf16 v[56:59], v[212:215], v[128:131], v[56:59]
    s_add_u32 s35, s33, 27648
    buffer_load_dwordx4 v5, s[20:23], s35 offen offset:3072 lds
    v_mfma_f32_16x16x32_bf16 v[60:63], v[212:215], v[132:135], v[60:63]
    v_mfma_f32_16x16x32_bf16 v[64:67], v[216:219], v[112:115], v[64:67]
    ds_read_b64_tr_b16 v[232:233], v8 offset:4096
    ds_read_b64_tr_b16 v[234:235], v8 offset:6144
    v_mfma_f32_16x16x32_bf16 v[68:71], v[216:219], v[116:119], v[68:71]
    v_mfma_f32_16x16x32_bf16 v[72:75], v[216:219], v[120:123], v[72:75]
    v_mfma_f32_16x16x32_bf16 v[76:79], v[216:219], v[124:127], v[76:79]
    v_mfma_f32_16x16x32_bf16 v[80:83], v[216:219], v[128:131], v[80:83]
    v_mfma_f32_16x16x32_bf16 v[84:87], v[216:219], v[132:135], v[84:87]
    v_mfma_f32_16x16x32_bf16 v[88:91], v[220:223], v[112:115], v[88:91]
    ds_read_b64_tr_b16 v[236:237], v9 offset:4096
    ds_read_b64_tr_b16 v[238:239], v9 offset:6144
    buffer_load_dwordx4 v[112:115], v4, s[16:19], s96 offen offset:0 sc1
    v_mfma_f32_16x16x32_bf16 v[92:95], v[220:223], v[116:119], v[92:95]
    buffer_load_dwordx4 v[116:119], v4, s[16:19], s97 offen offset:0 sc1
    v_mfma_f32_16x16x32_bf16 v[96:99], v[220:223], v[120:123], v[96:99]
    buffer_load_dwordx4 v[120:123], v4, s[16:19], s98 offen offset:0 sc1
    v_mfma_f32_16x16x32_bf16 v[100:103], v[220:223], v[124:127], v[100:103]
    buffer_load_dwordx4 v[124:127], v4, s[16:19], s99 offen offset:0 sc1
    v_mfma_f32_16x16x32_bf16 v[104:107], v[220:223], v[128:131], v[104:107]
    buffer_load_dwordx4 v[128:131], v4, s[16:19], s54 offen offset:0 sc1
    v_mfma_f32_16x16x32_bf16 v[108:111], v[220:223], v[132:135], v[108:111]
    buffer_load_dwordx4 v[132:135], v4, s[16:19], s55 offen offset:0 sc1
    s_waitcnt vmcnt(26)
    s_waitcnt lgkmcnt(0)
    v_mfma_f32_16x16x32_bf16 v[16:19], v[224:227], v[136:139], v[16:19]
    ds_read_b64_tr_b16 v[208:209], v6 offset:8192
    ds_read_b64_tr_b16 v[210:211], v6 offset:10240
    v_mfma_f32_16x16x32_bf16 v[20:23], v[224:227], v[140:143], v[20:23]
    v_mfma_f32_16x16x32_bf16 v[24:27], v[224:227], v[144:147], v[24:27]
    s_add_u32 m0, s59, 4096
    s_add_u32 s35, s33, 40960
    buffer_load_dwordx4 v5, s[20:23], s35 offen offset:0 lds
    v_mfma_f32_16x16x32_bf16 v[28:31], v[224:227], v[148:151], v[28:31]
    v_mfma_f32_16x16x32_bf16 v[32:35], v[224:227], v[152:155], v[32:35]
    s_add_u32 s35, s33, 50176
    buffer_load_dwordx4 v5, s[20:23], s35 offen offset:1024 lds
    v_mfma_f32_16x16x32_bf16 v[36:39], v[224:227], v[156:159], v[36:39]
    v_mfma_f32_16x16x32_bf16 v[40:43], v[228:231], v[136:139], v[40:43]
    ds_read_b64_tr_b16 v[212:213], v7 offset:8192
    ds_read_b64_tr_b16 v[214:215], v7 offset:10240
    v_mfma_f32_16x16x32_bf16 v[44:47], v[228:231], v[140:143], v[44:47]
    v_mfma_f32_16x16x32_bf16 v[48:51], v[228:231], v[144:147], v[48:51]
    s_add_u32 s35, s33, 59392
    buffer_load_dwordx4 v5, s[20:23], s35 offen offset:2048 lds
    v_mfma_f32_16x16x32_bf16 v[52:55], v[228:231], v[148:151], v[52:55]
    v_mfma_f32_16x16x32_bf16 v[56:59], v[228:231], v[152:155], v[56:59]
    s_add_u32 s35, s33, 68608
    buffer_load_dwordx4 v5, s[20:23], s35 offen offset:3072 lds
    v_mfma_f32_16x16x32_bf16 v[60:63], v[228:231], v[156:159], v[60:63]
    v_mfma_f32_16x16x32_bf16 v[64:67], v[232:235], v[136:139], v[64:67]
    ds_read_b64_tr_b16 v[216:217], v8 offset:8192
    ds_read_b64_tr_b16 v[218:219], v8 offset:10240
    v_mfma_f32_16x16x32_bf16 v[68:71], v[232:235], v[140:143], v[68:71]
    v_mfma_f32_16x16x32_bf16 v[72:75], v[232:235], v[144:147], v[72:75]
    v_mfma_f32_16x16x32_bf16 v[76:79], v[232:235], v[148:151], v[76:79]
    v_mfma_f32_16x16x32_bf16 v[80:83], v[232:235], v[152:155], v[80:83]
    v_mfma_f32_16x16x32_bf16 v[84:87], v[232:235], v[156:159], v[84:87]
    v_mfma_f32_16x16x32_bf16 v[88:91], v[236:239], v[136:139], v[88:91]
    ds_read_b64_tr_b16 v[220:221], v9 offset:8192
    ds_read_b64_tr_b16 v[222:223], v9 offset:10240
    buffer_load_dwordx4 v[136:139], v4, s[16:19], s96 offen offset:1024 sc1
    v_mfma_f32_16x16x32_bf16 v[92:95], v[236:239], v[140:143], v[92:95]
    buffer_load_dwordx4 v[140:143], v4, s[16:19], s97 offen offset:1024 sc1
    v_mfma_f32_16x16x32_bf16 v[96:99], v[236:239], v[144:147], v[96:99]
    buffer_load_dwordx4 v[144:147], v4, s[16:19], s98 offen offset:1024 sc1
    v_mfma_f32_16x16x32_bf16 v[100:103], v[236:239], v[148:151], v[100:103]
    buffer_load_dwordx4 v[148:151], v4, s[16:19], s99 offen offset:1024 sc1
    v_mfma_f32_16x16x32_bf16 v[104:107], v[236:239], v[152:155], v[104:107]
    buffer_load_dwordx4 v[152:155], v4, s[16:19], s54 offen offset:1024 sc1
    v_mfma_f32_16x16x32_bf16 v[108:111], v[236:239], v[156:159], v[108:111]
    buffer_load_dwordx4 v[156:159], v4, s[16:19], s55 offen offset:1024 sc1
    s_waitcnt vmcnt(26)
    s_waitcnt lgkmcnt(0)
    v_mfma_f32_16x16x32_bf16 v[16:19], v[208:211], v[160:163], v[16:19]
    ds_read_b64_tr_b16 v[224:225], v6 offset:12288
    ds_read_b64_tr_b16 v[226:227], v6 offset:14336
    v_mfma_f32_16x16x32_bf16 v[20:23], v[208:211], v[164:167], v[20:23]
    v_mfma_f32_16x16x32_bf16 v[24:27], v[208:211], v[168:171], v[24:27]
    s_add_u32 m0, s59, 8192
    s_add_u32 s35, s33, 81920
    buffer_load_dwordx4 v5, s[20:23], s35 offen offset:0 lds
    v_mfma_f32_16x16x32_bf16 v[28:31], v[208:211], v[172:175], v[28:31]
    v_mfma_f32_16x16x32_bf16 v[32:35], v[208:211], v[176:179], v[32:35]
    s_add_u32 s35, s33, 91136
    buffer_load_dwordx4 v5, s[20:23], s35 offen offset:1024 lds
    v_mfma_f32_16x16x32_bf16 v[36:39], v[208:211], v[180:183], v[36:39]
    v_mfma_f32_16x16x32_bf16 v[40:43], v[212:215], v[160:163], v[40:43]
    ds_read_b64_tr_b16 v[228:229], v7 offset:12288
    ds_read_b64_tr_b16 v[230:231], v7 offset:14336
    v_mfma_f32_16x16x32_bf16 v[44:47], v[212:215], v[164:167], v[44:47]
    v_mfma_f32_16x16x32_bf16 v[48:51], v[212:215], v[168:171], v[48:51]
    s_add_u32 s35, s33, 100352
    buffer_load_dwordx4 v5, s[20:23], s35 offen offset:2048 lds
    v_mfma_f32_16x16x32_bf16 v[52:55], v[212:215], v[172:175], v[52:55]
    v_mfma_f32_16x16x32_bf16 v[56:59], v[212:215], v[176:179], v[56:59]
    s_add_u32 s35, s33, 109568
    buffer_load_dwordx4 v5, s[20:23], s35 offen offset:3072 lds
    v_mfma_f32_16x16x32_bf16 v[60:63], v[212:215], v[180:183], v[60:63]
    v_mfma_f32_16x16x32_bf16 v[64:67], v[216:219], v[160:163], v[64:67]
    ds_read_b64_tr_b16 v[232:233], v8 offset:12288
    ds_read_b64_tr_b16 v[234:235], v8 offset:14336
    v_mfma_f32_16x16x32_bf16 v[68:71], v[216:219], v[164:167], v[68:71]
    v_mfma_f32_16x16x32_bf16 v[72:75], v[216:219], v[168:171], v[72:75]
    v_mfma_f32_16x16x32_bf16 v[76:79], v[216:219], v[172:175], v[76:79]
    v_mfma_f32_16x16x32_bf16 v[80:83], v[216:219], v[176:179], v[80:83]
    v_mfma_f32_16x16x32_bf16 v[84:87], v[216:219], v[180:183], v[84:87]
    v_mfma_f32_16x16x32_bf16 v[88:91], v[220:223], v[160:163], v[88:91]
    ds_read_b64_tr_b16 v[236:237], v9 offset:12288
    ds_read_b64_tr_b16 v[238:239], v9 offset:14336
    buffer_load_dwordx4 v[160:163], v4, s[16:19], s96 offen offset:2048 sc1
    v_mfma_f32_16x16x32_bf16 v[92:95], v[220:223], v[164:167], v[92:95]
    buffer_load_dwordx4 v[164:167], v4, s[16:19], s97 offen offset:2048 sc1
    v_mfma_f32_16x16x32_bf16 v[96:99], v[220:223], v[168:171], v[96:99]
    buffer_load_dwordx4 v[168:171], v4, s[16:19], s98 offen offset:2048 sc1
    v_mfma_f32_16x16x32_bf16 v[100:103], v[220:223], v[172:175], v[100:103]
    buffer_load_dwordx4 v[172:175], v4, s[16:19], s99 offen offset:2048 sc1
    v_mfma_f32_16x16x32_bf16 v[104:107], v[220:223], v[176:179], v[104:107]
    buffer_load_dwordx4 v[176:179], v4, s[16:19], s54 offen offset:2048 sc1
    v_mfma_f32_16x16x32_bf16 v[108:111], v[220:223], v[180:183], v[108:111]
    buffer_load_dwordx4 v[180:183], v4, s[16:19], s55 offen offset:2048 sc1
    s_waitcnt vmcnt(26)
    s_waitcnt lgkmcnt(0)
    v_mfma_f32_16x16x32_bf16 v[16:19], v[224:227], v[184:187], v[16:19]
    ds_read_b64_tr_b16 v[208:209], v6 offset:0
    ds_read_b64_tr_b16 v[210:211], v6 offset:2048
    v_mfma_f32_16x16x32_bf16 v[20:23], v[224:227], v[188:191], v[20:23]
    v_mfma_f32_16x16x32_bf16 v[24:27], v[224:227], v[192:195], v[24:27]
    s_add_u32 m0, s59, 12288
    s_add_u32 s35, s33, 122880
    buffer_load_dwordx4 v5, s[20:23], s35 offen offset:0 lds
    v_mfma_f32_16x16x32_bf16 v[28:31], v[224:227], v[196:199], v[28:31]
    v_mfma_f32_16x16x32_bf16 v[32:35], v[224:227], v[200:203], v[32:35]
    s_add_u32 s35, s33, 132096
    buffer_load_dwordx4 v5, s[20:23], s35 offen offset:1024 lds
    v_mfma_f32_16x16x32_bf16 v[36:39], v[224:227], v[204:207], v[36:39]
    v_mfma_f32_16x16x32_bf16 v[40:43], v[228:231], v[184:187], v[40:43]
    ds_read_b64_tr_b16 v[212:213], v7 offset:0
    ds_read_b64_tr_b16 v[214:215], v7 offset:2048
    v_mfma_f32_16x16x32_bf16 v[44:47], v[228:231], v[188:191], v[44:47]
    v_mfma_f32_16x16x32_bf16 v[48:51], v[228:231], v[192:195], v[48:51]
    s_add_u32 s35, s33, 141312
    buffer_load_dwordx4 v5, s[20:23], s35 offen offset:2048 lds
    v_mfma_f32_16x16x32_bf16 v[52:55], v[228:231], v[196:199], v[52:55]
    v_mfma_f32_16x16x32_bf16 v[56:59], v[228:231], v[200:203], v[56:59]
    s_add_u32 s35, s33, 150528
    buffer_load_dwordx4 v5, s[20:23], s35 offen offset:3072 lds
    v_mfma_f32_16x16x32_bf16 v[60:63], v[228:231], v[204:207], v[60:63]
    v_mfma_f32_16x16x32_bf16 v[64:67], v[232:235], v[184:187], v[64:67]
    ds_read_b64_tr_b16 v[216:217], v8 offset:0
    ds_read_b64_tr_b16 v[218:219], v8 offset:2048
    v_mfma_f32_16x16x32_bf16 v[68:71], v[232:235], v[188:191], v[68:71]
    v_mfma_f32_16x16x32_bf16 v[72:75], v[232:235], v[192:195], v[72:75]
    v_mfma_f32_16x16x32_bf16 v[76:79], v[232:235], v[196:199], v[76:79]
    v_mfma_f32_16x16x32_bf16 v[80:83], v[232:235], v[200:203], v[80:83]
    v_mfma_f32_16x16x32_bf16 v[84:87], v[232:235], v[204:207], v[84:87]
    v_mfma_f32_16x16x32_bf16 v[88:91], v[236:239], v[184:187], v[88:91]
    ds_read_b64_tr_b16 v[220:221], v9 offset:0
    ds_read_b64_tr_b16 v[222:223], v9 offset:2048
    buffer_load_dwordx4 v[184:187], v4, s[16:19], s96 offen offset:3072 sc1
    v_mfma_f32_16x16x32_bf16 v[92:95], v[236:239], v[188:191], v[92:95]
    buffer_load_dwordx4 v[188:191], v4, s[16:19], s97 offen offset:3072 sc1
    v_mfma_f32_16x16x32_bf16 v[96:99], v[236:239], v[192:195], v[96:99]
    buffer_load_dwordx4 v[192:195], v4, s[16:19], s98 offen offset:3072 sc1
    v_mfma_f32_16x16x32_bf16 v[100:103], v[236:239], v[196:199], v[100:103]
    buffer_load_dwordx4 v[196:199], v4, s[16:19], s99 offen offset:3072 sc1
    v_mfma_f32_16x16x32_bf16 v[104:107], v[236:239], v[200:203], v[104:107]
    buffer_load_dwordx4 v[200:203], v4, s[16:19], s54 offen offset:3072 sc1
    v_mfma_f32_16x16x32_bf16 v[108:111], v[236:239], v[204:207], v[108:111]
    buffer_load_dwordx4 v[204:207], v4, s[16:19], s55 offen offset:3072 sc1
    buffer_load_dword v10, v244, s[92:95], 0 offen sc1
    s_waitcnt vmcnt(27)
    s_waitcnt lgkmcnt(0)
    v_mfma_f32_16x16x32_bf16 v[16:19], v[208:211], v[112:115], v[16:19]
    ds_read_b64_tr_b16 v[224:225], v6 offset:4096
    ds_read_b64_tr_b16 v[226:227], v6 offset:6144
    v_mfma_f32_16x16x32_bf16 v[20:23], v[208:211], v[116:119], v[20:23]
    v_mfma_f32_16x16x32_bf16 v[24:27], v[208:211], v[120:123], v[24:27]
    v_mfma_f32_16x16x32_bf16 v[28:31], v[208:211], v[124:127], v[28:31]
    v_mfma_f32_16x16x32_bf16 v[32:35], v[208:211], v[128:131], v[32:35]
    v_mfma_f32_16x16x32_bf16 v[36:39], v[208:211], v[132:135], v[36:39]
    v_mfma_f32_16x16x32_bf16 v[40:43], v[212:215], v[112:115], v[40:43]
    ds_read_b64_tr_b16 v[228:229], v7 offset:4096
    ds_read_b64_tr_b16 v[230:231], v7 offset:6144
    v_mfma_f32_16x16x32_bf16 v[44:47], v[212:215], v[116:119], v[44:47]
    v_mfma_f32_16x16x32_bf16 v[48:51], v[212:215], v[120:123], v[48:51]
    v_mfma_f32_16x16x32_bf16 v[52:55], v[212:215], v[124:127], v[52:55]
    v_mfma_f32_16x16x32_bf16 v[56:59], v[212:215], v[128:131], v[56:59]
    v_mfma_f32_16x16x32_bf16 v[60:63], v[212:215], v[132:135], v[60:63]
    v_mfma_f32_16x16x32_bf16 v[64:67], v[216:219], v[112:115], v[64:67]
    ds_read_b64_tr_b16 v[232:233], v8 offset:4096
    ds_read_b64_tr_b16 v[234:235], v8 offset:6144
    v_mfma_f32_16x16x32_bf16 v[68:71], v[216:219], v[116:119], v[68:71]
    v_mfma_f32_16x16x32_bf16 v[72:75], v[216:219], v[120:123], v[72:75]
    v_mfma_f32_16x16x32_bf16 v[76:79], v[216:219], v[124:127], v[76:79]
    v_mfma_f32_16x16x32_bf16 v[80:83], v[216:219], v[128:131], v[80:83]
    v_mfma_f32_16x16x32_bf16 v[84:87], v[216:219], v[132:135], v[84:87]
    v_mfma_f32_16x16x32_bf16 v[88:91], v[220:223], v[112:115], v[88:91]
    ds_read_b64_tr_b16 v[236:237], v9 offset:4096
    ds_read_b64_tr_b16 v[238:239], v9 offset:6144
    v_mfma_f32_16x16x32_bf16 v[92:95], v[220:223], v[116:119], v[92:95]
    v_mfma_f32_16x16x32_bf16 v[96:99], v[220:223], v[120:123], v[96:99]
    v_mfma_f32_16x16x32_bf16 v[100:103], v[220:223], v[124:127], v[100:103]
    v_mfma_f32_16x16x32_bf16 v[104:107], v[220:223], v[128:131], v[104:107]
    v_mfma_f32_16x16x32_bf16 v[108:111], v[220:223], v[132:135], v[108:111]
    s_waitcnt vmcnt(17)
    s_waitcnt lgkmcnt(0)
    v_mfma_f32_16x16x32_bf16 v[16:19], v[224:227], v[136:139], v[16:19]
    ds_read_b64_tr_b16 v[208:209], v6 offset:8192
    ds_read_b64_tr_b16 v[210:211], v6 offset:10240
    v_mfma_f32_16x16x32_bf16 v[20:23], v[224:227], v[140:143], v[20:23]
    v_mfma_f32_16x16x32_bf16 v[24:27], v[224:227], v[144:147], v[24:27]
    v_mfma_f32_16x16x32_bf16 v[28:31], v[224:227], v[148:151], v[28:31]
    v_mfma_f32_16x16x32_bf16 v[32:35], v[224:227], v[152:155], v[32:35]
    v_mfma_f32_16x16x32_bf16 v[36:39], v[224:227], v[156:159], v[36:39]
    v_mfma_f32_16x16x32_bf16 v[40:43], v[228:231], v[136:139], v[40:43]
    ds_read_b64_tr_b16 v[212:213], v7 offset:8192
    ds_read_b64_tr_b16 v[214:215], v7 offset:10240
    v_mfma_f32_16x16x32_bf16 v[44:47], v[228:231], v[140:143], v[44:47]
    v_mfma_f32_16x16x32_bf16 v[48:51], v[228:231], v[144:147], v[48:51]
    v_mfma_f32_16x16x32_bf16 v[52:55], v[228:231], v[148:151], v[52:55]
    v_mfma_f32_16x16x32_bf16 v[56:59], v[228:231], v[152:155], v[56:59]
    v_mfma_f32_16x16x32_bf16 v[60:63], v[228:231], v[156:159], v[60:63]
    v_mfma_f32_16x16x32_bf16 v[64:67], v[232:235], v[136:139], v[64:67]
    ds_read_b64_tr_b16 v[216:217], v8 offset:8192
    ds_read_b64_tr_b16 v[218:219], v8 offset:10240
    v_mfma_f32_16x16x32_bf16 v[68:71], v[232:235], v[140:143], v[68:71]
    v_mfma_f32_16x16x32_bf16 v[72:75], v[232:235], v[144:147], v[72:75]
    v_mfma_f32_16x16x32_bf16 v[76:79], v[232:235], v[148:151], v[76:79]
    v_mfma_f32_16x16x32_bf16 v[80:83], v[232:235], v[152:155], v[80:83]
    v_mfma_f32_16x16x32_bf16 v[84:87], v[232:235], v[156:159], v[84:87]
    v_mfma_f32_16x16x32_bf16 v[88:91], v[236:239], v[136:139], v[88:91]
    ds_read_b64_tr_b16 v[220:221], v9 offset:8192
    ds_read_b64_tr_b16 v[222:223], v9 offset:10240
    v_mfma_f32_16x16x32_bf16 v[92:95], v[236:239], v[140:143], v[92:95]
    v_mfma_f32_16x16x32_bf16 v[96:99], v[236:239], v[144:147], v[96:99]
    v_mfma_f32_16x16x32_bf16 v[100:103], v[236:239], v[148:151], v[100:103]
    v_mfma_f32_16x16x32_bf16 v[104:107], v[236:239], v[152:155], v[104:107]
    v_mfma_f32_16x16x32_bf16 v[108:111], v[236:239], v[156:159], v[108:111]
    s_waitcnt vmcnt(7)
    s_waitcnt lgkmcnt(0)
    v_mfma_f32_16x16x32_bf16 v[16:19], v[208:211], v[160:163], v[16:19]
    ds_read_b64_tr_b16 v[224:225], v6 offset:12288
    ds_read_b64_tr_b16 v[226:227], v6 offset:14336
    v_mfma_f32_16x16x32_bf16 v[20:23], v[208:211], v[164:167], v[20:23]
    v_mfma_f32_16x16x32_bf16 v[24:27], v[208:211], v[168:171], v[24:27]
    v_mfma_f32_16x16x32_bf16 v[28:31], v[208:211], v[172:175], v[28:31]
    v_mfma_f32_16x16x32_bf16 v[32:35], v[208:211], v[176:179], v[32:35]
    v_mfma_f32_16x16x32_bf16 v[36:39], v[208:211], v[180:183], v[36:39]
    v_mfma_f32_16x16x32_bf16 v[40:43], v[212:215], v[160:163], v[40:43]
    ds_read_b64_tr_b16 v[228:229], v7 offset:12288
    ds_read_b64_tr_b16 v[230:231], v7 offset:14336
    v_mfma_f32_16x16x32_bf16 v[44:47], v[212:215], v[164:167], v[44:47]
    v_mfma_f32_16x16x32_bf16 v[48:51], v[212:215], v[168:171], v[48:51]
    v_mfma_f32_16x16x32_bf16 v[52:55], v[212:215], v[172:175], v[52:55]
    v_mfma_f32_16x16x32_bf16 v[56:59], v[212:215], v[176:179], v[56:59]
    v_mfma_f32_16x16x32_bf16 v[60:63], v[212:215], v[180:183], v[60:63]
    v_mfma_f32_16x16x32_bf16 v[64:67], v[216:219], v[160:163], v[64:67]
    ds_read_b64_tr_b16 v[232:233], v8 offset:12288
    ds_read_b64_tr_b16 v[234:235], v8 offset:14336
    v_mfma_f32_16x16x32_bf16 v[68:71], v[216:219], v[164:167], v[68:71]
    v_mfma_f32_16x16x32_bf16 v[72:75], v[216:219], v[168:171], v[72:75]
    v_mfma_f32_16x16x32_bf16 v[76:79], v[216:219], v[172:175], v[76:79]
    v_mfma_f32_16x16x32_bf16 v[80:83], v[216:219], v[176:179], v[80:83]
    v_mfma_f32_16x16x32_bf16 v[84:87], v[216:219], v[180:183], v[84:87]
    v_mfma_f32_16x16x32_bf16 v[88:91], v[220:223], v[160:163], v[88:91]
    ds_read_b64_tr_b16 v[236:237], v9 offset:12288
    ds_read_b64_tr_b16 v[238:239], v9 offset:14336
    v_mfma_f32_16x16x32_bf16 v[92:95], v[220:223], v[164:167], v[92:95]
    v_mfma_f32_16x16x32_bf16 v[96:99], v[220:223], v[168:171], v[96:99]
    v_mfma_f32_16x16x32_bf16 v[100:103], v[220:223], v[172:175], v[100:103]
    v_mfma_f32_16x16x32_bf16 v[104:107], v[220:223], v[176:179], v[104:107]
    v_mfma_f32_16x16x32_bf16 v[108:111], v[220:223], v[180:183], v[108:111]
    s_waitcnt vmcnt(0)
    v_cmp_ne_u32 vcc, v10, v13
    s_cbranch_vccnz p4_slowpoll_124
p4_pollok_125:
    s_mov_b32 s28, 0
    buffer_load_dwordx2 v[112:113], v242, s[24:27], s28 offen
    buffer_load_dword v148, v240, s[44:47], 0 offen offset:0 sc1
    s_mov_b32 s28, 20480
    buffer_load_dwordx2 v[114:115], v242, s[24:27], s28 offen
    buffer_load_dword v149, v240, s[44:47], 0 offen offset:64 sc1
    s_mov_b32 s28, 40960
    buffer_load_dwordx2 v[116:117], v242, s[24:27], s28 offen
    buffer_load_dword v150, v240, s[44:47], 0 offen offset:128 sc1
    s_mov_b32 s28, 61440
    buffer_load_dwordx2 v[118:119], v242, s[24:27], s28 offen
    buffer_load_dword v151, v240, s[44:47], 0 offen offset:192 sc1
    s_mov_b32 s28, 81920
    buffer_load_dwordx2 v[120:121], v242, s[24:27], s28 offen
    buffer_load_dword v152, v240, s[44:47], 0 offen offset:256 sc1
    s_mov_b32 s28, 102400
    buffer_load_dwordx2 v[122:123], v242, s[24:27], s28 offen
    buffer_load_dword v153, v240, s[44:47], 0 offen offset:320 sc1
    s_mov_b32 s28, 0
    buffer_load_ushort v124, v243, s[36:39], s28 offen offset:0 sc1
    buffer_load_ushort v128, v243, s[36:39], s28 offen offset:32 sc1
    buffer_load_ushort v132, v243, s[36:39], s28 offen offset:64 sc1
    buffer_load_ushort v136, v243, s[36:39], s28 offen offset:96 sc1
    buffer_load_ushort v140, v243, s[36:39], s28 offen offset:128 sc1
    buffer_load_ushort v144, v243, s[36:39], s28 offen offset:160 sc1
    s_mov_b32 s28, 4096
    buffer_load_ushort v125, v243, s[36:39], s28 offen offset:0 sc1
    buffer_load_ushort v129, v243, s[36:39], s28 offen offset:32 sc1
    buffer_load_ushort v133, v243, s[36:39], s28 offen offset:64 sc1
    buffer_load_ushort v137, v243, s[36:39], s28 offen offset:96 sc1
    buffer_load_ushort v141, v243, s[36:39], s28 offen offset:128 sc1
    buffer_load_ushort v145, v243, s[36:39], s28 offen offset:160 sc1
    s_mov_b32 s28, 8192
    buffer_load_ushort v126, v243, s[36:39], s28 offen offset:0 sc1
    buffer_load_ushort v130, v243, s[36:39], s28 offen offset:32 sc1
    buffer_load_ushort v134, v243, s[36:39], s28 offen offset:64 sc1
    buffer_load_ushort v138, v243, s[36:39], s28 offen offset:96 sc1
    buffer_load_ushort v142, v243, s[36:39], s28 offen offset:128 sc1
    buffer_load_ushort v146, v243, s[36:39], s28 offen offset:160 sc1
    s_mov_b32 s28, 12288
    buffer_load_ushort v127, v243, s[36:39], s28 offen offset:0 sc1
    buffer_load_ushort v131, v243, s[36:39], s28 offen offset:32 sc1
    buffer_load_ushort v135, v243, s[36:39], s28 offen offset:64 sc1
    buffer_load_ushort v139, v243, s[36:39], s28 offen offset:96 sc1
    buffer_load_ushort v143, v243, s[36:39], s28 offen offset:128 sc1
    buffer_load_ushort v147, v243, s[36:39], s28 offen offset:160 sc1
    s_waitcnt lgkmcnt(0)
    v_mfma_f32_16x16x32_bf16 v[16:19], v[224:227], v[184:187], v[16:19]
    v_mfma_f32_16x16x32_bf16 v[20:23], v[224:227], v[188:191], v[20:23]
    v_mfma_f32_16x16x32_bf16 v[24:27], v[224:227], v[192:195], v[24:27]
    v_mfma_f32_16x16x32_bf16 v[28:31], v[224:227], v[196:199], v[28:31]
    v_mfma_f32_16x16x32_bf16 v[32:35], v[224:227], v[200:203], v[32:35]
    v_mfma_f32_16x16x32_bf16 v[36:39], v[224:227], v[204:207], v[36:39]
    v_mfma_f32_16x16x32_bf16 v[40:43], v[228:231], v[184:187], v[40:43]
    v_mfma_f32_16x16x32_bf16 v[44:47], v[228:231], v[188:191], v[44:47]
    v_mfma_f32_16x16x32_bf16 v[48:51], v[228:231], v[192:195], v[48:51]
    v_mfma_f32_16x16x32_bf16 v[52:55], v[228:231], v[196:199], v[52:55]
    v_mfma_f32_16x16x32_bf16 v[56:59], v[228:231], v[200:203], v[56:59]
    v_mfma_f32_16x16x32_bf16 v[60:63], v[228:231], v[204:207], v[60:63]
    v_mfma_f32_16x16x32_bf16 v[64:67], v[232:235], v[184:187], v[64:67]
    v_mfma_f32_16x16x32_bf16 v[68:71], v[232:235], v[188:191], v[68:71]
    v_mfma_f32_16x16x32_bf16 v[72:75], v[232:235], v[192:195], v[72:75]
    v_mfma_f32_16x16x32_bf16 v[76:79], v[232:235], v[196:199], v[76:79]
    v_mfma_f32_16x16x32_bf16 v[80:83], v[232:235], v[200:203], v[80:83]
    v_mfma_f32_16x16x32_bf16 v[84:87], v[232:235], v[204:207], v[84:87]
    v_mfma_f32_16x16x32_bf16 v[88:91], v[236:239], v[184:187], v[88:91]
    v_mfma_f32_16x16x32_bf16 v[92:95], v[236:239], v[188:191], v[92:95]
    v_mfma_f32_16x16x32_bf16 v[96:99], v[236:239], v[192:195], v[96:99]
    v_mfma_f32_16x16x32_bf16 v[100:103], v[236:239], v[196:199], v[100:103]
    v_mfma_f32_16x16x32_bf16 v[104:107], v[236:239], v[200:203], v[104:107]
    v_mfma_f32_16x16x32_bf16 v[108:111], v[236:239], v[204:207], v[108:111]
    s_barrier
    s_mul_i32 s28, s3, 24576
    v_add_u32 v8, s28, v3
    ds_write_b128 v8, v[16:19] offset:0
    ds_write_b128 v8, v[20:23] offset:1024
    ds_write_b128 v8, v[24:27] offset:2048
    ds_write_b128 v8, v[28:31] offset:3072
    ds_write_b128 v8, v[32:35] offset:4096
    ds_write_b128 v8, v[36:39] offset:5120
    ds_write_b128 v8, v[40:43] offset:6144
    ds_write_b128 v8, v[44:47] offset:7168
    ds_write_b128 v8, v[48:51] offset:8192
    ds_write_b128 v8, v[52:55] offset:9216
    ds_write_b128 v8, v[56:59] offset:10240
    ds_write_b128 v8, v[60:63] offset:11264
    ds_write_b128 v8, v[64:67] offset:12288
    ds_write_b128 v8, v[68:71] offset:13312
    ds_write_b128 v8, v[72:75] offset:14336
    ds_write_b128 v8, v[76:79] offset:15360
    ds_write_b128 v8, v[80:83] offset:16384
    ds_write_b128 v8, v[84:87] offset:17408
    ds_write_b128 v8, v[88:91] offset:18432
    ds_write_b128 v8, v[92:95] offset:19456
    ds_write_b128 v8, v[96:99] offset:20480
    ds_write_b128 v8, v[100:103] offset:21504
    ds_write_b128 v8, v[104:107] offset:22528
    ds_write_b128 v8, v[108:111] offset:23552
    s_waitcnt vmcnt(0)
    v_sub_f32 v224, 1.0, v148
    v_cvt_pk_bf16_f32 v208, v224, v209
    v_lshlrev_b32 v224, 16, v208
    v_and_b32 v209, 0xffff0000, v208
    v_lshlrev_b32 v124, 16, v124
    v_lshlrev_b32 v225, 16, v112
    v_mul_f32 v160, v225, v124
    v_lshlrev_b32 v125, 16, v125
    v_and_b32 v225, 0xffff0000, v112
    v_mul_f32 v161, v225, v125
    v_lshlrev_b32 v126, 16, v126
    v_lshlrev_b32 v225, 16, v113
    v_mul_f32 v162, v225, v126
    v_lshlrev_b32 v127, 16, v127
    v_and_b32 v225, 0xffff0000, v113
    v_mul_f32 v163, v225, v127
    v_cvt_pk_bf16_f32 v208, v160, v161
    v_lshlrev_b32 v160, 16, v208
    v_and_b32 v161, 0xffff0000, v208
    v_cvt_pk_bf16_f32 v209, v162, v163
    v_lshlrev_b32 v162, 16, v209
    v_and_b32 v163, 0xffff0000, v209
    v_mul_f32 v160, v160, v224
    v_mul_f32 v161, v161, v224
    v_mul_f32 v162, v162, v224
    v_mul_f32 v163, v163, v224
    v_cvt_pk_bf16_f32 v208, v160, v161
    v_lshlrev_b32 v160, 16, v208
    v_and_b32 v161, 0xffff0000, v208
    v_cvt_pk_bf16_f32 v209, v162, v163
    v_lshlrev_b32 v162, 16, v209
    v_and_b32 v163, 0xffff0000, v209
    v_sub_f32 v224, 1.0, v149
    v_cvt_pk_bf16_f32 v208, v224, v209
    v_lshlrev_b32 v224, 16, v208
    v_and_b32 v209, 0xffff0000, v208
    v_lshlrev_b32 v128, 16, v128
    v_lshlrev_b32 v225, 16, v114
    v_mul_f32 v164, v225, v128
    v_lshlrev_b32 v129, 16, v129
    v_and_b32 v225, 0xffff0000, v114
    v_mul_f32 v165, v225, v129
    v_lshlrev_b32 v130, 16, v130
    v_lshlrev_b32 v225, 16, v115
    v_mul_f32 v166, v225, v130
    v_lshlrev_b32 v131, 16, v131
    v_and_b32 v225, 0xffff0000, v115
    v_mul_f32 v167, v225, v131
    v_cvt_pk_bf16_f32 v208, v164, v165
    v_lshlrev_b32 v164, 16, v208
    v_and_b32 v165, 0xffff0000, v208
    v_cvt_pk_bf16_f32 v209, v166, v167
    v_lshlrev_b32 v166, 16, v209
    v_and_b32 v167, 0xffff0000, v209
    v_mul_f32 v164, v164, v224
    v_mul_f32 v165, v165, v224
    v_mul_f32 v166, v166, v224
    v_mul_f32 v167, v167, v224
    v_cvt_pk_bf16_f32 v208, v164, v165
    v_lshlrev_b32 v164, 16, v208
    v_and_b32 v165, 0xffff0000, v208
    v_cvt_pk_bf16_f32 v209, v166, v167
    v_lshlrev_b32 v166, 16, v209
    v_and_b32 v167, 0xffff0000, v209
    v_sub_f32 v224, 1.0, v150
    v_cvt_pk_bf16_f32 v208, v224, v209
    v_lshlrev_b32 v224, 16, v208
    v_and_b32 v209, 0xffff0000, v208
    v_lshlrev_b32 v132, 16, v132
    v_lshlrev_b32 v225, 16, v116
    v_mul_f32 v168, v225, v132
    v_lshlrev_b32 v133, 16, v133
    v_and_b32 v225, 0xffff0000, v116
    v_mul_f32 v169, v225, v133
    v_lshlrev_b32 v134, 16, v134
    v_lshlrev_b32 v225, 16, v117
    v_mul_f32 v170, v225, v134
    v_lshlrev_b32 v135, 16, v135
    v_and_b32 v225, 0xffff0000, v117
    v_mul_f32 v171, v225, v135
    v_cvt_pk_bf16_f32 v208, v168, v169
    v_lshlrev_b32 v168, 16, v208
    v_and_b32 v169, 0xffff0000, v208
    v_cvt_pk_bf16_f32 v209, v170, v171
    v_lshlrev_b32 v170, 16, v209
    v_and_b32 v171, 0xffff0000, v209
    v_mul_f32 v168, v168, v224
    v_mul_f32 v169, v169, v224
    v_mul_f32 v170, v170, v224
    v_mul_f32 v171, v171, v224
    v_cvt_pk_bf16_f32 v208, v168, v169
    v_lshlrev_b32 v168, 16, v208
    v_and_b32 v169, 0xffff0000, v208
    v_cvt_pk_bf16_f32 v209, v170, v171
    v_lshlrev_b32 v170, 16, v209
    v_and_b32 v171, 0xffff0000, v209
    v_sub_f32 v224, 1.0, v151
    v_cvt_pk_bf16_f32 v208, v224, v209
    v_lshlrev_b32 v224, 16, v208
    v_and_b32 v209, 0xffff0000, v208
    v_lshlrev_b32 v136, 16, v136
    v_lshlrev_b32 v225, 16, v118
    v_mul_f32 v172, v225, v136
    v_lshlrev_b32 v137, 16, v137
    v_and_b32 v225, 0xffff0000, v118
    v_mul_f32 v173, v225, v137
    v_lshlrev_b32 v138, 16, v138
    v_lshlrev_b32 v225, 16, v119
    v_mul_f32 v174, v225, v138
    v_lshlrev_b32 v139, 16, v139
    v_and_b32 v225, 0xffff0000, v119
    v_mul_f32 v175, v225, v139
    v_cvt_pk_bf16_f32 v208, v172, v173
    v_lshlrev_b32 v172, 16, v208
    v_and_b32 v173, 0xffff0000, v208
    v_cvt_pk_bf16_f32 v209, v174, v175
    v_lshlrev_b32 v174, 16, v209
    v_and_b32 v175, 0xffff0000, v209
    v_mul_f32 v172, v172, v224
    v_mul_f32 v173, v173, v224
    v_mul_f32 v174, v174, v224
    v_mul_f32 v175, v175, v224
    v_cvt_pk_bf16_f32 v208, v172, v173
    v_lshlrev_b32 v172, 16, v208
    v_and_b32 v173, 0xffff0000, v208
    v_cvt_pk_bf16_f32 v209, v174, v175
    v_lshlrev_b32 v174, 16, v209
    v_and_b32 v175, 0xffff0000, v209
    v_sub_f32 v224, 1.0, v152
    v_cvt_pk_bf16_f32 v208, v224, v209
    v_lshlrev_b32 v224, 16, v208
    v_and_b32 v209, 0xffff0000, v208
    v_lshlrev_b32 v140, 16, v140
    v_lshlrev_b32 v225, 16, v120
    v_mul_f32 v176, v225, v140
    v_lshlrev_b32 v141, 16, v141
    v_and_b32 v225, 0xffff0000, v120
    v_mul_f32 v177, v225, v141
    v_lshlrev_b32 v142, 16, v142
    v_lshlrev_b32 v225, 16, v121
    v_mul_f32 v178, v225, v142
    v_lshlrev_b32 v143, 16, v143
    v_and_b32 v225, 0xffff0000, v121
    v_mul_f32 v179, v225, v143
    v_cvt_pk_bf16_f32 v208, v176, v177
    v_lshlrev_b32 v176, 16, v208
    v_and_b32 v177, 0xffff0000, v208
    v_cvt_pk_bf16_f32 v209, v178, v179
    v_lshlrev_b32 v178, 16, v209
    v_and_b32 v179, 0xffff0000, v209
    v_mul_f32 v176, v176, v224
    v_mul_f32 v177, v177, v224
    v_mul_f32 v178, v178, v224
    v_mul_f32 v179, v179, v224
    v_cvt_pk_bf16_f32 v208, v176, v177
    v_lshlrev_b32 v176, 16, v208
    v_and_b32 v177, 0xffff0000, v208
    v_cvt_pk_bf16_f32 v209, v178, v179
    v_lshlrev_b32 v178, 16, v209
    v_and_b32 v179, 0xffff0000, v209
    v_sub_f32 v224, 1.0, v153
    v_cvt_pk_bf16_f32 v208, v224, v209
    v_lshlrev_b32 v224, 16, v208
    v_and_b32 v209, 0xffff0000, v208
    v_lshlrev_b32 v144, 16, v144
    v_lshlrev_b32 v225, 16, v122
    v_mul_f32 v180, v225, v144
    v_lshlrev_b32 v145, 16, v145
    v_and_b32 v225, 0xffff0000, v122
    v_mul_f32 v181, v225, v145
    v_lshlrev_b32 v146, 16, v146
    v_lshlrev_b32 v225, 16, v123
    v_mul_f32 v182, v225, v146
    v_lshlrev_b32 v147, 16, v147
    v_and_b32 v225, 0xffff0000, v123
    v_mul_f32 v183, v225, v147
    v_cvt_pk_bf16_f32 v208, v180, v181
    v_lshlrev_b32 v180, 16, v208
    v_and_b32 v181, 0xffff0000, v208
    v_cvt_pk_bf16_f32 v209, v182, v183
    v_lshlrev_b32 v182, 16, v209
    v_and_b32 v183, 0xffff0000, v209
    v_mul_f32 v180, v180, v224
    v_mul_f32 v181, v181, v224
    v_mul_f32 v182, v182, v224
    v_mul_f32 v183, v183, v224
    v_cvt_pk_bf16_f32 v208, v180, v181
    v_lshlrev_b32 v180, 16, v208
    v_and_b32 v181, 0xffff0000, v208
    v_cvt_pk_bf16_f32 v209, v182, v183
    v_lshlrev_b32 v182, 16, v209
    v_and_b32 v183, 0xffff0000, v209
    s_waitcnt lgkmcnt(0)
    s_barrier
    s_mul_i32 s28, s3, 6144
    v_add_u32 v8, s28, v3
    v_add_u32 v9, 49152, v8
    ds_read_b128 v[16:19], v8 offset:0
    ds_read_b128 v[40:43], v8 offset:24576
    ds_read_b128 v[64:67], v9 offset:0
    ds_read_b128 v[88:91], v9 offset:24576
    ds_read_b128 v[20:23], v8 offset:1024
    ds_read_b128 v[44:47], v8 offset:25600
    ds_read_b128 v[68:71], v9 offset:1024
    ds_read_b128 v[92:95], v9 offset:25600
    ds_read_b128 v[24:27], v8 offset:2048
    ds_read_b128 v[48:51], v8 offset:26624
    ds_read_b128 v[72:75], v9 offset:2048
    ds_read_b128 v[96:99], v9 offset:26624
    ds_read_b128 v[28:31], v8 offset:3072
    ds_read_b128 v[52:55], v8 offset:27648
    ds_read_b128 v[76:79], v9 offset:3072
    ds_read_b128 v[100:103], v9 offset:27648
    ds_read_b128 v[32:35], v8 offset:4096
    ds_read_b128 v[56:59], v8 offset:28672
    ds_read_b128 v[80:83], v9 offset:4096
    ds_read_b128 v[104:107], v9 offset:28672
    ds_read_b128 v[36:39], v8 offset:5120
    ds_read_b128 v[60:63], v8 offset:29696
    ds_read_b128 v[84:87], v9 offset:5120
    ds_read_b128 v[108:111], v9 offset:29696
    s_waitcnt lgkmcnt(15)
    v_add_f32 v16, v16, v40
    v_add_f32 v64, v64, v88
    v_add_f32 v16, v16, v64
    v_add_f32 v17, v17, v41
    v_add_f32 v65, v65, v89
    v_add_f32 v17, v17, v65
    v_add_f32 v18, v18, v42
    v_add_f32 v66, v66, v90
    v_add_f32 v18, v18, v66
    v_add_f32 v19, v19, v43
    v_add_f32 v67, v67, v91
    v_add_f32 v19, v19, v67
    v_cvt_pk_bf16_f32 v208, v16, v17
    v_lshlrev_b32 v16, 16, v208
    v_and_b32 v17, 0xffff0000, v208
    v_cvt_pk_bf16_f32 v209, v18, v19
    v_lshlrev_b32 v18, 16, v209
    v_and_b32 v19, 0xffff0000, v209
    v_mul_f32 v16, v16, v148
    v_mul_f32 v17, v17, v148
    v_mul_f32 v18, v18, v148
    v_mul_f32 v19, v19, v148
    v_cvt_pk_bf16_f32 v208, v16, v17
    v_lshlrev_b32 v16, 16, v208
    v_and_b32 v17, 0xffff0000, v208
    v_cvt_pk_bf16_f32 v209, v18, v19
    v_lshlrev_b32 v18, 16, v209
    v_and_b32 v19, 0xffff0000, v209
    v_add_f32 v16, v16, v160
    v_add_f32 v17, v17, v161
    v_add_f32 v18, v18, v162
    v_add_f32 v19, v19, v163
    v_cvt_pk_bf16_f32 v210, v16, v17
    v_cvt_pk_bf16_f32 v211, v18, v19
    s_mov_b32 s28, 0
    buffer_store_dwordx2 v[210:211], v242, s[60:63], s28 offen
    s_waitcnt lgkmcnt(15)
    v_add_f32 v20, v20, v44
    v_add_f32 v68, v68, v92
    v_add_f32 v20, v20, v68
    v_add_f32 v21, v21, v45
    v_add_f32 v69, v69, v93
    v_add_f32 v21, v21, v69
    v_add_f32 v22, v22, v46
    v_add_f32 v70, v70, v94
    v_add_f32 v22, v22, v70
    v_add_f32 v23, v23, v47
    v_add_f32 v71, v71, v95
    v_add_f32 v23, v23, v71
    v_cvt_pk_bf16_f32 v208, v20, v21
    v_lshlrev_b32 v20, 16, v208
    v_and_b32 v21, 0xffff0000, v208
    v_cvt_pk_bf16_f32 v209, v22, v23
    v_lshlrev_b32 v22, 16, v209
    v_and_b32 v23, 0xffff0000, v209
    v_mul_f32 v20, v20, v149
    v_mul_f32 v21, v21, v149
    v_mul_f32 v22, v22, v149
    v_mul_f32 v23, v23, v149
    v_cvt_pk_bf16_f32 v208, v20, v21
    v_lshlrev_b32 v20, 16, v208
    v_and_b32 v21, 0xffff0000, v208
    v_cvt_pk_bf16_f32 v209, v22, v23
    v_lshlrev_b32 v22, 16, v209
    v_and_b32 v23, 0xffff0000, v209
    v_add_f32 v20, v20, v164
    v_add_f32 v21, v21, v165
    v_add_f32 v22, v22, v166
    v_add_f32 v23, v23, v167
    v_cvt_pk_bf16_f32 v212, v20, v21
    v_cvt_pk_bf16_f32 v213, v22, v23
    s_mov_b32 s28, 20480
    buffer_store_dwordx2 v[212:213], v242, s[60:63], s28 offen
    s_waitcnt lgkmcnt(12)
    v_add_f32 v24, v24, v48
    v_add_f32 v72, v72, v96
    v_add_f32 v24, v24, v72
    v_add_f32 v25, v25, v49
    v_add_f32 v73, v73, v97
    v_add_f32 v25, v25, v73
    v_add_f32 v26, v26, v50
    v_add_f32 v74, v74, v98
    v_add_f32 v26, v26, v74
    v_add_f32 v27, v27, v51
    v_add_f32 v75, v75, v99
    v_add_f32 v27, v27, v75
    v_cvt_pk_bf16_f32 v208, v24, v25
    v_lshlrev_b32 v24, 16, v208
    v_and_b32 v25, 0xffff0000, v208
    v_cvt_pk_bf16_f32 v209, v26, v27
    v_lshlrev_b32 v26, 16, v209
    v_and_b32 v27, 0xffff0000, v209
    v_mul_f32 v24, v24, v150
    v_mul_f32 v25, v25, v150
    v_mul_f32 v26, v26, v150
    v_mul_f32 v27, v27, v150
    v_cvt_pk_bf16_f32 v208, v24, v25
    v_lshlrev_b32 v24, 16, v208
    v_and_b32 v25, 0xffff0000, v208
    v_cvt_pk_bf16_f32 v209, v26, v27
    v_lshlrev_b32 v26, 16, v209
    v_and_b32 v27, 0xffff0000, v209
    v_add_f32 v24, v24, v168
    v_add_f32 v25, v25, v169
    v_add_f32 v26, v26, v170
    v_add_f32 v27, v27, v171
    v_cvt_pk_bf16_f32 v214, v24, v25
    v_cvt_pk_bf16_f32 v215, v26, v27
    s_mov_b32 s28, 40960
    buffer_store_dwordx2 v[214:215], v242, s[60:63], s28 offen
    s_waitcnt lgkmcnt(8)
    v_add_f32 v28, v28, v52
    v_add_f32 v76, v76, v100
    v_add_f32 v28, v28, v76
    v_add_f32 v29, v29, v53
    v_add_f32 v77, v77, v101
    v_add_f32 v29, v29, v77
    v_add_f32 v30, v30, v54
    v_add_f32 v78, v78, v102
    v_add_f32 v30, v30, v78
    v_add_f32 v31, v31, v55
    v_add_f32 v79, v79, v103
    v_add_f32 v31, v31, v79
    v_cvt_pk_bf16_f32 v208, v28, v29
    v_lshlrev_b32 v28, 16, v208
    v_and_b32 v29, 0xffff0000, v208
    v_cvt_pk_bf16_f32 v209, v30, v31
    v_lshlrev_b32 v30, 16, v209
    v_and_b32 v31, 0xffff0000, v209
    v_mul_f32 v28, v28, v151
    v_mul_f32 v29, v29, v151
    v_mul_f32 v30, v30, v151
    v_mul_f32 v31, v31, v151
    v_cvt_pk_bf16_f32 v208, v28, v29
    v_lshlrev_b32 v28, 16, v208
    v_and_b32 v29, 0xffff0000, v208
    v_cvt_pk_bf16_f32 v209, v30, v31
    v_lshlrev_b32 v30, 16, v209
    v_and_b32 v31, 0xffff0000, v209
    v_add_f32 v28, v28, v172
    v_add_f32 v29, v29, v173
    v_add_f32 v30, v30, v174
    v_add_f32 v31, v31, v175
    v_cvt_pk_bf16_f32 v216, v28, v29
    v_cvt_pk_bf16_f32 v217, v30, v31
    s_mov_b32 s28, 61440
    buffer_store_dwordx2 v[216:217], v242, s[60:63], s28 offen
    s_waitcnt lgkmcnt(4)
    v_add_f32 v32, v32, v56
    v_add_f32 v80, v80, v104
    v_add_f32 v32, v32, v80
    v_add_f32 v33, v33, v57
    v_add_f32 v81, v81, v105
    v_add_f32 v33, v33, v81
    v_add_f32 v34, v34, v58
    v_add_f32 v82, v82, v106
    v_add_f32 v34, v34, v82
    v_add_f32 v35, v35, v59
    v_add_f32 v83, v83, v107
    v_add_f32 v35, v35, v83
    v_cvt_pk_bf16_f32 v208, v32, v33
    v_lshlrev_b32 v32, 16, v208
    v_and_b32 v33, 0xffff0000, v208
    v_cvt_pk_bf16_f32 v209, v34, v35
    v_lshlrev_b32 v34, 16, v209
    v_and_b32 v35, 0xffff0000, v209
    v_mul_f32 v32, v32, v152
    v_mul_f32 v33, v33, v152
    v_mul_f32 v34, v34, v152
    v_mul_f32 v35, v35, v152
    v_cvt_pk_bf16_f32 v208, v32, v33
    v_lshlrev_b32 v32, 16, v208
    v_and_b32 v33, 0xffff0000, v208
    v_cvt_pk_bf16_f32 v209, v34, v35
    v_lshlrev_b32 v34, 16, v209
    v_and_b32 v35, 0xffff0000, v209
    v_add_f32 v32, v32, v176
    v_add_f32 v33, v33, v177
    v_add_f32 v34, v34, v178
    v_add_f32 v35, v35, v179
    v_cvt_pk_bf16_f32 v218, v32, v33
    v_cvt_pk_bf16_f32 v219, v34, v35
    s_mov_b32 s28, 81920
    buffer_store_dwordx2 v[218:219], v242, s[60:63], s28 offen
    s_waitcnt lgkmcnt(0)
    v_add_f32 v36, v36, v60
    v_add_f32 v84, v84, v108
    v_add_f32 v36, v36, v84
    v_add_f32 v37, v37, v61
    v_add_f32 v85, v85, v109
    v_add_f32 v37, v37, v85
    v_add_f32 v38, v38, v62
    v_add_f32 v86, v86, v110
    v_add_f32 v38, v38, v86
    v_add_f32 v39, v39, v63
    v_add_f32 v87, v87, v111
    v_add_f32 v39, v39, v87
    v_cvt_pk_bf16_f32 v208, v36, v37
    v_lshlrev_b32 v36, 16, v208
    v_and_b32 v37, 0xffff0000, v208
    v_cvt_pk_bf16_f32 v209, v38, v39
    v_lshlrev_b32 v38, 16, v209
    v_and_b32 v39, 0xffff0000, v209
    v_mul_f32 v36, v36, v153
    v_mul_f32 v37, v37, v153
    v_mul_f32 v38, v38, v153
    v_mul_f32 v39, v39, v153
    v_cvt_pk_bf16_f32 v208, v36, v37
    v_lshlrev_b32 v36, 16, v208
    v_and_b32 v37, 0xffff0000, v208
    v_cvt_pk_bf16_f32 v209, v38, v39
    v_lshlrev_b32 v38, 16, v209
    v_and_b32 v39, 0xffff0000, v209
    v_add_f32 v36, v36, v180
    v_add_f32 v37, v37, v181
    v_add_f32 v38, v38, v182
    v_add_f32 v39, v39, v183
    v_cvt_pk_bf16_f32 v220, v36, v37
    v_cvt_pk_bf16_f32 v221, v38, v39
    s_mov_b32 s28, 102400
    buffer_store_dwordx2 v[220:221], v242, s[60:63], s28 offen
    s_branch p4_fin_118
p4_slowpoll_124:
    s_mov_b32 s31, 0
p4_pl_127:
    s_sleep 8
    buffer_load_dword v10, v244, s[92:95], 0 offen sc1
    s_waitcnt vmcnt(0)
    v_cmp_ne_u32 vcc, v10, v13
    s_cbranch_vccz p4_pollok_125
    s_add_u32 s31, s31, 1
    s_cmp_lt_u32 s31, 524288
    s_cbranch_scc1 p4_pl_127
    s_branch p4_pollok_125
p4_conv_111:
    s_mov_b64 exec, 1
    buffer_store_dword v13, v12, s[92:95], s41 offen sc1
    s_mov_b64 exec, -1
    v_mov_b32 v250, v13
    s_sub_u32 s28, s3, 4
    s_lshl_b32 s56, s28, 8
    s_add_u32 s56, s56, s2
    s_cmp_ge_u32 s56, 640
    s_cbranch_scc1 k12_done_1
    s_mul_i32 s28, s28, 13056
    s_add_u32 s57, s57, s28
    s_add_u32 s24, s6, 0x4800000
    s_addc_u32 s25, s7, 0
    s_mov_b32 s26, 0x280000
    s_mov_b32 s27, 0x20000
    s_mov_b32 s16, s48
    s_mov_b32 s17, s49
    s_mov_b32 s18, 0x280000
    s_mov_b32 s19, 0x20000
    s_mov_b32 s20, s50
    s_mov_b32 s21, s51
    s_mov_b32 s22, 0x500
    s_mov_b32 s23, 0x20000
    v_lshlrev_b32 v4, 4, v2
    s_lshl_b32 s60, s56, 12
    s_add_u32 m0, s57, 64
    s_nop 0
    buffer_load_dwordx4 v4, s[16:19], s60 offen offset:0 lds
    buffer_load_dwordx4 v4, s[16:19], s60 offen offset:1024 lds
    buffer_load_dwordx4 v4, s[16:19], s60 offen offset:2048 lds
    buffer_load_dwordx4 v4, s[16:19], s60 offen offset:3072 lds
    s_lshl_b32 s61, s56, 1
    v_mov_b32 v11, s61
    buffer_load_ushort v10, v11, s[20:23], 0 offen
    s_lshr_b32 s28, s56, 6
    s_lshl_b32 s28, s28, 8
    s_add_u32 s28, s28, 4096
    v_lshlrev_b32 v252, 2, v2
    s_mov_b32 s31, 0
p4_upoll_128:
    buffer_load_dword v253, v252, s[92:95], s28 offen sc1
    s_waitcnt vmcnt(0)
    v_cmp_ne_u32 vcc, v253, v250
    s_cbranch_vccz p4_uok_129
    s_sleep 16
    s_add_u32 s31, s31, 1
    s_cmp_lt_u32 s31, 262144
    s_cbranch_scc1 p4_upoll_128
p4_uok_129:
    s_add_u32 m0, s57, 8384
    s_nop 0
    buffer_load_dwordx4 v4, s[24:27], s60 offen offset:0 sc1 lds
    buffer_load_dwordx4 v4, s[24:27], s60 offen offset:1024 sc1 lds
    buffer_load_dwordx4 v4, s[24:27], s60 offen offset:2048 sc1 lds
    buffer_load_dwordx4 v4, s[24:27], s60 offen offset:3072 sc1 lds
    v_mov_b32 v6, 0
    v_mov_b32 v7, 0
    v_lshlrev_b32 v5, 3, v2
    v_add_u32 v5, s57, v5
    ds_write_b64 v5, v[6:7] offset:12480
    v_and_b32 v8, 15, v2
    v_lshlrev_b32 v9, 2, v8
    v_add_u32 v9, s57, v9
    ds_write_b32 v9, v6
    ds_write_b32 v9, v6 offset:4160
    v_lshrrev_b32 v11, 4, v2
    v_add_u32 v5, 1, v8
    v_and_b32 v13, 1, v5
    v_sub_u32 v12, v8, v13
    v_lshlrev_b32 v12, 1, v12
    v_lshl_add_u32 v12, v11, 4, v12
    v_mul_u32_u24 v13, 4164, v13
    s_add_u32 s61, s57, 34
    v_add3_u32 v12, v12, v13, s61
    v_add_u32 v13, 1024, v12
    v_add_u32 v14, 2048, v12
    v_add_u32 v15, 3072, v12
    v_lshlrev_b32 v6, 4, v11
    v_lshlrev_b32 v9, 5, v8
    v_sub_u32 v6, v6, v9
    s_add_u32 s61, s57, 8864
    v_add_u32 v6, s61, v6
    v_lshl_add_u32 v9, v11, 3, v9
    s_add_u32 s61, s57, 8888
    v_sub_u32 v7, s61, v9
    s_waitcnt vmcnt(0)
    v_add_u32 v5, s57, v4
    s_waitcnt lgkmcnt(0)
    ds_read_b128 v[56:59], v5 offset:64
    ds_read_b32 v55, v5 offset:60
    ds_read_b128 v[64:67], v5 offset:1088
    ds_read_b32 v63, v5 offset:1084
    ds_read_b128 v[72:75], v5 offset:2112
    ds_read_b32 v71, v5 offset:2108
    ds_read_b128 v[80:83], v5 offset:3136
    ds_read_b32 v79, v5 offset:3132
    s_waitcnt lgkmcnt(6)
    v_alignbit_b32 v84, v56, v55, 16
    v_alignbit_b32 v85, v57, v56, 16
    v_alignbit_b32 v86, v58, v57, 16
    v_alignbit_b32 v87, v59, v58, 16
    ds_write_b128 v5, v[84:87] offset:4224
    s_waitcnt lgkmcnt(5)
    v_alignbit_b32 v88, v64, v63, 16
    v_alignbit_b32 v89, v65, v64, 16
    v_alignbit_b32 v90, v66, v65, 16
    v_alignbit_b32 v91, v67, v66, 16
    ds_write_b128 v5, v[88:91] offset:5248
    s_waitcnt lgkmcnt(4)
    v_alignbit_b32 v92, v72, v71, 16
    v_alignbit_b32 v93, v73, v72, 16
    v_alignbit_b32 v94, v74, v73, 16
    v_alignbit_b32 v95, v75, v74, 16
    ds_write_b128 v5, v[92:95] offset:6272
    s_waitcnt lgkmcnt(3)
    v_alignbit_b32 v96, v80, v79, 16
    v_alignbit_b32 v97, v81, v80, 16
    v_alignbit_b32 v98, v82, v81, 16
    v_alignbit_b32 v99, v83, v82, 16
    ds_write_b128 v5, v[96:99] offset:7296
    s_waitcnt lgkmcnt(0)
    ds_read_b128 v[84:87], v6 offset:3584
    ds_read2_b32 v[52:53], v12 offset0:0 offset1:1
    ds_read2_b32 v[54:55], v12 offset0:2 offset1:3
    ds_read_b128 v[88:91], v6 offset:3072
    ds_read2_b32 v[56:57], v12 offset0:128 offset1:129
    ds_read2_b32 v[58:59], v12 offset0:130 offset1:131
    ds_read_b128 v[92:95], v6 offset:2560
    ds_read2_b32 v[60:61], v13 offset0:0 offset1:1
    ds_read2_b32 v[62:63], v13 offset0:2 offset1:3
    ds_read_b128 v[96:99], v6 offset:2048
    ds_read2_b32 v[64:65], v13 offset0:128 offset1:129
    ds_read2_b32 v[66:67], v13 offset0:130 offset1:131
    ds_read_b128 v[100:103], v6 offset:1536
    ds_read2_b32 v[68:69], v14 offset0:0 offset1:1
    ds_read2_b32 v[70:71], v14 offset0:2 offset1:3
    ds_read_b128 v[104:107], v6 offset:1024
    ds_read2_b32 v[72:73], v14 offset0:128 offset1:129
    ds_read2_b32 v[74:75], v14 offset0:130 offset1:131
    ds_read_b128 v[108:111], v6 offset:512
    ds_read2_b32 v[76:77], v15 offset0:0 offset1:1
    ds_read2_b32 v[78:79], v15 offset0:2 offset1:3
    ds_read_b128 v[112:115], v6 offset:0
    ds_read2_b32 v[80:81], v15 offset0:128 offset1:129
    ds_read2_b32 v[82:83], v15 offset0:130 offset1:131
    s_waitcnt lgkmcnt(15)
    v_mfma_f32_16x16x32_bf16 v[20:23], v[52:55], v[84:87], 0
    v_mfma_f32_16x16x32_bf16 v[24:27], v[52:55], v[88:91], 0
    ds_read_b128 v[148:151], v6 offset:3648
    v_mfma_f32_16x16x32_bf16 v[24:27], v[56:59], v[84:87], v[24:27]
    v_mfma_f32_16x16x32_bf16 v[28:31], v[56:59], v[88:91], 0
    ds_read2_b32 v[116:117], v12 offset0:16 offset1:17
    ds_read2_b32 v[118:119], v12 offset0:18 offset1:19
    v_mfma_f32_16x16x32_bf16 v[28:31], v[52:55], v[92:95], v[28:31]
    v_mfma_f32_16x16x32_bf16 v[28:31], v[60:63], v[84:87], v[28:31]
    ds_read_b128 v[152:155], v6 offset:3136
    v_mfma_f32_16x16x32_bf16 v[32:35], v[56:59], v[92:95], 0
    v_mfma_f32_16x16x32_bf16 v[32:35], v[60:63], v[88:91], v[32:35]
    ds_read2_b32 v[120:121], v12 offset0:144 offset1:145
    ds_read2_b32 v[122:123], v12 offset0:146 offset1:147
    v_mfma_f32_16x16x32_bf16 v[36:39], v[60:63], v[92:95], 0
    s_waitcnt lgkmcnt(15)
    v_mfma_f32_16x16x32_bf16 v[32:35], v[52:55], v[96:99], v[32:35]
    ds_read_b128 v[156:159], v6 offset:2624
    v_mfma_f32_16x16x32_bf16 v[32:35], v[64:67], v[84:87], v[32:35]
    v_mfma_f32_16x16x32_bf16 v[36:39], v[56:59], v[96:99], v[36:39]
    ds_read2_b32 v[124:125], v13 offset0:16 offset1:17
    ds_read2_b32 v[126:127], v13 offset0:18 offset1:19
    v_mfma_f32_16x16x32_bf16 v[36:39], v[64:67], v[88:91], v[36:39]
    v_mfma_f32_16x16x32_bf16 v[40:43], v[60:63], v[96:99], 0
    ds_read_b128 v[160:163], v6 offset:2112
    v_mfma_f32_16x16x32_bf16 v[40:43], v[64:67], v[92:95], v[40:43]
    v_mfma_f32_16x16x32_bf16 v[44:47], v[64:67], v[96:99], 0
    ds_read2_b32 v[128:129], v13 offset0:144 offset1:145
    ds_read2_b32 v[130:131], v13 offset0:146 offset1:147
    v_mfma_f32_16x16x32_bf16 v[36:39], v[52:55], v[100:103], v[36:39]
    v_mfma_f32_16x16x32_bf16 v[36:39], v[68:71], v[84:87], v[36:39]
    ds_read_b128 v[164:167], v6 offset:1600
    v_mfma_f32_16x16x32_bf16 v[40:43], v[56:59], v[100:103], v[40:43]
    v_mfma_f32_16x16x32_bf16 v[40:43], v[68:71], v[88:91], v[40:43]
    ds_read2_b32 v[132:133], v14 offset0:16 offset1:17
    ds_read2_b32 v[134:135], v14 offset0:18 offset1:19
    v_mfma_f32_16x16x32_bf16 v[44:47], v[60:63], v[100:103], v[44:47]
    v_mfma_f32_16x16x32_bf16 v[44:47], v[68:71], v[92:95], v[44:47]
    ds_read_b128 v[168:171], v6 offset:1088
    v_mfma_f32_16x16x32_bf16 v[48:51], v[64:67], v[100:103], 0
    v_mfma_f32_16x16x32_bf16 v[48:51], v[68:71], v[96:99], v[48:51]
    ds_read2_b32 v[136:137], v14 offset0:144 offset1:145
    ds_read2_b32 v[138:139], v14 offset0:146 offset1:147
    s_waitcnt lgkmcnt(15)
    v_mfma_f32_16x16x32_bf16 v[40:43], v[52:55], v[104:107], v[40:43]
    v_mfma_f32_16x16x32_bf16 v[40:43], v[72:75], v[84:87], v[40:43]
    ds_read_b128 v[172:175], v6 offset:576
    v_mfma_f32_16x16x32_bf16 v[44:47], v[56:59], v[104:107], v[44:47]
    v_mfma_f32_16x16x32_bf16 v[44:47], v[72:75], v[88:91], v[44:47]
    ds_read2_b32 v[140:141], v15 offset0:16 offset1:17
    ds_read2_b32 v[142:143], v15 offset0:18 offset1:19
    v_mfma_f32_16x16x32_bf16 v[48:51], v[60:63], v[104:107], v[48:51]
    v_mfma_f32_16x16x32_bf16 v[48:51], v[72:75], v[92:95], v[48:51]
    ds_read_b128 v[176:179], v6 offset:64
    v_mfma_f32_16x16x32_bf16 v[44:47], v[52:55], v[108:111], v[44:47]
    v_mfma_f32_16x16x32_bf16 v[44:47], v[76:79], v[84:87], v[44:47]
    ds_read2_b32 v[144:145], v15 offset0:144 offset1:145
    ds_read2_b32 v[146:147], v15 offset0:146 offset1:147
    v_mfma_f32_16x16x32_bf16 v[48:51], v[56:59], v[108:111], v[48:51]
    v_mfma_f32_16x16x32_bf16 v[48:51], v[76:79], v[88:91], v[48:51]
    v_mfma_f32_16x16x32_bf16 v[48:51], v[52:55], v[112:115], v[48:51]
    v_mfma_f32_16x16x32_bf16 v[48:51], v[80:83], v[84:87], v[48:51]
    v_mfma_f32_16x16x32_bf16 v[20:23], v[116:119], v[148:151], v[20:23]
    s_waitcnt lgkmcnt(15)
    v_mfma_f32_16x16x32_bf16 v[24:27], v[116:119], v[152:155], v[24:27]
    ds_read_b128 v[84:87], v6 offset:3712
    v_mfma_f32_16x16x32_bf16 v[24:27], v[120:123], v[148:151], v[24:27]
    v_mfma_f32_16x16x32_bf16 v[28:31], v[120:123], v[152:155], v[28:31]
    ds_read2_b32 v[52:53], v12 offset0:32 offset1:33
    ds_read2_b32 v[54:55], v12 offset0:34 offset1:35
    v_mfma_f32_16x16x32_bf16 v[28:31], v[116:119], v[156:159], v[28:31]
    v_mfma_f32_16x16x32_bf16 v[28:31], v[124:127], v[148:151], v[28:31]
    ds_read_b128 v[88:91], v6 offset:3200
    v_mfma_f32_16x16x32_bf16 v[32:35], v[120:123], v[156:159], v[32:35]
    v_mfma_f32_16x16x32_bf16 v[32:35], v[124:127], v[152:155], v[32:35]
    ds_read2_b32 v[56:57], v12 offset0:160 offset1:161
    ds_read2_b32 v[58:59], v12 offset0:162 offset1:163
    v_mfma_f32_16x16x32_bf16 v[36:39], v[124:127], v[156:159], v[36:39]
    s_waitcnt lgkmcnt(15)
    v_mfma_f32_16x16x32_bf16 v[32:35], v[116:119], v[160:163], v[32:35]
    ds_read_b128 v[92:95], v6 offset:2688
    v_mfma_f32_16x16x32_bf16 v[32:35], v[128:131], v[148:151], v[32:35]
    v_mfma_f32_16x16x32_bf16 v[36:39], v[120:123], v[160:163], v[36:39]
    ds_read2_b32 v[60:61], v13 offset0:32 offset1:33
    ds_read2_b32 v[62:63], v13 offset0:34 offset1:35
    v_mfma_f32_16x16x32_bf16 v[36:39], v[128:131], v[152:155], v[36:39]
    v_mfma_f32_16x16x32_bf16 v[40:43], v[124:127], v[160:163], v[40:43]
    ds_read_b128 v[96:99], v6 offset:2176
    v_mfma_f32_16x16x32_bf16 v[40:43], v[128:131], v[156:159], v[40:43]
    v_mfma_f32_16x16x32_bf16 v[44:47], v[128:131], v[160:163], v[44:47]
    ds_read2_b32 v[64:65], v13 offset0:160 offset1:161
    ds_read2_b32 v[66:67], v13 offset0:162 offset1:163
    v_mfma_f32_16x16x32_bf16 v[36:39], v[116:119], v[164:167], v[36:39]
    v_mfma_f32_16x16x32_bf16 v[36:39], v[132:135], v[148:151], v[36:39]
    ds_read_b128 v[100:103], v6 offset:1664
    v_mfma_f32_16x16x32_bf16 v[40:43], v[120:123], v[164:167], v[40:43]
    v_mfma_f32_16x16x32_bf16 v[40:43], v[132:135], v[152:155], v[40:43]
    ds_read2_b32 v[68:69], v14 offset0:32 offset1:33
    ds_read2_b32 v[70:71], v14 offset0:34 offset1:35
    v_mfma_f32_16x16x32_bf16 v[44:47], v[124:127], v[164:167], v[44:47]
    v_mfma_f32_16x16x32_bf16 v[44:47], v[132:135], v[156:159], v[44:47]
    ds_read_b128 v[104:107], v6 offset:1152
    v_mfma_f32_16x16x32_bf16 v[48:51], v[128:131], v[164:167], v[48:51]
    v_mfma_f32_16x16x32_bf16 v[48:51], v[132:135], v[160:163], v[48:51]
    ds_read2_b32 v[72:73], v14 offset0:160 offset1:161
    ds_read2_b32 v[74:75], v14 offset0:162 offset1:163
    s_waitcnt lgkmcnt(15)
    v_mfma_f32_16x16x32_bf16 v[40:43], v[116:119], v[168:171], v[40:43]
    v_mfma_f32_16x16x32_bf16 v[40:43], v[136:139], v[148:151], v[40:43]
    ds_read_b128 v[108:111], v6 offset:640
    v_mfma_f32_16x16x32_bf16 v[44:47], v[120:123], v[168:171], v[44:47]
    v_mfma_f32_16x16x32_bf16 v[44:47], v[136:139], v[152:155], v[44:47]
    ds_read2_b32 v[76:77], v15 offset0:32 offset1:33
    ds_read2_b32 v[78:79], v15 offset0:34 offset1:35
    v_mfma_f32_16x16x32_bf16 v[48:51], v[124:127], v[168:171], v[48:51]
    v_mfma_f32_16x16x32_bf16 v[48:51], v[136:139], v[156:159], v[48:51]
    ds_read_b128 v[112:115], v6 offset:128
    v_mfma_f32_16x16x32_bf16 v[44:47], v[116:119], v[172:175], v[44:47]
    v_mfma_f32_16x16x32_bf16 v[44:47], v[140:143], v[148:151], v[44:47]
    ds_read2_b32 v[80:81], v15 offset0:160 offset1:161
    ds_read2_b32 v[82:83], v15 offset0:162 offset1:163
    v_mfma_f32_16x16x32_bf16 v[48:51], v[120:123], v[172:175], v[48:51]
    v_mfma_f32_16x16x32_bf16 v[48:51], v[140:143], v[152:155], v[48:51]
    v_mfma_f32_16x16x32_bf16 v[48:51], v[116:119], v[176:179], v[48:51]
    v_mfma_f32_16x16x32_bf16 v[48:51], v[144:147], v[148:151], v[48:51]
    v_mfma_f32_16x16x32_bf16 v[20:23], v[52:55], v[84:87], v[20:23]
    s_waitcnt lgkmcnt(15)
    v_mfma_f32_16x16x32_bf16 v[24:27], v[52:55], v[88:91], v[24:27]
    ds_read_b128 v[148:151], v6 offset:3776
    v_mfma_f32_16x16x32_bf16 v[24:27], v[56:59], v[84:87], v[24:27]
    v_mfma_f32_16x16x32_bf16 v[28:31], v[56:59], v[88:91], v[28:31]
    ds_read2_b32 v[116:117], v12 offset0:48 offset1:49
    ds_read2_b32 v[118:119], v12 offset0:50 offset1:51
    v_mfma_f32_16x16x32_bf16 v[28:31], v[52:55], v[92:95], v[28:31]
    v_mfma_f32_16x16x32_bf16 v[28:31], v[60:63], v[84:87], v[28:31]
    ds_read_b128 v[152:155], v6 offset:3264
    v_mfma_f32_16x16x32_bf16 v[32:35], v[56:59], v[92:95], v[32:35]
    v_mfma_f32_16x16x32_bf16 v[32:35], v[60:63], v[88:91], v[32:35]
    ds_read2_b32 v[120:121], v12 offset0:176 offset1:177
    ds_read2_b32 v[122:123], v12 offset0:178 offset1:179
    v_mfma_f32_16x16x32_bf16 v[36:39], v[60:63], v[92:95], v[36:39]
    s_waitcnt lgkmcnt(15)
    v_mfma_f32_16x16x32_bf16 v[32:35], v[52:55], v[96:99], v[32:35]
    ds_read_b128 v[156:159], v6 offset:2752
    v_mfma_f32_16x16x32_bf16 v[32:35], v[64:67], v[84:87], v[32:35]
    v_mfma_f32_16x16x32_bf16 v[36:39], v[56:59], v[96:99], v[36:39]
    ds_read2_b32 v[124:125], v13 offset0:48 offset1:49
    ds_read2_b32 v[126:127], v13 offset0:50 offset1:51
    v_mfma_f32_16x16x32_bf16 v[36:39], v[64:67], v[88:91], v[36:39]
    v_mfma_f32_16x16x32_bf16 v[40:43], v[60:63], v[96:99], v[40:43]
    ds_read_b128 v[160:163], v6 offset:2240
    v_mfma_f32_16x16x32_bf16 v[40:43], v[64:67], v[92:95], v[40:43]
    v_mfma_f32_16x16x32_bf16 v[44:47], v[64:67], v[96:99], v[44:47]
    ds_read2_b32 v[128:129], v13 offset0:176 offset1:177
    ds_read2_b32 v[130:131], v13 offset0:178 offset1:179
    v_mfma_f32_16x16x32_bf16 v[36:39], v[52:55], v[100:103], v[36:39]
    v_mfma_f32_16x16x32_bf16 v[36:39], v[68:71], v[84:87], v[36:39]
    ds_read_b128 v[164:167], v6 offset:1728
    v_mfma_f32_16x16x32_bf16 v[40:43], v[56:59], v[100:103], v[40:43]
    v_mfma_f32_16x16x32_bf16 v[40:43], v[68:71], v[88:91], v[40:43]
    ds_read2_b32 v[132:133], v14 offset0:48 offset1:49
    ds_read2_b32 v[134:135], v14 offset0:50 offset1:51
    v_mfma_f32_16x16x32_bf16 v[44:47], v[60:63], v[100:103], v[44:47]
    v_mfma_f32_16x16x32_bf16 v[44:47], v[68:71], v[92:95], v[44:47]
    ds_read_b128 v[168:171], v6 offset:1216
    v_mfma_f32_16x16x32_bf16 v[48:51], v[64:67], v[100:103], v[48:51]
    v_mfma_f32_16x16x32_bf16 v[48:51], v[68:71], v[96:99], v[48:51]
    ds_read2_b32 v[136:137], v14 offset0:176 offset1:177
    ds_read2_b32 v[138:139], v14 offset0:178 offset1:179
    s_waitcnt lgkmcnt(15)
    v_mfma_f32_16x16x32_bf16 v[40:43], v[52:55], v[104:107], v[40:43]
    v_mfma_f32_16x16x32_bf16 v[40:43], v[72:75], v[84:87], v[40:43]
    ds_read_b128 v[172:175], v6 offset:704
    v_mfma_f32_16x16x32_bf16 v[44:47], v[56:59], v[104:107], v[44:47]
    v_mfma_f32_16x16x32_bf16 v[44:47], v[72:75], v[88:91], v[44:47]
    ds_read2_b32 v[140:141], v15 offset0:48 offset1:49
    ds_read2_b32 v[142:143], v15 offset0:50 offset1:51
    v_mfma_f32_16x16x32_bf16 v[48:51], v[60:63], v[104:107], v[48:51]
    v_mfma_f32_16x16x32_bf16 v[48:51], v[72:75], v[92:95], v[48:51]
    ds_read_b128 v[176:179], v6 offset:192
    v_mfma_f32_16x16x32_bf16 v[44:47], v[52:55], v[108:111], v[44:47]
    v_mfma_f32_16x16x32_bf16 v[44:47], v[76:79], v[84:87], v[44:47]
    ds_read2_b32 v[144:145], v15 offset0:176 offset1:177
    ds_read2_b32 v[146:147], v15 offset0:178 offset1:179
    v_mfma_f32_16x16x32_bf16 v[48:51], v[56:59], v[108:111], v[48:51]
    v_mfma_f32_16x16x32_bf16 v[48:51], v[76:79], v[88:91], v[48:51]
    v_mfma_f32_16x16x32_bf16 v[48:51], v[52:55], v[112:115], v[48:51]
    v_mfma_f32_16x16x32_bf16 v[48:51], v[80:83], v[84:87], v[48:51]
    v_mfma_f32_16x16x32_bf16 v[20:23], v[116:119], v[148:151], v[20:23]
    s_waitcnt lgkmcnt(15)
    v_mfma_f32_16x16x32_bf16 v[24:27], v[116:119], v[152:155], v[24:27]
    ds_read_b128 v[84:87], v6 offset:3840
    v_mfma_f32_16x16x32_bf16 v[24:27], v[120:123], v[148:151], v[24:27]
    v_mfma_f32_16x16x32_bf16 v[28:31], v[120:123], v[152:155], v[28:31]
    ds_read2_b32 v[52:53], v12 offset0:64 offset1:65
    ds_read2_b32 v[54:55], v12 offset0:66 offset1:67
    v_mfma_f32_16x16x32_bf16 v[28:31], v[116:119], v[156:159], v[28:31]
    v_mfma_f32_16x16x32_bf16 v[28:31], v[124:127], v[148:151], v[28:31]
    ds_read_b128 v[88:91], v6 offset:3328
    v_mfma_f32_16x16x32_bf16 v[32:35], v[120:123], v[156:159], v[32:35]
    v_mfma_f32_16x16x32_bf16 v[32:35], v[124:127], v[152:155], v[32:35]
    ds_read2_b32 v[56:57], v12 offset0:192 offset1:193
    ds_read2_b32 v[58:59], v12 offset0:194 offset1:195
    v_mfma_f32_16x16x32_bf16 v[36:39], v[124:127], v[156:159], v[36:39]
    s_waitcnt lgkmcnt(15)
    v_mfma_f32_16x16x32_bf16 v[32:35], v[116:119], v[160:163], v[32:35]
    ds_read_b128 v[92:95], v6 offset:2816
    v_mfma_f32_16x16x32_bf16 v[32:35], v[128:131], v[148:151], v[32:35]
    v_mfma_f32_16x16x32_bf16 v[36:39], v[120:123], v[160:163], v[36:39]
    ds_read2_b32 v[60:61], v13 offset0:64 offset1:65
    ds_read2_b32 v[62:63], v13 offset0:66 offset1:67
    v_mfma_f32_16x16x32_bf16 v[36:39], v[128:131], v[152:155], v[36:39]
    v_mfma_f32_16x16x32_bf16 v[40:43], v[124:127], v[160:163], v[40:43]
    ds_read_b128 v[96:99], v6 offset:2304
    v_mfma_f32_16x16x32_bf16 v[40:43], v[128:131], v[156:159], v[40:43]
    v_mfma_f32_16x16x32_bf16 v[44:47], v[128:131], v[160:163], v[44:47]
    ds_read2_b32 v[64:65], v13 offset0:192 offset1:193
    ds_read2_b32 v[66:67], v13 offset0:194 offset1:195
    v_mfma_f32_16x16x32_bf16 v[36:39], v[116:119], v[164:167], v[36:39]
    v_mfma_f32_16x16x32_bf16 v[36:39], v[132:135], v[148:151], v[36:39]
    ds_read_b128 v[100:103], v6 offset:1792
    v_mfma_f32_16x16x32_bf16 v[40:43], v[120:123], v[164:167], v[40:43]
    v_mfma_f32_16x16x32_bf16 v[40:43], v[132:135], v[152:155], v[40:43]
    ds_read2_b32 v[68:69], v14 offset0:64 offset1:65
    ds_read2_b32 v[70:71], v14 offset0:66 offset1:67
    v_mfma_f32_16x16x32_bf16 v[44:47], v[124:127], v[164:167], v[44:47]
    v_mfma_f32_16x16x32_bf16 v[44:47], v[132:135], v[156:159], v[44:47]
    ds_read_b128 v[104:107], v6 offset:1280
    v_mfma_f32_16x16x32_bf16 v[48:51], v[128:131], v[164:167], v[48:51]
    v_mfma_f32_16x16x32_bf16 v[48:51], v[132:135], v[160:163], v[48:51]
    ds_read2_b32 v[72:73], v14 offset0:192 offset1:193
    ds_read2_b32 v[74:75], v14 offset0:194 offset1:195
    s_waitcnt lgkmcnt(15)
    v_mfma_f32_16x16x32_bf16 v[40:43], v[116:119], v[168:171], v[40:43]
    v_mfma_f32_16x16x32_bf16 v[40:43], v[136:139], v[148:151], v[40:43]
    ds_read_b128 v[108:111], v6 offset:768
    v_mfma_f32_16x16x32_bf16 v[44:47], v[120:123], v[168:171], v[44:47]
    v_mfma_f32_16x16x32_bf16 v[44:47], v[136:139], v[152:155], v[44:47]
    ds_read2_b32 v[76:77], v15 offset0:64 offset1:65
    ds_read2_b32 v[78:79], v15 offset0:66 offset1:67
    v_mfma_f32_16x16x32_bf16 v[48:51], v[124:127], v[168:171], v[48:51]
    v_mfma_f32_16x16x32_bf16 v[48:51], v[136:139], v[156:159], v[48:51]
    ds_read_b128 v[112:115], v6 offset:256
    v_mfma_f32_16x16x32_bf16 v[44:47], v[116:119], v[172:175], v[44:47]
    v_mfma_f32_16x16x32_bf16 v[44:47], v[140:143], v[148:151], v[44:47]
    ds_read2_b32 v[80:81], v15 offset0:192 offset1:193
    ds_read2_b32 v[82:83], v15 offset0:194 offset1:195
    v_mfma_f32_16x16x32_bf16 v[48:51], v[120:123], v[172:175], v[48:51]
    v_mfma_f32_16x16x32_bf16 v[48:51], v[140:143], v[152:155], v[48:51]
    v_mfma_f32_16x16x32_bf16 v[48:51], v[116:119], v[176:179], v[48:51]
    v_mfma_f32_16x16x32_bf16 v[48:51], v[144:147], v[148:151], v[48:51]
    v_mfma_f32_16x16x32_bf16 v[20:23], v[52:55], v[84:87], v[20:23]
    s_waitcnt lgkmcnt(15)
    v_mfma_f32_16x16x32_bf16 v[24:27], v[52:55], v[88:91], v[24:27]
    ds_read_b128 v[148:151], v6 offset:3904
    v_mfma_f32_16x16x32_bf16 v[24:27], v[56:59], v[84:87], v[24:27]
    v_mfma_f32_16x16x32_bf16 v[28:31], v[56:59], v[88:91], v[28:31]
    ds_read2_b32 v[116:117], v12 offset0:80 offset1:81
    ds_read2_b32 v[118:119], v12 offset0:82 offset1:83
    v_mfma_f32_16x16x32_bf16 v[28:31], v[52:55], v[92:95], v[28:31]
    v_mfma_f32_16x16x32_bf16 v[28:31], v[60:63], v[84:87], v[28:31]
    ds_read_b128 v[152:155], v6 offset:3392
    v_mfma_f32_16x16x32_bf16 v[32:35], v[56:59], v[92:95], v[32:35]
    v_mfma_f32_16x16x32_bf16 v[32:35], v[60:63], v[88:91], v[32:35]
    ds_read2_b32 v[120:121], v12 offset0:208 offset1:209
    ds_read2_b32 v[122:123], v12 offset0:210 offset1:211
    v_mfma_f32_16x16x32_bf16 v[36:39], v[60:63], v[92:95], v[36:39]
    s_waitcnt lgkmcnt(15)
    v_mfma_f32_16x16x32_bf16 v[32:35], v[52:55], v[96:99], v[32:35]
    ds_read_b128 v[156:159], v6 offset:2880
    v_mfma_f32_16x16x32_bf16 v[32:35], v[64:67], v[84:87], v[32:35]
    v_mfma_f32_16x16x32_bf16 v[36:39], v[56:59], v[96:99], v[36:39]
    ds_read2_b32 v[124:125], v13 offset0:80 offset1:81
    ds_read2_b32 v[126:127], v13 offset0:82 offset1:83
    v_mfma_f32_16x16x32_bf16 v[36:39], v[64:67], v[88:91], v[36:39]
    v_mfma_f32_16x16x32_bf16 v[40:43], v[60:63], v[96:99], v[40:43]
    ds_read_b128 v[160:163], v6 offset:2368
    v_mfma_f32_16x16x32_bf16 v[40:43], v[64:67], v[92:95], v[40:43]
    v_mfma_f32_16x16x32_bf16 v[44:47], v[64:67], v[96:99], v[44:47]
    ds_read2_b32 v[128:129], v13 offset0:208 offset1:209
    ds_read2_b32 v[130:131], v13 offset0:210 offset1:211
    v_mfma_f32_16x16x32_bf16 v[36:39], v[52:55], v[100:103], v[36:39]
    v_mfma_f32_16x16x32_bf16 v[36:39], v[68:71], v[84:87], v[36:39]
    ds_read_b128 v[164:167], v6 offset:1856
    v_mfma_f32_16x16x32_bf16 v[40:43], v[56:59], v[100:103], v[40:43]
    v_mfma_f32_16x16x32_bf16 v[40:43], v[68:71], v[88:91], v[40:43]
    ds_read2_b32 v[132:133], v14 offset0:80 offset1:81
    ds_read2_b32 v[134:135], v14 offset0:82 offset1:83
    v_mfma_f32_16x16x32_bf16 v[44:47], v[60:63], v[100:103], v[44:47]
    v_mfma_f32_16x16x32_bf16 v[44:47], v[68:71], v[92:95], v[44:47]
    ds_read_b128 v[168:171], v6 offset:1344
    v_mfma_f32_16x16x32_bf16 v[48:51], v[64:67], v[100:103], v[48:51]
    v_mfma_f32_16x16x32_bf16 v[48:51], v[68:71], v[96:99], v[48:51]
    ds_read2_b32 v[136:137], v14 offset0:208 offset1:209
    ds_read2_b32 v[138:139], v14 offset0:210 offset1:211
    s_waitcnt lgkmcnt(15)
    v_mfma_f32_16x16x32_bf16 v[40:43], v[52:55], v[104:107], v[40:43]
    v_mfma_f32_16x16x32_bf16 v[40:43], v[72:75], v[84:87], v[40:43]
    ds_read_b128 v[172:175], v6 offset:832
    v_mfma_f32_16x16x32_bf16 v[44:47], v[56:59], v[104:107], v[44:47]
    v_mfma_f32_16x16x32_bf16 v[44:47], v[72:75], v[88:91], v[44:47]
    ds_read2_b32 v[140:141], v15 offset0:80 offset1:81
    ds_read2_b32 v[142:143], v15 offset0:82 offset1:83
    v_mfma_f32_16x16x32_bf16 v[48:51], v[60:63], v[104:107], v[48:51]
    v_mfma_f32_16x16x32_bf16 v[48:51], v[72:75], v[92:95], v[48:51]
    ds_read_b128 v[176:179], v6 offset:320
    v_mfma_f32_16x16x32_bf16 v[44:47], v[52:55], v[108:111], v[44:47]
    v_mfma_f32_16x16x32_bf16 v[44:47], v[76:79], v[84:87], v[44:47]
    ds_read2_b32 v[144:145], v15 offset0:208 offset1:209
    ds_read2_b32 v[146:147], v15 offset0:210 offset1:211
    v_mfma_f32_16x16x32_bf16 v[48:51], v[56:59], v[108:111], v[48:51]
    v_mfma_f32_16x16x32_bf16 v[48:51], v[76:79], v[88:91], v[48:51]
    v_mfma_f32_16x16x32_bf16 v[48:51], v[52:55], v[112:115], v[48:51]
    v_mfma_f32_16x16x32_bf16 v[48:51], v[80:83], v[84:87], v[48:51]
    v_mfma_f32_16x16x32_bf16 v[20:23], v[116:119], v[148:151], v[20:23]
    s_waitcnt lgkmcnt(15)
    v_mfma_f32_16x16x32_bf16 v[24:27], v[116:119], v[152:155], v[24:27]
    ds_read_b128 v[84:87], v6 offset:3968
    v_mfma_f32_16x16x32_bf16 v[24:27], v[120:123], v[148:151], v[24:27]
    v_mfma_f32_16x16x32_bf16 v[28:31], v[120:123], v[152:155], v[28:31]
    ds_read2_b32 v[52:53], v12 offset0:96 offset1:97
    ds_read2_b32 v[54:55], v12 offset0:98 offset1:99
    v_mfma_f32_16x16x32_bf16 v[28:31], v[116:119], v[156:159], v[28:31]
    v_mfma_f32_16x16x32_bf16 v[28:31], v[124:127], v[148:151], v[28:31]
    ds_read_b128 v[88:91], v6 offset:3456
    v_mfma_f32_16x16x32_bf16 v[32:35], v[120:123], v[156:159], v[32:35]
    v_mfma_f32_16x16x32_bf16 v[32:35], v[124:127], v[152:155], v[32:35]
    ds_read2_b32 v[56:57], v12 offset0:224 offset1:225
    ds_read2_b32 v[58:59], v12 offset0:226 offset1:227
    v_mfma_f32_16x16x32_bf16 v[36:39], v[124:127], v[156:159], v[36:39]
    s_waitcnt lgkmcnt(15)
    v_mfma_f32_16x16x32_bf16 v[32:35], v[116:119], v[160:163], v[32:35]
    ds_read_b128 v[92:95], v6 offset:2944
    v_mfma_f32_16x16x32_bf16 v[32:35], v[128:131], v[148:151], v[32:35]
    v_mfma_f32_16x16x32_bf16 v[36:39], v[120:123], v[160:163], v[36:39]
    ds_read2_b32 v[60:61], v13 offset0:96 offset1:97
    ds_read2_b32 v[62:63], v13 offset0:98 offset1:99
    v_mfma_f32_16x16x32_bf16 v[36:39], v[128:131], v[152:155], v[36:39]
    v_mfma_f32_16x16x32_bf16 v[40:43], v[124:127], v[160:163], v[40:43]
    ds_read_b128 v[96:99], v6 offset:2432
    v_mfma_f32_16x16x32_bf16 v[40:43], v[128:131], v[156:159], v[40:43]
    v_mfma_f32_16x16x32_bf16 v[44:47], v[128:131], v[160:163], v[44:47]
    ds_read2_b32 v[64:65], v13 offset0:224 offset1:225
    ds_read2_b32 v[66:67], v13 offset0:226 offset1:227
    v_mfma_f32_16x16x32_bf16 v[36:39], v[116:119], v[164:167], v[36:39]
    v_mfma_f32_16x16x32_bf16 v[36:39], v[132:135], v[148:151], v[36:39]
    ds_read_b128 v[100:103], v6 offset:1920
    v_mfma_f32_16x16x32_bf16 v[40:43], v[120:123], v[164:167], v[40:43]
    v_mfma_f32_16x16x32_bf16 v[40:43], v[132:135], v[152:155], v[40:43]
    ds_read2_b32 v[68:69], v14 offset0:96 offset1:97
    ds_read2_b32 v[70:71], v14 offset0:98 offset1:99
    v_mfma_f32_16x16x32_bf16 v[44:47], v[124:127], v[164:167], v[44:47]
    v_mfma_f32_16x16x32_bf16 v[44:47], v[132:135], v[156:159], v[44:47]
    ds_read_b128 v[104:107], v6 offset:1408
    v_mfma_f32_16x16x32_bf16 v[48:51], v[128:131], v[164:167], v[48:51]
    v_mfma_f32_16x16x32_bf16 v[48:51], v[132:135], v[160:163], v[48:51]
    ds_read2_b32 v[72:73], v14 offset0:224 offset1:225
    ds_read2_b32 v[74:75], v14 offset0:226 offset1:227
    s_waitcnt lgkmcnt(15)
    v_mfma_f32_16x16x32_bf16 v[40:43], v[116:119], v[168:171], v[40:43]
    v_mfma_f32_16x16x32_bf16 v[40:43], v[136:139], v[148:151], v[40:43]
    ds_read_b128 v[108:111], v6 offset:896
    v_mfma_f32_16x16x32_bf16 v[44:47], v[120:123], v[168:171], v[44:47]
    v_mfma_f32_16x16x32_bf16 v[44:47], v[136:139], v[152:155], v[44:47]
    ds_read2_b32 v[76:77], v15 offset0:96 offset1:97
    ds_read2_b32 v[78:79], v15 offset0:98 offset1:99
    v_mfma_f32_16x16x32_bf16 v[48:51], v[124:127], v[168:171], v[48:51]
    v_mfma_f32_16x16x32_bf16 v[48:51], v[136:139], v[156:159], v[48:51]
    ds_read_b128 v[112:115], v6 offset:384
    v_mfma_f32_16x16x32_bf16 v[44:47], v[116:119], v[172:175], v[44:47]
    v_mfma_f32_16x16x32_bf16 v[44:47], v[140:143], v[148:151], v[44:47]
    ds_read2_b32 v[80:81], v15 offset0:224 offset1:225
    ds_read2_b32 v[82:83], v15 offset0:226 offset1:227
    v_mfma_f32_16x16x32_bf16 v[48:51], v[120:123], v[172:175], v[48:51]
    v_mfma_f32_16x16x32_bf16 v[48:51], v[140:143], v[152:155], v[48:51]
    v_mfma_f32_16x16x32_bf16 v[48:51], v[116:119], v[176:179], v[48:51]
    v_mfma_f32_16x16x32_bf16 v[48:51], v[144:147], v[148:151], v[48:51]
    v_mfma_f32_16x16x32_bf16 v[20:23], v[52:55], v[84:87], v[20:23]
    s_waitcnt lgkmcnt(15)
    v_mfma_f32_16x16x32_bf16 v[24:27], v[52:55], v[88:91], v[24:27]
    ds_read_b128 v[148:151], v6 offset:4032
    v_mfma_f32_16x16x32_bf16 v[24:27], v[56:59], v[84:87], v[24:27]
    v_mfma_f32_16x16x32_bf16 v[28:31], v[56:59], v[88:91], v[28:31]
    ds_read2_b32 v[116:117], v12 offset0:112 offset1:113
    ds_read2_b32 v[118:119], v12 offset0:114 offset1:115
    v_mfma_f32_16x16x32_bf16 v[28:31], v[52:55], v[92:95], v[28:31]
    v_mfma_f32_16x16x32_bf16 v[28:31], v[60:63], v[84:87], v[28:31]
    ds_read_b128 v[152:155], v6 offset:3520
    v_mfma_f32_16x16x32_bf16 v[32:35], v[56:59], v[92:95], v[32:35]
    v_mfma_f32_16x16x32_bf16 v[32:35], v[60:63], v[88:91], v[32:35]
    ds_read2_b32 v[120:121], v12 offset0:240 offset1:241
    ds_read2_b32 v[122:123], v12 offset0:242 offset1:243
    v_mfma_f32_16x16x32_bf16 v[36:39], v[60:63], v[92:95], v[36:39]
    s_waitcnt lgkmcnt(15)
    v_mfma_f32_16x16x32_bf16 v[32:35], v[52:55], v[96:99], v[32:35]
    ds_read_b128 v[156:159], v6 offset:3008
    v_mfma_f32_16x16x32_bf16 v[32:35], v[64:67], v[84:87], v[32:35]
    v_mfma_f32_16x16x32_bf16 v[36:39], v[56:59], v[96:99], v[36:39]
    ds_read2_b32 v[124:125], v13 offset0:112 offset1:113
    ds_read2_b32 v[126:127], v13 offset0:114 offset1:115
    v_mfma_f32_16x16x32_bf16 v[36:39], v[64:67], v[88:91], v[36:39]
    v_mfma_f32_16x16x32_bf16 v[40:43], v[60:63], v[96:99], v[40:43]
    ds_read_b128 v[160:163], v6 offset:2496
    v_mfma_f32_16x16x32_bf16 v[40:43], v[64:67], v[92:95], v[40:43]
    v_mfma_f32_16x16x32_bf16 v[44:47], v[64:67], v[96:99], v[44:47]
    ds_read2_b32 v[128:129], v13 offset0:240 offset1:241
    ds_read2_b32 v[130:131], v13 offset0:242 offset1:243
    v_mfma_f32_16x16x32_bf16 v[36:39], v[52:55], v[100:103], v[36:39]
    v_mfma_f32_16x16x32_bf16 v[36:39], v[68:71], v[84:87], v[36:39]
    ds_read_b128 v[164:167], v6 offset:1984
    v_mfma_f32_16x16x32_bf16 v[40:43], v[56:59], v[100:103], v[40:43]
    v_mfma_f32_16x16x32_bf16 v[40:43], v[68:71], v[88:91], v[40:43]
    ds_read2_b32 v[132:133], v14 offset0:112 offset1:113
    ds_read2_b32 v[134:135], v14 offset0:114 offset1:115
    v_mfma_f32_16x16x32_bf16 v[44:47], v[60:63], v[100:103], v[44:47]
    v_mfma_f32_16x16x32_bf16 v[44:47], v[68:71], v[92:95], v[44:47]
    ds_read_b128 v[168:171], v6 offset:1472
    v_mfma_f32_16x16x32_bf16 v[48:51], v[64:67], v[100:103], v[48:51]
    v_mfma_f32_16x16x32_bf16 v[48:51], v[68:71], v[96:99], v[48:51]
    ds_read2_b32 v[136:137], v14 offset0:240 offset1:241
    ds_read2_b32 v[138:139], v14 offset0:242 offset1:243
    s_waitcnt lgkmcnt(15)
    v_mfma_f32_16x16x32_bf16 v[40:43], v[52:55], v[104:107], v[40:43]
    v_mfma_f32_16x16x32_bf16 v[40:43], v[72:75], v[84:87], v[40:43]
    ds_read_b128 v[172:175], v6 offset:960
    v_mfma_f32_16x16x32_bf16 v[44:47], v[56:59], v[104:107], v[44:47]
    v_mfma_f32_16x16x32_bf16 v[44:47], v[72:75], v[88:91], v[44:47]
    ds_read2_b32 v[140:141], v15 offset0:112 offset1:113
    ds_read2_b32 v[142:143], v15 offset0:114 offset1:115
    v_mfma_f32_16x16x32_bf16 v[48:51], v[60:63], v[104:107], v[48:51]
    v_mfma_f32_16x16x32_bf16 v[48:51], v[72:75], v[92:95], v[48:51]
    ds_read_b128 v[176:179], v6 offset:448
    v_mfma_f32_16x16x32_bf16 v[44:47], v[52:55], v[108:111], v[44:47]
    v_mfma_f32_16x16x32_bf16 v[44:47], v[76:79], v[84:87], v[44:47]
    ds_read2_b32 v[144:145], v15 offset0:240 offset1:241
    ds_read2_b32 v[146:147], v15 offset0:242 offset1:243
    v_mfma_f32_16x16x32_bf16 v[48:51], v[56:59], v[108:111], v[48:51]
    v_mfma_f32_16x16x32_bf16 v[48:51], v[76:79], v[88:91], v[48:51]
    v_mfma_f32_16x16x32_bf16 v[48:51], v[52:55], v[112:115], v[48:51]
    v_mfma_f32_16x16x32_bf16 v[48:51], v[80:83], v[84:87], v[48:51]
    v_mfma_f32_16x16x32_bf16 v[20:23], v[116:119], v[148:151], v[20:23]
    s_waitcnt lgkmcnt(15)
    v_mfma_f32_16x16x32_bf16 v[24:27], v[116:119], v[152:155], v[24:27]
    v_mfma_f32_16x16x32_bf16 v[24:27], v[120:123], v[148:151], v[24:27]
    v_mfma_f32_16x16x32_bf16 v[28:31], v[120:123], v[152:155], v[28:31]
    v_mfma_f32_16x16x32_bf16 v[28:31], v[116:119], v[156:159], v[28:31]
    v_mfma_f32_16x16x32_bf16 v[28:31], v[124:127], v[148:151], v[28:31]
    v_mfma_f32_16x16x32_bf16 v[32:35], v[120:123], v[156:159], v[32:35]
    v_mfma_f32_16x16x32_bf16 v[32:35], v[124:127], v[152:155], v[32:35]
    v_mfma_f32_16x16x32_bf16 v[36:39], v[124:127], v[156:159], v[36:39]
    s_waitcnt lgkmcnt(14)
    v_mfma_f32_16x16x32_bf16 v[32:35], v[116:119], v[160:163], v[32:35]
    s_waitcnt lgkmcnt(12)
    v_mfma_f32_16x16x32_bf16 v[32:35], v[128:131], v[148:151], v[32:35]
    v_mfma_f32_16x16x32_bf16 v[36:39], v[120:123], v[160:163], v[36:39]
    v_mfma_f32_16x16x32_bf16 v[36:39], v[128:131], v[152:155], v[36:39]
    v_mfma_f32_16x16x32_bf16 v[40:43], v[124:127], v[160:163], v[40:43]
    v_mfma_f32_16x16x32_bf16 v[40:43], v[128:131], v[156:159], v[40:43]
    v_mfma_f32_16x16x32_bf16 v[44:47], v[128:131], v[160:163], v[44:47]
    s_waitcnt lgkmcnt(11)
    v_mfma_f32_16x16x32_bf16 v[36:39], v[116:119], v[164:167], v[36:39]
    s_waitcnt lgkmcnt(9)
    v_mfma_f32_16x16x32_bf16 v[36:39], v[132:135], v[148:151], v[36:39]
    v_mfma_f32_16x16x32_bf16 v[40:43], v[120:123], v[164:167], v[40:43]
    v_mfma_f32_16x16x32_bf16 v[40:43], v[132:135], v[152:155], v[40:43]
    v_mfma_f32_16x16x32_bf16 v[44:47], v[124:127], v[164:167], v[44:47]
    v_mfma_f32_16x16x32_bf16 v[44:47], v[132:135], v[156:159], v[44:47]
    v_mfma_f32_16x16x32_bf16 v[48:51], v[128:131], v[164:167], v[48:51]
    v_mfma_f32_16x16x32_bf16 v[48:51], v[132:135], v[160:163], v[48:51]
    s_waitcnt lgkmcnt(8)
    v_mfma_f32_16x16x32_bf16 v[40:43], v[116:119], v[168:171], v[40:43]
    s_waitcnt lgkmcnt(6)
    v_mfma_f32_16x16x32_bf16 v[40:43], v[136:139], v[148:151], v[40:43]
    v_mfma_f32_16x16x32_bf16 v[44:47], v[120:123], v[168:171], v[44:47]
    v_mfma_f32_16x16x32_bf16 v[44:47], v[136:139], v[152:155], v[44:47]
    v_mfma_f32_16x16x32_bf16 v[48:51], v[124:127], v[168:171], v[48:51]
    v_mfma_f32_16x16x32_bf16 v[48:51], v[136:139], v[156:159], v[48:51]
    s_waitcnt lgkmcnt(5)
    v_mfma_f32_16x16x32_bf16 v[44:47], v[116:119], v[172:175], v[44:47]
    s_waitcnt lgkmcnt(3)
    v_mfma_f32_16x16x32_bf16 v[44:47], v[140:143], v[148:151], v[44:47]
    v_mfma_f32_16x16x32_bf16 v[48:51], v[120:123], v[172:175], v[48:51]
    v_mfma_f32_16x16x32_bf16 v[48:51], v[140:143], v[152:155], v[48:51]
    s_waitcnt lgkmcnt(2)
    v_mfma_f32_16x16x32_bf16 v[48:51], v[116:119], v[176:179], v[48:51]
    s_waitcnt lgkmcnt(0)
    v_mfma_f32_16x16x32_bf16 v[48:51], v[144:147], v[148:151], v[48:51]
    ds_read_b64 v[52:53], v7 offset:3584
    ds_read_b64 v[54:55], v7 offset:3072
    ds_read_b64 v[56:57], v7 offset:2560
    ds_read_b64 v[58:59], v7 offset:2048
    ds_read_b64 v[60:61], v7 offset:1536
    ds_read_b64 v[62:63], v7 offset:1024
    ds_read_b64 v[64:65], v7 offset:512
    ds_read_b64 v[66:67], v7 offset:0
    v_lshlrev_b32 v10, 16, v10
    v_add_u32 v9, s57, v9
    s_waitcnt lgkmcnt(0)
    v_cvt_pk_bf16_f32 v88, v20, v21
    v_lshlrev_b32 v20, 16, v88
    v_and_b32 v21, 0xffff0000, v88
    v_cvt_pk_bf16_f32 v89, v22, v23
    v_lshlrev_b32 v22, 16, v89
    v_and_b32 v23, 0xffff0000, v89
    v_lshlrev_b32 v87, 16, v52
    v_and_b32 v86, 0xffff0000, v52
    v_lshlrev_b32 v85, 16, v53
    v_and_b32 v84, 0xffff0000, v53
    v_mul_f32 v84, v84, v10
    v_mul_f32 v85, v85, v10
    v_mul_f32 v86, v86, v10
    v_mul_f32 v87, v87, v10
    v_cvt_pk_bf16_f32 v88, v84, v85
    v_lshlrev_b32 v84, 16, v88
    v_and_b32 v85, 0xffff0000, v88
    v_cvt_pk_bf16_f32 v89, v86, v87
    v_lshlrev_b32 v86, 16, v89
    v_and_b32 v87, 0xffff0000, v89
    v_add_f32 v20, v20, v84
    v_add_f32 v21, v21, v85
    v_add_f32 v22, v22, v86
    v_add_f32 v23, v23, v87
    v_cvt_pk_bf16_f32 v90, v20, v21
    v_cvt_pk_bf16_f32 v91, v22, v23
    ds_write_b64 v9, v[90:91] offset:0
    v_cvt_pk_bf16_f32 v96, v24, v25
    v_lshlrev_b32 v24, 16, v96
    v_and_b32 v25, 0xffff0000, v96
    v_cvt_pk_bf16_f32 v97, v26, v27
    v_lshlrev_b32 v26, 16, v97
    v_and_b32 v27, 0xffff0000, v97
    v_lshlrev_b32 v95, 16, v54
    v_and_b32 v94, 0xffff0000, v54
    v_lshlrev_b32 v93, 16, v55
    v_and_b32 v92, 0xffff0000, v55
    v_mul_f32 v92, v92, v10
    v_mul_f32 v93, v93, v10
    v_mul_f32 v94, v94, v10
    v_mul_f32 v95, v95, v10
    v_cvt_pk_bf16_f32 v96, v92, v93
    v_lshlrev_b32 v92, 16, v96
    v_and_b32 v93, 0xffff0000, v96
    v_cvt_pk_bf16_f32 v97, v94, v95
    v_lshlrev_b32 v94, 16, v97
    v_and_b32 v95, 0xffff0000, v97
    v_add_f32 v24, v24, v92
    v_add_f32 v25, v25, v93
    v_add_f32 v26, v26, v94
    v_add_f32 v27, v27, v95
    v_cvt_pk_bf16_f32 v98, v24, v25
    v_cvt_pk_bf16_f32 v99, v26, v27
    ds_write_b64 v9, v[98:99] offset:512
    v_cvt_pk_bf16_f32 v88, v28, v29
    v_lshlrev_b32 v28, 16, v88
    v_and_b32 v29, 0xffff0000, v88
    v_cvt_pk_bf16_f32 v89, v30, v31
    v_lshlrev_b32 v30, 16, v89
    v_and_b32 v31, 0xffff0000, v89
    v_lshlrev_b32 v87, 16, v56
    v_and_b32 v86, 0xffff0000, v56
    v_lshlrev_b32 v85, 16, v57
    v_and_b32 v84, 0xffff0000, v57
    v_mul_f32 v84, v84, v10
    v_mul_f32 v85, v85, v10
    v_mul_f32 v86, v86, v10
    v_mul_f32 v87, v87, v10
    v_cvt_pk_bf16_f32 v88, v84, v85
    v_lshlrev_b32 v84, 16, v88
    v_and_b32 v85, 0xffff0000, v88
    v_cvt_pk_bf16_f32 v89, v86, v87
    v_lshlrev_b32 v86, 16, v89
    v_and_b32 v87, 0xffff0000, v89
    v_add_f32 v28, v28, v84
    v_add_f32 v29, v29, v85
    v_add_f32 v30, v30, v86
    v_add_f32 v31, v31, v87
    v_cvt_pk_bf16_f32 v90, v28, v29
    v_cvt_pk_bf16_f32 v91, v30, v31
    ds_write_b64 v9, v[90:91] offset:1024
    v_cvt_pk_bf16_f32 v96, v32, v33
    v_lshlrev_b32 v32, 16, v96
    v_and_b32 v33, 0xffff0000, v96
    v_cvt_pk_bf16_f32 v97, v34, v35
    v_lshlrev_b32 v34, 16, v97
    v_and_b32 v35, 0xffff0000, v97
    v_lshlrev_b32 v95, 16, v58
    v_and_b32 v94, 0xffff0000, v58
    v_lshlrev_b32 v93, 16, v59
    v_and_b32 v92, 0xffff0000, v59
    v_mul_f32 v92, v92, v10
    v_mul_f32 v93, v93, v10
    v_mul_f32 v94, v94, v10
    v_mul_f32 v95, v95, v10
    v_cvt_pk_bf16_f32 v96, v92, v93
    v_lshlrev_b32 v92, 16, v96
    v_and_b32 v93, 0xffff0000, v96
    v_cvt_pk_bf16_f32 v97, v94, v95
    v_lshlrev_b32 v94, 16, v97
    v_and_b32 v95, 0xffff0000, v97
    v_add_f32 v32, v32, v92
    v_add_f32 v33, v33, v93
    v_add_f32 v34, v34, v94
    v_add_f32 v35, v35, v95
    v_cvt_pk_bf16_f32 v98, v32, v33
    v_cvt_pk_bf16_f32 v99, v34, v35
    ds_write_b64 v9, v[98:99] offset:1536
    v_cvt_pk_bf16_f32 v88, v36, v37
    v_lshlrev_b32 v36, 16, v88
    v_and_b32 v37, 0xffff0000, v88
    v_cvt_pk_bf16_f32 v89, v38, v39
    v_lshlrev_b32 v38, 16, v89
    v_and_b32 v39, 0xffff0000, v89
    v_lshlrev_b32 v87, 16, v60
    v_and_b32 v86, 0xffff0000, v60
    v_lshlrev_b32 v85, 16, v61
    v_and_b32 v84, 0xffff0000, v61
    v_mul_f32 v84, v84, v10
    v_mul_f32 v85, v85, v10
    v_mul_f32 v86, v86, v10
    v_mul_f32 v87, v87, v10
    v_cvt_pk_bf16_f32 v88, v84, v85
    v_lshlrev_b32 v84, 16, v88
    v_and_b32 v85, 0xffff0000, v88
    v_cvt_pk_bf16_f32 v89, v86, v87
    v_lshlrev_b32 v86, 16, v89
    v_and_b32 v87, 0xffff0000, v89
    v_add_f32 v36, v36, v84
    v_add_f32 v37, v37, v85
    v_add_f32 v38, v38, v86
    v_add_f32 v39, v39, v87
    v_cvt_pk_bf16_f32 v90, v36, v37
    v_cvt_pk_bf16_f32 v91, v38, v39
    ds_write_b64 v9, v[90:91] offset:2048
    v_cvt_pk_bf16_f32 v96, v40, v41
    v_lshlrev_b32 v40, 16, v96
    v_and_b32 v41, 0xffff0000, v96
    v_cvt_pk_bf16_f32 v97, v42, v43
    v_lshlrev_b32 v42, 16, v97
    v_and_b32 v43, 0xffff0000, v97
    v_lshlrev_b32 v95, 16, v62
    v_and_b32 v94, 0xffff0000, v62
    v_lshlrev_b32 v93, 16, v63
    v_and_b32 v92, 0xffff0000, v63
    v_mul_f32 v92, v92, v10
    v_mul_f32 v93, v93, v10
    v_mul_f32 v94, v94, v10
    v_mul_f32 v95, v95, v10
    v_cvt_pk_bf16_f32 v96, v92, v93
    v_lshlrev_b32 v92, 16, v96
    v_and_b32 v93, 0xffff0000, v96
    v_cvt_pk_bf16_f32 v97, v94, v95
    v_lshlrev_b32 v94, 16, v97
    v_and_b32 v95, 0xffff0000, v97
    v_add_f32 v40, v40, v92
    v_add_f32 v41, v41, v93
    v_add_f32 v42, v42, v94
    v_add_f32 v43, v43, v95
    v_cvt_pk_bf16_f32 v98, v40, v41
    v_cvt_pk_bf16_f32 v99, v42, v43
    ds_write_b64 v9, v[98:99] offset:2560
    v_cvt_pk_bf16_f32 v88, v44, v45
    v_lshlrev_b32 v44, 16, v88
    v_and_b32 v45, 0xffff0000, v88
    v_cvt_pk_bf16_f32 v89, v46, v47
    v_lshlrev_b32 v46, 16, v89
    v_and_b32 v47, 0xffff0000, v89
    v_lshlrev_b32 v87, 16, v64
    v_and_b32 v86, 0xffff0000, v64
    v_lshlrev_b32 v85, 16, v65
    v_and_b32 v84, 0xffff0000, v65
    v_mul_f32 v84, v84, v10
    v_mul_f32 v85, v85, v10
    v_mul_f32 v86, v86, v10
    v_mul_f32 v87, v87, v10
    v_cvt_pk_bf16_f32 v88, v84, v85
    v_lshlrev_b32 v84, 16, v88
    v_and_b32 v85, 0xffff0000, v88
    v_cvt_pk_bf16_f32 v89, v86, v87
    v_lshlrev_b32 v86, 16, v89
    v_and_b32 v87, 0xffff0000, v89
    v_add_f32 v44, v44, v84
    v_add_f32 v45, v45, v85
    v_add_f32 v46, v46, v86
    v_add_f32 v47, v47, v87
    v_cvt_pk_bf16_f32 v90, v44, v45
    v_cvt_pk_bf16_f32 v91, v46, v47
    ds_write_b64 v9, v[90:91] offset:3072
    v_cvt_pk_bf16_f32 v96, v48, v49
    v_lshlrev_b32 v48, 16, v96
    v_and_b32 v49, 0xffff0000, v96
    v_cvt_pk_bf16_f32 v97, v50, v51
    v_lshlrev_b32 v50, 16, v97
    v_and_b32 v51, 0xffff0000, v97
    v_lshlrev_b32 v95, 16, v66
    v_and_b32 v94, 0xffff0000, v66
    v_lshlrev_b32 v93, 16, v67
    v_and_b32 v92, 0xffff0000, v67
    v_mul_f32 v92, v92, v10
    v_mul_f32 v93, v93, v10
    v_mul_f32 v94, v94, v10
    v_mul_f32 v95, v95, v10
    v_cvt_pk_bf16_f32 v96, v92, v93
    v_lshlrev_b32 v92, 16, v96
    v_and_b32 v93, 0xffff0000, v96
    v_cvt_pk_bf16_f32 v97, v94, v95
    v_lshlrev_b32 v94, 16, v97
    v_and_b32 v95, 0xffff0000, v97
    v_add_f32 v48, v48, v92
    v_add_f32 v49, v49, v93
    v_add_f32 v50, v50, v94
    v_add_f32 v51, v51, v95
    v_cvt_pk_bf16_f32 v98, v48, v49
    v_cvt_pk_bf16_f32 v99, v50, v51
    ds_write_b64 v9, v[98:99] offset:3584
    v_add_u32 v5, s57, v4
    s_waitcnt lgkmcnt(0)
    ds_read_b128 v[20:23], v5 offset:0
    ds_read_b128 v[24:27], v5 offset:1024
    ds_read_b128 v[28:31], v5 offset:2048
    ds_read_b128 v[32:35], v5 offset:3072
    s_waitcnt lgkmcnt(3)
    buffer_store_dwordx4 v[20:23], v4, s[36:39], s60 offen offset:0 sc1
    s_waitcnt lgkmcnt(2)
    buffer_store_dwordx4 v[24:27], v4, s[36:39], s60 offen offset:1024 sc1
    s_waitcnt lgkmcnt(1)
    buffer_store_dwordx4 v[28:31], v4, s[36:39], s60 offen offset:2048 sc1
    s_waitcnt lgkmcnt(0)
    buffer_store_dwordx4 v[32:35], v4, s[36:39], s60 offen offset:3072 sc1
    s_waitcnt vmcnt(0)
    s_lshl_b32 s28, s56, 2
    s_add_u32 s28, s28, 10240
    v_mov_b32 v12, 0
    s_mov_b64 exec, 1
    buffer_store_dword v250, v12, s[92:95], s28 offen sc1
    s_mov_b64 exec, -1
p4_fin_118:
k12_done_1:
    s_endpgm
.p2align 2
p4_table:
.long 1280
.long 328960
.long 66831
.long 394511
.long 132382
.long 460062
.long 197936
.long 525616
.long 66816
.long 394496
.long 132367
.long 460047
.long 197921
.long 525601
.long 263472
.long 591152
.long 132352
.long 460032
.long 197906
.long 525586
.long 263457
.long 591137
.long 1330
.long 329010
.long 198144
.long 525824
.long 263442
.long 591122
.long 1315
.long 328995
.long 66866
.long 394546
.long 263680
.long 591360
.long 1300
.long 328980
.long 66851
.long 394531
.long 132402
.long 460082
.long 1285
.long 328965
.long 66836
.long 394516
.long 132387
.long 460067
.long 197941
.long 525621
.long 66821
.long 394501
.long 132372
.long 460052
.long 197926
.long 525606
.long 263477
.long 591157
.long 132357
.long 460037
.long 197911
.long 525591
.long 263462
.long 591142
.long 1335
.long 329015
.long 198150
.long 525830
.long 263447
.long 591127
.long 1320
.long 329000
.long 66871
.long 394551
.long 263686
.long 591366
.long 1305
.long 328985
.long 66856
.long 394536
.long 132407
.long 460087
.long 1290
.long 328970
.long 66841
.long 394521
.long 132392
.long 460072
.long 197946
.long 525626
.long 66826
.long 394506
.long 132377
.long 460057
.long 197931
.long 525611
.long 263482
.long 591162
.long 132362
.long 460042
.long 197916
.long 525596
.long 263467
.long 591147
.long 1340
.long 329020
.long 198156
.long 525836
.long 263452
.long 591132
.long 1325
.long 329005
.long 66876
.long 394556
.long 263692
.long 591372
.long 1310
.long 328990
.long 66861
.long 394541
.long 132412
.long 460092
.long 1295
.long 328975
.long 66846
.long 394526
.long 132397
.long 460077
.long 197951
.long 525631
.long 263487
.long 591167
.long 1360
.long 329040
.long 66911
.long 394591
.long 132462
.long 460142
.long 1345
.long 329025
.long 66896
.long 394576
.long 132447
.long 460127
.long 198001
.long 525681
.long 66881
.long 394561
.long 132432
.long 460112
.long 197986
.long 525666
.long 263537
.long 591217
.long 132417
.long 460097
.long 197971
.long 525651
.long 263522
.long 591202
.long 1395
.long 329075
.long 197956
.long 525636
.long 263507
.long 591187
.long 1380
.long 329060
.long 66931
.long 394611
.long 263492
.long 591172
.long 1365
.long 329045
.long 66916
.long 394596
.long 132467
.long 460147
.long 1350
.long 329030
.long 66901
.long 394581
.long 132452
.long 460132
.long 198006
.long 525686
.long 66886
.long 394566
.long 132437
.long 460117
.long 197991
.long 525671
.long 263542
.long 591222
.long 132422
.long 460102
.long 197976
.long 525656
.long 263527
.long 591207
.long 1400
.long 329080
.long 197961
.long 525641
.long 263512
.long 591192
.long 1385
.long 329065
.long 66936
.long 394616
.long 263497
.long 591177
.long 1370
.long 329050
.long 66921
.long 394601
.long 132472
.long 460152
.long 1355
.long 329035
.long 66906
.long 394586
.long 132457
.long 460137
.long 1403
.long 329083
.long 66891
.long 394571
.long 132442
.long 460122
.long 197996
.long 525676
.long 66939
.long 394619
.long 132427
.long 460107
.long 197981
.long 525661
.long 263532
.long 591212
.long 132475
.long 460155
.long 197966
.long 525646
.long 263517
.long 591197
.long 1390
.long 329070
.long 198011
.long 525691
.long 263502
.long 591182
.long 1375
.long 329055
.long 66926
.long 394606
.long 263547
.long 591227

.section .rodata,"a"
.p2align 6
.amdhsa_kernel main_kernel
  .amdhsa_next_free_vgpr 256
  .amdhsa_next_free_sgpr 102
  .amdhsa_accum_offset 256
  .amdhsa_group_segment_fixed_size 0
  .amdhsa_kernarg_size 128
  .amdhsa_user_sgpr_count 2
  .amdhsa_user_sgpr_kernarg_segment_ptr 1
  .amdhsa_system_sgpr_workgroup_id_x 1
  .amdhsa_float_denorm_mode_32 3
.end_amdhsa_kernel
```
